```python
import torch

def _softmax(x, axis=-1):
    return torch.softmax(x, dim=axis)
def _gelu(x):
    return torch.nn.functional.gelu(x, approximate="tanh")
def _silu(x):
    return torch.nn.functional.silu(x)
def _sigmoid(x):
    return torch.sigmoid(x)
def _layernorm(x, axis=-1, eps=1e-5):
    m = x.mean(dim=axis, keepdim=True)
    v = x.var(dim=axis, keepdim=True, unbiased=False)
    return (x - m) / torch.sqrt(v + eps)
def _scatter_add(tgt, idx, src, axis=0):
    return tgt.clone().index_add_(axis, idx, src)
def _segment_sum(src, seg, n):
    out = torch.zeros((n,) + src.shape[1:], dtype=src.dtype)
    return out.index_add_(0, seg, src)
def _pad(x, pw):
    flat = tuple(v for pair in reversed(pw) for v in pair)
    return torch.nn.functional.pad(x, flat)

kernel_name = 'parallel_sum__sliding_block__geglu_ffn__prompt'

def setup_inputs():

    _w = (lambda a: (lambda t: t.to(torch.bfloat16) if t.is_floating_point() else t)(torch.as_tensor(a)))
    def _A_setup():
        B, S, D = 1, 2048, 640
        return {
            "x": _w((lambda *s: torch.randn(*s, dtype=torch.bfloat16) * 0.05)(B, S, D)),
            "wqkv": _w((lambda *s: torch.randn(*s, dtype=torch.bfloat16) * 0.05)(D, 3 * D)),
            "wo": _w((lambda *s: torch.randn(*s, dtype=torch.bfloat16) * 0.05)(D, D)),
        }
    _A_in = _A_setup()

    def _B_setup():
        B, S, D, F = 1, 2048, 640, 1728
        return {
            "x": _w((lambda *s: torch.randn(*s, dtype=torch.bfloat16) * 0.05)(B, S, D)),
            "w_gate": _w((lambda *s: torch.randn(*s, dtype=torch.bfloat16) * 0.05)(D, F)),
            "w_up": _w((lambda *s: torch.randn(*s, dtype=torch.bfloat16) * 0.05)(D, F)),
            "w_down": _w((lambda *s: torch.randn(*s, dtype=torch.bfloat16) * 0.05)(F, D)),
        }
    _B_in = _B_setup()

    return {
        "A_x": _A_in["x"],
        "A_wqkv": _A_in["wqkv"],
        "A_wo": _A_in["wo"],
        "B_x": _B_in["x"],
        "B_w_gate": _B_in["w_gate"],
        "B_w_up": _B_in["w_up"],
        "B_w_down": _B_in["w_down"],
    }

def reference(A_x, A_wqkv, A_wo, B_x, B_w_gate, B_w_up, B_w_down):
    def _A_ref(x, wqkv, wo):
        B, S, D = x.shape
        H = 32; Dh = D // H; W = 256
        qkv = (lambda x, *d: x.permute(*d))((x @ wqkv).reshape(B, S, 3, H, Dh), 2, 0, 3, 1, 4)
        q, k, v = qkv[0], qkv[1], qkv[2]
        scores = torch.einsum("bhqd,bhkd->bhqk", q, k) * (Dh ** -0.5)
        idx = torch.arange(S)
        mask = (idx[:, None] - idx[None, :] >= 0) & (idx[:, None] - idx[None, :] < W)
        scores = torch.where(mask[None, None], scores, -1e9)
        p = _softmax(scores, axis=-1)
        o = torch.einsum("bhqk,bhkd->bhqd", p, v)
        return (lambda x, *d: x.permute(*d))(o, 0, 2, 1, 3).reshape(B, S, D) @ wo

    def _B_ref(x, w_gate, w_up, w_down):
        return (_gelu(x @ w_gate) * (x @ w_up)) @ w_down

    x = A_x
    xn = _layernorm(x, axis=-1)
    return x + _A_ref(xn, A_wqkv, A_wo) + _B_ref(xn, B_w_gate, B_w_up, B_w_down)
```

```asm
; @launch grid=(256,1,1) block=(256,1,1) lds=163840
.amdgcn_target "amdgcn-amd-amdhsa--gfx950"
.text
.globl parallel_sum__sliding_block__geglu_ffn__prompt_kernel
.p2align 8
.type parallel_sum__sliding_block__geglu_ffn__prompt_kernel,@function
parallel_sum__sliding_block__geglu_ffn__prompt_kernel:
    s_cmp_ge_u32 s2, 256
    s_cbranch_scc1 K1_END
    s_getpc_b64 s[60:61]
CPF_A:
    s_lshr_b32 s62, s2, 3
    s_lshl_b32 s62, s62, 12
    v_lshlrev_b32 v208, 4, v0
    v_add_u32 v208, s62, v208
    v_min_u32 v208, K1_END-CPF_A-16, v208
    v_and_b32 v208, -16, v208
    v_mov_b32 v209, s61
    v_add_co_u32 v208, vcc, s60, v208
    s_nop 0
    s_load_dwordx2 s[4:5], s[0:1], 0
    v_addc_co_u32 v209, vcc, 0, v209, vcc
    global_load_dwordx4 a[252:255], v[208:209], off
    s_load_dwordx2 s[8:9], s[0:1], 8
    s_load_dwordx2 s[12:13], s[0:1], 32
    s_load_dwordx2 s[16:17], s[0:1], 40
    s_load_dwordx2 s[20:21], s[0:1], 72
    s_load_dwordx2 s[44:45], s[0:1], 48
    s_load_dwordx2 s[48:49], s[0:1], 16
    s_mov_b32 s6, 2621440
    s_mov_b32 s7, 0x20000
    s_mov_b32 s10, 2457600
    s_mov_b32 s11, 0x20000
    s_mov_b32 s14, 2211840
    s_mov_b32 s15, 0x20000
    s_mov_b32 s18, 2211840
    s_mov_b32 s19, 0x20000
    s_mov_b32 s22, 25165824
    s_mov_b32 s23, 0x20000
    s_mov_b32 s46, 2211840
    s_mov_b32 s47, 0x20000
    s_mov_b32 s50, 819200
    s_mov_b32 s51, 0x20000
    v_lshrrev_b32 v200, 6, v0
    v_and_b32 v201, 63, v0
    s_and_b32 s24, s2, 7
    v_readfirstlane_b32 s25, v200
    s_lshr_b32 s26, s2, 3
    s_and_b32 s27, s24, 1
    s_lshl_b32 s27, s27, 3
    s_and_b32 s28, s26, 7
    s_add_u32 s27, s27, s28
    s_lshr_b32 s30, s24, 1
    s_lshr_b32 s29, s26, 3
    s_lshr_b32 s31, s28, 2
    s_lshr_b32 s32, s30, 1
    s_lshl_b32 s33, s30, 2
    s_mul_i32 s34, s30, 3
    s_lshl_b32 s35, s31, 1
    s_add_u32 s34, s34, s35
    s_lshl_b32 s35, s32, 1
    s_sub_u32 s33, s33, s35
    s_cmp_eq_u32 s31, s32
    s_cselect_b32 s28, s34, s33
    s_cselect_b32 s35, 3, 4
    s_add_u32 s28, s28, s29
    s_and_b32 s30, s30, 1
    s_add_u32 s30, s30, 14
    s_cmp_eq_u32 s29, s35
    s_cselect_b32 s28, s30, s28
    v_lshlrev_b32 v170, 4, v201
    s_lshl_b32 s68, s2, 2
    s_add_u32 s68, s68, s25
    s_lshl_b32 s68, s68, 10
    s_load_dwordx2 s[84:85], s[0:1], 64
    s_load_dwordx2 s[96:97], s[0:1], 56
    s_memrealtime s[100:101]
    s_lshl_b32 s89, s27, 12
    s_lshl_b32 s81, s28, 2
    s_add_u32 s89, s89, s81
    s_add_u32 s89, s89, 23068672
    s_cmp_eq_u32 s25, 0
    s_mov_b32 s81, 0x7fe00000
    s_cselect_b32 s81, 23068672, s81
    s_cmp_ge_u32 s28, 14
    s_cbranch_scc1 K1_RP
    v_lshrrev_b32 v202, 3, v201
    v_and_b32 v203, 7, v201
    v_lshrrev_b32 v204, 1, v202
    v_xor_b32 v207, v203, v204
    v_lshlrev_b32 v207, 4, v207
    v_mul_u32_u24 v192, 1280, v202
    v_add_u32 v192, v192, v207
    v_add_u32 v193, 9216, v192
    v_xor_b32 v194, 64, v192
    v_add_u32 v194, 20480, v194
    v_add_u32 v195, 9216, v194
    s_lshl_b32 s29, s27, 2
    s_add_u32 s29, s29, s25
    s_mul_i32 s43, s29, 40960
    s_lshl_b32 s36, s25, 11
    s_waitcnt lgkmcnt(0)
    s_cmp_eq_u32 s28, 13
    s_cbranch_scc1 K1_SP
    s_add_u32 s37, s68, 0
    buffer_load_dwordx4 a[252:255], v170, s[4:7], s37 offen
    s_add_u32 s37, s68, 1048576
    buffer_load_dwordx4 a[252:255], v170, s[4:7], s37 offen
    s_add_u32 s37, s68, 2097152
    buffer_load_dwordx4 a[252:255], v170, s[4:7], s37 offen
    s_add_u32 m0, s36, 0
    s_add_u32 s37, s43, 0
    buffer_load_dwordx4 v192, s[4:7], s37 offen lds
    buffer_load_dwordx4 v193, s[4:7], s37 offen offset:1024 lds
    s_add_u32 m0, s36, 8192
    s_add_u32 s37, s43, 0
    buffer_load_dwordx4 v194, s[4:7], s37 offen lds
    buffer_load_dwordx4 v195, s[4:7], s37 offen offset:1024 lds
    s_add_u32 m0, s36, 16384
    s_add_u32 s37, s43, 128
    buffer_load_dwordx4 v192, s[4:7], s37 offen lds
    buffer_load_dwordx4 v193, s[4:7], s37 offen offset:1024 lds
    s_add_u32 m0, s36, 24576
    s_add_u32 s37, s43, 128
    buffer_load_dwordx4 v194, s[4:7], s37 offen lds
    buffer_load_dwordx4 v195, s[4:7], s37 offen offset:1024 lds
    s_add_u32 m0, s36, 32768
    s_add_u32 s37, s43, 256
    buffer_load_dwordx4 v192, s[4:7], s37 offen lds
    buffer_load_dwordx4 v193, s[4:7], s37 offen offset:1024 lds
    s_add_u32 m0, s36, 40960
    s_add_u32 s37, s43, 256
    buffer_load_dwordx4 v194, s[4:7], s37 offen lds
    buffer_load_dwordx4 v195, s[4:7], s37 offen offset:1024 lds
    s_add_u32 m0, s36, 49152
    s_add_u32 s37, s43, 384
    buffer_load_dwordx4 v192, s[4:7], s37 offen lds
    buffer_load_dwordx4 v193, s[4:7], s37 offen offset:1024 lds
    s_add_u32 m0, s36, 57344
    s_add_u32 s37, s43, 384
    buffer_load_dwordx4 v194, s[4:7], s37 offen lds
    buffer_load_dwordx4 v195, s[4:7], s37 offen offset:1024 lds
    s_add_u32 m0, s36, 65536
    s_add_u32 s37, s43, 512
    buffer_load_dwordx4 v192, s[4:7], s37 offen lds
    buffer_load_dwordx4 v193, s[4:7], s37 offen offset:1024 lds
    s_add_u32 m0, s36, 73728
    s_add_u32 s37, s43, 512
    buffer_load_dwordx4 v194, s[4:7], s37 offen lds
    buffer_load_dwordx4 v195, s[4:7], s37 offen offset:1024 lds
    s_add_u32 m0, s36, 81920
    s_add_u32 s37, s43, 640
    buffer_load_dwordx4 v192, s[4:7], s37 offen lds
    buffer_load_dwordx4 v193, s[4:7], s37 offen offset:1024 lds
    s_add_u32 m0, s36, 90112
    s_add_u32 s37, s43, 640
    buffer_load_dwordx4 v194, s[4:7], s37 offen lds
    buffer_load_dwordx4 v195, s[4:7], s37 offen offset:1024 lds
    s_add_u32 m0, s36, 98304
    s_add_u32 s37, s43, 768
    buffer_load_dwordx4 v192, s[4:7], s37 offen lds
    buffer_load_dwordx4 v193, s[4:7], s37 offen offset:1024 lds
    s_add_u32 m0, s36, 106496
    s_add_u32 s37, s43, 768
    buffer_load_dwordx4 v194, s[4:7], s37 offen lds
    buffer_load_dwordx4 v195, s[4:7], s37 offen offset:1024 lds
    v_and_b32 v204, 1, v204
    v_lshlrev_b32 v204, 2, v204
    v_xor_b32 v203, v203, v204
    v_lshlrev_b32 v203, 4, v203
    s_lshl_b32 s30, s25, 4
    v_add_u32 v202, s30, v202
    v_mul_u32_u24 v160, 3840, v202
    v_mul_u32_u24 v162, 3456, v202
    v_add_u32 v160, v160, v203
    v_add_u32 v162, v162, v203
    v_add_u32 v161, 29696, v160
    v_add_u32 v163, 26624, v162
    v_and_b32 v202, 3, v201
    v_bfe_u32 v203, v201, 2, 2
    v_bfe_u32 v204, v201, 4, 1
    v_lshrrev_b32 v205, 5, v201
    v_lshlrev_b32 v206, 10, v205
    v_lshl_add_u32 v206, v203, 7, v206
    v_lshl_add_u32 v206, v204, 5, v206
    v_lshl_add_u32 v206, v202, 3, v206
    v_lshrrev_b32 v203, 1, v203
    v_lshlrev_b32 v203, 6, v203
    v_add_u32 v164, v206, v203
    v_xor_b32 v165, 64, v164
    v_add_u32 v166, 0x10000, v164
    v_add_u32 v167, 0x10000, v165
    v_add_u32 v168, 0x20000, v164
    v_add_u32 v169, 0x20000, v165
    v_bfe_u32 v202, v201, 1, 2
    v_lshl_or_b32 v202, v204, 2, v202
    v_xor_b32 v202, v202, v205
    v_lshlrev_b32 v202, 4, v202
    v_lshl_add_u32 v202, v204, 13, v202
    v_and_b32 v203, 15, v201
    v_lshl_add_u32 v202, v203, 7, v202
    v_add_u32 v196, s36, v202
    v_xor_b32 v197, 32, v196
    v_xor_b32 v198, 64, v196
    v_xor_b32 v199, 96, v196
    v_bfe_u32 v202, v201, 2, 1
    v_bfe_u32 v203, v201, 3, 1
    v_bfe_u32 v206, v201, 1, 1
    v_lshl_add_u32 v203, v203, 1, v206
    v_lshl_add_u32 v203, v204, 2, v203
    v_and_b32 v206, 1, v201
    v_lshlrev_b32 v206, 4, v206
    v_mov_b32 v207, 0x3f80
    v_lshlrev_b32 v206, v206, v207
    v_cmp_eq_u32 vcc, v202, v205
    v_mov_b32 v207, 0
    s_nop 0
    v_cndmask_b32 v206, v207, v206, vcc
    v_cmp_eq_u32 vcc, 0, v203
    s_nop 1
    v_cndmask_b32 v240, v207, v206, vcc
    v_cmp_eq_u32 vcc, 1, v203
    s_nop 1
    v_cndmask_b32 v241, v207, v206, vcc
    v_cmp_eq_u32 vcc, 2, v203
    s_nop 1
    v_cndmask_b32 v242, v207, v206, vcc
    v_cmp_eq_u32 vcc, 3, v203
    s_nop 1
    v_cndmask_b32 v243, v207, v206, vcc
    v_cmp_eq_u32 vcc, 4, v203
    s_nop 1
    v_cndmask_b32 v244, v207, v206, vcc
    v_cmp_eq_u32 vcc, 5, v203
    s_nop 1
    v_cndmask_b32 v245, v207, v206, vcc
    v_cmp_eq_u32 vcc, 6, v203
    s_nop 1
    v_cndmask_b32 v246, v207, v206, vcc
    v_cmp_eq_u32 vcc, 7, v203
    s_nop 1
    v_cndmask_b32 v247, v207, v206, vcc
    s_mul_i32 s52, s29, 122880
    s_mul_i32 s53, s29, 151552
    s_add_u32 s53, s53, 8388608
    s_lshl_b32 s30, s28, 8
    s_lshl_b32 s33, s28, 13
    s_add_u32 s33, s33, s52
    s_cmp_lt_u32 s28, 5
    s_cselect_b32 s40, 0x3ea52b5c, 1.0
    s_lshl_b32 s31, s28, 8
    s_add_u32 s32, s31, 128
    s_lshl_b32 s34, s28, 13
    s_add_u32 s34, s34, s53
    s_add_u32 s35, s34, 4096
    v_mov_b32 v200, 0
    v_mov_b32 v201, 0
    v_mov_b32 v202, 0
    v_mov_b32 v203, 0
    s_mov_b32 s38, 0x3f803f80
    s_waitcnt vmcnt(24)
    ds_read_b128 v[0:3], v196 offset:0
    ds_read_b128 v[4:7], v197 offset:0
    ds_read_b128 v[8:11], v198 offset:0
    ds_read_b128 v[12:15], v199 offset:0
    s_add_u32 m0, s36, 114688
    s_add_u32 s37, s43, 896
    buffer_load_dwordx4 v192, s[4:7], s37 offen lds
    buffer_load_dwordx4 v193, s[4:7], s37 offen offset:1024 lds
    s_add_u32 m0, s36, 122880
    s_add_u32 s37, s43, 896
    buffer_load_dwordx4 v194, s[4:7], s37 offen lds
    buffer_load_dwordx4 v195, s[4:7], s37 offen offset:1024 lds
    s_waitcnt lgkmcnt(0)
    s_waitcnt vmcnt(24)
    ds_read_b128 v[16:19], v196 offset:16384
    ds_read_b128 v[20:23], v197 offset:16384
    ds_read_b128 v[24:27], v198 offset:16384
    ds_read_b128 v[28:31], v199 offset:16384
    s_add_u32 m0, s36, 131072
    s_add_u32 s37, s43, 1024
    buffer_load_dwordx4 v192, s[4:7], s37 offen lds
    v_dot2_f32_bf16 v200, v0, s38, v200
    v_dot2_f32_bf16 v202, v0, v0, v202
    v_dot2_f32_bf16 v201, v1, s38, v201
    v_dot2_f32_bf16 v203, v1, v1, v203
    v_dot2_f32_bf16 v200, v2, s38, v200
    v_dot2_f32_bf16 v202, v2, v2, v202
    v_dot2_f32_bf16 v201, v3, s38, v201
    v_dot2_f32_bf16 v203, v3, v3, v203
    buffer_load_dwordx4 v193, s[4:7], s37 offen offset:1024 lds
    v_dot2_f32_bf16 v200, v4, s38, v200
    v_dot2_f32_bf16 v202, v4, v4, v202
    v_dot2_f32_bf16 v201, v5, s38, v201
    v_dot2_f32_bf16 v203, v5, v5, v203
    v_dot2_f32_bf16 v200, v6, s38, v200
    v_dot2_f32_bf16 v202, v6, v6, v202
    v_dot2_f32_bf16 v201, v7, s38, v201
    v_dot2_f32_bf16 v203, v7, v7, v203
    s_add_u32 m0, s36, 139264
    s_add_u32 s37, s43, 1024
    buffer_load_dwordx4 v194, s[4:7], s37 offen lds
    v_dot2_f32_bf16 v200, v8, s38, v200
    v_dot2_f32_bf16 v202, v8, v8, v202
    v_dot2_f32_bf16 v201, v9, s38, v201
    v_dot2_f32_bf16 v203, v9, v9, v203
    v_dot2_f32_bf16 v200, v10, s38, v200
    v_dot2_f32_bf16 v202, v10, v10, v202
    v_dot2_f32_bf16 v201, v11, s38, v201
    v_dot2_f32_bf16 v203, v11, v11, v203
    buffer_load_dwordx4 v195, s[4:7], s37 offen offset:1024 lds
    v_dot2_f32_bf16 v200, v12, s38, v200
    v_dot2_f32_bf16 v202, v12, v12, v202
    v_dot2_f32_bf16 v201, v13, s38, v201
    v_dot2_f32_bf16 v203, v13, v13, v203
    v_dot2_f32_bf16 v200, v14, s38, v200
    v_dot2_f32_bf16 v202, v14, v14, v202
    v_dot2_f32_bf16 v201, v15, s38, v201
    v_dot2_f32_bf16 v203, v15, v15, v203
    s_waitcnt lgkmcnt(0)
    s_waitcnt vmcnt(24)
    ds_read_b128 v[32:35], v196 offset:32768
    ds_read_b128 v[36:39], v197 offset:32768
    ds_read_b128 v[40:43], v198 offset:32768
    ds_read_b128 v[44:47], v199 offset:32768
    s_add_u32 m0, s36, 147456
    s_add_u32 s37, s43, 1152
    buffer_load_dwordx4 v192, s[4:7], s37 offen lds
    v_dot2_f32_bf16 v200, v16, s38, v200
    v_dot2_f32_bf16 v202, v16, v16, v202
    v_dot2_f32_bf16 v201, v17, s38, v201
    v_dot2_f32_bf16 v203, v17, v17, v203
    v_dot2_f32_bf16 v200, v18, s38, v200
    v_dot2_f32_bf16 v202, v18, v18, v202
    v_dot2_f32_bf16 v201, v19, s38, v201
    v_dot2_f32_bf16 v203, v19, v19, v203
    buffer_load_dwordx4 v193, s[4:7], s37 offen offset:1024 lds
    v_dot2_f32_bf16 v200, v20, s38, v200
    v_dot2_f32_bf16 v202, v20, v20, v202
    v_dot2_f32_bf16 v201, v21, s38, v201
    v_dot2_f32_bf16 v203, v21, v21, v203
    v_dot2_f32_bf16 v200, v22, s38, v200
    v_dot2_f32_bf16 v202, v22, v22, v202
    v_dot2_f32_bf16 v201, v23, s38, v201
    v_dot2_f32_bf16 v203, v23, v23, v203
    s_add_u32 m0, s36, 155648
    s_add_u32 s37, s43, 1152
    buffer_load_dwordx4 v194, s[4:7], s37 offen lds
    v_dot2_f32_bf16 v200, v24, s38, v200
    v_dot2_f32_bf16 v202, v24, v24, v202
    v_dot2_f32_bf16 v201, v25, s38, v201
    v_dot2_f32_bf16 v203, v25, v25, v203
    v_dot2_f32_bf16 v200, v26, s38, v200
    v_dot2_f32_bf16 v202, v26, v26, v202
    v_dot2_f32_bf16 v201, v27, s38, v201
    v_dot2_f32_bf16 v203, v27, v27, v203
    buffer_load_dwordx4 v195, s[4:7], s37 offen offset:1024 lds
    v_dot2_f32_bf16 v200, v28, s38, v200
    v_dot2_f32_bf16 v202, v28, v28, v202
    v_dot2_f32_bf16 v201, v29, s38, v201
    v_dot2_f32_bf16 v203, v29, v29, v203
    v_dot2_f32_bf16 v200, v30, s38, v200
    v_dot2_f32_bf16 v202, v30, v30, v202
    v_dot2_f32_bf16 v201, v31, s38, v201
    v_dot2_f32_bf16 v203, v31, v31, v203
    s_waitcnt lgkmcnt(0)
    s_waitcnt vmcnt(24)
    ds_read_b128 v[48:51], v196 offset:49152
    ds_read_b128 v[52:55], v197 offset:49152
    ds_read_b128 v[56:59], v198 offset:49152
    ds_read_b128 v[60:63], v199 offset:49152
    s_add_u32 m0, s36, 0
    s_add_u32 s37, s30, 0
    buffer_load_dwordx4 v160, s[8:11], s37 offen lds
    buffer_load_dwordx4 v161, s[8:11], s37 offen offset:1024 lds
    v_dot2_f32_bf16 v200, v32, s38, v200
    v_dot2_f32_bf16 v202, v32, v32, v202
    v_dot2_f32_bf16 v201, v33, s38, v201
    v_dot2_f32_bf16 v203, v33, v33, v203
    v_dot2_f32_bf16 v200, v34, s38, v200
    v_dot2_f32_bf16 v202, v34, v34, v202
    v_dot2_f32_bf16 v201, v35, s38, v201
    v_dot2_f32_bf16 v203, v35, v35, v203
    s_add_u32 m0, s36, 8192
    s_add_u32 s37, s30, 128
    buffer_load_dwordx4 v160, s[8:11], s37 offen lds
    buffer_load_dwordx4 v161, s[8:11], s37 offen offset:1024 lds
    v_dot2_f32_bf16 v200, v36, s38, v200
    v_dot2_f32_bf16 v202, v36, v36, v202
    v_dot2_f32_bf16 v201, v37, s38, v201
    v_dot2_f32_bf16 v203, v37, v37, v203
    v_dot2_f32_bf16 v200, v38, s38, v200
    v_dot2_f32_bf16 v202, v38, v38, v202
    v_dot2_f32_bf16 v201, v39, s38, v201
    v_dot2_f32_bf16 v203, v39, v39, v203
    s_add_u32 m0, s36, 16384
    s_add_u32 s37, s30, 245760
    buffer_load_dwordx4 v160, s[8:11], s37 offen lds
    buffer_load_dwordx4 v161, s[8:11], s37 offen offset:1024 lds
    v_dot2_f32_bf16 v200, v40, s38, v200
    v_dot2_f32_bf16 v202, v40, v40, v202
    v_dot2_f32_bf16 v201, v41, s38, v201
    v_dot2_f32_bf16 v203, v41, v41, v203
    v_dot2_f32_bf16 v200, v42, s38, v200
    v_dot2_f32_bf16 v202, v42, v42, v202
    v_dot2_f32_bf16 v201, v43, s38, v201
    v_dot2_f32_bf16 v203, v43, v43, v203
    s_add_u32 m0, s36, 24576
    s_add_u32 s37, s30, 245888
    buffer_load_dwordx4 v160, s[8:11], s37 offen lds
    buffer_load_dwordx4 v161, s[8:11], s37 offen offset:1024 lds
    v_dot2_f32_bf16 v200, v44, s38, v200
    v_dot2_f32_bf16 v202, v44, v44, v202
    v_dot2_f32_bf16 v201, v45, s38, v201
    v_dot2_f32_bf16 v203, v45, v45, v203
    v_dot2_f32_bf16 v200, v46, s38, v200
    v_dot2_f32_bf16 v202, v46, v46, v202
    v_dot2_f32_bf16 v201, v47, s38, v201
    v_dot2_f32_bf16 v203, v47, v47, v203
    s_waitcnt lgkmcnt(0)
    s_waitcnt vmcnt(28)
    v_add_u32 v196, 0x10000, v196
    v_add_u32 v197, 0x10000, v197
    v_add_u32 v198, 0x10000, v198
    v_add_u32 v199, 0x10000, v199
    ds_read_b128 v[64:67], v196 offset:0
    ds_read_b128 v[68:71], v197 offset:0
    ds_read_b128 v[72:75], v198 offset:0
    ds_read_b128 v[76:79], v199 offset:0
    s_add_u32 m0, s36, 32768
    s_add_u32 s37, s30, 491520
    buffer_load_dwordx4 v160, s[8:11], s37 offen lds
    buffer_load_dwordx4 v161, s[8:11], s37 offen offset:1024 lds
    v_dot2_f32_bf16 v200, v48, s38, v200
    v_dot2_f32_bf16 v202, v48, v48, v202
    v_dot2_f32_bf16 v201, v49, s38, v201
    v_dot2_f32_bf16 v203, v49, v49, v203
    v_dot2_f32_bf16 v200, v50, s38, v200
    v_dot2_f32_bf16 v202, v50, v50, v202
    v_dot2_f32_bf16 v201, v51, s38, v201
    v_dot2_f32_bf16 v203, v51, v51, v203
    s_add_u32 m0, s36, 40960
    s_add_u32 s37, s30, 491648
    buffer_load_dwordx4 v160, s[8:11], s37 offen lds
    buffer_load_dwordx4 v161, s[8:11], s37 offen offset:1024 lds
    v_dot2_f32_bf16 v200, v52, s38, v200
    v_dot2_f32_bf16 v202, v52, v52, v202
    v_dot2_f32_bf16 v201, v53, s38, v201
    v_dot2_f32_bf16 v203, v53, v53, v203
    v_dot2_f32_bf16 v200, v54, s38, v200
    v_dot2_f32_bf16 v202, v54, v54, v202
    v_dot2_f32_bf16 v201, v55, s38, v201
    v_dot2_f32_bf16 v203, v55, v55, v203
    s_add_u32 m0, s36, 49152
    s_add_u32 s37, s30, 737280
    buffer_load_dwordx4 v160, s[8:11], s37 offen lds
    buffer_load_dwordx4 v161, s[8:11], s37 offen offset:1024 lds
    v_dot2_f32_bf16 v200, v56, s38, v200
    v_dot2_f32_bf16 v202, v56, v56, v202
    v_dot2_f32_bf16 v201, v57, s38, v201
    v_dot2_f32_bf16 v203, v57, v57, v203
    v_dot2_f32_bf16 v200, v58, s38, v200
    v_dot2_f32_bf16 v202, v58, v58, v202
    v_dot2_f32_bf16 v201, v59, s38, v201
    v_dot2_f32_bf16 v203, v59, v59, v203
    s_add_u32 m0, s36, 57344
    s_add_u32 s37, s30, 737408
    buffer_load_dwordx4 v160, s[8:11], s37 offen lds
    buffer_load_dwordx4 v161, s[8:11], s37 offen offset:1024 lds
    v_dot2_f32_bf16 v200, v60, s38, v200
    v_dot2_f32_bf16 v202, v60, v60, v202
    v_dot2_f32_bf16 v201, v61, s38, v201
    v_dot2_f32_bf16 v203, v61, v61, v203
    v_dot2_f32_bf16 v200, v62, s38, v200
    v_dot2_f32_bf16 v202, v62, v62, v202
    v_dot2_f32_bf16 v201, v63, s38, v201
    v_dot2_f32_bf16 v203, v63, v63, v203
    s_waitcnt lgkmcnt(0)
    s_waitcnt vmcnt(32)
    ds_read_b128 v[80:83], v196 offset:16384
    ds_read_b128 v[84:87], v197 offset:16384
    ds_read_b128 v[88:91], v198 offset:16384
    ds_read_b128 v[92:95], v199 offset:16384
    v_dot2_f32_bf16 v200, v64, s38, v200
    v_dot2_f32_bf16 v202, v64, v64, v202
    v_dot2_f32_bf16 v201, v65, s38, v201
    v_dot2_f32_bf16 v203, v65, v65, v203
    v_dot2_f32_bf16 v200, v66, s38, v200
    v_dot2_f32_bf16 v202, v66, v66, v202
    v_dot2_f32_bf16 v201, v67, s38, v201
    v_dot2_f32_bf16 v203, v67, v67, v203
    v_dot2_f32_bf16 v200, v68, s38, v200
    v_dot2_f32_bf16 v202, v68, v68, v202
    v_dot2_f32_bf16 v201, v69, s38, v201
    v_dot2_f32_bf16 v203, v69, v69, v203
    v_dot2_f32_bf16 v200, v70, s38, v200
    v_dot2_f32_bf16 v202, v70, v70, v202
    v_dot2_f32_bf16 v201, v71, s38, v201
    v_dot2_f32_bf16 v203, v71, v71, v203
    v_dot2_f32_bf16 v200, v72, s38, v200
    v_dot2_f32_bf16 v202, v72, v72, v202
    v_dot2_f32_bf16 v201, v73, s38, v201
    v_dot2_f32_bf16 v203, v73, v73, v203
    v_dot2_f32_bf16 v200, v74, s38, v200
    v_dot2_f32_bf16 v202, v74, v74, v202
    v_dot2_f32_bf16 v201, v75, s38, v201
    v_dot2_f32_bf16 v203, v75, v75, v203
    v_dot2_f32_bf16 v200, v76, s38, v200
    v_dot2_f32_bf16 v202, v76, v76, v202
    v_dot2_f32_bf16 v201, v77, s38, v201
    v_dot2_f32_bf16 v203, v77, v77, v203
    v_dot2_f32_bf16 v200, v78, s38, v200
    v_dot2_f32_bf16 v202, v78, v78, v202
    v_dot2_f32_bf16 v201, v79, s38, v201
    v_dot2_f32_bf16 v203, v79, v79, v203
    s_waitcnt lgkmcnt(0)
    s_waitcnt vmcnt(28)
    ds_read_b128 v[96:99], v196 offset:32768
    ds_read_b128 v[100:103], v197 offset:32768
    ds_read_b128 v[104:107], v198 offset:32768
    ds_read_b128 v[108:111], v199 offset:32768
    v_dot2_f32_bf16 v200, v80, s38, v200
    v_dot2_f32_bf16 v202, v80, v80, v202
    v_dot2_f32_bf16 v201, v81, s38, v201
    v_dot2_f32_bf16 v203, v81, v81, v203
    v_dot2_f32_bf16 v200, v82, s38, v200
    v_dot2_f32_bf16 v202, v82, v82, v202
    v_dot2_f32_bf16 v201, v83, s38, v201
    v_dot2_f32_bf16 v203, v83, v83, v203
    v_dot2_f32_bf16 v200, v84, s38, v200
    v_dot2_f32_bf16 v202, v84, v84, v202
    v_dot2_f32_bf16 v201, v85, s38, v201
    v_dot2_f32_bf16 v203, v85, v85, v203
    v_dot2_f32_bf16 v200, v86, s38, v200
    v_dot2_f32_bf16 v202, v86, v86, v202
    v_dot2_f32_bf16 v201, v87, s38, v201
    v_dot2_f32_bf16 v203, v87, v87, v203
    v_dot2_f32_bf16 v200, v88, s38, v200
    v_dot2_f32_bf16 v202, v88, v88, v202
    v_dot2_f32_bf16 v201, v89, s38, v201
    v_dot2_f32_bf16 v203, v89, v89, v203
    v_dot2_f32_bf16 v200, v90, s38, v200
    v_dot2_f32_bf16 v202, v90, v90, v202
    v_dot2_f32_bf16 v201, v91, s38, v201
    v_dot2_f32_bf16 v203, v91, v91, v203
    v_dot2_f32_bf16 v200, v92, s38, v200
    v_dot2_f32_bf16 v202, v92, v92, v202
    v_dot2_f32_bf16 v201, v93, s38, v201
    v_dot2_f32_bf16 v203, v93, v93, v203
    v_dot2_f32_bf16 v200, v94, s38, v200
    v_dot2_f32_bf16 v202, v94, v94, v202
    v_dot2_f32_bf16 v201, v95, s38, v201
    v_dot2_f32_bf16 v203, v95, v95, v203
    s_waitcnt lgkmcnt(0)
    s_waitcnt vmcnt(24)
    ds_read_b128 v[112:115], v196 offset:49152
    ds_read_b128 v[116:119], v197 offset:49152
    ds_read_b128 v[120:123], v198 offset:49152
    ds_read_b128 v[124:127], v199 offset:49152
    v_dot2_f32_bf16 v200, v96, s38, v200
    v_dot2_f32_bf16 v202, v96, v96, v202
    v_dot2_f32_bf16 v201, v97, s38, v201
    v_dot2_f32_bf16 v203, v97, v97, v203
    v_dot2_f32_bf16 v200, v98, s38, v200
    v_dot2_f32_bf16 v202, v98, v98, v202
    v_dot2_f32_bf16 v201, v99, s38, v201
    v_dot2_f32_bf16 v203, v99, v99, v203
    v_dot2_f32_bf16 v200, v100, s38, v200
    v_dot2_f32_bf16 v202, v100, v100, v202
    v_dot2_f32_bf16 v201, v101, s38, v201
    v_dot2_f32_bf16 v203, v101, v101, v203
    v_dot2_f32_bf16 v200, v102, s38, v200
    v_dot2_f32_bf16 v202, v102, v102, v202
    v_dot2_f32_bf16 v201, v103, s38, v201
    v_dot2_f32_bf16 v203, v103, v103, v203
    v_dot2_f32_bf16 v200, v104, s38, v200
    v_dot2_f32_bf16 v202, v104, v104, v202
    v_dot2_f32_bf16 v201, v105, s38, v201
    v_dot2_f32_bf16 v203, v105, v105, v203
    v_dot2_f32_bf16 v200, v106, s38, v200
    v_dot2_f32_bf16 v202, v106, v106, v202
    v_dot2_f32_bf16 v201, v107, s38, v201
    v_dot2_f32_bf16 v203, v107, v107, v203
    v_dot2_f32_bf16 v200, v108, s38, v200
    v_dot2_f32_bf16 v202, v108, v108, v202
    v_dot2_f32_bf16 v201, v109, s38, v201
    v_dot2_f32_bf16 v203, v109, v109, v203
    v_dot2_f32_bf16 v200, v110, s38, v200
    v_dot2_f32_bf16 v202, v110, v110, v202
    v_dot2_f32_bf16 v201, v111, s38, v201
    v_dot2_f32_bf16 v203, v111, v111, v203
    s_waitcnt lgkmcnt(0)
    s_waitcnt vmcnt(20)
    v_add_u32 v196, 0x10000, v196
    v_add_u32 v197, 0x10000, v197
    v_add_u32 v198, 0x10000, v198
    v_add_u32 v199, 0x10000, v199
    ds_read_b128 v[128:131], v196 offset:0
    ds_read_b128 v[132:135], v197 offset:0
    ds_read_b128 v[136:139], v198 offset:0
    ds_read_b128 v[140:143], v199 offset:0
    v_dot2_f32_bf16 v200, v112, s38, v200
    v_dot2_f32_bf16 v202, v112, v112, v202
    v_dot2_f32_bf16 v201, v113, s38, v201
    v_dot2_f32_bf16 v203, v113, v113, v203
    v_dot2_f32_bf16 v200, v114, s38, v200
    v_dot2_f32_bf16 v202, v114, v114, v202
    v_dot2_f32_bf16 v201, v115, s38, v201
    v_dot2_f32_bf16 v203, v115, v115, v203
    v_dot2_f32_bf16 v200, v116, s38, v200
    v_dot2_f32_bf16 v202, v116, v116, v202
    v_dot2_f32_bf16 v201, v117, s38, v201
    v_dot2_f32_bf16 v203, v117, v117, v203
    v_dot2_f32_bf16 v200, v118, s38, v200
    v_dot2_f32_bf16 v202, v118, v118, v202
    v_dot2_f32_bf16 v201, v119, s38, v201
    v_dot2_f32_bf16 v203, v119, v119, v203
    v_dot2_f32_bf16 v200, v120, s38, v200
    v_dot2_f32_bf16 v202, v120, v120, v202
    v_dot2_f32_bf16 v201, v121, s38, v201
    v_dot2_f32_bf16 v203, v121, v121, v203
    v_dot2_f32_bf16 v200, v122, s38, v200
    v_dot2_f32_bf16 v202, v122, v122, v202
    v_dot2_f32_bf16 v201, v123, s38, v201
    v_dot2_f32_bf16 v203, v123, v123, v203
    v_dot2_f32_bf16 v200, v124, s38, v200
    v_dot2_f32_bf16 v202, v124, v124, v202
    v_dot2_f32_bf16 v201, v125, s38, v201
    v_dot2_f32_bf16 v203, v125, v125, v203
    v_dot2_f32_bf16 v200, v126, s38, v200
    v_dot2_f32_bf16 v202, v126, v126, v202
    v_dot2_f32_bf16 v201, v127, s38, v201
    v_dot2_f32_bf16 v203, v127, v127, v203
    s_waitcnt lgkmcnt(0)
    s_waitcnt vmcnt(16)
    ds_read_b128 v[144:147], v196 offset:16384
    ds_read_b128 v[148:151], v197 offset:16384
    ds_read_b128 v[152:155], v198 offset:16384
    ds_read_b128 v[156:159], v199 offset:16384
    s_add_u32 s37, s68, 0
    buffer_load_dwordx4 a[252:255], v170, s[12:15], s37 offen
    s_add_u32 s37, s68, 1048576
    buffer_load_dwordx4 a[252:255], v170, s[12:15], s37 offen
    v_dot2_f32_bf16 v200, v128, s38, v200
    v_dot2_f32_bf16 v202, v128, v128, v202
    v_dot2_f32_bf16 v201, v129, s38, v201
    v_dot2_f32_bf16 v203, v129, v129, v203
    v_dot2_f32_bf16 v200, v130, s38, v200
    v_dot2_f32_bf16 v202, v130, v130, v202
    v_dot2_f32_bf16 v201, v131, s38, v201
    v_dot2_f32_bf16 v203, v131, v131, v203
    s_add_u32 s37, s68, 2097152
    buffer_load_dwordx4 a[252:255], v170, s[12:15], s37 offen
    s_add_u32 s37, s68, 0
    buffer_load_dwordx4 a[252:255], v170, s[16:19], s37 offen
    v_dot2_f32_bf16 v200, v132, s38, v200
    v_dot2_f32_bf16 v202, v132, v132, v202
    v_dot2_f32_bf16 v201, v133, s38, v201
    v_dot2_f32_bf16 v203, v133, v133, v203
    v_dot2_f32_bf16 v200, v134, s38, v200
    v_dot2_f32_bf16 v202, v134, v134, v202
    v_dot2_f32_bf16 v201, v135, s38, v201
    v_dot2_f32_bf16 v203, v135, v135, v203
    s_add_u32 s37, s68, 1048576
    buffer_load_dwordx4 a[252:255], v170, s[16:19], s37 offen
    s_add_u32 s37, s68, 2097152
    buffer_load_dwordx4 a[252:255], v170, s[16:19], s37 offen
    v_dot2_f32_bf16 v200, v136, s38, v200
    v_dot2_f32_bf16 v202, v136, v136, v202
    v_dot2_f32_bf16 v201, v137, s38, v201
    v_dot2_f32_bf16 v203, v137, v137, v203
    v_dot2_f32_bf16 v200, v138, s38, v200
    v_dot2_f32_bf16 v202, v138, v138, v202
    v_dot2_f32_bf16 v201, v139, s38, v201
    v_dot2_f32_bf16 v203, v139, v139, v203
    v_dot2_f32_bf16 v200, v140, s38, v200
    v_dot2_f32_bf16 v202, v140, v140, v202
    v_dot2_f32_bf16 v201, v141, s38, v201
    v_dot2_f32_bf16 v203, v141, v141, v203
    v_dot2_f32_bf16 v200, v142, s38, v200
    v_dot2_f32_bf16 v202, v142, v142, v202
    v_dot2_f32_bf16 v201, v143, s38, v201
    v_dot2_f32_bf16 v203, v143, v143, v203
    s_waitcnt lgkmcnt(0)
    v_dot2_f32_bf16 v200, v144, s38, v200
    v_dot2_f32_bf16 v202, v144, v144, v202
    v_dot2_f32_bf16 v201, v145, s38, v201
    v_dot2_f32_bf16 v203, v145, v145, v203
    v_dot2_f32_bf16 v200, v146, s38, v200
    v_dot2_f32_bf16 v202, v146, v146, v202
    v_dot2_f32_bf16 v201, v147, s38, v201
    v_dot2_f32_bf16 v203, v147, v147, v203
    v_dot2_f32_bf16 v200, v148, s38, v200
    v_dot2_f32_bf16 v202, v148, v148, v202
    v_dot2_f32_bf16 v201, v149, s38, v201
    v_dot2_f32_bf16 v203, v149, v149, v203
    v_dot2_f32_bf16 v200, v150, s38, v200
    v_dot2_f32_bf16 v202, v150, v150, v202
    v_dot2_f32_bf16 v201, v151, s38, v201
    v_dot2_f32_bf16 v203, v151, v151, v203
    v_dot2_f32_bf16 v200, v152, s38, v200
    v_dot2_f32_bf16 v202, v152, v152, v202
    v_dot2_f32_bf16 v201, v153, s38, v201
    v_dot2_f32_bf16 v203, v153, v153, v203
    v_dot2_f32_bf16 v200, v154, s38, v200
    v_dot2_f32_bf16 v202, v154, v154, v202
    v_dot2_f32_bf16 v201, v155, s38, v201
    v_dot2_f32_bf16 v203, v155, v155, v203
    v_dot2_f32_bf16 v200, v156, s38, v200
    v_dot2_f32_bf16 v202, v156, v156, v202
    v_dot2_f32_bf16 v201, v157, s38, v201
    v_dot2_f32_bf16 v203, v157, v157, v203
    v_dot2_f32_bf16 v200, v158, s38, v200
    v_dot2_f32_bf16 v202, v158, v158, v202
    v_dot2_f32_bf16 v201, v159, s38, v201
    v_dot2_f32_bf16 v203, v159, v159, v203
    s_nop 2
    v_add_f32 v200, v200, v201
    v_add_f32 v202, v202, v203
    v_mov_b32 v201, v200
    v_mov_b32 v203, v202
    s_nop 1
    v_permlane32_swap_b32 v200, v201
    v_permlane32_swap_b32 v202, v203
    s_nop 1
    v_add_f32 v200, v200, v201
    v_add_f32 v202, v202, v203
    v_mul_f32 v200, 0xbacccccd, v200
    v_mul_f32 v202, 0x3acccccd, v202
    v_fma_f32 v202, -v200, v200, v202
    v_max_f32 v202, 0, v202
    v_add_f32 v202, 0x3727c5ac, v202
    v_sqrt_f32 v172, v202
    s_mov_b32 s41, 0xc0135761
    v_mov_b32 v173, s41
    v_rcp_f32 v171, v172
    s_mov_b32 s41, 0xbdd2d3e8
    v_mov_b32 v224, v200
    v_mov_b32 v225, v200
    v_mov_b32 v226, v200
    v_mov_b32 v227, v200
    v_mov_b32 v228, v200
    v_mov_b32 v229, v200
    v_mov_b32 v230, v200
    v_mov_b32 v231, v200
    v_mov_b32 v232, v200
    v_mov_b32 v233, v200
    v_mov_b32 v234, v200
    v_mov_b32 v235, v200
    v_mov_b32 v236, v200
    v_mov_b32 v237, v200
    v_mov_b32 v238, v200
    v_mov_b32 v239, v200
    v_mul_f32 v191, s40, v171
    s_nop 0
    v_mfma_f32_32x32x16_bf16 v[192:207], v[240:243], v[0:3], v[224:239]
    v_mfma_f32_32x32x16_bf16 v[192:207], v[244:247], v[4:7], v[192:207]
    s_waitcnt vmcnt(14)
    s_barrier
    ds_read_b64_tr_b16 a[64:65], v164 offset:0
    ds_read_b64_tr_b16 a[66:67], v164 offset:512
    ds_read_b64_tr_b16 a[68:69], v165 offset:0
    ds_read_b64_tr_b16 a[70:71], v165 offset:512
    ds_read_b64_tr_b16 a[72:73], v164 offset:8192
    ds_read_b64_tr_b16 a[74:75], v164 offset:8704
    ds_read_b64_tr_b16 a[76:77], v165 offset:8192
    ds_read_b64_tr_b16 a[78:79], v165 offset:8704
    ds_read_b64_tr_b16 a[80:81], v164 offset:2048
    ds_read_b64_tr_b16 a[82:83], v164 offset:2560
    ds_read_b64_tr_b16 a[84:85], v165 offset:2048
    ds_read_b64_tr_b16 a[86:87], v165 offset:2560
    ds_read_b64_tr_b16 a[88:89], v164 offset:10240
    ds_read_b64_tr_b16 a[90:91], v164 offset:10752
    ds_read_b64_tr_b16 a[92:93], v165 offset:10240
    ds_read_b64_tr_b16 a[94:95], v165 offset:10752
    v_cvt_pk_bf16_f32 v0, v192, v193
    v_cvt_pk_bf16_f32 v1, v194, v195
    v_cvt_pk_bf16_f32 v2, v196, v197
    v_cvt_pk_bf16_f32 v3, v198, v199
    v_cvt_pk_bf16_f32 v4, v200, v201
    v_cvt_pk_bf16_f32 v5, v202, v203
    v_cvt_pk_bf16_f32 v6, v204, v205
    v_cvt_pk_bf16_f32 v7, v206, v207
    s_cmp_lg_u32 s25, 0
    s_cbranch_scc1 NO1
    s_or_b32 s98, s100, 1
    s_mov_b32 s99, 0
    s_mov_b32 s101, s98
    s_atomic_cmpswap s[98:99], s[84:85], 0 glc
NO1:
    s_waitcnt lgkmcnt(8)
    v_mfma_f32_32x32x16_bf16 a[0:15], a[64:67], v[0:3], 0
    s_waitcnt vmcnt(6)
    s_barrier
    ds_read_b64_tr_b16 a[96:97], v164 offset:4096
    ds_read_b64_tr_b16 a[98:99], v164 offset:4608
    ds_read_b64_tr_b16 a[100:101], v165 offset:4096
    ds_read_b64_tr_b16 a[102:103], v165 offset:4608
    v_mfma_f32_32x32x16_bf16 a[16:31], a[68:71], v[0:3], 0
    ds_read_b64_tr_b16 a[104:105], v164 offset:12288
    ds_read_b64_tr_b16 a[106:107], v164 offset:12800
    ds_read_b64_tr_b16 a[108:109], v165 offset:12288
    ds_read_b64_tr_b16 a[110:111], v165 offset:12800
    v_mfma_f32_32x32x16_bf16 v[208:223], v[240:243], v[8:11], v[224:239]
    v_mfma_f32_32x32x16_bf16 a[32:47], a[72:75], v[0:3], 0
    s_add_u32 m0, s36, 65536
    s_add_u32 s37, s30, 983040
    buffer_load_dwordx4 v160, s[8:11], s37 offen lds
    v_mfma_f32_32x32x16_bf16 a[48:63], a[76:79], v[0:3], 0
    v_mfma_f32_32x32x16_bf16 v[208:223], v[244:247], v[12:15], v[208:223]
    buffer_load_dwordx4 v161, s[8:11], s37 offen offset:1024 lds
    s_waitcnt lgkmcnt(8)
    v_mfma_f32_32x32x16_bf16 a[0:15], a[80:83], v[4:7], a[0:15]
    ds_read_b64_tr_b16 a[64:65], v164 offset:6144
    ds_read_b64_tr_b16 a[66:67], v164 offset:6656
    ds_read_b64_tr_b16 a[68:69], v165 offset:6144
    ds_read_b64_tr_b16 a[70:71], v165 offset:6656
    v_mfma_f32_32x32x16_bf16 a[16:31], a[84:87], v[4:7], a[16:31]
    ds_read_b64_tr_b16 a[72:73], v164 offset:14336
    ds_read_b64_tr_b16 a[74:75], v164 offset:14848
    ds_read_b64_tr_b16 a[76:77], v165 offset:14336
    ds_read_b64_tr_b16 a[78:79], v165 offset:14848
    v_mfma_f32_32x32x16_bf16 a[32:47], a[88:91], v[4:7], a[32:47]
    v_cvt_pk_bf16_f32 v8, v208, v209
    v_cvt_pk_bf16_f32 v9, v210, v211
    v_cvt_pk_bf16_f32 v10, v212, v213
    v_cvt_pk_bf16_f32 v11, v214, v215
    s_add_u32 m0, s36, 73728
    s_add_u32 s37, s30, 983168
    buffer_load_dwordx4 v160, s[8:11], s37 offen lds
    v_mfma_f32_32x32x16_bf16 a[48:63], a[92:95], v[4:7], a[48:63]
    v_cvt_pk_bf16_f32 v12, v216, v217
    v_cvt_pk_bf16_f32 v13, v218, v219
    v_cvt_pk_bf16_f32 v14, v220, v221
    v_cvt_pk_bf16_f32 v15, v222, v223
    s_nop 0
    buffer_load_dwordx4 v161, s[8:11], s37 offen offset:1024 lds
    s_waitcnt lgkmcnt(8)
    v_mfma_f32_32x32x16_bf16 a[0:15], a[96:99], v[8:11], a[0:15]
    ds_read_b64_tr_b16 a[80:81], v164 offset:16384
    ds_read_b64_tr_b16 a[82:83], v164 offset:16896
    ds_read_b64_tr_b16 a[84:85], v165 offset:16384
    ds_read_b64_tr_b16 a[86:87], v165 offset:16896
    v_mfma_f32_32x32x16_bf16 a[16:31], a[100:103], v[8:11], a[16:31]
    ds_read_b64_tr_b16 a[88:89], v164 offset:24576
    ds_read_b64_tr_b16 a[90:91], v164 offset:25088
    ds_read_b64_tr_b16 a[92:93], v165 offset:24576
    ds_read_b64_tr_b16 a[94:95], v165 offset:25088
    v_mfma_f32_32x32x16_bf16 v[192:207], v[240:243], v[16:19], v[224:239]
    v_mfma_f32_32x32x16_bf16 a[32:47], a[104:107], v[8:11], a[32:47]
    s_add_u32 m0, s36, 81920
    s_add_u32 s37, s30, 1228800
    buffer_load_dwordx4 v160, s[8:11], s37 offen lds
    v_mfma_f32_32x32x16_bf16 a[48:63], a[108:111], v[8:11], a[48:63]
    v_mfma_f32_32x32x16_bf16 v[192:207], v[244:247], v[20:23], v[192:207]
    buffer_load_dwordx4 v161, s[8:11], s37 offen offset:1024 lds
    s_waitcnt lgkmcnt(8)
    v_mfma_f32_32x32x16_bf16 a[0:15], a[64:67], v[12:15], a[0:15]
    ds_read_b64_tr_b16 a[96:97], v164 offset:18432
    ds_read_b64_tr_b16 a[98:99], v164 offset:18944
    ds_read_b64_tr_b16 a[100:101], v165 offset:18432
    ds_read_b64_tr_b16 a[102:103], v165 offset:18944
    v_mfma_f32_32x32x16_bf16 a[16:31], a[68:71], v[12:15], a[16:31]
    ds_read_b64_tr_b16 a[104:105], v164 offset:26624
    ds_read_b64_tr_b16 a[106:107], v164 offset:27136
    ds_read_b64_tr_b16 a[108:109], v165 offset:26624
    ds_read_b64_tr_b16 a[110:111], v165 offset:27136
    v_mfma_f32_32x32x16_bf16 a[32:47], a[72:75], v[12:15], a[32:47]
    v_cvt_pk_bf16_f32 v16, v192, v193
    v_cvt_pk_bf16_f32 v17, v194, v195
    v_cvt_pk_bf16_f32 v18, v196, v197
    v_cvt_pk_bf16_f32 v19, v198, v199
    s_add_u32 m0, s36, 90112
    s_add_u32 s37, s30, 1228928
    buffer_load_dwordx4 v160, s[8:11], s37 offen lds
    v_mfma_f32_32x32x16_bf16 a[48:63], a[76:79], v[12:15], a[48:63]
    v_cvt_pk_bf16_f32 v20, v200, v201
    v_cvt_pk_bf16_f32 v21, v202, v203
    v_cvt_pk_bf16_f32 v22, v204, v205
    v_cvt_pk_bf16_f32 v23, v206, v207
    s_nop 0
    buffer_load_dwordx4 v161, s[8:11], s37 offen offset:1024 lds
    s_waitcnt lgkmcnt(8)
    v_mfma_f32_32x32x16_bf16 a[0:15], a[80:83], v[16:19], a[0:15]
    ds_read_b64_tr_b16 a[64:65], v164 offset:20480
    ds_read_b64_tr_b16 a[66:67], v164 offset:20992
    ds_read_b64_tr_b16 a[68:69], v165 offset:20480
    ds_read_b64_tr_b16 a[70:71], v165 offset:20992
    v_mfma_f32_32x32x16_bf16 a[16:31], a[84:87], v[16:19], a[16:31]
    ds_read_b64_tr_b16 a[72:73], v164 offset:28672
    ds_read_b64_tr_b16 a[74:75], v164 offset:29184
    ds_read_b64_tr_b16 a[76:77], v165 offset:28672
    ds_read_b64_tr_b16 a[78:79], v165 offset:29184
    v_mfma_f32_32x32x16_bf16 v[208:223], v[240:243], v[24:27], v[224:239]
    v_mfma_f32_32x32x16_bf16 a[32:47], a[88:91], v[16:19], a[32:47]
    s_add_u32 m0, s36, 98304
    s_add_u32 s37, s30, 1474560
    buffer_load_dwordx4 v160, s[8:11], s37 offen lds
    v_mfma_f32_32x32x16_bf16 a[48:63], a[92:95], v[16:19], a[48:63]
    v_mfma_f32_32x32x16_bf16 v[208:223], v[244:247], v[28:31], v[208:223]
    buffer_load_dwordx4 v161, s[8:11], s37 offen offset:1024 lds
    s_waitcnt lgkmcnt(8)
    v_mfma_f32_32x32x16_bf16 a[0:15], a[96:99], v[20:23], a[0:15]
    ds_read_b64_tr_b16 a[80:81], v164 offset:22528
    ds_read_b64_tr_b16 a[82:83], v164 offset:23040
    ds_read_b64_tr_b16 a[84:85], v165 offset:22528
    ds_read_b64_tr_b16 a[86:87], v165 offset:23040
    v_mfma_f32_32x32x16_bf16 a[16:31], a[100:103], v[20:23], a[16:31]
    ds_read_b64_tr_b16 a[88:89], v164 offset:30720
    ds_read_b64_tr_b16 a[90:91], v164 offset:31232
    ds_read_b64_tr_b16 a[92:93], v165 offset:30720
    ds_read_b64_tr_b16 a[94:95], v165 offset:31232
    v_mfma_f32_32x32x16_bf16 a[32:47], a[104:107], v[20:23], a[32:47]
    v_cvt_pk_bf16_f32 v24, v208, v209
    v_cvt_pk_bf16_f32 v25, v210, v211
    v_cvt_pk_bf16_f32 v26, v212, v213
    v_cvt_pk_bf16_f32 v27, v214, v215
    s_add_u32 m0, s36, 106496
    s_add_u32 s37, s30, 1474688
    buffer_load_dwordx4 v160, s[8:11], s37 offen lds
    v_mfma_f32_32x32x16_bf16 a[48:63], a[108:111], v[20:23], a[48:63]
    v_cvt_pk_bf16_f32 v28, v216, v217
    v_cvt_pk_bf16_f32 v29, v218, v219
    v_cvt_pk_bf16_f32 v30, v220, v221
    v_cvt_pk_bf16_f32 v31, v222, v223
    s_nop 0
    buffer_load_dwordx4 v161, s[8:11], s37 offen offset:1024 lds
    s_waitcnt lgkmcnt(8)
    v_mfma_f32_32x32x16_bf16 a[0:15], a[64:67], v[24:27], a[0:15]
    ds_read_b64_tr_b16 a[96:97], v164 offset:32768
    ds_read_b64_tr_b16 a[98:99], v164 offset:33280
    ds_read_b64_tr_b16 a[100:101], v165 offset:32768
    ds_read_b64_tr_b16 a[102:103], v165 offset:33280
    v_mfma_f32_32x32x16_bf16 a[16:31], a[68:71], v[24:27], a[16:31]
    ds_read_b64_tr_b16 a[104:105], v164 offset:40960
    ds_read_b64_tr_b16 a[106:107], v164 offset:41472
    ds_read_b64_tr_b16 a[108:109], v165 offset:40960
    ds_read_b64_tr_b16 a[110:111], v165 offset:41472
    v_mfma_f32_32x32x16_bf16 v[192:207], v[240:243], v[32:35], v[224:239]
    v_mfma_f32_32x32x16_bf16 a[32:47], a[72:75], v[24:27], a[32:47]
    s_add_u32 m0, s36, 114688
    s_add_u32 s37, s30, 1720320
    buffer_load_dwordx4 v160, s[8:11], s37 offen lds
    v_mfma_f32_32x32x16_bf16 a[48:63], a[76:79], v[24:27], a[48:63]
    v_mfma_f32_32x32x16_bf16 v[192:207], v[244:247], v[36:39], v[192:207]
    buffer_load_dwordx4 v161, s[8:11], s37 offen offset:1024 lds
    s_waitcnt lgkmcnt(8)
    v_mfma_f32_32x32x16_bf16 a[0:15], a[80:83], v[28:31], a[0:15]
    ds_read_b64_tr_b16 a[64:65], v164 offset:34816
    ds_read_b64_tr_b16 a[66:67], v164 offset:35328
    ds_read_b64_tr_b16 a[68:69], v165 offset:34816
    ds_read_b64_tr_b16 a[70:71], v165 offset:35328
    v_mfma_f32_32x32x16_bf16 a[16:31], a[84:87], v[28:31], a[16:31]
    ds_read_b64_tr_b16 a[72:73], v164 offset:43008
    ds_read_b64_tr_b16 a[74:75], v164 offset:43520
    ds_read_b64_tr_b16 a[76:77], v165 offset:43008
    ds_read_b64_tr_b16 a[78:79], v165 offset:43520
    v_mfma_f32_32x32x16_bf16 a[32:47], a[88:91], v[28:31], a[32:47]
    v_cvt_pk_bf16_f32 v32, v192, v193
    v_cvt_pk_bf16_f32 v33, v194, v195
    v_cvt_pk_bf16_f32 v34, v196, v197
    v_cvt_pk_bf16_f32 v35, v198, v199
    s_add_u32 m0, s36, 122880
    s_add_u32 s37, s30, 1720448
    buffer_load_dwordx4 v160, s[8:11], s37 offen lds
    v_mfma_f32_32x32x16_bf16 a[48:63], a[92:95], v[28:31], a[48:63]
    v_cvt_pk_bf16_f32 v36, v200, v201
    v_cvt_pk_bf16_f32 v37, v202, v203
    v_cvt_pk_bf16_f32 v38, v204, v205
    v_cvt_pk_bf16_f32 v39, v206, v207
    s_nop 0
    buffer_load_dwordx4 v161, s[8:11], s37 offen offset:1024 lds
    s_waitcnt lgkmcnt(8)
    v_mfma_f32_32x32x16_bf16 a[0:15], a[96:99], v[32:35], a[0:15]
    s_waitcnt vmcnt(8)
    s_barrier
    ds_read_b64_tr_b16 a[80:81], v164 offset:36864
    ds_read_b64_tr_b16 a[82:83], v164 offset:37376
    ds_read_b64_tr_b16 a[84:85], v165 offset:36864
    ds_read_b64_tr_b16 a[86:87], v165 offset:37376
    v_mfma_f32_32x32x16_bf16 a[16:31], a[100:103], v[32:35], a[16:31]
    ds_read_b64_tr_b16 a[88:89], v164 offset:45056
    ds_read_b64_tr_b16 a[90:91], v164 offset:45568
    ds_read_b64_tr_b16 a[92:93], v165 offset:45056
    ds_read_b64_tr_b16 a[94:95], v165 offset:45568
    v_mfma_f32_32x32x16_bf16 v[208:223], v[240:243], v[40:43], v[224:239]
    v_mfma_f32_32x32x16_bf16 a[32:47], a[104:107], v[32:35], a[32:47]
    s_add_u32 m0, s36, 131072
    s_add_u32 s37, s30, 1966080
    buffer_load_dwordx4 v160, s[8:11], s37 offen lds
    v_mfma_f32_32x32x16_bf16 a[48:63], a[108:111], v[32:35], a[48:63]
    v_mfma_f32_32x32x16_bf16 v[208:223], v[244:247], v[44:47], v[208:223]
    buffer_load_dwordx4 v161, s[8:11], s37 offen offset:1024 lds
    s_waitcnt lgkmcnt(8)
    v_mfma_f32_32x32x16_bf16 a[0:15], a[64:67], v[36:39], a[0:15]
    ds_read_b64_tr_b16 a[96:97], v164 offset:38912
    ds_read_b64_tr_b16 a[98:99], v164 offset:39424
    ds_read_b64_tr_b16 a[100:101], v165 offset:38912
    ds_read_b64_tr_b16 a[102:103], v165 offset:39424
    v_mfma_f32_32x32x16_bf16 a[16:31], a[68:71], v[36:39], a[16:31]
    ds_read_b64_tr_b16 a[104:105], v164 offset:47104
    ds_read_b64_tr_b16 a[106:107], v164 offset:47616
    ds_read_b64_tr_b16 a[108:109], v165 offset:47104
    ds_read_b64_tr_b16 a[110:111], v165 offset:47616
    v_mfma_f32_32x32x16_bf16 a[32:47], a[72:75], v[36:39], a[32:47]
    v_cvt_pk_bf16_f32 v40, v208, v209
    v_cvt_pk_bf16_f32 v41, v210, v211
    v_cvt_pk_bf16_f32 v42, v212, v213
    v_cvt_pk_bf16_f32 v43, v214, v215
    s_add_u32 m0, s36, 139264
    s_add_u32 s37, s30, 1966208
    buffer_load_dwordx4 v160, s[8:11], s37 offen lds
    v_mfma_f32_32x32x16_bf16 a[48:63], a[76:79], v[36:39], a[48:63]
    v_cvt_pk_bf16_f32 v44, v216, v217
    v_cvt_pk_bf16_f32 v45, v218, v219
    v_cvt_pk_bf16_f32 v46, v220, v221
    v_cvt_pk_bf16_f32 v47, v222, v223
    s_nop 0
    buffer_load_dwordx4 v161, s[8:11], s37 offen offset:1024 lds
    s_waitcnt lgkmcnt(8)
    v_mfma_f32_32x32x16_bf16 a[0:15], a[80:83], v[40:43], a[0:15]
    ds_read_b64_tr_b16 a[64:65], v164 offset:49152
    ds_read_b64_tr_b16 a[66:67], v164 offset:49664
    ds_read_b64_tr_b16 a[68:69], v165 offset:49152
    ds_read_b64_tr_b16 a[70:71], v165 offset:49664
    v_mfma_f32_32x32x16_bf16 a[16:31], a[84:87], v[40:43], a[16:31]
    ds_read_b64_tr_b16 a[72:73], v164 offset:57344
    ds_read_b64_tr_b16 a[74:75], v164 offset:57856
    ds_read_b64_tr_b16 a[76:77], v165 offset:57344
    ds_read_b64_tr_b16 a[78:79], v165 offset:57856
    v_mfma_f32_32x32x16_bf16 v[192:207], v[240:243], v[48:51], v[224:239]
    v_mfma_f32_32x32x16_bf16 a[32:47], a[88:91], v[40:43], a[32:47]
    s_add_u32 m0, s36, 147456
    s_add_u32 s37, s30, 2211840
    buffer_load_dwordx4 v160, s[8:11], s37 offen lds
    v_mfma_f32_32x32x16_bf16 a[48:63], a[92:95], v[40:43], a[48:63]
    v_mfma_f32_32x32x16_bf16 v[192:207], v[244:247], v[52:55], v[192:207]
    buffer_load_dwordx4 v161, s[8:11], s37 offen offset:1024 lds
    s_waitcnt lgkmcnt(8)
    v_mfma_f32_32x32x16_bf16 a[0:15], a[96:99], v[44:47], a[0:15]
    ds_read_b64_tr_b16 a[80:81], v164 offset:51200
    ds_read_b64_tr_b16 a[82:83], v164 offset:51712
    ds_read_b64_tr_b16 a[84:85], v165 offset:51200
    ds_read_b64_tr_b16 a[86:87], v165 offset:51712
    v_mfma_f32_32x32x16_bf16 a[16:31], a[100:103], v[44:47], a[16:31]
    ds_read_b64_tr_b16 a[88:89], v164 offset:59392
    ds_read_b64_tr_b16 a[90:91], v164 offset:59904
    ds_read_b64_tr_b16 a[92:93], v165 offset:59392
    ds_read_b64_tr_b16 a[94:95], v165 offset:59904
    v_mfma_f32_32x32x16_bf16 a[32:47], a[104:107], v[44:47], a[32:47]
    v_cvt_pk_bf16_f32 v48, v192, v193
    v_cvt_pk_bf16_f32 v49, v194, v195
    v_cvt_pk_bf16_f32 v50, v196, v197
    v_cvt_pk_bf16_f32 v51, v198, v199
    s_add_u32 m0, s36, 155648
    s_add_u32 s37, s30, 2211968
    buffer_load_dwordx4 v160, s[8:11], s37 offen lds
    v_mfma_f32_32x32x16_bf16 a[48:63], a[108:111], v[44:47], a[48:63]
    v_cvt_pk_bf16_f32 v52, v200, v201
    v_cvt_pk_bf16_f32 v53, v202, v203
    v_cvt_pk_bf16_f32 v54, v204, v205
    v_cvt_pk_bf16_f32 v55, v206, v207
    s_nop 0
    buffer_load_dwordx4 v161, s[8:11], s37 offen offset:1024 lds
    s_waitcnt lgkmcnt(8)
    v_mfma_f32_32x32x16_bf16 a[0:15], a[64:67], v[48:51], a[0:15]
    ds_read_b64_tr_b16 a[96:97], v164 offset:53248
    ds_read_b64_tr_b16 a[98:99], v164 offset:53760
    ds_read_b64_tr_b16 a[100:101], v165 offset:53248
    ds_read_b64_tr_b16 a[102:103], v165 offset:53760
    v_mfma_f32_32x32x16_bf16 a[16:31], a[68:71], v[48:51], a[16:31]
    ds_read_b64_tr_b16 a[104:105], v164 offset:61440
    ds_read_b64_tr_b16 a[106:107], v164 offset:61952
    ds_read_b64_tr_b16 a[108:109], v165 offset:61440
    ds_read_b64_tr_b16 a[110:111], v165 offset:61952
    v_mfma_f32_32x32x16_bf16 v[208:223], v[240:243], v[56:59], v[224:239]
    v_mfma_f32_32x32x16_bf16 a[32:47], a[72:75], v[48:51], a[32:47]
    s_add_u32 m0, s36, 0
    s_add_u32 s37, s31, 0
    buffer_load_dwordx4 v162, s[12:15], s37 offen lds
    v_mfma_f32_32x32x16_bf16 a[48:63], a[76:79], v[48:51], a[48:63]
    v_mfma_f32_32x32x16_bf16 v[208:223], v[244:247], v[60:63], v[208:223]
    buffer_load_dwordx4 v163, s[12:15], s37 offen offset:1024 lds
    s_waitcnt lgkmcnt(8)
    v_mfma_f32_32x32x16_bf16 a[0:15], a[80:83], v[52:55], a[0:15]
    ds_read_b64_tr_b16 a[64:65], v164 offset:55296
    ds_read_b64_tr_b16 a[66:67], v164 offset:55808
    ds_read_b64_tr_b16 a[68:69], v165 offset:55296
    ds_read_b64_tr_b16 a[70:71], v165 offset:55808
    v_mfma_f32_32x32x16_bf16 a[16:31], a[84:87], v[52:55], a[16:31]
    ds_read_b64_tr_b16 a[72:73], v164 offset:63488
    ds_read_b64_tr_b16 a[74:75], v164 offset:64000
    ds_read_b64_tr_b16 a[76:77], v165 offset:63488
    ds_read_b64_tr_b16 a[78:79], v165 offset:64000
    v_mfma_f32_32x32x16_bf16 a[32:47], a[88:91], v[52:55], a[32:47]
    v_cvt_pk_bf16_f32 v56, v208, v209
    v_cvt_pk_bf16_f32 v57, v210, v211
    v_cvt_pk_bf16_f32 v58, v212, v213
    v_cvt_pk_bf16_f32 v59, v214, v215
    s_add_u32 m0, s36, 8192
    s_nop 0
    buffer_load_dwordx4 v162, s[16:19], s37 offen lds
    v_mfma_f32_32x32x16_bf16 a[48:63], a[92:95], v[52:55], a[48:63]
    v_cvt_pk_bf16_f32 v60, v216, v217
    v_cvt_pk_bf16_f32 v61, v218, v219
    v_cvt_pk_bf16_f32 v62, v220, v221
    v_cvt_pk_bf16_f32 v63, v222, v223
    s_nop 0
    buffer_load_dwordx4 v163, s[16:19], s37 offen offset:1024 lds
    s_waitcnt lgkmcnt(8)
    v_mfma_f32_32x32x16_bf16 a[0:15], a[96:99], v[56:59], a[0:15]
    ds_read_b64_tr_b16 a[80:81], v166 offset:0
    ds_read_b64_tr_b16 a[82:83], v166 offset:512
    ds_read_b64_tr_b16 a[84:85], v167 offset:0
    ds_read_b64_tr_b16 a[86:87], v167 offset:512
    v_mfma_f32_32x32x16_bf16 a[16:31], a[100:103], v[56:59], a[16:31]
    ds_read_b64_tr_b16 a[88:89], v166 offset:8192
    ds_read_b64_tr_b16 a[90:91], v166 offset:8704
    ds_read_b64_tr_b16 a[92:93], v167 offset:8192
    ds_read_b64_tr_b16 a[94:95], v167 offset:8704
    v_mfma_f32_32x32x16_bf16 v[192:207], v[240:243], v[64:67], v[224:239]
    v_mfma_f32_32x32x16_bf16 a[32:47], a[104:107], v[56:59], a[32:47]
    s_add_u32 m0, s36, 16384
    s_add_u32 s37, s31, 221184
    buffer_load_dwordx4 v162, s[12:15], s37 offen lds
    v_mfma_f32_32x32x16_bf16 a[48:63], a[108:111], v[56:59], a[48:63]
    v_mfma_f32_32x32x16_bf16 v[192:207], v[244:247], v[68:71], v[192:207]
    buffer_load_dwordx4 v163, s[12:15], s37 offen offset:1024 lds
    s_waitcnt lgkmcnt(8)
    v_mfma_f32_32x32x16_bf16 a[0:15], a[64:67], v[60:63], a[0:15]
    ds_read_b64_tr_b16 a[96:97], v166 offset:2048
    ds_read_b64_tr_b16 a[98:99], v166 offset:2560
    ds_read_b64_tr_b16 a[100:101], v167 offset:2048
    ds_read_b64_tr_b16 a[102:103], v167 offset:2560
    v_mfma_f32_32x32x16_bf16 a[16:31], a[68:71], v[60:63], a[16:31]
    ds_read_b64_tr_b16 a[104:105], v166 offset:10240
    ds_read_b64_tr_b16 a[106:107], v166 offset:10752
    ds_read_b64_tr_b16 a[108:109], v167 offset:10240
    ds_read_b64_tr_b16 a[110:111], v167 offset:10752
    v_mfma_f32_32x32x16_bf16 a[32:47], a[72:75], v[60:63], a[32:47]
    v_cvt_pk_bf16_f32 v64, v192, v193
    v_cvt_pk_bf16_f32 v65, v194, v195
    v_cvt_pk_bf16_f32 v66, v196, v197
    v_cvt_pk_bf16_f32 v67, v198, v199
    s_add_u32 m0, s36, 24576
    s_nop 0
    buffer_load_dwordx4 v162, s[16:19], s37 offen lds
    v_mfma_f32_32x32x16_bf16 a[48:63], a[76:79], v[60:63], a[48:63]
    v_cvt_pk_bf16_f32 v68, v200, v201
    v_cvt_pk_bf16_f32 v69, v202, v203
    v_cvt_pk_bf16_f32 v70, v204, v205
    v_cvt_pk_bf16_f32 v71, v206, v207
    s_nop 0
    buffer_load_dwordx4 v163, s[16:19], s37 offen offset:1024 lds
    s_waitcnt lgkmcnt(8)
    v_mfma_f32_32x32x16_bf16 a[0:15], a[80:83], v[64:67], a[0:15]
    s_waitcnt vmcnt(16)
    s_barrier
    ds_read_b64_tr_b16 a[64:65], v166 offset:4096
    ds_read_b64_tr_b16 a[66:67], v166 offset:4608
    ds_read_b64_tr_b16 a[68:69], v167 offset:4096
    ds_read_b64_tr_b16 a[70:71], v167 offset:4608
    v_mfma_f32_32x32x16_bf16 a[16:31], a[84:87], v[64:67], a[16:31]
    ds_read_b64_tr_b16 a[72:73], v166 offset:12288
    ds_read_b64_tr_b16 a[74:75], v166 offset:12800
    ds_read_b64_tr_b16 a[76:77], v167 offset:12288
    ds_read_b64_tr_b16 a[78:79], v167 offset:12800
    v_mfma_f32_32x32x16_bf16 v[208:223], v[240:243], v[72:75], v[224:239]
    v_mfma_f32_32x32x16_bf16 a[32:47], a[88:91], v[64:67], a[32:47]
    s_add_u32 m0, s36, 32768
    s_add_u32 s37, s31, 442368
    buffer_load_dwordx4 v162, s[12:15], s37 offen lds
    v_mfma_f32_32x32x16_bf16 a[48:63], a[92:95], v[64:67], a[48:63]
    v_mfma_f32_32x32x16_bf16 v[208:223], v[244:247], v[76:79], v[208:223]
    s_waitcnt lgkmcnt(8)
    v_mfma_f32_32x32x16_bf16 a[0:15], a[96:99], v[68:71], a[0:15]
    ds_read_b64_tr_b16 a[80:81], v166 offset:6144
    ds_read_b64_tr_b16 a[82:83], v166 offset:6656
    ds_read_b64_tr_b16 a[84:85], v167 offset:6144
    ds_read_b64_tr_b16 a[86:87], v167 offset:6656
    v_mfma_f32_32x32x16_bf16 a[16:31], a[100:103], v[68:71], a[16:31]
    ds_read_b64_tr_b16 a[88:89], v166 offset:14336
    ds_read_b64_tr_b16 a[90:91], v166 offset:14848
    ds_read_b64_tr_b16 a[92:93], v167 offset:14336
    ds_read_b64_tr_b16 a[94:95], v167 offset:14848
    v_mfma_f32_32x32x16_bf16 a[32:47], a[104:107], v[68:71], a[32:47]
    v_cvt_pk_bf16_f32 v72, v208, v209
    v_cvt_pk_bf16_f32 v73, v210, v211
    v_cvt_pk_bf16_f32 v74, v212, v213
    v_cvt_pk_bf16_f32 v75, v214, v215
    buffer_load_dwordx4 v163, s[12:15], s37 offen offset:1024 lds
    v_mfma_f32_32x32x16_bf16 a[48:63], a[108:111], v[68:71], a[48:63]
    v_cvt_pk_bf16_f32 v76, v216, v217
    v_cvt_pk_bf16_f32 v77, v218, v219
    v_cvt_pk_bf16_f32 v78, v220, v221
    v_cvt_pk_bf16_f32 v79, v222, v223
    s_nop 0
    s_waitcnt lgkmcnt(8)
    v_mfma_f32_32x32x16_bf16 a[0:15], a[64:67], v[72:75], a[0:15]
    ds_read_b64_tr_b16 a[96:97], v166 offset:16384
    ds_read_b64_tr_b16 a[98:99], v166 offset:16896
    ds_read_b64_tr_b16 a[100:101], v167 offset:16384
    ds_read_b64_tr_b16 a[102:103], v167 offset:16896
    v_mfma_f32_32x32x16_bf16 a[16:31], a[68:71], v[72:75], a[16:31]
    ds_read_b64_tr_b16 a[104:105], v166 offset:24576
    ds_read_b64_tr_b16 a[106:107], v166 offset:25088
    ds_read_b64_tr_b16 a[108:109], v167 offset:24576
    ds_read_b64_tr_b16 a[110:111], v167 offset:25088
    v_mfma_f32_32x32x16_bf16 v[192:207], v[240:243], v[80:83], v[224:239]
    v_mfma_f32_32x32x16_bf16 a[32:47], a[72:75], v[72:75], a[32:47]
    s_add_u32 m0, s36, 40960
    s_nop 0
    buffer_load_dwordx4 v162, s[16:19], s37 offen lds
    v_mfma_f32_32x32x16_bf16 a[48:63], a[76:79], v[72:75], a[48:63]
    v_mfma_f32_32x32x16_bf16 v[192:207], v[244:247], v[84:87], v[192:207]
    s_waitcnt lgkmcnt(8)
    v_mfma_f32_32x32x16_bf16 a[0:15], a[80:83], v[76:79], a[0:15]
    ds_read_b64_tr_b16 a[64:65], v166 offset:18432
    ds_read_b64_tr_b16 a[66:67], v166 offset:18944
    ds_read_b64_tr_b16 a[68:69], v167 offset:18432
    ds_read_b64_tr_b16 a[70:71], v167 offset:18944
    v_mfma_f32_32x32x16_bf16 a[16:31], a[84:87], v[76:79], a[16:31]
    ds_read_b64_tr_b16 a[72:73], v166 offset:26624
    ds_read_b64_tr_b16 a[74:75], v166 offset:27136
    ds_read_b64_tr_b16 a[76:77], v167 offset:26624
    ds_read_b64_tr_b16 a[78:79], v167 offset:27136
    v_mfma_f32_32x32x16_bf16 a[32:47], a[88:91], v[76:79], a[32:47]
    v_cvt_pk_bf16_f32 v80, v192, v193
    v_cvt_pk_bf16_f32 v81, v194, v195
    v_cvt_pk_bf16_f32 v82, v196, v197
    v_cvt_pk_bf16_f32 v83, v198, v199
    buffer_load_dwordx4 v163, s[16:19], s37 offen offset:1024 lds
    v_mfma_f32_32x32x16_bf16 a[48:63], a[92:95], v[76:79], a[48:63]
    v_cvt_pk_bf16_f32 v84, v200, v201
    v_cvt_pk_bf16_f32 v85, v202, v203
    v_cvt_pk_bf16_f32 v86, v204, v205
    v_cvt_pk_bf16_f32 v87, v206, v207
    s_nop 0
    s_waitcnt lgkmcnt(8)
    v_mfma_f32_32x32x16_bf16 a[0:15], a[96:99], v[80:83], a[0:15]
    ds_read_b64_tr_b16 a[80:81], v166 offset:20480
    ds_read_b64_tr_b16 a[82:83], v166 offset:20992
    ds_read_b64_tr_b16 a[84:85], v167 offset:20480
    ds_read_b64_tr_b16 a[86:87], v167 offset:20992
    v_mfma_f32_32x32x16_bf16 a[16:31], a[100:103], v[80:83], a[16:31]
    ds_read_b64_tr_b16 a[88:89], v166 offset:28672
    ds_read_b64_tr_b16 a[90:91], v166 offset:29184
    ds_read_b64_tr_b16 a[92:93], v167 offset:28672
    ds_read_b64_tr_b16 a[94:95], v167 offset:29184
    v_mfma_f32_32x32x16_bf16 v[208:223], v[240:243], v[88:91], v[224:239]
    v_mfma_f32_32x32x16_bf16 a[32:47], a[104:107], v[80:83], a[32:47]
    s_add_u32 m0, s36, 49152
    s_add_u32 s37, s31, 663552
    buffer_load_dwordx4 v162, s[12:15], s37 offen lds
    v_mfma_f32_32x32x16_bf16 a[48:63], a[108:111], v[80:83], a[48:63]
    v_mfma_f32_32x32x16_bf16 v[208:223], v[244:247], v[92:95], v[208:223]
    s_waitcnt lgkmcnt(8)
    v_mfma_f32_32x32x16_bf16 a[0:15], a[64:67], v[84:87], a[0:15]
    ds_read_b64_tr_b16 a[96:97], v166 offset:22528
    ds_read_b64_tr_b16 a[98:99], v166 offset:23040
    ds_read_b64_tr_b16 a[100:101], v167 offset:22528
    ds_read_b64_tr_b16 a[102:103], v167 offset:23040
    v_mfma_f32_32x32x16_bf16 a[16:31], a[68:71], v[84:87], a[16:31]
    ds_read_b64_tr_b16 a[104:105], v166 offset:30720
    ds_read_b64_tr_b16 a[106:107], v166 offset:31232
    ds_read_b64_tr_b16 a[108:109], v167 offset:30720
    ds_read_b64_tr_b16 a[110:111], v167 offset:31232
    v_mfma_f32_32x32x16_bf16 a[32:47], a[72:75], v[84:87], a[32:47]
    v_cvt_pk_bf16_f32 v88, v208, v209
    v_cvt_pk_bf16_f32 v89, v210, v211
    v_cvt_pk_bf16_f32 v90, v212, v213
    v_cvt_pk_bf16_f32 v91, v214, v215
    buffer_load_dwordx4 v163, s[12:15], s37 offen offset:1024 lds
    v_mfma_f32_32x32x16_bf16 a[48:63], a[76:79], v[84:87], a[48:63]
    v_cvt_pk_bf16_f32 v92, v216, v217
    v_cvt_pk_bf16_f32 v93, v218, v219
    v_cvt_pk_bf16_f32 v94, v220, v221
    v_cvt_pk_bf16_f32 v95, v222, v223
    s_nop 0
    s_waitcnt lgkmcnt(8)
    v_mfma_f32_32x32x16_bf16 a[0:15], a[80:83], v[88:91], a[0:15]
    ds_read_b64_tr_b16 a[64:65], v166 offset:32768
    ds_read_b64_tr_b16 a[66:67], v166 offset:33280
    ds_read_b64_tr_b16 a[68:69], v167 offset:32768
    ds_read_b64_tr_b16 a[70:71], v167 offset:33280
    v_mfma_f32_32x32x16_bf16 a[16:31], a[84:87], v[88:91], a[16:31]
    ds_read_b64_tr_b16 a[72:73], v166 offset:40960
    ds_read_b64_tr_b16 a[74:75], v166 offset:41472
    ds_read_b64_tr_b16 a[76:77], v167 offset:40960
    ds_read_b64_tr_b16 a[78:79], v167 offset:41472
    v_mfma_f32_32x32x16_bf16 v[192:207], v[240:243], v[96:99], v[224:239]
    v_mfma_f32_32x32x16_bf16 a[32:47], a[88:91], v[88:91], a[32:47]
    s_add_u32 m0, s36, 57344
    s_nop 0
    buffer_load_dwordx4 v162, s[16:19], s37 offen lds
    v_mfma_f32_32x32x16_bf16 a[48:63], a[92:95], v[88:91], a[48:63]
    v_mfma_f32_32x32x16_bf16 v[192:207], v[244:247], v[100:103], v[192:207]
    s_waitcnt lgkmcnt(8)
    v_mfma_f32_32x32x16_bf16 a[0:15], a[96:99], v[92:95], a[0:15]
    ds_read_b64_tr_b16 a[80:81], v166 offset:34816
    ds_read_b64_tr_b16 a[82:83], v166 offset:35328
    ds_read_b64_tr_b16 a[84:85], v167 offset:34816
    ds_read_b64_tr_b16 a[86:87], v167 offset:35328
    v_mfma_f32_32x32x16_bf16 a[16:31], a[100:103], v[92:95], a[16:31]
    ds_read_b64_tr_b16 a[88:89], v166 offset:43008
    ds_read_b64_tr_b16 a[90:91], v166 offset:43520
    ds_read_b64_tr_b16 a[92:93], v167 offset:43008
    ds_read_b64_tr_b16 a[94:95], v167 offset:43520
    v_mfma_f32_32x32x16_bf16 a[32:47], a[104:107], v[92:95], a[32:47]
    v_cvt_pk_bf16_f32 v96, v192, v193
    v_cvt_pk_bf16_f32 v97, v194, v195
    v_cvt_pk_bf16_f32 v98, v196, v197
    v_cvt_pk_bf16_f32 v99, v198, v199
    buffer_load_dwordx4 v163, s[16:19], s37 offen offset:1024 lds
    v_mfma_f32_32x32x16_bf16 a[48:63], a[108:111], v[92:95], a[48:63]
    v_cvt_pk_bf16_f32 v100, v200, v201
    v_cvt_pk_bf16_f32 v101, v202, v203
    v_cvt_pk_bf16_f32 v102, v204, v205
    v_cvt_pk_bf16_f32 v103, v206, v207
    s_nop 0
    s_waitcnt lgkmcnt(8)
    v_mfma_f32_32x32x16_bf16 a[0:15], a[64:67], v[96:99], a[0:15]
    s_waitcnt vmcnt(16)
    s_barrier
    ds_read_b64_tr_b16 a[96:97], v166 offset:36864
    ds_read_b64_tr_b16 a[98:99], v166 offset:37376
    ds_read_b64_tr_b16 a[100:101], v167 offset:36864
    ds_read_b64_tr_b16 a[102:103], v167 offset:37376
    v_mfma_f32_32x32x16_bf16 a[16:31], a[68:71], v[96:99], a[16:31]
    ds_read_b64_tr_b16 a[104:105], v166 offset:45056
    ds_read_b64_tr_b16 a[106:107], v166 offset:45568
    ds_read_b64_tr_b16 a[108:109], v167 offset:45056
    ds_read_b64_tr_b16 a[110:111], v167 offset:45568
    v_mfma_f32_32x32x16_bf16 v[208:223], v[240:243], v[104:107], v[224:239]
    v_mfma_f32_32x32x16_bf16 a[32:47], a[72:75], v[96:99], a[32:47]
    s_add_u32 m0, s36, 65536
    s_add_u32 s37, s31, 884736
    buffer_load_dwordx4 v162, s[12:15], s37 offen lds
    v_mfma_f32_32x32x16_bf16 a[48:63], a[76:79], v[96:99], a[48:63]
    v_mfma_f32_32x32x16_bf16 v[208:223], v[244:247], v[108:111], v[208:223]
    s_waitcnt lgkmcnt(8)
    v_mfma_f32_32x32x16_bf16 a[0:15], a[80:83], v[100:103], a[0:15]
    ds_read_b64_tr_b16 a[64:65], v166 offset:38912
    ds_read_b64_tr_b16 a[66:67], v166 offset:39424
    ds_read_b64_tr_b16 a[68:69], v167 offset:38912
    ds_read_b64_tr_b16 a[70:71], v167 offset:39424
    v_mfma_f32_32x32x16_bf16 a[16:31], a[84:87], v[100:103], a[16:31]
    ds_read_b64_tr_b16 a[72:73], v166 offset:47104
    ds_read_b64_tr_b16 a[74:75], v166 offset:47616
    ds_read_b64_tr_b16 a[76:77], v167 offset:47104
    ds_read_b64_tr_b16 a[78:79], v167 offset:47616
    v_mfma_f32_32x32x16_bf16 a[32:47], a[88:91], v[100:103], a[32:47]
    v_cvt_pk_bf16_f32 v104, v208, v209
    v_cvt_pk_bf16_f32 v105, v210, v211
    v_cvt_pk_bf16_f32 v106, v212, v213
    v_cvt_pk_bf16_f32 v107, v214, v215
    buffer_load_dwordx4 v163, s[12:15], s37 offen offset:1024 lds
    v_mfma_f32_32x32x16_bf16 a[48:63], a[92:95], v[100:103], a[48:63]
    v_cvt_pk_bf16_f32 v108, v216, v217
    v_cvt_pk_bf16_f32 v109, v218, v219
    v_cvt_pk_bf16_f32 v110, v220, v221
    v_cvt_pk_bf16_f32 v111, v222, v223
    s_nop 0
    s_waitcnt lgkmcnt(8)
    v_mfma_f32_32x32x16_bf16 a[0:15], a[96:99], v[104:107], a[0:15]
    ds_read_b64_tr_b16 a[80:81], v166 offset:49152
    ds_read_b64_tr_b16 a[82:83], v166 offset:49664
    ds_read_b64_tr_b16 a[84:85], v167 offset:49152
    ds_read_b64_tr_b16 a[86:87], v167 offset:49664
    v_mfma_f32_32x32x16_bf16 a[16:31], a[100:103], v[104:107], a[16:31]
    ds_read_b64_tr_b16 a[88:89], v166 offset:57344
    ds_read_b64_tr_b16 a[90:91], v166 offset:57856
    ds_read_b64_tr_b16 a[92:93], v167 offset:57344
    ds_read_b64_tr_b16 a[94:95], v167 offset:57856
    v_mfma_f32_32x32x16_bf16 v[192:207], v[240:243], v[112:115], v[224:239]
    v_mfma_f32_32x32x16_bf16 a[32:47], a[104:107], v[104:107], a[32:47]
    s_add_u32 m0, s36, 73728
    s_nop 0
    buffer_load_dwordx4 v162, s[16:19], s37 offen lds
    v_mfma_f32_32x32x16_bf16 a[48:63], a[108:111], v[104:107], a[48:63]
    v_mfma_f32_32x32x16_bf16 v[192:207], v[244:247], v[116:119], v[192:207]
    s_waitcnt lgkmcnt(8)
    v_mfma_f32_32x32x16_bf16 a[0:15], a[64:67], v[108:111], a[0:15]
    ds_read_b64_tr_b16 a[96:97], v166 offset:51200
    ds_read_b64_tr_b16 a[98:99], v166 offset:51712
    ds_read_b64_tr_b16 a[100:101], v167 offset:51200
    ds_read_b64_tr_b16 a[102:103], v167 offset:51712
    v_mfma_f32_32x32x16_bf16 a[16:31], a[68:71], v[108:111], a[16:31]
    ds_read_b64_tr_b16 a[104:105], v166 offset:59392
    ds_read_b64_tr_b16 a[106:107], v166 offset:59904
    ds_read_b64_tr_b16 a[108:109], v167 offset:59392
    ds_read_b64_tr_b16 a[110:111], v167 offset:59904
    v_mfma_f32_32x32x16_bf16 a[32:47], a[72:75], v[108:111], a[32:47]
    v_cvt_pk_bf16_f32 v112, v192, v193
    v_cvt_pk_bf16_f32 v113, v194, v195
    v_cvt_pk_bf16_f32 v114, v196, v197
    v_cvt_pk_bf16_f32 v115, v198, v199
    buffer_load_dwordx4 v163, s[16:19], s37 offen offset:1024 lds
    v_mfma_f32_32x32x16_bf16 a[48:63], a[76:79], v[108:111], a[48:63]
    v_cvt_pk_bf16_f32 v116, v200, v201
    v_cvt_pk_bf16_f32 v117, v202, v203
    v_cvt_pk_bf16_f32 v118, v204, v205
    v_cvt_pk_bf16_f32 v119, v206, v207
    s_nop 0
    s_waitcnt lgkmcnt(8)
    v_mfma_f32_32x32x16_bf16 a[0:15], a[80:83], v[112:115], a[0:15]
    ds_read_b64_tr_b16 a[64:65], v166 offset:53248
    ds_read_b64_tr_b16 a[66:67], v166 offset:53760
    ds_read_b64_tr_b16 a[68:69], v167 offset:53248
    ds_read_b64_tr_b16 a[70:71], v167 offset:53760
    v_mfma_f32_32x32x16_bf16 a[16:31], a[84:87], v[112:115], a[16:31]
    ds_read_b64_tr_b16 a[72:73], v166 offset:61440
    ds_read_b64_tr_b16 a[74:75], v166 offset:61952
    ds_read_b64_tr_b16 a[76:77], v167 offset:61440
    ds_read_b64_tr_b16 a[78:79], v167 offset:61952
    v_mfma_f32_32x32x16_bf16 v[208:223], v[240:243], v[120:123], v[224:239]
    v_mfma_f32_32x32x16_bf16 a[32:47], a[88:91], v[112:115], a[32:47]
    s_add_u32 m0, s36, 81920
    s_add_u32 s37, s31, 1105920
    buffer_load_dwordx4 v162, s[12:15], s37 offen lds
    v_mfma_f32_32x32x16_bf16 a[48:63], a[92:95], v[112:115], a[48:63]
    v_mfma_f32_32x32x16_bf16 v[208:223], v[244:247], v[124:127], v[208:223]
    s_waitcnt lgkmcnt(8)
    v_mfma_f32_32x32x16_bf16 a[0:15], a[96:99], v[116:119], a[0:15]
    ds_read_b64_tr_b16 a[80:81], v166 offset:55296
    ds_read_b64_tr_b16 a[82:83], v166 offset:55808
    ds_read_b64_tr_b16 a[84:85], v167 offset:55296
    ds_read_b64_tr_b16 a[86:87], v167 offset:55808
    v_mfma_f32_32x32x16_bf16 a[16:31], a[100:103], v[116:119], a[16:31]
    ds_read_b64_tr_b16 a[88:89], v166 offset:63488
    ds_read_b64_tr_b16 a[90:91], v166 offset:64000
    ds_read_b64_tr_b16 a[92:93], v167 offset:63488
    ds_read_b64_tr_b16 a[94:95], v167 offset:64000
    v_mfma_f32_32x32x16_bf16 a[32:47], a[104:107], v[116:119], a[32:47]
    v_cvt_pk_bf16_f32 v120, v208, v209
    v_cvt_pk_bf16_f32 v121, v210, v211
    v_cvt_pk_bf16_f32 v122, v212, v213
    v_cvt_pk_bf16_f32 v123, v214, v215
    buffer_load_dwordx4 v163, s[12:15], s37 offen offset:1024 lds
    v_mfma_f32_32x32x16_bf16 a[48:63], a[108:111], v[116:119], a[48:63]
    v_cvt_pk_bf16_f32 v124, v216, v217
    v_cvt_pk_bf16_f32 v125, v218, v219
    v_cvt_pk_bf16_f32 v126, v220, v221
    v_cvt_pk_bf16_f32 v127, v222, v223
    s_nop 0
    s_waitcnt lgkmcnt(8)
    v_mfma_f32_32x32x16_bf16 a[0:15], a[64:67], v[120:123], a[0:15]
    ds_read_b64_tr_b16 a[96:97], v168 offset:0
    ds_read_b64_tr_b16 a[98:99], v168 offset:512
    ds_read_b64_tr_b16 a[100:101], v169 offset:0
    ds_read_b64_tr_b16 a[102:103], v169 offset:512
    v_mfma_f32_32x32x16_bf16 a[16:31], a[68:71], v[120:123], a[16:31]
    ds_read_b64_tr_b16 a[104:105], v168 offset:8192
    ds_read_b64_tr_b16 a[106:107], v168 offset:8704
    ds_read_b64_tr_b16 a[108:109], v169 offset:8192
    ds_read_b64_tr_b16 a[110:111], v169 offset:8704
    v_mfma_f32_32x32x16_bf16 v[192:207], v[240:243], v[128:131], v[224:239]
    v_mfma_f32_32x32x16_bf16 a[32:47], a[72:75], v[120:123], a[32:47]
    s_add_u32 m0, s36, 90112
    s_nop 0
    buffer_load_dwordx4 v162, s[16:19], s37 offen lds
    v_mfma_f32_32x32x16_bf16 a[48:63], a[76:79], v[120:123], a[48:63]
    v_mfma_f32_32x32x16_bf16 v[192:207], v[244:247], v[132:135], v[192:207]
    s_waitcnt lgkmcnt(8)
    v_mfma_f32_32x32x16_bf16 a[0:15], a[80:83], v[124:127], a[0:15]
    ds_read_b64_tr_b16 a[64:65], v168 offset:2048
    ds_read_b64_tr_b16 a[66:67], v168 offset:2560
    ds_read_b64_tr_b16 a[68:69], v169 offset:2048
    ds_read_b64_tr_b16 a[70:71], v169 offset:2560
    v_mfma_f32_32x32x16_bf16 a[16:31], a[84:87], v[124:127], a[16:31]
    ds_read_b64_tr_b16 a[72:73], v168 offset:10240
    ds_read_b64_tr_b16 a[74:75], v168 offset:10752
    ds_read_b64_tr_b16 a[76:77], v169 offset:10240
    ds_read_b64_tr_b16 a[78:79], v169 offset:10752
    v_mfma_f32_32x32x16_bf16 a[32:47], a[88:91], v[124:127], a[32:47]
    v_cvt_pk_bf16_f32 v128, v192, v193
    v_cvt_pk_bf16_f32 v129, v194, v195
    v_cvt_pk_bf16_f32 v130, v196, v197
    v_cvt_pk_bf16_f32 v131, v198, v199
    buffer_load_dwordx4 v163, s[16:19], s37 offen offset:1024 lds
    v_mfma_f32_32x32x16_bf16 a[48:63], a[92:95], v[124:127], a[48:63]
    v_cvt_pk_bf16_f32 v132, v200, v201
    v_cvt_pk_bf16_f32 v133, v202, v203
    v_cvt_pk_bf16_f32 v134, v204, v205
    v_cvt_pk_bf16_f32 v135, v206, v207
    s_nop 0
    s_waitcnt lgkmcnt(8)
    v_mfma_f32_32x32x16_bf16 a[0:15], a[96:99], v[128:131], a[0:15]
    s_waitcnt vmcnt(16)
    s_barrier
    ds_read_b64_tr_b16 a[80:81], v168 offset:4096
    ds_read_b64_tr_b16 a[82:83], v168 offset:4608
    ds_read_b64_tr_b16 a[84:85], v169 offset:4096
    ds_read_b64_tr_b16 a[86:87], v169 offset:4608
    v_mfma_f32_32x32x16_bf16 a[16:31], a[100:103], v[128:131], a[16:31]
    ds_read_b64_tr_b16 a[88:89], v168 offset:12288
    ds_read_b64_tr_b16 a[90:91], v168 offset:12800
    ds_read_b64_tr_b16 a[92:93], v169 offset:12288
    ds_read_b64_tr_b16 a[94:95], v169 offset:12800
    v_mfma_f32_32x32x16_bf16 v[208:223], v[240:243], v[136:139], v[224:239]
    v_mfma_f32_32x32x16_bf16 a[32:47], a[104:107], v[128:131], a[32:47]
    s_add_u32 m0, s36, 98304
    s_add_u32 s37, s31, 1327104
    buffer_load_dwordx4 v162, s[12:15], s37 offen lds
    v_mfma_f32_32x32x16_bf16 a[48:63], a[108:111], v[128:131], a[48:63]
    v_mfma_f32_32x32x16_bf16 v[208:223], v[244:247], v[140:143], v[208:223]
    s_waitcnt lgkmcnt(8)
    v_mfma_f32_32x32x16_bf16 a[0:15], a[64:67], v[132:135], a[0:15]
    ds_read_b64_tr_b16 a[96:97], v168 offset:6144
    ds_read_b64_tr_b16 a[98:99], v168 offset:6656
    ds_read_b64_tr_b16 a[100:101], v169 offset:6144
    ds_read_b64_tr_b16 a[102:103], v169 offset:6656
    v_mfma_f32_32x32x16_bf16 a[16:31], a[68:71], v[132:135], a[16:31]
    ds_read_b64_tr_b16 a[104:105], v168 offset:14336
    ds_read_b64_tr_b16 a[106:107], v168 offset:14848
    ds_read_b64_tr_b16 a[108:109], v169 offset:14336
    ds_read_b64_tr_b16 a[110:111], v169 offset:14848
    v_mfma_f32_32x32x16_bf16 a[32:47], a[72:75], v[132:135], a[32:47]
    v_cvt_pk_bf16_f32 v136, v208, v209
    v_cvt_pk_bf16_f32 v137, v210, v211
    v_cvt_pk_bf16_f32 v138, v212, v213
    v_cvt_pk_bf16_f32 v139, v214, v215
    buffer_load_dwordx4 v163, s[12:15], s37 offen offset:1024 lds
    v_mfma_f32_32x32x16_bf16 a[48:63], a[76:79], v[132:135], a[48:63]
    v_cvt_pk_bf16_f32 v140, v216, v217
    v_cvt_pk_bf16_f32 v141, v218, v219
    v_cvt_pk_bf16_f32 v142, v220, v221
    v_cvt_pk_bf16_f32 v143, v222, v223
    s_nop 0
    s_waitcnt lgkmcnt(8)
    v_mfma_f32_32x32x16_bf16 a[0:15], a[80:83], v[136:139], a[0:15]
    ds_read_b64_tr_b16 a[64:65], v168 offset:16384
    ds_read_b64_tr_b16 a[66:67], v168 offset:16896
    ds_read_b64_tr_b16 a[68:69], v169 offset:16384
    ds_read_b64_tr_b16 a[70:71], v169 offset:16896
    v_mfma_f32_32x32x16_bf16 a[16:31], a[84:87], v[136:139], a[16:31]
    ds_read_b64_tr_b16 a[72:73], v168 offset:24576
    ds_read_b64_tr_b16 a[74:75], v168 offset:25088
    ds_read_b64_tr_b16 a[76:77], v169 offset:24576
    ds_read_b64_tr_b16 a[78:79], v169 offset:25088
    v_mfma_f32_32x32x16_bf16 v[192:207], v[240:243], v[144:147], v[224:239]
    v_mfma_f32_32x32x16_bf16 a[32:47], a[88:91], v[136:139], a[32:47]
    s_add_u32 m0, s36, 106496
    s_nop 0
    buffer_load_dwordx4 v162, s[16:19], s37 offen lds
    v_mfma_f32_32x32x16_bf16 a[48:63], a[92:95], v[136:139], a[48:63]
    v_mfma_f32_32x32x16_bf16 v[192:207], v[244:247], v[148:151], v[192:207]
    s_waitcnt lgkmcnt(8)
    v_mfma_f32_32x32x16_bf16 a[0:15], a[96:99], v[140:143], a[0:15]
    ds_read_b64_tr_b16 a[80:81], v168 offset:18432
    ds_read_b64_tr_b16 a[82:83], v168 offset:18944
    ds_read_b64_tr_b16 a[84:85], v169 offset:18432
    ds_read_b64_tr_b16 a[86:87], v169 offset:18944
    v_mfma_f32_32x32x16_bf16 a[16:31], a[100:103], v[140:143], a[16:31]
    ds_read_b64_tr_b16 a[88:89], v168 offset:26624
    ds_read_b64_tr_b16 a[90:91], v168 offset:27136
    ds_read_b64_tr_b16 a[92:93], v169 offset:26624
    ds_read_b64_tr_b16 a[94:95], v169 offset:27136
    v_mfma_f32_32x32x16_bf16 a[32:47], a[104:107], v[140:143], a[32:47]
    v_cvt_pk_bf16_f32 v144, v192, v193
    v_cvt_pk_bf16_f32 v145, v194, v195
    v_cvt_pk_bf16_f32 v146, v196, v197
    v_cvt_pk_bf16_f32 v147, v198, v199
    buffer_load_dwordx4 v163, s[16:19], s37 offen offset:1024 lds
    v_mfma_f32_32x32x16_bf16 a[48:63], a[108:111], v[140:143], a[48:63]
    v_cvt_pk_bf16_f32 v148, v200, v201
    v_cvt_pk_bf16_f32 v149, v202, v203
    v_cvt_pk_bf16_f32 v150, v204, v205
    v_cvt_pk_bf16_f32 v151, v206, v207
    s_nop 0
    s_waitcnt lgkmcnt(8)
    v_mfma_f32_32x32x16_bf16 a[0:15], a[64:67], v[144:147], a[0:15]
    ds_read_b64_tr_b16 a[96:97], v168 offset:20480
    ds_read_b64_tr_b16 a[98:99], v168 offset:20992
    ds_read_b64_tr_b16 a[100:101], v169 offset:20480
    ds_read_b64_tr_b16 a[102:103], v169 offset:20992
    v_mfma_f32_32x32x16_bf16 a[16:31], a[68:71], v[144:147], a[16:31]
    ds_read_b64_tr_b16 a[104:105], v168 offset:28672
    ds_read_b64_tr_b16 a[106:107], v168 offset:29184
    ds_read_b64_tr_b16 a[108:109], v169 offset:28672
    ds_read_b64_tr_b16 a[110:111], v169 offset:29184
    v_mfma_f32_32x32x16_bf16 v[208:223], v[240:243], v[152:155], v[224:239]
    v_mfma_f32_32x32x16_bf16 a[32:47], a[72:75], v[144:147], a[32:47]
    s_add_u32 m0, s36, 114688
    s_add_u32 s37, s31, 1548288
    buffer_load_dwordx4 v162, s[12:15], s37 offen lds
    v_mfma_f32_32x32x16_bf16 a[48:63], a[76:79], v[144:147], a[48:63]
    v_mfma_f32_32x32x16_bf16 v[208:223], v[244:247], v[156:159], v[208:223]
    s_waitcnt lgkmcnt(8)
    v_mfma_f32_32x32x16_bf16 a[0:15], a[80:83], v[148:151], a[0:15]
    ds_read_b64_tr_b16 a[64:65], v168 offset:22528
    ds_read_b64_tr_b16 a[66:67], v168 offset:23040
    ds_read_b64_tr_b16 a[68:69], v169 offset:22528
    ds_read_b64_tr_b16 a[70:71], v169 offset:23040
    v_mfma_f32_32x32x16_bf16 a[16:31], a[84:87], v[148:151], a[16:31]
    ds_read_b64_tr_b16 a[72:73], v168 offset:30720
    ds_read_b64_tr_b16 a[74:75], v168 offset:31232
    ds_read_b64_tr_b16 a[76:77], v169 offset:30720
    ds_read_b64_tr_b16 a[78:79], v169 offset:31232
    v_mfma_f32_32x32x16_bf16 a[32:47], a[88:91], v[148:151], a[32:47]
    v_cvt_pk_bf16_f32 v152, v208, v209
    v_cvt_pk_bf16_f32 v153, v210, v211
    v_cvt_pk_bf16_f32 v154, v212, v213
    v_cvt_pk_bf16_f32 v155, v214, v215
    buffer_load_dwordx4 v163, s[12:15], s37 offen offset:1024 lds
    v_mfma_f32_32x32x16_bf16 a[48:63], a[92:95], v[148:151], a[48:63]
    v_cvt_pk_bf16_f32 v156, v216, v217
    v_cvt_pk_bf16_f32 v157, v218, v219
    v_cvt_pk_bf16_f32 v158, v220, v221
    v_cvt_pk_bf16_f32 v159, v222, v223
    s_nop 0
    s_waitcnt lgkmcnt(8)
    v_mfma_f32_32x32x16_bf16 a[0:15], a[96:99], v[152:155], a[0:15]
    ds_read_b64_tr_b16 a[80:81], v164 offset:0
    ds_read_b64_tr_b16 a[82:83], v164 offset:512
    ds_read_b64_tr_b16 a[84:85], v165 offset:0
    ds_read_b64_tr_b16 a[86:87], v165 offset:512
    v_mfma_f32_32x32x16_bf16 a[16:31], a[100:103], v[152:155], a[16:31]
    ds_read_b64_tr_b16 a[88:89], v164 offset:8192
    ds_read_b64_tr_b16 a[90:91], v164 offset:8704
    ds_read_b64_tr_b16 a[92:93], v165 offset:8192
    ds_read_b64_tr_b16 a[94:95], v165 offset:8704
    v_mfma_f32_32x32x16_bf16 a[32:47], a[104:107], v[152:155], a[32:47]
    s_add_u32 m0, s36, 122880
    s_nop 0
    buffer_load_dwordx4 v162, s[16:19], s37 offen lds
    v_mfma_f32_32x32x16_bf16 a[48:63], a[108:111], v[152:155], a[48:63]
    s_waitcnt lgkmcnt(8)
    v_mfma_f32_32x32x16_bf16 a[0:15], a[64:67], v[156:159], a[0:15]
    ds_read_b64_tr_b16 a[96:97], v164 offset:2048
    ds_read_b64_tr_b16 a[98:99], v164 offset:2560
    ds_read_b64_tr_b16 a[100:101], v165 offset:2048
    ds_read_b64_tr_b16 a[102:103], v165 offset:2560
    v_mfma_f32_32x32x16_bf16 a[16:31], a[68:71], v[156:159], a[16:31]
    ds_read_b64_tr_b16 a[104:105], v164 offset:10240
    ds_read_b64_tr_b16 a[106:107], v164 offset:10752
    ds_read_b64_tr_b16 a[108:109], v165 offset:10240
    ds_read_b64_tr_b16 a[110:111], v165 offset:10752
    v_mfma_f32_32x32x16_bf16 a[32:47], a[72:75], v[156:159], a[32:47]
    buffer_load_dwordx4 v163, s[16:19], s37 offen offset:1024 lds
    v_mfma_f32_32x32x16_bf16 a[48:63], a[76:79], v[156:159], a[48:63]
    s_waitcnt lgkmcnt(8)
    v_mfma_f32_32x32x16_bf16 v[192:207], a[80:83], v[0:3], 0
    s_waitcnt vmcnt(16)
    s_barrier
    ds_read_b64_tr_b16 a[64:65], v164 offset:4096
    ds_read_b64_tr_b16 a[66:67], v164 offset:4608
    ds_read_b64_tr_b16 a[68:69], v165 offset:4096
    ds_read_b64_tr_b16 a[70:71], v165 offset:4608
    v_mfma_f32_32x32x16_bf16 v[208:223], a[84:87], v[0:3], 0
    ds_read_b64_tr_b16 a[72:73], v164 offset:12288
    ds_read_b64_tr_b16 a[74:75], v164 offset:12800
    ds_read_b64_tr_b16 a[76:77], v165 offset:12288
    ds_read_b64_tr_b16 a[78:79], v165 offset:12800
    v_mfma_f32_32x32x16_bf16 v[224:239], a[88:91], v[0:3], 0
    s_add_u32 m0, s36, 131072
    s_add_u32 s37, s31, 1769472
    buffer_load_dwordx4 v162, s[12:15], s37 offen lds
    v_mfma_f32_32x32x16_bf16 v[240:255], a[92:95], v[0:3], 0
    s_waitcnt lgkmcnt(8)
    v_mfma_f32_32x32x16_bf16 v[192:207], a[96:99], v[4:7], v[192:207]
    ds_read_b64_tr_b16 a[80:81], v164 offset:6144
    ds_read_b64_tr_b16 a[82:83], v164 offset:6656
    ds_read_b64_tr_b16 a[84:85], v165 offset:6144
    ds_read_b64_tr_b16 a[86:87], v165 offset:6656
    v_mfma_f32_32x32x16_bf16 v[208:223], a[100:103], v[4:7], v[208:223]
    ds_read_b64_tr_b16 a[88:89], v164 offset:14336
    ds_read_b64_tr_b16 a[90:91], v164 offset:14848
    ds_read_b64_tr_b16 a[92:93], v165 offset:14336
    ds_read_b64_tr_b16 a[94:95], v165 offset:14848
    v_accvgpr_read_b32 v174, a0
    v_mfma_f32_32x32x16_bf16 v[224:239], a[104:107], v[4:7], v[224:239]
    buffer_load_dwordx4 v163, s[12:15], s37 offen offset:1024 lds
    v_accvgpr_read_b32 v175, a1
    v_accvgpr_read_b32 v176, a2
    v_accvgpr_read_b32 v177, a3
    v_mfma_f32_32x32x16_bf16 v[240:255], a[108:111], v[4:7], v[240:255]
    v_accvgpr_read_b32 v178, a4
    v_accvgpr_read_b32 v179, a5
    v_accvgpr_read_b32 v180, a6
    s_waitcnt lgkmcnt(8)
    v_mfma_f32_32x32x16_bf16 v[192:207], a[64:67], v[8:11], v[192:207]
    ds_read_b64_tr_b16 a[96:97], v164 offset:16384
    ds_read_b64_tr_b16 a[98:99], v164 offset:16896
    ds_read_b64_tr_b16 a[100:101], v165 offset:16384
    ds_read_b64_tr_b16 a[102:103], v165 offset:16896
    v_accvgpr_read_b32 v181, a7
    v_mfma_f32_32x32x16_bf16 v[208:223], a[68:71], v[8:11], v[208:223]
    ds_read_b64_tr_b16 a[104:105], v164 offset:24576
    ds_read_b64_tr_b16 a[106:107], v164 offset:25088
    ds_read_b64_tr_b16 a[108:109], v165 offset:24576
    ds_read_b64_tr_b16 a[110:111], v165 offset:25088
    v_mul_f32 v174, v191, v174
    v_mfma_f32_32x32x16_bf16 v[224:239], a[72:75], v[8:11], v[224:239]
    s_add_u32 m0, s36, 139264
    s_nop 0
    buffer_load_dwordx4 v162, s[16:19], s37 offen lds
    v_mul_f32 v175, v191, v175
    v_mul_f32 v176, v191, v176
    v_mul_f32 v177, v191, v177
    v_mfma_f32_32x32x16_bf16 v[240:255], a[76:79], v[8:11], v[240:255]
    v_mul_f32 v178, v191, v178
    v_mul_f32 v179, v191, v179
    v_mul_f32 v180, v191, v180
    s_waitcnt lgkmcnt(8)
    v_mfma_f32_32x32x16_bf16 v[192:207], a[80:83], v[12:15], v[192:207]
    ds_read_b64_tr_b16 a[64:65], v164 offset:18432
    ds_read_b64_tr_b16 a[66:67], v164 offset:18944
    ds_read_b64_tr_b16 a[68:69], v165 offset:18432
    ds_read_b64_tr_b16 a[70:71], v165 offset:18944
    v_mul_f32 v181, v191, v181
    v_mfma_f32_32x32x16_bf16 v[208:223], a[84:87], v[12:15], v[208:223]
    ds_read_b64_tr_b16 a[72:73], v164 offset:26624
    ds_read_b64_tr_b16 a[74:75], v164 offset:27136
    ds_read_b64_tr_b16 a[76:77], v165 offset:26624
    ds_read_b64_tr_b16 a[78:79], v165 offset:27136
    v_cvt_pk_bf16_f32 v182, v174, v175
    v_mfma_f32_32x32x16_bf16 v[224:239], a[88:91], v[12:15], v[224:239]
    buffer_load_dwordx4 v163, s[16:19], s37 offen offset:1024 lds
    v_cvt_pk_bf16_f32 v183, v176, v177
    v_cvt_pk_bf16_f32 v184, v178, v179
    v_cvt_pk_bf16_f32 v185, v180, v181
    v_mfma_f32_32x32x16_bf16 v[240:255], a[92:95], v[12:15], v[240:255]
    s_add_u32 s42, s33, 0
    buffer_store_dwordx4 v[182:185], v170, s[20:23], s42 offen sc1
    v_accvgpr_read_b32 v174, a8
    v_accvgpr_read_b32 v175, a9
    s_waitcnt lgkmcnt(8)
    v_mfma_f32_32x32x16_bf16 v[192:207], a[96:99], v[16:19], v[192:207]
    ds_read_b64_tr_b16 a[80:81], v164 offset:20480
    ds_read_b64_tr_b16 a[82:83], v164 offset:20992
    ds_read_b64_tr_b16 a[84:85], v165 offset:20480
    ds_read_b64_tr_b16 a[86:87], v165 offset:20992
    v_accvgpr_read_b32 v176, a10
    v_mfma_f32_32x32x16_bf16 v[208:223], a[100:103], v[16:19], v[208:223]
    ds_read_b64_tr_b16 a[88:89], v164 offset:28672
    ds_read_b64_tr_b16 a[90:91], v164 offset:29184
    ds_read_b64_tr_b16 a[92:93], v165 offset:28672
    ds_read_b64_tr_b16 a[94:95], v165 offset:29184
    v_accvgpr_read_b32 v177, a11
    v_mfma_f32_32x32x16_bf16 v[224:239], a[104:107], v[16:19], v[224:239]
    s_add_u32 m0, s36, 147456
    s_add_u32 s37, s31, 1990656
    buffer_load_dwordx4 v162, s[12:15], s37 offen lds
    v_accvgpr_read_b32 v178, a12
    v_accvgpr_read_b32 v179, a13
    v_accvgpr_read_b32 v180, a14
    v_mfma_f32_32x32x16_bf16 v[240:255], a[108:111], v[16:19], v[240:255]
    v_accvgpr_read_b32 v181, a15
    v_mul_f32 v174, v191, v174
    v_mul_f32 v175, v191, v175
    s_waitcnt lgkmcnt(8)
    v_mfma_f32_32x32x16_bf16 v[192:207], a[64:67], v[20:23], v[192:207]
    ds_read_b64_tr_b16 a[96:97], v164 offset:22528
    ds_read_b64_tr_b16 a[98:99], v164 offset:23040
    ds_read_b64_tr_b16 a[100:101], v165 offset:22528
    ds_read_b64_tr_b16 a[102:103], v165 offset:23040
    v_mul_f32 v176, v191, v176
    v_mfma_f32_32x32x16_bf16 v[208:223], a[68:71], v[20:23], v[208:223]
    ds_read_b64_tr_b16 a[104:105], v164 offset:30720
    ds_read_b64_tr_b16 a[106:107], v164 offset:31232
    ds_read_b64_tr_b16 a[108:109], v165 offset:30720
    ds_read_b64_tr_b16 a[110:111], v165 offset:31232
    v_mul_f32 v177, v191, v177
    v_mfma_f32_32x32x16_bf16 v[224:239], a[72:75], v[20:23], v[224:239]
    buffer_load_dwordx4 v163, s[12:15], s37 offen offset:1024 lds
    v_mul_f32 v178, v191, v178
    v_mul_f32 v179, v191, v179
    v_mul_f32 v180, v191, v180
    v_mfma_f32_32x32x16_bf16 v[240:255], a[76:79], v[20:23], v[240:255]
    v_mul_f32 v181, v191, v181
    v_cvt_pk_bf16_f32 v186, v174, v175
    v_cvt_pk_bf16_f32 v187, v176, v177
    s_waitcnt lgkmcnt(8)
    v_mfma_f32_32x32x16_bf16 v[192:207], a[80:83], v[24:27], v[192:207]
    ds_read_b64_tr_b16 a[64:65], v164 offset:32768
    ds_read_b64_tr_b16 a[66:67], v164 offset:33280
    ds_read_b64_tr_b16 a[68:69], v165 offset:32768
    ds_read_b64_tr_b16 a[70:71], v165 offset:33280
    v_cvt_pk_bf16_f32 v188, v178, v179
    v_mfma_f32_32x32x16_bf16 v[208:223], a[84:87], v[24:27], v[208:223]
    ds_read_b64_tr_b16 a[72:73], v164 offset:40960
    ds_read_b64_tr_b16 a[74:75], v164 offset:41472
    ds_read_b64_tr_b16 a[76:77], v165 offset:40960
    ds_read_b64_tr_b16 a[78:79], v165 offset:41472
    v_cvt_pk_bf16_f32 v189, v180, v181
    v_mfma_f32_32x32x16_bf16 v[224:239], a[88:91], v[24:27], v[224:239]
    s_add_u32 m0, s36, 155648
    s_nop 0
    buffer_load_dwordx4 v162, s[16:19], s37 offen lds
    s_add_u32 s42, s33, 1024
    buffer_store_dwordx4 v[186:189], v170, s[20:23], s42 offen sc1
    v_accvgpr_read_b32 v174, a16
    v_accvgpr_read_b32 v175, a17
    v_mfma_f32_32x32x16_bf16 v[240:255], a[92:95], v[24:27], v[240:255]
    v_accvgpr_read_b32 v176, a18
    v_accvgpr_read_b32 v177, a19
    v_accvgpr_read_b32 v178, a20
    s_waitcnt lgkmcnt(8)
    v_mfma_f32_32x32x16_bf16 v[192:207], a[96:99], v[28:31], v[192:207]
    ds_read_b64_tr_b16 a[80:81], v164 offset:34816
    ds_read_b64_tr_b16 a[82:83], v164 offset:35328
    ds_read_b64_tr_b16 a[84:85], v165 offset:34816
    ds_read_b64_tr_b16 a[86:87], v165 offset:35328
    v_accvgpr_read_b32 v179, a21
    v_mfma_f32_32x32x16_bf16 v[208:223], a[100:103], v[28:31], v[208:223]
    ds_read_b64_tr_b16 a[88:89], v164 offset:43008
    ds_read_b64_tr_b16 a[90:91], v164 offset:43520
    ds_read_b64_tr_b16 a[92:93], v165 offset:43008
    ds_read_b64_tr_b16 a[94:95], v165 offset:43520
    v_accvgpr_read_b32 v180, a22
    v_mfma_f32_32x32x16_bf16 v[224:239], a[104:107], v[28:31], v[224:239]
    buffer_load_dwordx4 v163, s[16:19], s37 offen offset:1024 lds
    v_accvgpr_read_b32 v181, a23
    v_mul_f32 v174, v191, v174
    v_mul_f32 v175, v191, v175
    v_mfma_f32_32x32x16_bf16 v[240:255], a[108:111], v[28:31], v[240:255]
    v_mul_f32 v176, v191, v176
    v_mul_f32 v177, v191, v177
    v_mul_f32 v178, v191, v178
    s_waitcnt lgkmcnt(8)
    v_mfma_f32_32x32x16_bf16 v[192:207], a[64:67], v[32:35], v[192:207]
    s_waitcnt vmcnt(18)
    s_barrier
    ds_read_b64_tr_b16 a[96:97], v164 offset:36864
    ds_read_b64_tr_b16 a[98:99], v164 offset:37376
    ds_read_b64_tr_b16 a[100:101], v165 offset:36864
    ds_read_b64_tr_b16 a[102:103], v165 offset:37376
    v_mul_f32 v179, v191, v179
    v_mfma_f32_32x32x16_bf16 v[208:223], a[68:71], v[32:35], v[208:223]
    ds_read_b64_tr_b16 a[104:105], v164 offset:45056
    ds_read_b64_tr_b16 a[106:107], v164 offset:45568
    ds_read_b64_tr_b16 a[108:109], v165 offset:45056
    ds_read_b64_tr_b16 a[110:111], v165 offset:45568
    v_mul_f32 v180, v191, v180
    v_mfma_f32_32x32x16_bf16 v[224:239], a[72:75], v[32:35], v[224:239]
    s_add_u32 m0, s36, 0
    s_add_u32 s37, s32, 0
    buffer_load_dwordx4 v162, s[12:15], s37 offen lds
    v_mul_f32 v181, v191, v181
    v_cvt_pk_bf16_f32 v182, v174, v175
    v_cvt_pk_bf16_f32 v183, v176, v177
    v_mfma_f32_32x32x16_bf16 v[240:255], a[76:79], v[32:35], v[240:255]
    v_cvt_pk_bf16_f32 v184, v178, v179
    v_cvt_pk_bf16_f32 v185, v180, v181
    s_add_u32 s42, s33, 2048
    buffer_store_dwordx4 v[182:185], v170, s[20:23], s42 offen sc1
    s_waitcnt lgkmcnt(8)
    v_mfma_f32_32x32x16_bf16 v[192:207], a[80:83], v[36:39], v[192:207]
    ds_read_b64_tr_b16 a[64:65], v164 offset:38912
    ds_read_b64_tr_b16 a[66:67], v164 offset:39424
    ds_read_b64_tr_b16 a[68:69], v165 offset:38912
    ds_read_b64_tr_b16 a[70:71], v165 offset:39424
    v_accvgpr_read_b32 v174, a24
    v_mfma_f32_32x32x16_bf16 v[208:223], a[84:87], v[36:39], v[208:223]
    ds_read_b64_tr_b16 a[72:73], v164 offset:47104
    ds_read_b64_tr_b16 a[74:75], v164 offset:47616
    ds_read_b64_tr_b16 a[76:77], v165 offset:47104
    ds_read_b64_tr_b16 a[78:79], v165 offset:47616
    v_accvgpr_read_b32 v175, a25
    v_mfma_f32_32x32x16_bf16 v[224:239], a[88:91], v[36:39], v[224:239]
    buffer_load_dwordx4 v163, s[12:15], s37 offen offset:1024 lds
    v_accvgpr_read_b32 v176, a26
    v_accvgpr_read_b32 v177, a27
    v_accvgpr_read_b32 v178, a28
    v_mfma_f32_32x32x16_bf16 v[240:255], a[92:95], v[36:39], v[240:255]
    v_accvgpr_read_b32 v179, a29
    v_accvgpr_read_b32 v180, a30
    v_accvgpr_read_b32 v181, a31
    s_waitcnt lgkmcnt(8)
    v_mfma_f32_32x32x16_bf16 v[192:207], a[96:99], v[40:43], v[192:207]
    ds_read_b64_tr_b16 a[80:81], v164 offset:49152
    ds_read_b64_tr_b16 a[82:83], v164 offset:49664
    ds_read_b64_tr_b16 a[84:85], v165 offset:49152
    ds_read_b64_tr_b16 a[86:87], v165 offset:49664
    v_mul_f32 v174, v191, v174
    v_mfma_f32_32x32x16_bf16 v[208:223], a[100:103], v[40:43], v[208:223]
    ds_read_b64_tr_b16 a[88:89], v164 offset:57344
    ds_read_b64_tr_b16 a[90:91], v164 offset:57856
    ds_read_b64_tr_b16 a[92:93], v165 offset:57344
    ds_read_b64_tr_b16 a[94:95], v165 offset:57856
    v_mul_f32 v175, v191, v175
    v_mfma_f32_32x32x16_bf16 v[224:239], a[104:107], v[40:43], v[224:239]
    s_add_u32 m0, s36, 8192
    s_nop 0
    buffer_load_dwordx4 v162, s[16:19], s37 offen lds
    v_mul_f32 v176, v191, v176
    v_mul_f32 v177, v191, v177
    v_mul_f32 v178, v191, v178
    v_mfma_f32_32x32x16_bf16 v[240:255], a[108:111], v[40:43], v[240:255]
    v_mul_f32 v179, v191, v179
    v_mul_f32 v180, v191, v180
    v_mul_f32 v181, v191, v181
    s_waitcnt lgkmcnt(8)
    v_mfma_f32_32x32x16_bf16 v[192:207], a[64:67], v[44:47], v[192:207]
    ds_read_b64_tr_b16 a[96:97], v164 offset:51200
    ds_read_b64_tr_b16 a[98:99], v164 offset:51712
    ds_read_b64_tr_b16 a[100:101], v165 offset:51200
    ds_read_b64_tr_b16 a[102:103], v165 offset:51712
    v_cvt_pk_bf16_f32 v186, v174, v175
    v_mfma_f32_32x32x16_bf16 v[208:223], a[68:71], v[44:47], v[208:223]
    ds_read_b64_tr_b16 a[104:105], v164 offset:59392
    ds_read_b64_tr_b16 a[106:107], v164 offset:59904
    ds_read_b64_tr_b16 a[108:109], v165 offset:59392
    ds_read_b64_tr_b16 a[110:111], v165 offset:59904
    v_cvt_pk_bf16_f32 v187, v176, v177
    v_mfma_f32_32x32x16_bf16 v[224:239], a[72:75], v[44:47], v[224:239]
    buffer_load_dwordx4 v163, s[16:19], s37 offen offset:1024 lds
    v_cvt_pk_bf16_f32 v188, v178, v179
    v_cvt_pk_bf16_f32 v189, v180, v181
    s_add_u32 s42, s33, 3072
    buffer_store_dwordx4 v[186:189], v170, s[20:23], s42 offen sc1
    v_mfma_f32_32x32x16_bf16 v[240:255], a[76:79], v[44:47], v[240:255]
    v_accvgpr_read_b32 v174, a32
    v_accvgpr_read_b32 v175, a33
    s_waitcnt lgkmcnt(8)
    v_mfma_f32_32x32x16_bf16 v[192:207], a[80:83], v[48:51], v[192:207]
    ds_read_b64_tr_b16 a[64:65], v164 offset:53248
    ds_read_b64_tr_b16 a[66:67], v164 offset:53760
    ds_read_b64_tr_b16 a[68:69], v165 offset:53248
    ds_read_b64_tr_b16 a[70:71], v165 offset:53760
    v_accvgpr_read_b32 v176, a34
    v_mfma_f32_32x32x16_bf16 v[208:223], a[84:87], v[48:51], v[208:223]
    ds_read_b64_tr_b16 a[72:73], v164 offset:61440
    ds_read_b64_tr_b16 a[74:75], v164 offset:61952
    ds_read_b64_tr_b16 a[76:77], v165 offset:61440
    ds_read_b64_tr_b16 a[78:79], v165 offset:61952
    v_accvgpr_read_b32 v177, a35
    v_mfma_f32_32x32x16_bf16 v[224:239], a[88:91], v[48:51], v[224:239]
    s_add_u32 m0, s36, 16384
    s_add_u32 s37, s32, 221184
    buffer_load_dwordx4 v162, s[12:15], s37 offen lds
    v_accvgpr_read_b32 v178, a36
    v_accvgpr_read_b32 v179, a37
    v_accvgpr_read_b32 v180, a38
    v_mfma_f32_32x32x16_bf16 v[240:255], a[92:95], v[48:51], v[240:255]
    v_accvgpr_read_b32 v181, a39
    v_mul_f32 v174, v191, v174
    v_mul_f32 v175, v191, v175
    s_waitcnt lgkmcnt(8)
    v_mfma_f32_32x32x16_bf16 v[192:207], a[96:99], v[52:55], v[192:207]
    ds_read_b64_tr_b16 a[80:81], v164 offset:55296
    ds_read_b64_tr_b16 a[82:83], v164 offset:55808
    ds_read_b64_tr_b16 a[84:85], v165 offset:55296
    ds_read_b64_tr_b16 a[86:87], v165 offset:55808
    v_mul_f32 v176, v191, v176
    v_mfma_f32_32x32x16_bf16 v[208:223], a[100:103], v[52:55], v[208:223]
    ds_read_b64_tr_b16 a[88:89], v164 offset:63488
    ds_read_b64_tr_b16 a[90:91], v164 offset:64000
    ds_read_b64_tr_b16 a[92:93], v165 offset:63488
    ds_read_b64_tr_b16 a[94:95], v165 offset:64000
    v_mul_f32 v177, v191, v177
    v_mfma_f32_32x32x16_bf16 v[224:239], a[104:107], v[52:55], v[224:239]
    buffer_load_dwordx4 v163, s[12:15], s37 offen offset:1024 lds
    v_mul_f32 v178, v191, v178
    v_mul_f32 v179, v191, v179
    v_mul_f32 v180, v191, v180
    v_mfma_f32_32x32x16_bf16 v[240:255], a[108:111], v[52:55], v[240:255]
    v_mul_f32 v181, v191, v181
    v_cvt_pk_bf16_f32 v182, v174, v175
    v_cvt_pk_bf16_f32 v183, v176, v177
    s_waitcnt lgkmcnt(8)
    v_mfma_f32_32x32x16_bf16 v[192:207], a[64:67], v[56:59], v[192:207]
    ds_read_b64_tr_b16 a[96:97], v166 offset:0
    ds_read_b64_tr_b16 a[98:99], v166 offset:512
    ds_read_b64_tr_b16 a[100:101], v167 offset:0
    ds_read_b64_tr_b16 a[102:103], v167 offset:512
    v_cvt_pk_bf16_f32 v184, v178, v179
    v_mfma_f32_32x32x16_bf16 v[208:223], a[68:71], v[56:59], v[208:223]
    ds_read_b64_tr_b16 a[104:105], v166 offset:8192
    ds_read_b64_tr_b16 a[106:107], v166 offset:8704
    ds_read_b64_tr_b16 a[108:109], v167 offset:8192
    ds_read_b64_tr_b16 a[110:111], v167 offset:8704
    v_cvt_pk_bf16_f32 v185, v180, v181
    v_mfma_f32_32x32x16_bf16 v[224:239], a[72:75], v[56:59], v[224:239]
    s_add_u32 m0, s36, 24576
    s_nop 0
    buffer_load_dwordx4 v162, s[16:19], s37 offen lds
    s_add_u32 s42, s33, 4096
    buffer_store_dwordx4 v[182:185], v170, s[20:23], s42 offen sc1
    v_accvgpr_read_b32 v174, a40
    v_accvgpr_read_b32 v175, a41
    v_mfma_f32_32x32x16_bf16 v[240:255], a[76:79], v[56:59], v[240:255]
    v_accvgpr_read_b32 v176, a42
    v_accvgpr_read_b32 v177, a43
    v_accvgpr_read_b32 v178, a44
    s_waitcnt lgkmcnt(8)
    v_mfma_f32_32x32x16_bf16 v[192:207], a[80:83], v[60:63], v[192:207]
    ds_read_b64_tr_b16 a[64:65], v166 offset:2048
    ds_read_b64_tr_b16 a[66:67], v166 offset:2560
    ds_read_b64_tr_b16 a[68:69], v167 offset:2048
    ds_read_b64_tr_b16 a[70:71], v167 offset:2560
    v_accvgpr_read_b32 v179, a45
    v_mfma_f32_32x32x16_bf16 v[208:223], a[84:87], v[60:63], v[208:223]
    ds_read_b64_tr_b16 a[72:73], v166 offset:10240
    ds_read_b64_tr_b16 a[74:75], v166 offset:10752
    ds_read_b64_tr_b16 a[76:77], v167 offset:10240
    ds_read_b64_tr_b16 a[78:79], v167 offset:10752
    v_accvgpr_read_b32 v180, a46
    v_mfma_f32_32x32x16_bf16 v[224:239], a[88:91], v[60:63], v[224:239]
    buffer_load_dwordx4 v163, s[16:19], s37 offen offset:1024 lds
    v_accvgpr_read_b32 v181, a47
    v_mul_f32 v174, v191, v174
    v_mul_f32 v175, v191, v175
    v_mfma_f32_32x32x16_bf16 v[240:255], a[92:95], v[60:63], v[240:255]
    v_mul_f32 v176, v191, v176
    v_mul_f32 v177, v191, v177
    v_mul_f32 v178, v191, v178
    s_waitcnt lgkmcnt(8)
    v_mfma_f32_32x32x16_bf16 v[192:207], a[96:99], v[64:67], v[192:207]
    s_waitcnt vmcnt(21)
    s_barrier
    ds_read_b64_tr_b16 a[80:81], v166 offset:4096
    ds_read_b64_tr_b16 a[82:83], v166 offset:4608
    ds_read_b64_tr_b16 a[84:85], v167 offset:4096
    ds_read_b64_tr_b16 a[86:87], v167 offset:4608
    v_mul_f32 v179, v191, v179
    v_mfma_f32_32x32x16_bf16 v[208:223], a[100:103], v[64:67], v[208:223]
    ds_read_b64_tr_b16 a[88:89], v166 offset:12288
    ds_read_b64_tr_b16 a[90:91], v166 offset:12800
    ds_read_b64_tr_b16 a[92:93], v167 offset:12288
    ds_read_b64_tr_b16 a[94:95], v167 offset:12800
    v_mul_f32 v180, v191, v180
    v_mfma_f32_32x32x16_bf16 v[224:239], a[104:107], v[64:67], v[224:239]
    s_add_u32 m0, s36, 32768
    s_add_u32 s37, s32, 442368
    buffer_load_dwordx4 v162, s[12:15], s37 offen lds
    v_mul_f32 v181, v191, v181
    v_cvt_pk_bf16_f32 v186, v174, v175
    v_cvt_pk_bf16_f32 v187, v176, v177
    v_mfma_f32_32x32x16_bf16 v[240:255], a[108:111], v[64:67], v[240:255]
    v_cvt_pk_bf16_f32 v188, v178, v179
    v_cvt_pk_bf16_f32 v189, v180, v181
    s_add_u32 s42, s33, 5120
    buffer_store_dwordx4 v[186:189], v170, s[20:23], s42 offen sc1
    s_waitcnt lgkmcnt(8)
    v_mfma_f32_32x32x16_bf16 v[192:207], a[64:67], v[68:71], v[192:207]
    ds_read_b64_tr_b16 a[96:97], v166 offset:6144
    ds_read_b64_tr_b16 a[98:99], v166 offset:6656
    ds_read_b64_tr_b16 a[100:101], v167 offset:6144
    ds_read_b64_tr_b16 a[102:103], v167 offset:6656
    v_accvgpr_read_b32 v174, a48
    v_mfma_f32_32x32x16_bf16 v[208:223], a[68:71], v[68:71], v[208:223]
    ds_read_b64_tr_b16 a[104:105], v166 offset:14336
    ds_read_b64_tr_b16 a[106:107], v166 offset:14848
    ds_read_b64_tr_b16 a[108:109], v167 offset:14336
    ds_read_b64_tr_b16 a[110:111], v167 offset:14848
    v_accvgpr_read_b32 v175, a49
    v_mfma_f32_32x32x16_bf16 v[224:239], a[72:75], v[68:71], v[224:239]
    buffer_load_dwordx4 v163, s[12:15], s37 offen offset:1024 lds
    v_accvgpr_read_b32 v176, a50
    v_accvgpr_read_b32 v177, a51
    v_accvgpr_read_b32 v178, a52
    v_mfma_f32_32x32x16_bf16 v[240:255], a[76:79], v[68:71], v[240:255]
    v_accvgpr_read_b32 v179, a53
    v_accvgpr_read_b32 v180, a54
    v_accvgpr_read_b32 v181, a55
    s_waitcnt lgkmcnt(8)
    v_mfma_f32_32x32x16_bf16 v[192:207], a[80:83], v[72:75], v[192:207]
    ds_read_b64_tr_b16 a[64:65], v166 offset:16384
    ds_read_b64_tr_b16 a[66:67], v166 offset:16896
    ds_read_b64_tr_b16 a[68:69], v167 offset:16384
    ds_read_b64_tr_b16 a[70:71], v167 offset:16896
    v_mul_f32 v174, v191, v174
    v_mfma_f32_32x32x16_bf16 v[208:223], a[84:87], v[72:75], v[208:223]
    ds_read_b64_tr_b16 a[72:73], v166 offset:24576
    ds_read_b64_tr_b16 a[74:75], v166 offset:25088
    ds_read_b64_tr_b16 a[76:77], v167 offset:24576
    ds_read_b64_tr_b16 a[78:79], v167 offset:25088
    v_mul_f32 v175, v191, v175
    v_mfma_f32_32x32x16_bf16 v[224:239], a[88:91], v[72:75], v[224:239]
    s_add_u32 m0, s36, 40960
    s_nop 0
    buffer_load_dwordx4 v162, s[16:19], s37 offen lds
    v_mul_f32 v176, v191, v176
    v_mul_f32 v177, v191, v177
    v_mul_f32 v178, v191, v178
    v_mfma_f32_32x32x16_bf16 v[240:255], a[92:95], v[72:75], v[240:255]
    v_mul_f32 v179, v191, v179
    v_mul_f32 v180, v191, v180
    v_mul_f32 v181, v191, v181
    s_waitcnt lgkmcnt(8)
    v_mfma_f32_32x32x16_bf16 v[192:207], a[96:99], v[76:79], v[192:207]
    ds_read_b64_tr_b16 a[80:81], v166 offset:18432
    ds_read_b64_tr_b16 a[82:83], v166 offset:18944
    ds_read_b64_tr_b16 a[84:85], v167 offset:18432
    ds_read_b64_tr_b16 a[86:87], v167 offset:18944
    v_cvt_pk_bf16_f32 v182, v174, v175
    v_mfma_f32_32x32x16_bf16 v[208:223], a[100:103], v[76:79], v[208:223]
    ds_read_b64_tr_b16 a[88:89], v166 offset:26624
    ds_read_b64_tr_b16 a[90:91], v166 offset:27136
    ds_read_b64_tr_b16 a[92:93], v167 offset:26624
    ds_read_b64_tr_b16 a[94:95], v167 offset:27136
    v_cvt_pk_bf16_f32 v183, v176, v177
    v_mfma_f32_32x32x16_bf16 v[224:239], a[104:107], v[76:79], v[224:239]
    buffer_load_dwordx4 v163, s[16:19], s37 offen offset:1024 lds
    v_cvt_pk_bf16_f32 v184, v178, v179
    v_cvt_pk_bf16_f32 v185, v180, v181
    s_add_u32 s42, s33, 6144
    buffer_store_dwordx4 v[182:185], v170, s[20:23], s42 offen sc1
    v_mfma_f32_32x32x16_bf16 v[240:255], a[108:111], v[76:79], v[240:255]
    v_accvgpr_read_b32 v174, a56
    v_accvgpr_read_b32 v175, a57
    v_accvgpr_read_b32 v176, a58
    s_waitcnt lgkmcnt(8)
    v_mfma_f32_32x32x16_bf16 v[192:207], a[64:67], v[80:83], v[192:207]
    ds_read_b64_tr_b16 a[96:97], v166 offset:20480
    ds_read_b64_tr_b16 a[98:99], v166 offset:20992
    ds_read_b64_tr_b16 a[100:101], v167 offset:20480
    ds_read_b64_tr_b16 a[102:103], v167 offset:20992
    v_accvgpr_read_b32 v177, a59
    v_mfma_f32_32x32x16_bf16 v[208:223], a[68:71], v[80:83], v[208:223]
    ds_read_b64_tr_b16 a[104:105], v166 offset:28672
    ds_read_b64_tr_b16 a[106:107], v166 offset:29184
    ds_read_b64_tr_b16 a[108:109], v167 offset:28672
    ds_read_b64_tr_b16 a[110:111], v167 offset:29184
    v_accvgpr_read_b32 v178, a60
    v_mfma_f32_32x32x16_bf16 v[224:239], a[72:75], v[80:83], v[224:239]
    s_add_u32 m0, s36, 49152
    s_add_u32 s37, s32, 663552
    buffer_load_dwordx4 v162, s[12:15], s37 offen lds
    v_accvgpr_read_b32 v179, a61
    v_accvgpr_read_b32 v180, a62
    v_accvgpr_read_b32 v181, a63
    v_mfma_f32_32x32x16_bf16 v[240:255], a[76:79], v[80:83], v[240:255]
    v_mul_f32 v174, v191, v174
    v_mul_f32 v175, v191, v175
    v_mul_f32 v176, v191, v176
    s_waitcnt lgkmcnt(8)
    v_mfma_f32_32x32x16_bf16 v[192:207], a[80:83], v[84:87], v[192:207]
    ds_read_b64_tr_b16 a[64:65], v166 offset:22528
    ds_read_b64_tr_b16 a[66:67], v166 offset:23040
    ds_read_b64_tr_b16 a[68:69], v167 offset:22528
    ds_read_b64_tr_b16 a[70:71], v167 offset:23040
    v_mul_f32 v177, v191, v177
    v_mfma_f32_32x32x16_bf16 v[208:223], a[84:87], v[84:87], v[208:223]
    ds_read_b64_tr_b16 a[72:73], v166 offset:30720
    ds_read_b64_tr_b16 a[74:75], v166 offset:31232
    ds_read_b64_tr_b16 a[76:77], v167 offset:30720
    ds_read_b64_tr_b16 a[78:79], v167 offset:31232
    v_mul_f32 v178, v191, v178
    v_mfma_f32_32x32x16_bf16 v[224:239], a[88:91], v[84:87], v[224:239]
    buffer_load_dwordx4 v163, s[12:15], s37 offen offset:1024 lds
    v_mul_f32 v179, v191, v179
    v_mul_f32 v180, v191, v180
    v_mul_f32 v181, v191, v181
    v_mfma_f32_32x32x16_bf16 v[240:255], a[92:95], v[84:87], v[240:255]
    v_cvt_pk_bf16_f32 v186, v174, v175
    v_cvt_pk_bf16_f32 v187, v176, v177
    v_cvt_pk_bf16_f32 v188, v178, v179
    s_waitcnt lgkmcnt(8)
    v_mfma_f32_32x32x16_bf16 v[192:207], a[96:99], v[88:91], v[192:207]
    ds_read_b64_tr_b16 a[80:81], v166 offset:32768
    ds_read_b64_tr_b16 a[82:83], v166 offset:33280
    ds_read_b64_tr_b16 a[84:85], v167 offset:32768
    ds_read_b64_tr_b16 a[86:87], v167 offset:33280
    v_cvt_pk_bf16_f32 v189, v180, v181
    v_mfma_f32_32x32x16_bf16 v[208:223], a[100:103], v[88:91], v[208:223]
    ds_read_b64_tr_b16 a[88:89], v166 offset:40960
    ds_read_b64_tr_b16 a[90:91], v166 offset:41472
    ds_read_b64_tr_b16 a[92:93], v167 offset:40960
    ds_read_b64_tr_b16 a[94:95], v167 offset:41472
    s_add_u32 s42, s33, 7168
    buffer_store_dwordx4 v[186:189], v170, s[20:23], s42 offen sc1
    v_mfma_f32_32x32x16_bf16 v[224:239], a[104:107], v[88:91], v[224:239]
    s_add_u32 m0, s36, 57344
    s_nop 0
    buffer_load_dwordx4 v162, s[16:19], s37 offen lds
    v_mfma_f32_32x32x16_bf16 v[240:255], a[108:111], v[88:91], v[240:255]
    s_waitcnt lgkmcnt(8)
    v_mfma_f32_32x32x16_bf16 v[192:207], a[64:67], v[92:95], v[192:207]
    ds_read_b64_tr_b16 a[96:97], v166 offset:34816
    ds_read_b64_tr_b16 a[98:99], v166 offset:35328
    ds_read_b64_tr_b16 a[100:101], v167 offset:34816
    ds_read_b64_tr_b16 a[102:103], v167 offset:35328
    v_mfma_f32_32x32x16_bf16 v[208:223], a[68:71], v[92:95], v[208:223]
    ds_read_b64_tr_b16 a[104:105], v166 offset:43008
    ds_read_b64_tr_b16 a[106:107], v166 offset:43520
    ds_read_b64_tr_b16 a[108:109], v167 offset:43008
    ds_read_b64_tr_b16 a[110:111], v167 offset:43520
    v_mfma_f32_32x32x16_bf16 v[224:239], a[72:75], v[92:95], v[224:239]
    buffer_load_dwordx4 v163, s[16:19], s37 offen offset:1024 lds
    v_mfma_f32_32x32x16_bf16 v[240:255], a[76:79], v[92:95], v[240:255]
    s_waitcnt lgkmcnt(8)
    v_mfma_f32_32x32x16_bf16 v[192:207], a[80:83], v[96:99], v[192:207]
    s_waitcnt vmcnt(22)
    s_barrier
    s_waitcnt lgkmcnt(0)
    s_cmp_eq_u32 s98, 0
    s_cselect_b32 s98, s101, s98
    ds_read_b64_tr_b16 a[64:65], v166 offset:36864
    ds_read_b64_tr_b16 a[66:67], v166 offset:37376
    ds_read_b64_tr_b16 a[68:69], v167 offset:36864
    ds_read_b64_tr_b16 a[70:71], v167 offset:37376
    v_mfma_f32_32x32x16_bf16 v[208:223], a[84:87], v[96:99], v[208:223]
    ds_read_b64_tr_b16 a[72:73], v166 offset:45056
    ds_read_b64_tr_b16 a[74:75], v166 offset:45568
    ds_read_b64_tr_b16 a[76:77], v167 offset:45056
    ds_read_b64_tr_b16 a[78:79], v167 offset:45568
    v_mfma_f32_32x32x16_bf16 v[224:239], a[88:91], v[96:99], v[224:239]
    s_add_u32 m0, s36, 65536
    s_add_u32 s37, s32, 884736
    buffer_load_dwordx4 v162, s[12:15], s37 offen lds
    v_mfma_f32_32x32x16_bf16 v[240:255], a[92:95], v[96:99], v[240:255]
    s_waitcnt lgkmcnt(8)
    v_mfma_f32_32x32x16_bf16 v[192:207], a[96:99], v[100:103], v[192:207]
    ds_read_b64_tr_b16 a[80:81], v166 offset:38912
    ds_read_b64_tr_b16 a[82:83], v166 offset:39424
    ds_read_b64_tr_b16 a[84:85], v167 offset:38912
    ds_read_b64_tr_b16 a[86:87], v167 offset:39424
    v_mfma_f32_32x32x16_bf16 v[208:223], a[100:103], v[100:103], v[208:223]
    ds_read_b64_tr_b16 a[88:89], v166 offset:47104
    ds_read_b64_tr_b16 a[90:91], v166 offset:47616
    ds_read_b64_tr_b16 a[92:93], v167 offset:47104
    ds_read_b64_tr_b16 a[94:95], v167 offset:47616
    v_mfma_f32_32x32x16_bf16 v[224:239], a[104:107], v[100:103], v[224:239]
    buffer_load_dwordx4 v163, s[12:15], s37 offen offset:1024 lds
    v_mfma_f32_32x32x16_bf16 v[240:255], a[108:111], v[100:103], v[240:255]
    s_waitcnt lgkmcnt(8)
    v_mfma_f32_32x32x16_bf16 v[192:207], a[64:67], v[104:107], v[192:207]
    ds_read_b64_tr_b16 a[96:97], v166 offset:49152
    ds_read_b64_tr_b16 a[98:99], v166 offset:49664
    ds_read_b64_tr_b16 a[100:101], v167 offset:49152
    ds_read_b64_tr_b16 a[102:103], v167 offset:49664
    v_mfma_f32_32x32x16_bf16 v[208:223], a[68:71], v[104:107], v[208:223]
    ds_read_b64_tr_b16 a[104:105], v166 offset:57344
    ds_read_b64_tr_b16 a[106:107], v166 offset:57856
    ds_read_b64_tr_b16 a[108:109], v167 offset:57344
    ds_read_b64_tr_b16 a[110:111], v167 offset:57856
    v_mfma_f32_32x32x16_bf16 v[224:239], a[72:75], v[104:107], v[224:239]
    s_add_u32 m0, s36, 73728
    s_nop 0
    buffer_load_dwordx4 v162, s[16:19], s37 offen lds
    v_mfma_f32_32x32x16_bf16 v[240:255], a[76:79], v[104:107], v[240:255]
    s_waitcnt lgkmcnt(8)
    v_mfma_f32_32x32x16_bf16 v[192:207], a[80:83], v[108:111], v[192:207]
    ds_read_b64_tr_b16 a[64:65], v166 offset:51200
    ds_read_b64_tr_b16 a[66:67], v166 offset:51712
    ds_read_b64_tr_b16 a[68:69], v167 offset:51200
    ds_read_b64_tr_b16 a[70:71], v167 offset:51712
    v_mfma_f32_32x32x16_bf16 v[208:223], a[84:87], v[108:111], v[208:223]
    ds_read_b64_tr_b16 a[72:73], v166 offset:59392
    ds_read_b64_tr_b16 a[74:75], v166 offset:59904
    ds_read_b64_tr_b16 a[76:77], v167 offset:59392
    ds_read_b64_tr_b16 a[78:79], v167 offset:59904
    v_mfma_f32_32x32x16_bf16 v[224:239], a[88:91], v[108:111], v[224:239]
    buffer_load_dwordx4 v163, s[16:19], s37 offen offset:1024 lds
    v_mfma_f32_32x32x16_bf16 v[240:255], a[92:95], v[108:111], v[240:255]
    s_waitcnt lgkmcnt(8)
    v_mfma_f32_32x32x16_bf16 v[192:207], a[96:99], v[112:115], v[192:207]
    ds_read_b64_tr_b16 a[80:81], v166 offset:53248
    ds_read_b64_tr_b16 a[82:83], v166 offset:53760
    ds_read_b64_tr_b16 a[84:85], v167 offset:53248
    ds_read_b64_tr_b16 a[86:87], v167 offset:53760
    v_mfma_f32_32x32x16_bf16 v[208:223], a[100:103], v[112:115], v[208:223]
    ds_read_b64_tr_b16 a[88:89], v166 offset:61440
    ds_read_b64_tr_b16 a[90:91], v166 offset:61952
    ds_read_b64_tr_b16 a[92:93], v167 offset:61440
    ds_read_b64_tr_b16 a[94:95], v167 offset:61952
    v_mfma_f32_32x32x16_bf16 v[224:239], a[104:107], v[112:115], v[224:239]
    s_add_u32 m0, s36, 81920
    s_add_u32 s37, s32, 1105920
    buffer_load_dwordx4 v162, s[12:15], s37 offen lds
    v_mfma_f32_32x32x16_bf16 v[240:255], a[108:111], v[112:115], v[240:255]
    s_waitcnt lgkmcnt(8)
    v_mfma_f32_32x32x16_bf16 v[192:207], a[64:67], v[116:119], v[192:207]
    ds_read_b64_tr_b16 a[96:97], v166 offset:55296
    ds_read_b64_tr_b16 a[98:99], v166 offset:55808
    ds_read_b64_tr_b16 a[100:101], v167 offset:55296
    ds_read_b64_tr_b16 a[102:103], v167 offset:55808
    v_mfma_f32_32x32x16_bf16 v[208:223], a[68:71], v[116:119], v[208:223]
    ds_read_b64_tr_b16 a[104:105], v166 offset:63488
    ds_read_b64_tr_b16 a[106:107], v166 offset:64000
    ds_read_b64_tr_b16 a[108:109], v167 offset:63488
    ds_read_b64_tr_b16 a[110:111], v167 offset:64000
    v_mfma_f32_32x32x16_bf16 v[224:239], a[72:75], v[116:119], v[224:239]
    buffer_load_dwordx4 v163, s[12:15], s37 offen offset:1024 lds
    v_mfma_f32_32x32x16_bf16 v[240:255], a[76:79], v[116:119], v[240:255]
    s_waitcnt lgkmcnt(8)
    v_mfma_f32_32x32x16_bf16 v[192:207], a[80:83], v[120:123], v[192:207]
    ds_read_b64_tr_b16 a[64:65], v168 offset:0
    ds_read_b64_tr_b16 a[66:67], v168 offset:512
    ds_read_b64_tr_b16 a[68:69], v169 offset:0
    ds_read_b64_tr_b16 a[70:71], v169 offset:512
    v_mfma_f32_32x32x16_bf16 v[208:223], a[84:87], v[120:123], v[208:223]
    ds_read_b64_tr_b16 a[72:73], v168 offset:8192
    ds_read_b64_tr_b16 a[74:75], v168 offset:8704
    ds_read_b64_tr_b16 a[76:77], v169 offset:8192
    ds_read_b64_tr_b16 a[78:79], v169 offset:8704
    v_mfma_f32_32x32x16_bf16 v[224:239], a[88:91], v[120:123], v[224:239]
    s_add_u32 m0, s36, 90112
    s_nop 0
    buffer_load_dwordx4 v162, s[16:19], s37 offen lds
    v_mfma_f32_32x32x16_bf16 v[240:255], a[92:95], v[120:123], v[240:255]
    s_waitcnt lgkmcnt(8)
    v_mfma_f32_32x32x16_bf16 v[192:207], a[96:99], v[124:127], v[192:207]
    ds_read_b64_tr_b16 a[80:81], v168 offset:2048
    ds_read_b64_tr_b16 a[82:83], v168 offset:2560
    ds_read_b64_tr_b16 a[84:85], v169 offset:2048
    ds_read_b64_tr_b16 a[86:87], v169 offset:2560
    v_mfma_f32_32x32x16_bf16 v[208:223], a[100:103], v[124:127], v[208:223]
    ds_read_b64_tr_b16 a[88:89], v168 offset:10240
    ds_read_b64_tr_b16 a[90:91], v168 offset:10752
    ds_read_b64_tr_b16 a[92:93], v169 offset:10240
    ds_read_b64_tr_b16 a[94:95], v169 offset:10752
    v_mfma_f32_32x32x16_bf16 v[224:239], a[104:107], v[124:127], v[224:239]
    buffer_load_dwordx4 v163, s[16:19], s37 offen offset:1024 lds
    v_mfma_f32_32x32x16_bf16 v[240:255], a[108:111], v[124:127], v[240:255]
    s_waitcnt lgkmcnt(8)
    v_mfma_f32_32x32x16_bf16 v[192:207], a[64:67], v[128:131], v[192:207]
    s_waitcnt vmcnt(19)
    s_barrier
    ds_read_b64_tr_b16 a[96:97], v168 offset:4096
    ds_read_b64_tr_b16 a[98:99], v168 offset:4608
    ds_read_b64_tr_b16 a[100:101], v169 offset:4096
    ds_read_b64_tr_b16 a[102:103], v169 offset:4608
    v_mfma_f32_32x32x16_bf16 v[208:223], a[68:71], v[128:131], v[208:223]
    ds_read_b64_tr_b16 a[104:105], v168 offset:12288
    ds_read_b64_tr_b16 a[106:107], v168 offset:12800
    ds_read_b64_tr_b16 a[108:109], v169 offset:12288
    ds_read_b64_tr_b16 a[110:111], v169 offset:12800
    v_mfma_f32_32x32x16_bf16 v[224:239], a[72:75], v[128:131], v[224:239]
    s_add_u32 m0, s36, 98304
    s_add_u32 s37, s32, 1327104
    buffer_load_dwordx4 v162, s[12:15], s37 offen lds
    v_mfma_f32_32x32x16_bf16 v[240:255], a[76:79], v[128:131], v[240:255]
    s_waitcnt lgkmcnt(8)
    v_mfma_f32_32x32x16_bf16 v[192:207], a[80:83], v[132:135], v[192:207]
    ds_read_b64_tr_b16 a[64:65], v168 offset:6144
    ds_read_b64_tr_b16 a[66:67], v168 offset:6656
    ds_read_b64_tr_b16 a[68:69], v169 offset:6144
    ds_read_b64_tr_b16 a[70:71], v169 offset:6656
    v_mfma_f32_32x32x16_bf16 v[208:223], a[84:87], v[132:135], v[208:223]
    ds_read_b64_tr_b16 a[72:73], v168 offset:14336
    ds_read_b64_tr_b16 a[74:75], v168 offset:14848
    ds_read_b64_tr_b16 a[76:77], v169 offset:14336
    ds_read_b64_tr_b16 a[78:79], v169 offset:14848
    v_mfma_f32_32x32x16_bf16 v[224:239], a[88:91], v[132:135], v[224:239]
    buffer_load_dwordx4 v163, s[12:15], s37 offen offset:1024 lds
    v_mfma_f32_32x32x16_bf16 v[240:255], a[92:95], v[132:135], v[240:255]
    s_waitcnt lgkmcnt(8)
    v_mfma_f32_32x32x16_bf16 v[192:207], a[96:99], v[136:139], v[192:207]
    ds_read_b64_tr_b16 a[80:81], v168 offset:16384
    ds_read_b64_tr_b16 a[82:83], v168 offset:16896
    ds_read_b64_tr_b16 a[84:85], v169 offset:16384
    ds_read_b64_tr_b16 a[86:87], v169 offset:16896
    v_mfma_f32_32x32x16_bf16 v[208:223], a[100:103], v[136:139], v[208:223]
    ds_read_b64_tr_b16 a[88:89], v168 offset:24576
    ds_read_b64_tr_b16 a[90:91], v168 offset:25088
    ds_read_b64_tr_b16 a[92:93], v169 offset:24576
    ds_read_b64_tr_b16 a[94:95], v169 offset:25088
    v_mfma_f32_32x32x16_bf16 v[224:239], a[104:107], v[136:139], v[224:239]
    s_add_u32 m0, s36, 106496
    s_nop 0
    buffer_load_dwordx4 v162, s[16:19], s37 offen lds
    v_mfma_f32_32x32x16_bf16 v[240:255], a[108:111], v[136:139], v[240:255]
    s_waitcnt lgkmcnt(8)
    v_mfma_f32_32x32x16_bf16 v[192:207], a[64:67], v[140:143], v[192:207]
    ds_read_b64_tr_b16 a[96:97], v168 offset:18432
    ds_read_b64_tr_b16 a[98:99], v168 offset:18944
    ds_read_b64_tr_b16 a[100:101], v169 offset:18432
    ds_read_b64_tr_b16 a[102:103], v169 offset:18944
    v_mfma_f32_32x32x16_bf16 v[208:223], a[68:71], v[140:143], v[208:223]
    ds_read_b64_tr_b16 a[104:105], v168 offset:26624
    ds_read_b64_tr_b16 a[106:107], v168 offset:27136
    ds_read_b64_tr_b16 a[108:109], v169 offset:26624
    ds_read_b64_tr_b16 a[110:111], v169 offset:27136
    v_mfma_f32_32x32x16_bf16 v[224:239], a[72:75], v[140:143], v[224:239]
    buffer_load_dwordx4 v163, s[16:19], s37 offen offset:1024 lds
    v_mfma_f32_32x32x16_bf16 v[240:255], a[76:79], v[140:143], v[240:255]
    s_waitcnt lgkmcnt(8)
    v_mfma_f32_32x32x16_bf16 v[192:207], a[80:83], v[144:147], v[192:207]
    ds_read_b64_tr_b16 a[64:65], v168 offset:20480
    ds_read_b64_tr_b16 a[66:67], v168 offset:20992
    ds_read_b64_tr_b16 a[68:69], v169 offset:20480
    ds_read_b64_tr_b16 a[70:71], v169 offset:20992
    v_mfma_f32_32x32x16_bf16 v[208:223], a[84:87], v[144:147], v[208:223]
    ds_read_b64_tr_b16 a[72:73], v168 offset:28672
    ds_read_b64_tr_b16 a[74:75], v168 offset:29184
    ds_read_b64_tr_b16 a[76:77], v169 offset:28672
    ds_read_b64_tr_b16 a[78:79], v169 offset:29184
    v_mfma_f32_32x32x16_bf16 v[224:239], a[88:91], v[144:147], v[224:239]
    s_add_u32 m0, s36, 114688
    s_add_u32 s37, s32, 1548288
    buffer_load_dwordx4 v162, s[12:15], s37 offen lds
    v_mfma_f32_32x32x16_bf16 v[240:255], a[92:95], v[144:147], v[240:255]
    s_waitcnt lgkmcnt(8)
    v_mfma_f32_32x32x16_bf16 v[192:207], a[96:99], v[148:151], v[192:207]
    ds_read_b64_tr_b16 a[80:81], v168 offset:22528
    ds_read_b64_tr_b16 a[82:83], v168 offset:23040
    ds_read_b64_tr_b16 a[84:85], v169 offset:22528
    ds_read_b64_tr_b16 a[86:87], v169 offset:23040
    v_mfma_f32_32x32x16_bf16 v[208:223], a[100:103], v[148:151], v[208:223]
    ds_read_b64_tr_b16 a[88:89], v168 offset:30720
    ds_read_b64_tr_b16 a[90:91], v168 offset:31232
    ds_read_b64_tr_b16 a[92:93], v169 offset:30720
    ds_read_b64_tr_b16 a[94:95], v169 offset:31232
    v_mfma_f32_32x32x16_bf16 v[224:239], a[104:107], v[148:151], v[224:239]
    buffer_load_dwordx4 v163, s[12:15], s37 offen offset:1024 lds
    v_mfma_f32_32x32x16_bf16 v[240:255], a[108:111], v[148:151], v[240:255]
    s_waitcnt lgkmcnt(8)
    v_mfma_f32_32x32x16_bf16 v[192:207], a[64:67], v[152:155], v[192:207]
    ds_read_b64_tr_b16 a[96:97], v164 offset:0
    ds_read_b64_tr_b16 a[98:99], v164 offset:512
    ds_read_b64_tr_b16 a[100:101], v165 offset:0
    ds_read_b64_tr_b16 a[102:103], v165 offset:512
    v_mfma_f32_32x32x16_bf16 v[208:223], a[68:71], v[152:155], v[208:223]
    ds_read_b64_tr_b16 a[104:105], v164 offset:8192
    ds_read_b64_tr_b16 a[106:107], v164 offset:8704
    ds_read_b64_tr_b16 a[108:109], v165 offset:8192
    ds_read_b64_tr_b16 a[110:111], v165 offset:8704
    v_mfma_f32_32x32x16_bf16 v[224:239], a[72:75], v[152:155], v[224:239]
    s_add_u32 m0, s36, 122880
    s_nop 0
    buffer_load_dwordx4 v162, s[16:19], s37 offen lds
    v_mfma_f32_32x32x16_bf16 v[240:255], a[76:79], v[152:155], v[240:255]
    s_waitcnt lgkmcnt(8)
    v_mfma_f32_32x32x16_bf16 v[192:207], a[80:83], v[156:159], v[192:207]
    ds_read_b64_tr_b16 a[64:65], v164 offset:2048
    ds_read_b64_tr_b16 a[66:67], v164 offset:2560
    ds_read_b64_tr_b16 a[68:69], v165 offset:2048
    ds_read_b64_tr_b16 a[70:71], v165 offset:2560
    v_mfma_f32_32x32x16_bf16 v[208:223], a[84:87], v[156:159], v[208:223]
    ds_read_b64_tr_b16 a[72:73], v164 offset:10240
    ds_read_b64_tr_b16 a[74:75], v164 offset:10752
    ds_read_b64_tr_b16 a[76:77], v165 offset:10240
    ds_read_b64_tr_b16 a[78:79], v165 offset:10752
    v_mfma_f32_32x32x16_bf16 v[224:239], a[88:91], v[156:159], v[224:239]
    buffer_load_dwordx4 v163, s[16:19], s37 offen offset:1024 lds
    v_mfma_f32_32x32x16_bf16 v[240:255], a[92:95], v[156:159], v[240:255]
    s_waitcnt lgkmcnt(8)
    v_mfma_f32_32x32x16_bf16 a[0:15], a[96:99], v[0:3], 0
    s_waitcnt vmcnt(16)
    s_barrier
    s_cmp_lg_u32 s25, 0
    s_cbranch_scc1 FL2
    s_add_u32 s83, s98, 1
    v_mov_b32 v174, s83
    v_mov_b32 v175, 0
    s_mov_b64 exec, 1
    buffer_store_dword v174, v175, s[20:23], s89 offen offset:0 sc1
    s_mov_b64 exec, -1
FL2:
    ds_read_b64_tr_b16 a[80:81], v164 offset:4096
    ds_read_b64_tr_b16 a[82:83], v164 offset:4608
    ds_read_b64_tr_b16 a[84:85], v165 offset:4096
    ds_read_b64_tr_b16 a[86:87], v165 offset:4608
    v_mfma_f32_32x32x16_bf16 a[16:31], a[100:103], v[0:3], 0
    ds_read_b64_tr_b16 a[88:89], v164 offset:12288
    ds_read_b64_tr_b16 a[90:91], v164 offset:12800
    ds_read_b64_tr_b16 a[92:93], v165 offset:12288
    ds_read_b64_tr_b16 a[94:95], v165 offset:12800
    v_mfma_f32_32x32x16_bf16 a[32:47], a[104:107], v[0:3], 0
    s_add_u32 m0, s36, 131072
    s_add_u32 s37, s32, 1769472
    buffer_load_dwordx4 v162, s[12:15], s37 offen lds
    v_mfma_f32_32x32x16_bf16 a[48:63], a[108:111], v[0:3], 0
    s_waitcnt lgkmcnt(8)
    v_mfma_f32_32x32x16_bf16 a[0:15], a[64:67], v[4:7], a[0:15]
    ds_read_b64_tr_b16 a[96:97], v164 offset:6144
    ds_read_b64_tr_b16 a[98:99], v164 offset:6656
    ds_read_b64_tr_b16 a[100:101], v165 offset:6144
    ds_read_b64_tr_b16 a[102:103], v165 offset:6656
    v_mfma_f32_32x32x16_bf16 a[16:31], a[68:71], v[4:7], a[16:31]
    ds_read_b64_tr_b16 a[104:105], v164 offset:14336
    ds_read_b64_tr_b16 a[106:107], v164 offset:14848
    ds_read_b64_tr_b16 a[108:109], v165 offset:14336
    ds_read_b64_tr_b16 a[110:111], v165 offset:14848
    v_mul_f32 v192, v192, v171
    v_mfma_f32_32x32x16_bf16 a[32:47], a[72:75], v[4:7], a[32:47]
    buffer_load_dwordx4 v163, s[12:15], s37 offen offset:1024 lds
    v_mul_f32 v193, v193, v171
    v_mul_f32 v194, v194, v171
    v_mul_f32 v195, v195, v171
    v_mfma_f32_32x32x16_bf16 a[48:63], a[76:79], v[4:7], a[48:63]
    v_mul_f32 v174, v192, v192
    v_mul_f32 v175, v193, v193
    v_mul_f32 v176, v194, v194
    s_waitcnt lgkmcnt(8)
    v_mfma_f32_32x32x16_bf16 a[0:15], a[80:83], v[8:11], a[0:15]
    ds_read_b64_tr_b16 a[64:65], v164 offset:16384
    ds_read_b64_tr_b16 a[66:67], v164 offset:16896
    ds_read_b64_tr_b16 a[68:69], v165 offset:16384
    ds_read_b64_tr_b16 a[70:71], v165 offset:16896
    v_mul_f32 v177, v195, v195
    v_mfma_f32_32x32x16_bf16 a[16:31], a[84:87], v[8:11], a[16:31]
    ds_read_b64_tr_b16 a[72:73], v164 offset:24576
    ds_read_b64_tr_b16 a[74:75], v164 offset:25088
    ds_read_b64_tr_b16 a[76:77], v165 offset:24576
    ds_read_b64_tr_b16 a[78:79], v165 offset:25088
    v_fma_f32 v174, v174, s41, v173
    v_mfma_f32_32x32x16_bf16 a[32:47], a[88:91], v[8:11], a[32:47]
    s_add_u32 m0, s36, 139264
    s_nop 0
    buffer_load_dwordx4 v162, s[16:19], s37 offen lds
    v_fma_f32 v175, v175, s41, v173
    v_fma_f32 v176, v176, s41, v173
    v_mfma_f32_32x32x16_bf16 a[48:63], a[92:95], v[8:11], a[48:63]
    v_fma_f32 v177, v177, s41, v173
    v_mul_f32 v174, v174, v192
    v_mul_f32 v175, v175, v193
    s_waitcnt lgkmcnt(8)
    v_mfma_f32_32x32x16_bf16 a[0:15], a[96:99], v[12:15], a[0:15]
    ds_read_b64_tr_b16 a[80:81], v164 offset:18432
    ds_read_b64_tr_b16 a[82:83], v164 offset:18944
    ds_read_b64_tr_b16 a[84:85], v165 offset:18432
    ds_read_b64_tr_b16 a[86:87], v165 offset:18944
    v_mul_f32 v176, v176, v194
    v_mfma_f32_32x32x16_bf16 a[16:31], a[100:103], v[12:15], a[16:31]
    ds_read_b64_tr_b16 a[88:89], v164 offset:26624
    ds_read_b64_tr_b16 a[90:91], v164 offset:27136
    ds_read_b64_tr_b16 a[92:93], v165 offset:26624
    ds_read_b64_tr_b16 a[94:95], v165 offset:27136
    v_mul_f32 v177, v177, v195
    v_mfma_f32_32x32x16_bf16 a[32:47], a[104:107], v[12:15], a[32:47]
    buffer_load_dwordx4 v163, s[16:19], s37 offen offset:1024 lds
    v_exp_f32 v174, v174
    v_mul_f32 v192, v192, v224
    v_exp_f32 v175, v175
    v_mul_f32 v193, v193, v225
    v_exp_f32 v176, v176
    v_mul_f32 v194, v194, v226
    v_mfma_f32_32x32x16_bf16 a[48:63], a[108:111], v[12:15], a[48:63]
    v_exp_f32 v177, v177
    v_mul_f32 v195, v195, v227
    v_fma_f32 v174, v174, v172, v172
    v_fma_f32 v175, v175, v172, v172
    s_waitcnt lgkmcnt(8)
    v_mfma_f32_32x32x16_bf16 a[0:15], a[64:67], v[16:19], a[0:15]
    ds_read_b64_tr_b16 a[96:97], v164 offset:20480
    ds_read_b64_tr_b16 a[98:99], v164 offset:20992
    ds_read_b64_tr_b16 a[100:101], v165 offset:20480
    ds_read_b64_tr_b16 a[102:103], v165 offset:20992
    v_fma_f32 v176, v176, v172, v172
    v_mfma_f32_32x32x16_bf16 a[16:31], a[68:71], v[16:19], a[16:31]
    s_lshl_b32 s60, s24, 12
    s_add_u32 s60, s60, s81
    s_add_u32 s60, s60, 0x40000
    v_and_b32 v190, 0x1ff, v170
    v_lshrrev_b32 v190, 2, v190
    v_add_u32 v190, s60, v190
    buffer_load_dword v0, v190, s[20:23], 0 offen sc1
    ds_read_b64_tr_b16 a[104:105], v164 offset:28672
    ds_read_b64_tr_b16 a[106:107], v164 offset:29184
    ds_read_b64_tr_b16 a[108:109], v165 offset:28672
    ds_read_b64_tr_b16 a[110:111], v165 offset:29184
    v_mfma_f32_32x32x16_bf16 a[32:47], a[72:75], v[16:19], a[32:47]
    s_add_u32 m0, s36, 147456
    s_add_u32 s37, s32, 1990656
    buffer_load_dwordx4 v162, s[12:15], s37 offen lds
    v_fma_f32 v177, v177, v172, v172
    v_rcp_f32 v174, v174
    v_rcp_f32 v175, v175
    v_mfma_f32_32x32x16_bf16 a[48:63], a[76:79], v[16:19], a[48:63]
    v_rcp_f32 v176, v176
    v_rcp_f32 v177, v177
    v_mul_f32 v192, v192, v174
    s_waitcnt lgkmcnt(8)
    v_mfma_f32_32x32x16_bf16 a[0:15], a[80:83], v[20:23], a[0:15]
    ds_read_b64_tr_b16 a[64:65], v164 offset:22528
    ds_read_b64_tr_b16 a[66:67], v164 offset:23040
    ds_read_b64_tr_b16 a[68:69], v165 offset:22528
    ds_read_b64_tr_b16 a[70:71], v165 offset:23040
    v_mul_f32 v193, v193, v175
    v_mfma_f32_32x32x16_bf16 a[16:31], a[84:87], v[20:23], a[16:31]
    ds_read_b64_tr_b16 a[72:73], v164 offset:30720
    ds_read_b64_tr_b16 a[74:75], v164 offset:31232
    ds_read_b64_tr_b16 a[76:77], v165 offset:30720
    ds_read_b64_tr_b16 a[78:79], v165 offset:31232
    v_mul_f32 v194, v194, v176
    v_mfma_f32_32x32x16_bf16 a[32:47], a[88:91], v[20:23], a[32:47]
    buffer_load_dwordx4 v163, s[12:15], s37 offen offset:1024 lds
    v_mul_f32 v195, v195, v177
    v_cvt_pk_bf16_f32 v182, v192, v193
    v_cvt_pk_bf16_f32 v183, v194, v195
    v_mfma_f32_32x32x16_bf16 a[48:63], a[92:95], v[20:23], a[48:63]
    v_mul_f32 v196, v196, v171
    v_mul_f32 v197, v197, v171
    s_waitcnt lgkmcnt(8)
    v_mfma_f32_32x32x16_bf16 a[0:15], a[96:99], v[24:27], a[0:15]
    ds_read_b64_tr_b16 a[80:81], v164 offset:32768
    ds_read_b64_tr_b16 a[82:83], v164 offset:33280
    ds_read_b64_tr_b16 a[84:85], v165 offset:32768
    ds_read_b64_tr_b16 a[86:87], v165 offset:33280
    v_mul_f32 v198, v198, v171
    v_mfma_f32_32x32x16_bf16 a[16:31], a[100:103], v[24:27], a[16:31]
    ds_read_b64_tr_b16 a[88:89], v164 offset:40960
    ds_read_b64_tr_b16 a[90:91], v164 offset:41472
    ds_read_b64_tr_b16 a[92:93], v165 offset:40960
    ds_read_b64_tr_b16 a[94:95], v165 offset:41472
    v_mul_f32 v199, v199, v171
    v_mfma_f32_32x32x16_bf16 a[32:47], a[104:107], v[24:27], a[32:47]
    s_add_u32 m0, s36, 155648
    s_nop 0
    buffer_load_dwordx4 v162, s[16:19], s37 offen lds
    v_mul_f32 v178, v196, v196
    v_mul_f32 v179, v197, v197
    v_mul_f32 v180, v198, v198
    v_mfma_f32_32x32x16_bf16 a[48:63], a[108:111], v[24:27], a[48:63]
    v_mul_f32 v181, v199, v199
    v_fma_f32 v178, v178, s41, v173
    v_fma_f32 v179, v179, s41, v173
    s_waitcnt lgkmcnt(8)
    v_mfma_f32_32x32x16_bf16 a[0:15], a[64:67], v[28:31], a[0:15]
    ds_read_b64_tr_b16 a[96:97], v164 offset:34816
    ds_read_b64_tr_b16 a[98:99], v164 offset:35328
    ds_read_b64_tr_b16 a[100:101], v165 offset:34816
    ds_read_b64_tr_b16 a[102:103], v165 offset:35328
    v_fma_f32 v180, v180, s41, v173
    v_mfma_f32_32x32x16_bf16 a[16:31], a[68:71], v[28:31], a[16:31]
    ds_read_b64_tr_b16 a[104:105], v164 offset:43008
    ds_read_b64_tr_b16 a[106:107], v164 offset:43520
    ds_read_b64_tr_b16 a[108:109], v165 offset:43008
    ds_read_b64_tr_b16 a[110:111], v165 offset:43520
    v_fma_f32 v181, v181, s41, v173
    v_mfma_f32_32x32x16_bf16 a[32:47], a[72:75], v[28:31], a[32:47]
    buffer_load_dwordx4 v163, s[16:19], s37 offen offset:1024 lds
    v_mul_f32 v178, v178, v196
    v_mul_f32 v179, v179, v197
    v_mfma_f32_32x32x16_bf16 a[48:63], a[76:79], v[28:31], a[48:63]
    v_mul_f32 v180, v180, v198
    v_mul_f32 v181, v181, v199
    v_exp_f32 v178, v178
    v_mul_f32 v196, v196, v228
    s_waitcnt lgkmcnt(8)
    v_mfma_f32_32x32x16_bf16 a[0:15], a[80:83], v[32:35], a[0:15]
    s_waitcnt vmcnt(17)
    v_mov_b32 v1, 2
    s_cmp_lg_u32 s25, 0
    s_cbranch_scc1 PD3
    s_waitcnt vmcnt(4)
    s_mov_b32 s88, 0
    s_add_u32 s83, s98, 1
PL3:
    v_subrev_u32 v0, s83, v0
    v_cmp_lt_u32 vcc, v1, v0
    s_cbranch_vccz PD3
    s_add_u32 s88, s88, 1
    s_cmp_gt_u32 s88, 0x40000
    s_cbranch_scc1 PD3
    s_sleep 4
    buffer_load_dword v0, v190, s[20:23], 0 offen sc1
    s_waitcnt vmcnt(0)
    s_branch PL3
PD3:
    s_barrier
    s_lshr_b32 s56, s26, 2
    s_mul_i32 s57, s56, 378880
    s_mul_i32 s67, s25, 5120
    s_add_u32 s57, s57, s67
    s_add_u32 s57, s57, 18874368
    ds_read_b64_tr_b16 a[64:65], v164 offset:36864
    ds_read_b64_tr_b16 a[66:67], v164 offset:37376
    ds_read_b64_tr_b16 a[68:69], v165 offset:36864
    ds_read_b64_tr_b16 a[70:71], v165 offset:37376
    v_exp_f32 v179, v179
    v_mul_f32 v197, v197, v229
    v_mfma_f32_32x32x16_bf16 a[16:31], a[84:87], v[32:35], a[16:31]
    ds_read_b64_tr_b16 a[72:73], v164 offset:45056
    ds_read_b64_tr_b16 a[74:75], v164 offset:45568
    ds_read_b64_tr_b16 a[76:77], v165 offset:45056
    ds_read_b64_tr_b16 a[78:79], v165 offset:45568
    v_exp_f32 v180, v180
    v_mul_f32 v198, v198, v230
    v_mfma_f32_32x32x16_bf16 a[32:47], a[88:91], v[32:35], a[32:47]
    s_add_u32 s67, s57, 0
    buffer_load_dwordx4 a[112:115], v170, s[20:23], s67 offen offset:0 sc1
    v_exp_f32 v181, v181
    v_mul_f32 v199, v199, v231
    v_fma_f32 v178, v178, v172, v172
    v_fma_f32 v179, v179, v172, v172
    v_mfma_f32_32x32x16_bf16 a[48:63], a[92:95], v[32:35], a[48:63]
    buffer_load_dwordx4 a[116:119], v170, s[20:23], s67 offen offset:1024 sc1
    v_fma_f32 v180, v180, v172, v172
    v_fma_f32 v181, v181, v172, v172
    s_waitcnt lgkmcnt(8)
    v_mfma_f32_32x32x16_bf16 a[0:15], a[96:99], v[36:39], a[0:15]
    ds_read_b64_tr_b16 a[80:81], v164 offset:38912
    ds_read_b64_tr_b16 a[82:83], v164 offset:39424
    ds_read_b64_tr_b16 a[84:85], v165 offset:38912
    ds_read_b64_tr_b16 a[86:87], v165 offset:39424
    v_rcp_f32 v178, v178
    v_mfma_f32_32x32x16_bf16 a[16:31], a[100:103], v[36:39], a[16:31]
    ds_read_b64_tr_b16 a[88:89], v164 offset:47104
    ds_read_b64_tr_b16 a[90:91], v164 offset:47616
    ds_read_b64_tr_b16 a[92:93], v165 offset:47104
    ds_read_b64_tr_b16 a[94:95], v165 offset:47616
    v_rcp_f32 v179, v179
    v_mfma_f32_32x32x16_bf16 a[32:47], a[104:107], v[36:39], a[32:47]
    buffer_load_dwordx4 a[120:123], v170, s[20:23], s67 offen offset:2048 sc1
    v_rcp_f32 v180, v180
    v_rcp_f32 v181, v181
    v_mul_f32 v196, v196, v178
    v_mfma_f32_32x32x16_bf16 a[48:63], a[108:111], v[36:39], a[48:63]
    buffer_load_dwordx4 a[124:127], v170, s[20:23], s67 offen offset:3072 sc1
    v_mul_f32 v197, v197, v179
    v_mul_f32 v198, v198, v180
    v_mul_f32 v199, v199, v181
    s_waitcnt lgkmcnt(8)
    v_mfma_f32_32x32x16_bf16 a[0:15], a[64:67], v[40:43], a[0:15]
    ds_read_b64_tr_b16 a[96:97], v164 offset:49152
    ds_read_b64_tr_b16 a[98:99], v164 offset:49664
    ds_read_b64_tr_b16 a[100:101], v165 offset:49152
    ds_read_b64_tr_b16 a[102:103], v165 offset:49664
    v_cvt_pk_bf16_f32 v184, v196, v197
    v_mfma_f32_32x32x16_bf16 a[16:31], a[68:71], v[40:43], a[16:31]
    ds_read_b64_tr_b16 a[104:105], v164 offset:57344
    ds_read_b64_tr_b16 a[106:107], v164 offset:57856
    ds_read_b64_tr_b16 a[108:109], v165 offset:57344
    ds_read_b64_tr_b16 a[110:111], v165 offset:57856
    v_cvt_pk_bf16_f32 v185, v198, v199
    v_mfma_f32_32x32x16_bf16 a[32:47], a[72:75], v[40:43], a[32:47]
    s_add_u32 s67, s57, 4096
    buffer_load_dwordx4 a[128:131], v170, s[20:23], s67 offen offset:0 sc1
    s_add_u32 s42, s34, 0
    buffer_store_dwordx4 v[182:185], v170, s[20:23], s42 offen sc1
    v_mul_f32 v200, v200, v171
    v_mfma_f32_32x32x16_bf16 a[48:63], a[76:79], v[40:43], a[48:63]
    s_add_u32 s67, s57, 20480
    buffer_load_dwordx4 a[132:135], v170, s[20:23], s67 offen offset:0 sc1
    v_mul_f32 v201, v201, v171
    v_mul_f32 v202, v202, v171
    v_mul_f32 v203, v203, v171
    s_waitcnt lgkmcnt(8)
    v_mfma_f32_32x32x16_bf16 a[0:15], a[80:83], v[44:47], a[0:15]
    ds_read_b64_tr_b16 a[64:65], v164 offset:51200
    ds_read_b64_tr_b16 a[66:67], v164 offset:51712
    ds_read_b64_tr_b16 a[68:69], v165 offset:51200
    ds_read_b64_tr_b16 a[70:71], v165 offset:51712
    v_mul_f32 v174, v200, v200
    v_mfma_f32_32x32x16_bf16 a[16:31], a[84:87], v[44:47], a[16:31]
    ds_read_b64_tr_b16 a[72:73], v164 offset:59392
    ds_read_b64_tr_b16 a[74:75], v164 offset:59904
    ds_read_b64_tr_b16 a[76:77], v165 offset:59392
    ds_read_b64_tr_b16 a[78:79], v165 offset:59904
    v_mul_f32 v175, v201, v201
    v_mfma_f32_32x32x16_bf16 a[32:47], a[88:91], v[44:47], a[32:47]
    buffer_load_dwordx4 a[136:139], v170, s[20:23], s67 offen offset:1024 sc1
    v_mul_f32 v176, v202, v202
    v_mul_f32 v177, v203, v203
    v_fma_f32 v174, v174, s41, v173
    v_mfma_f32_32x32x16_bf16 a[48:63], a[92:95], v[44:47], a[48:63]
    buffer_load_dwordx4 a[140:143], v170, s[20:23], s67 offen offset:2048 sc1
    v_fma_f32 v175, v175, s41, v173
    v_fma_f32 v176, v176, s41, v173
    s_waitcnt lgkmcnt(8)
    v_mfma_f32_32x32x16_bf16 a[0:15], a[96:99], v[48:51], a[0:15]
    ds_read_b64_tr_b16 a[80:81], v164 offset:53248
    ds_read_b64_tr_b16 a[82:83], v164 offset:53760
    ds_read_b64_tr_b16 a[84:85], v165 offset:53248
    ds_read_b64_tr_b16 a[86:87], v165 offset:53760
    v_fma_f32 v177, v177, s41, v173
    v_mfma_f32_32x32x16_bf16 a[16:31], a[100:103], v[48:51], a[16:31]
    ds_read_b64_tr_b16 a[88:89], v164 offset:61440
    ds_read_b64_tr_b16 a[90:91], v164 offset:61952
    ds_read_b64_tr_b16 a[92:93], v165 offset:61440
    ds_read_b64_tr_b16 a[94:95], v165 offset:61952
    v_mul_f32 v174, v174, v200
    v_mfma_f32_32x32x16_bf16 a[32:47], a[104:107], v[48:51], a[32:47]
    buffer_load_dwordx4 a[144:147], v170, s[20:23], s67 offen offset:3072 sc1
    v_mul_f32 v175, v175, v201
    v_mul_f32 v176, v176, v202
    v_mul_f32 v177, v177, v203
    v_mfma_f32_32x32x16_bf16 a[48:63], a[108:111], v[48:51], a[48:63]
    s_add_u32 s67, s57, 24576
    buffer_load_dwordx4 a[148:151], v170, s[20:23], s67 offen offset:0 sc1
    v_exp_f32 v174, v174
    v_mul_f32 v200, v200, v232
    v_exp_f32 v175, v175
    v_mul_f32 v201, v201, v233
    v_exp_f32 v176, v176
    v_mul_f32 v202, v202, v234
    s_waitcnt lgkmcnt(8)
    v_mfma_f32_32x32x16_bf16 a[0:15], a[64:67], v[52:55], a[0:15]
    ds_read_b64_tr_b16 a[96:97], v164 offset:55296
    ds_read_b64_tr_b16 a[98:99], v164 offset:55808
    ds_read_b64_tr_b16 a[100:101], v165 offset:55296
    ds_read_b64_tr_b16 a[102:103], v165 offset:55808
    v_exp_f32 v177, v177
    v_mul_f32 v203, v203, v235
    v_mfma_f32_32x32x16_bf16 a[16:31], a[68:71], v[52:55], a[16:31]
    ds_read_b64_tr_b16 a[104:105], v164 offset:63488
    ds_read_b64_tr_b16 a[106:107], v164 offset:64000
    ds_read_b64_tr_b16 a[108:109], v165 offset:63488
    ds_read_b64_tr_b16 a[110:111], v165 offset:64000
    v_fma_f32 v174, v174, v172, v172
    v_mfma_f32_32x32x16_bf16 a[32:47], a[72:75], v[52:55], a[32:47]
    s_add_u32 s67, s57, 40960
    buffer_load_dwordx4 a[152:155], v170, s[20:23], s67 offen offset:0 sc1
    v_fma_f32 v175, v175, v172, v172
    v_fma_f32 v176, v176, v172, v172
    v_mfma_f32_32x32x16_bf16 a[48:63], a[76:79], v[52:55], a[48:63]
    buffer_load_dwordx4 a[156:159], v170, s[20:23], s67 offen offset:1024 sc1
    v_fma_f32 v177, v177, v172, v172
    v_rcp_f32 v174, v174
    v_rcp_f32 v175, v175
    s_waitcnt lgkmcnt(8)
    v_mfma_f32_32x32x16_bf16 a[0:15], a[80:83], v[56:59], a[0:15]
    ds_read_b64_tr_b16 a[64:65], v166 offset:0
    ds_read_b64_tr_b16 a[66:67], v166 offset:512
    ds_read_b64_tr_b16 a[68:69], v167 offset:0
    ds_read_b64_tr_b16 a[70:71], v167 offset:512
    v_rcp_f32 v176, v176
    v_mfma_f32_32x32x16_bf16 a[16:31], a[84:87], v[56:59], a[16:31]
    ds_read_b64_tr_b16 a[72:73], v166 offset:8192
    ds_read_b64_tr_b16 a[74:75], v166 offset:8704
    ds_read_b64_tr_b16 a[76:77], v167 offset:8192
    ds_read_b64_tr_b16 a[78:79], v167 offset:8704
    v_rcp_f32 v177, v177
    v_mfma_f32_32x32x16_bf16 a[32:47], a[88:91], v[56:59], a[32:47]
    buffer_load_dwordx4 a[160:163], v170, s[20:23], s67 offen offset:2048 sc1
    v_mul_f32 v200, v200, v174
    v_mul_f32 v201, v201, v175
    v_mul_f32 v202, v202, v176
    v_mfma_f32_32x32x16_bf16 a[48:63], a[92:95], v[56:59], a[48:63]
    buffer_load_dwordx4 a[164:167], v170, s[20:23], s67 offen offset:3072 sc1
    v_mul_f32 v203, v203, v177
    v_cvt_pk_bf16_f32 v186, v200, v201
    v_cvt_pk_bf16_f32 v187, v202, v203
    s_waitcnt lgkmcnt(8)
    v_mfma_f32_32x32x16_bf16 a[0:15], a[96:99], v[60:63], a[0:15]
    ds_read_b64_tr_b16 a[80:81], v166 offset:2048
    ds_read_b64_tr_b16 a[82:83], v166 offset:2560
    ds_read_b64_tr_b16 a[84:85], v167 offset:2048
    ds_read_b64_tr_b16 a[86:87], v167 offset:2560
    v_mfma_f32_32x32x16_bf16 a[16:31], a[100:103], v[60:63], a[16:31]
    ds_read_b64_tr_b16 a[88:89], v166 offset:10240
    ds_read_b64_tr_b16 a[90:91], v166 offset:10752
    ds_read_b64_tr_b16 a[92:93], v167 offset:10240
    ds_read_b64_tr_b16 a[94:95], v167 offset:10752
    v_mul_f32 v204, v204, v171
    v_mfma_f32_32x32x16_bf16 a[32:47], a[104:107], v[60:63], a[32:47]
    s_add_u32 s67, s57, 45056
    buffer_load_dwordx4 a[168:171], v170, s[20:23], s67 offen offset:0 sc1
    v_mul_f32 v205, v205, v171
    v_mul_f32 v206, v206, v171
    v_mul_f32 v207, v207, v171
    v_mfma_f32_32x32x16_bf16 a[48:63], a[108:111], v[60:63], a[48:63]
    s_add_u32 s67, s57, 61440
    buffer_load_dwordx4 a[172:175], v170, s[20:23], s67 offen offset:0 sc1
    v_mul_f32 v178, v204, v204
    v_mul_f32 v179, v205, v205
    v_mul_f32 v180, v206, v206
    s_waitcnt lgkmcnt(8)
    v_mfma_f32_32x32x16_bf16 a[0:15], a[64:67], v[64:67], a[0:15]
    s_waitcnt vmcnt(26)
    s_barrier
    ds_read_b64_tr_b16 a[96:97], v166 offset:4096
    ds_read_b64_tr_b16 a[98:99], v166 offset:4608
    ds_read_b64_tr_b16 a[100:101], v167 offset:4096
    ds_read_b64_tr_b16 a[102:103], v167 offset:4608
    v_mul_f32 v181, v207, v207
    v_mfma_f32_32x32x16_bf16 a[16:31], a[68:71], v[64:67], a[16:31]
    ds_read_b64_tr_b16 a[104:105], v166 offset:12288
    ds_read_b64_tr_b16 a[106:107], v166 offset:12800
    ds_read_b64_tr_b16 a[108:109], v167 offset:12288
    ds_read_b64_tr_b16 a[110:111], v167 offset:12800
    v_fma_f32 v178, v178, s41, v173
    v_mfma_f32_32x32x16_bf16 a[32:47], a[72:75], v[64:67], a[32:47]
    buffer_load_dwordx4 a[176:179], v170, s[20:23], s67 offen offset:1024 sc1
    v_fma_f32 v179, v179, s41, v173
    v_fma_f32 v180, v180, s41, v173
    v_fma_f32 v181, v181, s41, v173
    v_mfma_f32_32x32x16_bf16 a[48:63], a[76:79], v[64:67], a[48:63]
    buffer_load_dwordx4 a[180:183], v170, s[20:23], s67 offen offset:2048 sc1
    v_mul_f32 v178, v178, v204
    v_mul_f32 v179, v179, v205
    s_waitcnt lgkmcnt(8)
    v_mfma_f32_32x32x16_bf16 a[0:15], a[80:83], v[68:71], a[0:15]
    ds_read_b64_tr_b16 a[64:65], v166 offset:6144
    ds_read_b64_tr_b16 a[66:67], v166 offset:6656
    ds_read_b64_tr_b16 a[68:69], v167 offset:6144
    ds_read_b64_tr_b16 a[70:71], v167 offset:6656
    v_mul_f32 v180, v180, v206
    v_mfma_f32_32x32x16_bf16 a[16:31], a[84:87], v[68:71], a[16:31]
    ds_read_b64_tr_b16 a[72:73], v166 offset:14336
    ds_read_b64_tr_b16 a[74:75], v166 offset:14848
    ds_read_b64_tr_b16 a[76:77], v167 offset:14336
    ds_read_b64_tr_b16 a[78:79], v167 offset:14848
    v_mul_f32 v181, v181, v207
    v_mfma_f32_32x32x16_bf16 a[32:47], a[88:91], v[68:71], a[32:47]
    buffer_load_dwordx4 a[184:187], v170, s[20:23], s67 offen offset:3072 sc1
    v_exp_f32 v178, v178
    v_mul_f32 v204, v204, v236
    v_exp_f32 v179, v179
    v_mul_f32 v205, v205, v237
    v_exp_f32 v180, v180
    v_mul_f32 v206, v206, v238
    v_mfma_f32_32x32x16_bf16 a[48:63], a[92:95], v[68:71], a[48:63]
    s_add_u32 s67, s57, 65536
    buffer_load_dwordx4 a[188:191], v170, s[20:23], s67 offen offset:0 sc1
    v_exp_f32 v181, v181
    v_mul_f32 v207, v207, v239
    v_fma_f32 v178, v178, v172, v172
    v_fma_f32 v179, v179, v172, v172
    s_waitcnt lgkmcnt(8)
    v_mfma_f32_32x32x16_bf16 a[0:15], a[96:99], v[72:75], a[0:15]
    ds_read_b64_tr_b16 a[80:81], v166 offset:16384
    ds_read_b64_tr_b16 a[82:83], v166 offset:16896
    ds_read_b64_tr_b16 a[84:85], v167 offset:16384
    ds_read_b64_tr_b16 a[86:87], v167 offset:16896
    v_fma_f32 v180, v180, v172, v172
    v_mfma_f32_32x32x16_bf16 a[16:31], a[100:103], v[72:75], a[16:31]
    v_lshrrev_b32 v56, 4, v170
    s_cmp_ge_u32 s28, 12
    s_cselect_b32 s61, 15, 14
    v_lshrrev_b32 v59, 4, v56
    v_sub_u32 v57, s27, v59
    v_cmp_gt_u32 vcc, 3, v59
    v_cmp_le_i32 s[94:95], 0, v57
    v_and_b32 v59, 15, v56
    s_and_b64 s[94:95], vcc, s[94:95]
    v_cmp_gt_u32 vcc, s61, v59
    v_lshlrev_b32 v57, 12, v57
    v_lshl_add_u32 v57, v59, 2, v57
    s_and_b64 vcc, vcc, s[94:95]
    v_add_u32 v57, s81, v57
    v_mov_b32 v58, -1
    v_mov_b32 v59, 0x7ff00000
    v_cndmask_b32 v58, v58, 2, vcc
    v_cndmask_b32 v57, v59, v57, vcc
    buffer_load_dword v61, v57, s[20:23], 0 offen sc1
    ds_read_b64_tr_b16 a[88:89], v166 offset:24576
    ds_read_b64_tr_b16 a[90:91], v166 offset:25088
    ds_read_b64_tr_b16 a[92:93], v167 offset:24576
    ds_read_b64_tr_b16 a[94:95], v167 offset:25088
    v_mfma_f32_32x32x16_bf16 a[32:47], a[104:107], v[72:75], a[32:47]
    s_add_u32 s67, s57, 81920
    buffer_load_dwordx4 a[192:195], v170, s[20:23], s67 offen offset:0 sc1
    v_fma_f32 v181, v181, v172, v172
    v_rcp_f32 v178, v178
    v_rcp_f32 v179, v179
    v_mfma_f32_32x32x16_bf16 a[48:63], a[108:111], v[72:75], a[48:63]
    buffer_load_dwordx4 a[196:199], v170, s[20:23], s67 offen offset:1024 sc1
    v_rcp_f32 v180, v180
    v_rcp_f32 v181, v181
    v_mul_f32 v204, v204, v178
    s_waitcnt lgkmcnt(8)
    v_mfma_f32_32x32x16_bf16 a[0:15], a[64:67], v[76:79], a[0:15]
    ds_read_b64_tr_b16 a[96:97], v166 offset:18432
    ds_read_b64_tr_b16 a[98:99], v166 offset:18944
    ds_read_b64_tr_b16 a[100:101], v167 offset:18432
    ds_read_b64_tr_b16 a[102:103], v167 offset:18944
    v_mul_f32 v205, v205, v179
    v_mfma_f32_32x32x16_bf16 a[16:31], a[68:71], v[76:79], a[16:31]
    ds_read_b64_tr_b16 a[104:105], v166 offset:26624
    ds_read_b64_tr_b16 a[106:107], v166 offset:27136
    ds_read_b64_tr_b16 a[108:109], v167 offset:26624
    ds_read_b64_tr_b16 a[110:111], v167 offset:27136
    v_mul_f32 v206, v206, v180
    v_mfma_f32_32x32x16_bf16 a[32:47], a[72:75], v[76:79], a[32:47]
    buffer_load_dwordx4 a[200:203], v170, s[20:23], s67 offen offset:2048 sc1
    v_mul_f32 v207, v207, v181
    v_cvt_pk_bf16_f32 v188, v204, v205
    v_cvt_pk_bf16_f32 v189, v206, v207
    v_mfma_f32_32x32x16_bf16 a[48:63], a[76:79], v[76:79], a[48:63]
    buffer_load_dwordx4 a[204:207], v170, s[20:23], s67 offen offset:3072 sc1
    s_add_u32 s42, s34, 1024
    buffer_store_dwordx4 v[186:189], v170, s[20:23], s42 offen sc1
    v_mul_f32 v208, v208, v171
    s_waitcnt lgkmcnt(8)
    v_mfma_f32_32x32x16_bf16 a[0:15], a[80:83], v[80:83], a[0:15]
    ds_read_b64_tr_b16 a[64:65], v166 offset:20480
    ds_read_b64_tr_b16 a[66:67], v166 offset:20992
    ds_read_b64_tr_b16 a[68:69], v167 offset:20480
    ds_read_b64_tr_b16 a[70:71], v167 offset:20992
    v_mul_f32 v209, v209, v171
    v_mfma_f32_32x32x16_bf16 a[16:31], a[84:87], v[80:83], a[16:31]
    ds_read_b64_tr_b16 a[72:73], v166 offset:28672
    ds_read_b64_tr_b16 a[74:75], v166 offset:29184
    ds_read_b64_tr_b16 a[76:77], v167 offset:28672
    ds_read_b64_tr_b16 a[78:79], v167 offset:29184
    v_mul_f32 v210, v210, v171
    v_mfma_f32_32x32x16_bf16 a[32:47], a[88:91], v[80:83], a[32:47]
    s_add_u32 s67, s57, 86016
    buffer_load_dwordx4 a[208:211], v170, s[20:23], s67 offen offset:0 sc1
    v_mul_f32 v211, v211, v171
    v_mul_f32 v174, v208, v208
    v_mul_f32 v175, v209, v209
    v_mfma_f32_32x32x16_bf16 a[48:63], a[92:95], v[80:83], a[48:63]
    s_add_u32 s67, s57, 102400
    buffer_load_dwordx4 a[212:215], v170, s[20:23], s67 offen offset:0 sc1
    v_mul_f32 v176, v210, v210
    v_mul_f32 v177, v211, v211
    v_fma_f32 v174, v174, s41, v173
    s_waitcnt lgkmcnt(8)
    v_mfma_f32_32x32x16_bf16 a[0:15], a[96:99], v[84:87], a[0:15]
    ds_read_b64_tr_b16 a[80:81], v166 offset:22528
    ds_read_b64_tr_b16 a[82:83], v166 offset:23040
    ds_read_b64_tr_b16 a[84:85], v167 offset:22528
    ds_read_b64_tr_b16 a[86:87], v167 offset:23040
    v_fma_f32 v175, v175, s41, v173
    v_mfma_f32_32x32x16_bf16 a[16:31], a[100:103], v[84:87], a[16:31]
    ds_read_b64_tr_b16 a[88:89], v166 offset:30720
    ds_read_b64_tr_b16 a[90:91], v166 offset:31232
    ds_read_b64_tr_b16 a[92:93], v167 offset:30720
    ds_read_b64_tr_b16 a[94:95], v167 offset:31232
    v_fma_f32 v176, v176, s41, v173
    v_mfma_f32_32x32x16_bf16 a[32:47], a[104:107], v[84:87], a[32:47]
    buffer_load_dwordx4 a[216:219], v170, s[20:23], s67 offen offset:1024 sc1
    v_fma_f32 v177, v177, s41, v173
    v_mul_f32 v174, v174, v208
    v_mfma_f32_32x32x16_bf16 a[48:63], a[108:111], v[84:87], a[48:63]
    buffer_load_dwordx4 a[220:223], v170, s[20:23], s67 offen offset:2048 sc1
    v_mul_f32 v175, v175, v209
    v_mul_f32 v176, v176, v210
    v_mul_f32 v177, v177, v211
    s_waitcnt lgkmcnt(8)
    v_mfma_f32_32x32x16_bf16 a[0:15], a[64:67], v[88:91], a[0:15]
    ds_read_b64_tr_b16 a[96:97], v166 offset:32768
    ds_read_b64_tr_b16 a[98:99], v166 offset:33280
    ds_read_b64_tr_b16 a[100:101], v167 offset:32768
    ds_read_b64_tr_b16 a[102:103], v167 offset:33280
    v_exp_f32 v174, v174
    v_mul_f32 v208, v208, v240
    v_mfma_f32_32x32x16_bf16 a[16:31], a[68:71], v[88:91], a[16:31]
    ds_read_b64_tr_b16 a[104:105], v166 offset:40960
    ds_read_b64_tr_b16 a[106:107], v166 offset:41472
    ds_read_b64_tr_b16 a[108:109], v167 offset:40960
    ds_read_b64_tr_b16 a[110:111], v167 offset:41472
    v_exp_f32 v175, v175
    v_mul_f32 v209, v209, v241
    v_mfma_f32_32x32x16_bf16 a[32:47], a[72:75], v[88:91], a[32:47]
    buffer_load_dwordx4 a[224:227], v170, s[20:23], s67 offen offset:3072 sc1
    v_exp_f32 v176, v176
    v_mul_f32 v210, v210, v242
    v_exp_f32 v177, v177
    v_mul_f32 v211, v211, v243
    v_fma_f32 v174, v174, v172, v172
    v_mfma_f32_32x32x16_bf16 a[48:63], a[76:79], v[88:91], a[48:63]
    s_add_u32 s67, s57, 106496
    buffer_load_dwordx4 a[228:231], v170, s[20:23], s67 offen offset:0 sc1
    v_fma_f32 v175, v175, v172, v172
    v_fma_f32 v176, v176, v172, v172
    s_waitcnt lgkmcnt(8)
    v_mfma_f32_32x32x16_bf16 a[0:15], a[80:83], v[92:95], a[0:15]
    ds_read_b64_tr_b16 a[64:65], v166 offset:34816
    ds_read_b64_tr_b16 a[66:67], v166 offset:35328
    ds_read_b64_tr_b16 a[68:69], v167 offset:34816
    ds_read_b64_tr_b16 a[70:71], v167 offset:35328
    v_fma_f32 v177, v177, v172, v172
    v_mfma_f32_32x32x16_bf16 a[16:31], a[84:87], v[92:95], a[16:31]
    ds_read_b64_tr_b16 a[72:73], v166 offset:43008
    ds_read_b64_tr_b16 a[74:75], v166 offset:43520
    ds_read_b64_tr_b16 a[76:77], v167 offset:43008
    ds_read_b64_tr_b16 a[78:79], v167 offset:43520
    v_rcp_f32 v174, v174
    v_mfma_f32_32x32x16_bf16 a[32:47], a[88:91], v[92:95], a[32:47]
    s_add_u32 s67, s57, 122880
    buffer_load_dwordx4 a[232:235], v170, s[20:23], s67 offen offset:0 sc1
    v_rcp_f32 v175, v175
    v_rcp_f32 v176, v176
    v_rcp_f32 v177, v177
    v_mfma_f32_32x32x16_bf16 a[48:63], a[92:95], v[92:95], a[48:63]
    buffer_load_dwordx4 a[236:239], v170, s[20:23], s67 offen offset:1024 sc1
    v_mul_f32 v208, v208, v174
    v_mul_f32 v209, v209, v175
    v_mul_f32 v210, v210, v176
    s_waitcnt lgkmcnt(8)
    v_mfma_f32_32x32x16_bf16 a[0:15], a[96:99], v[96:99], a[0:15]
    s_waitcnt vmcnt(35)
    s_cmp_lg_u32 s25, 0
    s_cbranch_scc1 PD4
    s_waitcnt vmcnt(13)
    s_mov_b32 s88, 0
    s_add_u32 s83, s98, 1
PL4:
    v_subrev_u32 v61, s83, v61
    v_cmp_lt_u32 vcc, v58, v61
    s_cbranch_vccz PD4
    s_add_u32 s88, s88, 1
    s_cmp_gt_u32 s88, 0x40000
    s_cbranch_scc1 PD4
    s_sleep 4
    buffer_load_dword v61, v57, s[20:23], 0 offen sc1
    s_waitcnt vmcnt(0)
    s_branch PL4
PD4:
    s_barrier
    s_mul_i32 s62, s28, 5
    s_lshr_b32 s62, s62, 1
    s_lshl_b32 s63, s27, 2
    s_add_u32 s63, s63, s25
    s_mul_i32 s64, s63, 122880
    s_lshl_b32 s65, s62, 10
    s_add_u32 s64, s64, s65
    s_mov_b32 s61, s28
    ds_read_b64_tr_b16 a[80:81], v166 offset:36864
    ds_read_b64_tr_b16 a[82:83], v166 offset:37376
    ds_read_b64_tr_b16 a[84:85], v167 offset:36864
    ds_read_b64_tr_b16 a[86:87], v167 offset:37376
    v_mul_f32 v211, v211, v177
    v_mfma_f32_32x32x16_bf16 a[16:31], a[100:103], v[96:99], a[16:31]
    ds_read_b64_tr_b16 a[88:89], v166 offset:45056
    ds_read_b64_tr_b16 a[90:91], v166 offset:45568
    ds_read_b64_tr_b16 a[92:93], v167 offset:45056
    ds_read_b64_tr_b16 a[94:95], v167 offset:45568
    v_cvt_pk_bf16_f32 v182, v208, v209
    v_mfma_f32_32x32x16_bf16 a[32:47], a[104:107], v[96:99], a[32:47]
    buffer_load_dwordx4 a[240:243], v170, s[20:23], s67 offen offset:2048 sc1
    v_cvt_pk_bf16_f32 v183, v210, v211
    v_mul_f32 v212, v212, v171
    v_mfma_f32_32x32x16_bf16 a[48:63], a[108:111], v[96:99], a[48:63]
    buffer_load_dwordx4 a[244:247], v170, s[20:23], s67 offen offset:3072 sc1
    v_mul_f32 v213, v213, v171
    v_mul_f32 v214, v214, v171
    v_mul_f32 v215, v215, v171
    s_waitcnt lgkmcnt(8)
    v_mfma_f32_32x32x16_bf16 a[0:15], a[64:67], v[100:103], a[0:15]
    ds_read_b64_tr_b16 a[96:97], v166 offset:38912
    ds_read_b64_tr_b16 a[98:99], v166 offset:39424
    ds_read_b64_tr_b16 a[100:101], v167 offset:38912
    ds_read_b64_tr_b16 a[102:103], v167 offset:39424
    v_mul_f32 v178, v212, v212
    v_mfma_f32_32x32x16_bf16 a[16:31], a[68:71], v[100:103], a[16:31]
    ds_read_b64_tr_b16 a[104:105], v166 offset:47104
    ds_read_b64_tr_b16 a[106:107], v166 offset:47616
    ds_read_b64_tr_b16 a[108:109], v167 offset:47104
    ds_read_b64_tr_b16 a[110:111], v167 offset:47616
    v_mul_f32 v179, v213, v213
    v_mfma_f32_32x32x16_bf16 a[32:47], a[72:75], v[100:103], a[32:47]
    s_add_u32 s67, s57, 126976
    buffer_load_dwordx4 a[248:251], v170, s[20:23], s67 offen offset:0 sc1
    v_mul_f32 v180, v214, v214
    v_mul_f32 v181, v215, v215
    v_fma_f32 v178, v178, s41, v173
    v_mfma_f32_32x32x16_bf16 a[48:63], a[76:79], v[100:103], a[48:63]
    s_add_u32 s65, s64, 4294025216
    s_cmp_lt_u32 s63, 8
    s_cselect_b32 s65, 0x7ff00000, s65
    buffer_load_dwordx4 v[0:3], v170, s[20:23], s65 offen offset:0 sc1
    v_fma_f32 v179, v179, s41, v173
    v_fma_f32 v180, v180, s41, v173
    v_fma_f32 v181, v181, s41, v173
    s_waitcnt lgkmcnt(8)
    v_mfma_f32_32x32x16_bf16 a[0:15], a[80:83], v[104:107], a[0:15]
    ds_read_b64_tr_b16 a[64:65], v166 offset:49152
    ds_read_b64_tr_b16 a[66:67], v166 offset:49664
    ds_read_b64_tr_b16 a[68:69], v167 offset:49152
    ds_read_b64_tr_b16 a[70:71], v167 offset:49664
    v_mfma_f32_32x32x16_bf16 a[16:31], a[84:87], v[104:107], a[16:31]
    ds_read_b64_tr_b16 a[72:73], v166 offset:57344
    ds_read_b64_tr_b16 a[74:75], v166 offset:57856
    ds_read_b64_tr_b16 a[76:77], v167 offset:57344
    ds_read_b64_tr_b16 a[78:79], v167 offset:57856
    v_mul_f32 v178, v178, v212
    v_mfma_f32_32x32x16_bf16 a[32:47], a[88:91], v[104:107], a[32:47]
    buffer_load_dwordx4 v[4:7], v170, s[20:23], s65 offen offset:1024 sc1
    v_mul_f32 v179, v179, v213
    v_mul_f32 v180, v180, v214
    v_mul_f32 v181, v181, v215
    v_mfma_f32_32x32x16_bf16 a[48:63], a[92:95], v[104:107], a[48:63]
    buffer_load_dwordx4 v[8:11], v170, s[20:23], s65 offen offset:2048 sc1
    v_exp_f32 v178, v178
    v_mul_f32 v212, v212, v244
    v_exp_f32 v179, v179
    v_mul_f32 v213, v213, v245
    v_exp_f32 v180, v180
    v_mul_f32 v214, v214, v246
    s_waitcnt lgkmcnt(8)
    v_mfma_f32_32x32x16_bf16 a[0:15], a[96:99], v[108:111], a[0:15]
    ds_read_b64_tr_b16 a[80:81], v166 offset:51200
    ds_read_b64_tr_b16 a[82:83], v166 offset:51712
    ds_read_b64_tr_b16 a[84:85], v167 offset:51200
    ds_read_b64_tr_b16 a[86:87], v167 offset:51712
    v_exp_f32 v181, v181
    v_mul_f32 v215, v215, v247
    v_mfma_f32_32x32x16_bf16 a[16:31], a[100:103], v[108:111], a[16:31]
    ds_read_b64_tr_b16 a[88:89], v166 offset:59392
    ds_read_b64_tr_b16 a[90:91], v166 offset:59904
    ds_read_b64_tr_b16 a[92:93], v167 offset:59392
    ds_read_b64_tr_b16 a[94:95], v167 offset:59904
    v_fma_f32 v178, v178, v172, v172
    v_mfma_f32_32x32x16_bf16 a[32:47], a[104:107], v[108:111], a[32:47]
    s_add_u32 s65, s64, 4294066176
    s_cmp_lt_u32 s63, 8
    s_cselect_b32 s65, 0x7ff00000, s65
    buffer_load_dwordx4 v[12:15], v170, s[20:23], s65 offen offset:0 sc1
    v_fma_f32 v179, v179, v172, v172
    v_fma_f32 v180, v180, v172, v172
    v_mfma_f32_32x32x16_bf16 a[48:63], a[108:111], v[108:111], a[48:63]
    buffer_load_dwordx4 v[16:19], v170, s[20:23], s65 offen offset:1024 sc1
    v_fma_f32 v181, v181, v172, v172
    v_rcp_f32 v178, v178
    v_rcp_f32 v179, v179
    s_waitcnt lgkmcnt(8)
    v_mfma_f32_32x32x16_bf16 a[0:15], a[64:67], v[112:115], a[0:15]
    ds_read_b64_tr_b16 a[96:97], v166 offset:53248
    ds_read_b64_tr_b16 a[98:99], v166 offset:53760
    ds_read_b64_tr_b16 a[100:101], v167 offset:53248
    ds_read_b64_tr_b16 a[102:103], v167 offset:53760
    v_rcp_f32 v180, v180
    v_mfma_f32_32x32x16_bf16 a[16:31], a[68:71], v[112:115], a[16:31]
    ds_read_b64_tr_b16 a[104:105], v166 offset:61440
    ds_read_b64_tr_b16 a[106:107], v166 offset:61952
    ds_read_b64_tr_b16 a[108:109], v167 offset:61440
    ds_read_b64_tr_b16 a[110:111], v167 offset:61952
    v_rcp_f32 v181, v181
    v_mfma_f32_32x32x16_bf16 a[32:47], a[72:75], v[112:115], a[32:47]
    buffer_load_dwordx4 v[20:23], v170, s[20:23], s65 offen offset:2048 sc1
    v_mul_f32 v212, v212, v178
    v_mul_f32 v213, v213, v179
    v_mul_f32 v214, v214, v180
    v_mfma_f32_32x32x16_bf16 a[48:63], a[76:79], v[112:115], a[48:63]
    s_add_u32 s65, s64, 4294516736
    s_cmp_lt_u32 s63, 4
    s_cselect_b32 s65, 0x7ff00000, s65
    buffer_load_dwordx4 v[24:27], v170, s[20:23], s65 offen offset:0 sc1
    v_mul_f32 v215, v215, v181
    v_cvt_pk_bf16_f32 v184, v212, v213
    v_cvt_pk_bf16_f32 v185, v214, v215
    s_waitcnt lgkmcnt(8)
    v_mfma_f32_32x32x16_bf16 a[0:15], a[80:83], v[116:119], a[0:15]
    ds_read_b64_tr_b16 a[64:65], v166 offset:55296
    ds_read_b64_tr_b16 a[66:67], v166 offset:55808
    ds_read_b64_tr_b16 a[68:69], v167 offset:55296
    ds_read_b64_tr_b16 a[70:71], v167 offset:55808
    s_add_u32 s42, s34, 2048
    buffer_store_dwordx4 v[182:185], v170, s[20:23], s42 offen sc1
    v_mfma_f32_32x32x16_bf16 a[16:31], a[84:87], v[116:119], a[16:31]
    ds_read_b64_tr_b16 a[72:73], v166 offset:63488
    ds_read_b64_tr_b16 a[74:75], v166 offset:64000
    ds_read_b64_tr_b16 a[76:77], v167 offset:63488
    ds_read_b64_tr_b16 a[78:79], v167 offset:64000
    v_mfma_f32_32x32x16_bf16 a[32:47], a[88:91], v[116:119], a[32:47]
    buffer_load_dwordx4 v[28:31], v170, s[20:23], s65 offen offset:1024 sc1
    v_mul_f32 v216, v216, v171
    v_mul_f32 v217, v217, v171
    v_mul_f32 v218, v218, v171
    v_mfma_f32_32x32x16_bf16 a[48:63], a[92:95], v[116:119], a[48:63]
    buffer_load_dwordx4 v[32:35], v170, s[20:23], s65 offen offset:2048 sc1
    v_mul_f32 v219, v219, v171
    v_mul_f32 v174, v216, v216
    v_mul_f32 v175, v217, v217
    s_waitcnt lgkmcnt(8)
    v_mfma_f32_32x32x16_bf16 a[0:15], a[96:99], v[120:123], a[0:15]
    ds_read_b64_tr_b16 a[80:81], v168 offset:0
    ds_read_b64_tr_b16 a[82:83], v168 offset:512
    ds_read_b64_tr_b16 a[84:85], v169 offset:0
    ds_read_b64_tr_b16 a[86:87], v169 offset:512
    v_mul_f32 v176, v218, v218
    v_mfma_f32_32x32x16_bf16 a[16:31], a[100:103], v[120:123], a[16:31]
    ds_read_b64_tr_b16 a[88:89], v168 offset:8192
    ds_read_b64_tr_b16 a[90:91], v168 offset:8704
    ds_read_b64_tr_b16 a[92:93], v169 offset:8192
    ds_read_b64_tr_b16 a[94:95], v169 offset:8704
    v_mul_f32 v177, v219, v219
    v_mfma_f32_32x32x16_bf16 a[32:47], a[104:107], v[120:123], a[32:47]
    s_add_u32 s65, s64, 4294557696
    s_cmp_lt_u32 s63, 4
    s_cselect_b32 s65, 0x7ff00000, s65
    buffer_load_dwordx4 v[36:39], v170, s[20:23], s65 offen offset:0 sc1
    v_fma_f32 v174, v174, s41, v173
    v_fma_f32 v175, v175, s41, v173
    v_fma_f32 v176, v176, s41, v173
    v_mfma_f32_32x32x16_bf16 a[48:63], a[108:111], v[120:123], a[48:63]
    buffer_load_dwordx4 v[40:43], v170, s[20:23], s65 offen offset:1024 sc1
    v_fma_f32 v177, v177, s41, v173
    v_mul_f32 v174, v174, v216
    s_waitcnt lgkmcnt(8)
    v_mfma_f32_32x32x16_bf16 a[0:15], a[64:67], v[124:127], a[0:15]
    ds_read_b64_tr_b16 a[96:97], v168 offset:2048
    ds_read_b64_tr_b16 a[98:99], v168 offset:2560
    ds_read_b64_tr_b16 a[100:101], v169 offset:2048
    ds_read_b64_tr_b16 a[102:103], v169 offset:2560
    v_mul_f32 v175, v175, v217
    v_mfma_f32_32x32x16_bf16 a[16:31], a[68:71], v[124:127], a[16:31]
    ds_read_b64_tr_b16 a[104:105], v168 offset:10240
    ds_read_b64_tr_b16 a[106:107], v168 offset:10752
    ds_read_b64_tr_b16 a[108:109], v169 offset:10240
    ds_read_b64_tr_b16 a[110:111], v169 offset:10752
    v_mul_f32 v176, v176, v218
    v_mfma_f32_32x32x16_bf16 a[32:47], a[72:75], v[124:127], a[32:47]
    buffer_load_dwordx4 v[44:47], v170, s[20:23], s65 offen offset:2048 sc1
    v_mul_f32 v177, v177, v219
    v_exp_f32 v174, v174
    v_mul_f32 v216, v216, v248
    v_exp_f32 v175, v175
    v_mul_f32 v217, v217, v249
    v_mfma_f32_32x32x16_bf16 a[48:63], a[76:79], v[124:127], a[48:63]
    s_add_u32 s65, s64, 40960
    buffer_load_dwordx4 v[48:51], v170, s[20:23], s65 offen offset:0 sc1
    v_exp_f32 v176, v176
    v_mul_f32 v218, v218, v250
    v_exp_f32 v177, v177
    v_mul_f32 v219, v219, v251
    v_fma_f32 v174, v174, v172, v172
    s_waitcnt lgkmcnt(8)
    v_mfma_f32_32x32x16_bf16 a[0:15], a[80:83], v[128:131], a[0:15]
    ds_read_b64_tr_b16 a[64:65], v168 offset:4096
    ds_read_b64_tr_b16 a[66:67], v168 offset:4608
    ds_read_b64_tr_b16 a[68:69], v169 offset:4096
    ds_read_b64_tr_b16 a[70:71], v169 offset:4608
    v_fma_f32 v175, v175, v172, v172
    v_mfma_f32_32x32x16_bf16 a[16:31], a[84:87], v[128:131], a[16:31]
    ds_read_b64_tr_b16 a[72:73], v168 offset:12288
    ds_read_b64_tr_b16 a[74:75], v168 offset:12800
    ds_read_b64_tr_b16 a[76:77], v169 offset:12288
    ds_read_b64_tr_b16 a[78:79], v169 offset:12800
    v_fma_f32 v176, v176, v172, v172
    v_mfma_f32_32x32x16_bf16 a[32:47], a[88:91], v[128:131], a[32:47]
    buffer_load_dwordx4 v[52:55], v170, s[20:23], s65 offen offset:1024 sc1
    v_fma_f32 v177, v177, v172, v172
    v_rcp_f32 v174, v174
    v_mfma_f32_32x32x16_bf16 a[48:63], a[92:95], v[128:131], a[48:63]
    buffer_load_dwordx4 v[56:59], v170, s[20:23], s65 offen offset:2048 sc1
    v_rcp_f32 v175, v175
    v_rcp_f32 v176, v176
    v_rcp_f32 v177, v177
    s_waitcnt lgkmcnt(8)
    v_mfma_f32_32x32x16_bf16 a[0:15], a[96:99], v[132:135], a[0:15]
    ds_read_b64_tr_b16 a[80:81], v168 offset:6144
    ds_read_b64_tr_b16 a[82:83], v168 offset:6656
    ds_read_b64_tr_b16 a[84:85], v169 offset:6144
    ds_read_b64_tr_b16 a[86:87], v169 offset:6656
    v_mul_f32 v216, v216, v174
    v_mfma_f32_32x32x16_bf16 a[16:31], a[100:103], v[132:135], a[16:31]
    ds_read_b64_tr_b16 a[88:89], v168 offset:14336
    ds_read_b64_tr_b16 a[90:91], v168 offset:14848
    ds_read_b64_tr_b16 a[92:93], v169 offset:14336
    ds_read_b64_tr_b16 a[94:95], v169 offset:14848
    v_mul_f32 v217, v217, v175
    v_mfma_f32_32x32x16_bf16 a[32:47], a[104:107], v[132:135], a[32:47]
    s_add_u32 s65, s64, 81920
    buffer_load_dwordx4 v[60:63], v170, s[20:23], s65 offen offset:0 sc1
    v_mul_f32 v218, v218, v176
    v_mul_f32 v219, v219, v177
    v_cvt_pk_bf16_f32 v186, v216, v217
    v_mfma_f32_32x32x16_bf16 a[48:63], a[108:111], v[132:135], a[48:63]
    buffer_load_dwordx4 v[64:67], v170, s[20:23], s65 offen offset:1024 sc1
    v_cvt_pk_bf16_f32 v187, v218, v219
    v_mul_f32 v220, v220, v171
    s_waitcnt lgkmcnt(8)
    v_mfma_f32_32x32x16_bf16 a[0:15], a[64:67], v[136:139], a[0:15]
    ds_read_b64_tr_b16 a[96:97], v168 offset:16384
    ds_read_b64_tr_b16 a[98:99], v168 offset:16896
    ds_read_b64_tr_b16 a[100:101], v169 offset:16384
    ds_read_b64_tr_b16 a[102:103], v169 offset:16896
    v_mul_f32 v221, v221, v171
    v_mfma_f32_32x32x16_bf16 a[16:31], a[68:71], v[136:139], a[16:31]
    ds_read_b64_tr_b16 a[104:105], v168 offset:24576
    ds_read_b64_tr_b16 a[106:107], v168 offset:25088
    ds_read_b64_tr_b16 a[108:109], v169 offset:24576
    ds_read_b64_tr_b16 a[110:111], v169 offset:25088
    v_mul_f32 v222, v222, v171
    v_mfma_f32_32x32x16_bf16 a[32:47], a[72:75], v[136:139], a[32:47]
    buffer_load_dwordx4 v[68:71], v170, s[20:23], s65 offen offset:2048 sc1
    v_mul_f32 v223, v223, v171
    v_mul_f32 v178, v220, v220
    v_mul_f32 v179, v221, v221
    v_mfma_f32_32x32x16_bf16 a[48:63], a[76:79], v[136:139], a[48:63]
    s_and_b32 s66, s61, 1
    v_and_b32 v84, 0x1ff, v170
    v_lshrrev_b32 v85, 9, v170
    s_cmp_eq_u32 s66, 0
    s_cbranch_scc0 AQ0_5
    v_mul_u32_u24 v86, 8, v85
    v_add_u32 v86, v86, v84
    buffer_load_dwordx2 v[72:73], v86, s[20:23], s64 offen offset:0 sc1
    buffer_load_dwordx2 v[74:75], v86, s[20:23], s64 offen offset:512 sc1
    buffer_load_dwordx2 v[76:77], v84, s[20:23], s64 offen offset:1024 sc1
    v_mul_u32_u24 v86, 1016, v85
    v_add_u32 v86, v86, v84
    buffer_load_dwordx2 v[78:79], v86, s[20:23], s64 offen offset:1032 sc1
    buffer_load_dwordx2 v[80:81], v86, s[20:23], s64 offen offset:1544 sc1
    buffer_load_dwordx2 v[82:83], v84, s[20:23], s64 offen offset:1536 sc1
AQ0_5:
    s_cmp_eq_u32 s66, 1
    s_cbranch_scc0 AQ1_5
    v_mul_u32_u24 v86, 1016, v85
    v_add_u32 v86, v86, v84
    buffer_load_dwordx2 v[72:73], v86, s[20:23], s64 offen offset:8 sc1
    buffer_load_dwordx2 v[74:75], v86, s[20:23], s64 offen offset:520 sc1
    buffer_load_dwordx2 v[76:77], v84, s[20:23], s64 offen offset:1032 sc1
    v_mul_u32_u24 v86, 8, v85
    v_add_u32 v86, v86, v84
    buffer_load_dwordx2 v[78:79], v86, s[20:23], s64 offen offset:2048 sc1
    buffer_load_dwordx2 v[80:81], v86, s[20:23], s64 offen offset:2560 sc1
    buffer_load_dwordx2 v[82:83], v84, s[20:23], s64 offen offset:1544 sc1
AQ1_5:
    v_mul_f32 v180, v222, v222
    v_mul_f32 v181, v223, v223
    v_fma_f32 v178, v178, s41, v173
    s_waitcnt lgkmcnt(8)
    v_mfma_f32_32x32x16_bf16 a[0:15], a[80:83], v[140:143], a[0:15]
    ds_read_b64_tr_b16 a[64:65], v168 offset:18432
    ds_read_b64_tr_b16 a[66:67], v168 offset:18944
    ds_read_b64_tr_b16 a[68:69], v169 offset:18432
    ds_read_b64_tr_b16 a[70:71], v169 offset:18944
    v_fma_f32 v179, v179, s41, v173
    v_mfma_f32_32x32x16_bf16 a[16:31], a[84:87], v[140:143], a[16:31]
    ds_read_b64_tr_b16 a[72:73], v168 offset:26624
    ds_read_b64_tr_b16 a[74:75], v168 offset:27136
    ds_read_b64_tr_b16 a[76:77], v169 offset:26624
    ds_read_b64_tr_b16 a[78:79], v169 offset:27136
    v_fma_f32 v180, v180, s41, v173
    v_mfma_f32_32x32x16_bf16 a[32:47], a[88:91], v[140:143], a[32:47]
    v_fma_f32 v181, v181, s41, v173
    v_mul_f32 v178, v178, v220
    v_mfma_f32_32x32x16_bf16 a[48:63], a[92:95], v[140:143], a[48:63]
    v_mul_f32 v179, v179, v221
    v_mul_f32 v180, v180, v222
    v_mul_f32 v181, v181, v223
    s_waitcnt lgkmcnt(8)
    v_mfma_f32_32x32x16_bf16 a[0:15], a[96:99], v[144:147], a[0:15]
    ds_read_b64_tr_b16 a[80:81], v168 offset:20480
    ds_read_b64_tr_b16 a[82:83], v168 offset:20992
    ds_read_b64_tr_b16 a[84:85], v169 offset:20480
    ds_read_b64_tr_b16 a[86:87], v169 offset:20992
    v_exp_f32 v178, v178
    v_mul_f32 v220, v220, v252
    v_mfma_f32_32x32x16_bf16 a[16:31], a[100:103], v[144:147], a[16:31]
    ds_read_b64_tr_b16 a[88:89], v168 offset:28672
    ds_read_b64_tr_b16 a[90:91], v168 offset:29184
    ds_read_b64_tr_b16 a[92:93], v169 offset:28672
    ds_read_b64_tr_b16 a[94:95], v169 offset:29184
    v_exp_f32 v179, v179
    v_mul_f32 v221, v221, v253
    v_mfma_f32_32x32x16_bf16 a[32:47], a[104:107], v[144:147], a[32:47]
    v_exp_f32 v180, v180
    v_mul_f32 v222, v222, v254
    v_exp_f32 v181, v181
    v_mul_f32 v223, v223, v255
    v_fma_f32 v178, v178, v172, v172
    v_mfma_f32_32x32x16_bf16 a[48:63], a[108:111], v[144:147], a[48:63]
    v_fma_f32 v179, v179, v172, v172
    v_fma_f32 v180, v180, v172, v172
    s_waitcnt lgkmcnt(8)
    v_mfma_f32_32x32x16_bf16 a[0:15], a[64:67], v[148:151], a[0:15]
    ds_read_b64_tr_b16 a[96:97], v168 offset:22528
    ds_read_b64_tr_b16 a[98:99], v168 offset:23040
    ds_read_b64_tr_b16 a[100:101], v169 offset:22528
    ds_read_b64_tr_b16 a[102:103], v169 offset:23040
    v_fma_f32 v181, v181, v172, v172
    v_mfma_f32_32x32x16_bf16 a[16:31], a[68:71], v[148:151], a[16:31]
    ds_read_b64_tr_b16 a[104:105], v168 offset:30720
    ds_read_b64_tr_b16 a[106:107], v168 offset:31232
    ds_read_b64_tr_b16 a[108:109], v169 offset:30720
    ds_read_b64_tr_b16 a[110:111], v169 offset:31232
    v_rcp_f32 v178, v178
    v_mfma_f32_32x32x16_bf16 a[32:47], a[72:75], v[148:151], a[32:47]
    v_rcp_f32 v179, v179
    v_rcp_f32 v180, v180
    v_rcp_f32 v181, v181
    v_mfma_f32_32x32x16_bf16 a[48:63], a[76:79], v[148:151], a[48:63]
    v_mul_f32 v220, v220, v178
    v_mul_f32 v221, v221, v179
    v_mul_f32 v222, v222, v180
    s_waitcnt lgkmcnt(8)
    v_mfma_f32_32x32x16_bf16 a[0:15], a[80:83], v[152:155], a[0:15]
    v_mul_f32 v223, v223, v181
    v_mfma_f32_32x32x16_bf16 a[16:31], a[84:87], v[152:155], a[16:31]
    v_cvt_pk_bf16_f32 v188, v220, v221
    v_mfma_f32_32x32x16_bf16 a[32:47], a[88:91], v[152:155], a[32:47]
    v_cvt_pk_bf16_f32 v189, v222, v223
    s_add_u32 s42, s34, 3072
    buffer_store_dwordx4 v[186:189], v170, s[20:23], s42 offen sc1
    v_mfma_f32_32x32x16_bf16 a[48:63], a[92:95], v[152:155], a[48:63]
    s_waitcnt lgkmcnt(0)
    v_mfma_f32_32x32x16_bf16 a[0:15], a[96:99], v[156:159], a[0:15]
    v_mfma_f32_32x32x16_bf16 a[16:31], a[100:103], v[156:159], a[16:31]
    v_mfma_f32_32x32x16_bf16 a[32:47], a[104:107], v[156:159], a[32:47]
    v_mfma_f32_32x32x16_bf16 a[48:63], a[108:111], v[156:159], a[48:63]
    v_lshrrev_b32 v106, 9, v170
    v_mul_u32_u24 v106, 288, v106
    v_bfe_u32 v107, v170, 4, 5
    v_lshl_add_u32 v106, v107, 3, v106
    s_mul_i32 s67, s25, 3744
    s_add_u32 s67, s67, 41472
    v_add_u32 v107, s67, v106
    s_mul_i32 s67, s25, 3456
    v_add_u32 v106, s67, v106
    s_waitcnt vmcnt(1)
    v_mov_b32 v92, s41
    v_mov_b32 v93, s41
    v_mov_b32 v94, v173
    v_mov_b32 v95, v173
    v_mov_b32 v96, v171
    v_mov_b32 v97, v171
    v_mov_b32 v98, v172
    v_mov_b32 v99, v172
    s_nop 3
    v_accvgpr_read_b32 v192, a0
    ds_write_b64 v106, v[0:1] offset:0
    v_accvgpr_read_b32 v193, a1
    v_accvgpr_read_b32 v194, a2
    v_accvgpr_read_b32 v195, a3
    v_accvgpr_read_b32 v224, a32
    v_accvgpr_read_b32 v225, a33
    ds_write_b64 v106, v[2:3] offset:576
    v_accvgpr_read_b32 v226, a34
    v_accvgpr_read_b32 v227, a35
    v_pk_mul_f32 v[192:193], v[192:193], v[96:97]
    v_pk_mul_f32 v[194:195], v[194:195], v[96:97]
    v_pk_mul_f32 v[174:175], v[192:193], v[192:193]
    ds_write_b64 v106, v[4:5] offset:1152
    v_pk_mul_f32 v[176:177], v[194:195], v[194:195]
    v_pk_fma_f32 v[174:175], v[174:175], v[92:93], v[94:95]
    v_pk_fma_f32 v[176:177], v[176:177], v[92:93], v[94:95]
    v_pk_mul_f32 v[174:175], v[174:175], v[192:193]
    v_pk_mul_f32 v[176:177], v[176:177], v[194:195]
    ds_write_b64 v106, v[6:7] offset:1728
    v_exp_f32 v174, v174
    v_exp_f32 v175, v175
    v_exp_f32 v176, v176
    v_exp_f32 v177, v177
    v_pk_mul_f32 v[192:193], v[192:193], v[224:225]
    ds_write_b64 v106, v[8:9] offset:2304
    v_pk_mul_f32 v[194:195], v[194:195], v[226:227]
    v_pk_fma_f32 v[174:175], v[174:175], v[98:99], v[98:99]
    v_pk_fma_f32 v[176:177], v[176:177], v[98:99], v[98:99]
    v_rcp_f32 v174, v174
    v_rcp_f32 v175, v175
    ds_write_b64 v106, v[10:11] offset:2880
    v_rcp_f32 v176, v176
    v_rcp_f32 v177, v177
    s_nop 0
    v_pk_mul_f32 v[192:193], v[192:193], v[174:175]
    v_pk_mul_f32 v[194:195], v[194:195], v[176:177]
    ds_write_b64 v107, v[12:13] offset:0
    v_cvt_pk_bf16_f32 v182, v192, v193
    v_cvt_pk_bf16_f32 v183, v194, v195
    v_accvgpr_read_b32 v196, a4
    v_accvgpr_read_b32 v197, a5
    v_accvgpr_read_b32 v198, a6
    ds_write_b64 v107, v[14:15] offset:576
    v_accvgpr_read_b32 v199, a7
    v_accvgpr_read_b32 v228, a36
    v_accvgpr_read_b32 v229, a37
    v_accvgpr_read_b32 v230, a38
    v_accvgpr_read_b32 v231, a39
    ds_write_b64 v107, v[16:17] offset:1152
    v_pk_mul_f32 v[196:197], v[196:197], v[96:97]
    v_pk_mul_f32 v[198:199], v[198:199], v[96:97]
    v_pk_mul_f32 v[178:179], v[196:197], v[196:197]
    v_pk_mul_f32 v[180:181], v[198:199], v[198:199]
    v_pk_fma_f32 v[178:179], v[178:179], v[92:93], v[94:95]
    ds_write_b64 v107, v[18:19] offset:1728
    v_pk_fma_f32 v[180:181], v[180:181], v[92:93], v[94:95]
    v_pk_mul_f32 v[178:179], v[178:179], v[196:197]
    v_pk_mul_f32 v[180:181], v[180:181], v[198:199]
    v_exp_f32 v178, v178
    v_exp_f32 v179, v179
    ds_write_b64 v107, v[20:21] offset:2304
    v_exp_f32 v180, v180
    v_exp_f32 v181, v181
    v_pk_mul_f32 v[196:197], v[196:197], v[228:229]
    v_pk_mul_f32 v[198:199], v[198:199], v[230:231]
    v_pk_fma_f32 v[178:179], v[178:179], v[98:99], v[98:99]
    ds_write_b64 v107, v[22:23] offset:2880
    v_pk_fma_f32 v[180:181], v[180:181], v[98:99], v[98:99]
    v_rcp_f32 v178, v178
    v_rcp_f32 v179, v179
    v_rcp_f32 v180, v180
    v_rcp_f32 v181, v181
    ds_write_b64 v106, v[24:25] offset:13824
    s_nop 0
    v_pk_mul_f32 v[196:197], v[196:197], v[178:179]
    v_pk_mul_f32 v[198:199], v[198:199], v[180:181]
    v_cvt_pk_bf16_f32 v184, v196, v197
    v_cvt_pk_bf16_f32 v185, v198, v199
    ds_write_b64 v106, v[26:27] offset:14400
    s_add_u32 s42, s35, 0
    buffer_store_dwordx4 v[182:185], v170, s[20:23], s42 offen sc1
    v_accvgpr_read_b32 v200, a8
    v_accvgpr_read_b32 v201, a9
    v_accvgpr_read_b32 v202, a10
    v_accvgpr_read_b32 v203, a11
    ds_write_b64 v106, v[28:29] offset:14976
    v_accvgpr_read_b32 v232, a40
    v_accvgpr_read_b32 v233, a41
    v_accvgpr_read_b32 v234, a42
    v_accvgpr_read_b32 v235, a43
    v_pk_mul_f32 v[200:201], v[200:201], v[96:97]
    ds_write_b64 v106, v[30:31] offset:15552
    v_pk_mul_f32 v[202:203], v[202:203], v[96:97]
    v_pk_mul_f32 v[174:175], v[200:201], v[200:201]
    v_pk_mul_f32 v[176:177], v[202:203], v[202:203]
    v_pk_fma_f32 v[174:175], v[174:175], v[92:93], v[94:95]
    v_pk_fma_f32 v[176:177], v[176:177], v[92:93], v[94:95]
    ds_write_b64 v106, v[32:33] offset:16128
    v_pk_mul_f32 v[174:175], v[174:175], v[200:201]
    v_pk_mul_f32 v[176:177], v[176:177], v[202:203]
    v_exp_f32 v174, v174
    v_exp_f32 v175, v175
    v_exp_f32 v176, v176
    ds_write_b64 v106, v[34:35] offset:16704
    v_exp_f32 v177, v177
    v_pk_mul_f32 v[200:201], v[200:201], v[232:233]
    v_pk_mul_f32 v[202:203], v[202:203], v[234:235]
    v_pk_fma_f32 v[174:175], v[174:175], v[98:99], v[98:99]
    v_pk_fma_f32 v[176:177], v[176:177], v[98:99], v[98:99]
    ds_write_b64 v107, v[36:37] offset:14976
    v_rcp_f32 v174, v174
    v_rcp_f32 v175, v175
    v_rcp_f32 v176, v176
    v_rcp_f32 v177, v177
    s_nop 0
    ds_write_b64 v107, v[38:39] offset:15552
    v_pk_mul_f32 v[200:201], v[200:201], v[174:175]
    v_pk_mul_f32 v[202:203], v[202:203], v[176:177]
    v_cvt_pk_bf16_f32 v186, v200, v201
    v_cvt_pk_bf16_f32 v187, v202, v203
    v_accvgpr_read_b32 v204, a12
    ds_write_b64 v107, v[40:41] offset:16128
    v_accvgpr_read_b32 v205, a13
    v_accvgpr_read_b32 v206, a14
    v_accvgpr_read_b32 v207, a15
    v_accvgpr_read_b32 v236, a44
    v_accvgpr_read_b32 v237, a45
    ds_write_b64 v107, v[42:43] offset:16704
    v_accvgpr_read_b32 v238, a46
    v_accvgpr_read_b32 v239, a47
    v_pk_mul_f32 v[204:205], v[204:205], v[96:97]
    v_pk_mul_f32 v[206:207], v[206:207], v[96:97]
    v_pk_mul_f32 v[178:179], v[204:205], v[204:205]
    ds_write_b64 v107, v[44:45] offset:17280
    v_pk_mul_f32 v[180:181], v[206:207], v[206:207]
    v_pk_fma_f32 v[178:179], v[178:179], v[92:93], v[94:95]
    v_pk_fma_f32 v[180:181], v[180:181], v[92:93], v[94:95]
    v_pk_mul_f32 v[178:179], v[178:179], v[204:205]
    v_pk_mul_f32 v[180:181], v[180:181], v[206:207]
    ds_write_b64 v107, v[46:47] offset:17856
    v_exp_f32 v178, v178
    v_exp_f32 v179, v179
    v_exp_f32 v180, v180
    v_exp_f32 v181, v181
    v_pk_mul_f32 v[204:205], v[204:205], v[236:237]
    ds_write_b64 v106, v[48:49] offset:27648
    v_pk_mul_f32 v[206:207], v[206:207], v[238:239]
    v_pk_fma_f32 v[178:179], v[178:179], v[98:99], v[98:99]
    v_pk_fma_f32 v[180:181], v[180:181], v[98:99], v[98:99]
    v_rcp_f32 v178, v178
    v_rcp_f32 v179, v179
    ds_write_b64 v106, v[50:51] offset:28224
    v_rcp_f32 v180, v180
    v_rcp_f32 v181, v181
    s_nop 0
    v_pk_mul_f32 v[204:205], v[204:205], v[178:179]
    v_pk_mul_f32 v[206:207], v[206:207], v[180:181]
    ds_write_b64 v106, v[52:53] offset:28800
    v_cvt_pk_bf16_f32 v188, v204, v205
    v_cvt_pk_bf16_f32 v189, v206, v207
    s_add_u32 s42, s35, 1024
    buffer_store_dwordx4 v[186:189], v170, s[20:23], s42 offen sc1
    v_accvgpr_read_b32 v208, a16
    v_accvgpr_read_b32 v209, a17
    ds_write_b64 v106, v[54:55] offset:29376
    v_accvgpr_read_b32 v210, a18
    v_accvgpr_read_b32 v211, a19
    v_accvgpr_read_b32 v240, a48
    v_accvgpr_read_b32 v241, a49
    v_accvgpr_read_b32 v242, a50
    ds_write_b64 v106, v[56:57] offset:29952
    v_accvgpr_read_b32 v243, a51
    v_pk_mul_f32 v[208:209], v[208:209], v[96:97]
    v_pk_mul_f32 v[210:211], v[210:211], v[96:97]
    v_pk_mul_f32 v[174:175], v[208:209], v[208:209]
    v_pk_mul_f32 v[176:177], v[210:211], v[210:211]
    ds_write_b64 v106, v[58:59] offset:30528
    v_pk_fma_f32 v[174:175], v[174:175], v[92:93], v[94:95]
    v_pk_fma_f32 v[176:177], v[176:177], v[92:93], v[94:95]
    v_pk_mul_f32 v[174:175], v[174:175], v[208:209]
    v_pk_mul_f32 v[176:177], v[176:177], v[210:211]
    v_exp_f32 v174, v174
    ds_write_b64 v107, v[60:61] offset:29952
    v_exp_f32 v175, v175
    v_exp_f32 v176, v176
    v_exp_f32 v177, v177
    v_pk_mul_f32 v[208:209], v[208:209], v[240:241]
    v_pk_mul_f32 v[210:211], v[210:211], v[242:243]
    ds_write_b64 v107, v[62:63] offset:30528
    v_pk_fma_f32 v[174:175], v[174:175], v[98:99], v[98:99]
    v_pk_fma_f32 v[176:177], v[176:177], v[98:99], v[98:99]
    v_rcp_f32 v174, v174
    v_rcp_f32 v175, v175
    v_rcp_f32 v176, v176
    ds_write_b64 v107, v[64:65] offset:31104
    v_rcp_f32 v177, v177
    s_nop 0
    v_pk_mul_f32 v[208:209], v[208:209], v[174:175]
    v_pk_mul_f32 v[210:211], v[210:211], v[176:177]
    v_cvt_pk_bf16_f32 v182, v208, v209
    ds_write_b64 v107, v[66:67] offset:31680
    v_cvt_pk_bf16_f32 v183, v210, v211
    v_accvgpr_read_b32 v212, a20
    v_accvgpr_read_b32 v213, a21
    v_accvgpr_read_b32 v214, a22
    v_accvgpr_read_b32 v215, a23
    ds_write_b64 v107, v[68:69] offset:32256
    v_accvgpr_read_b32 v244, a52
    v_accvgpr_read_b32 v245, a53
    v_accvgpr_read_b32 v246, a54
    v_accvgpr_read_b32 v247, a55
    v_pk_mul_f32 v[212:213], v[212:213], v[96:97]
    ds_write_b64 v107, v[70:71] offset:32832
    v_pk_mul_f32 v[214:215], v[214:215], v[96:97]
    v_pk_mul_f32 v[178:179], v[212:213], v[212:213]
    v_pk_mul_f32 v[180:181], v[214:215], v[214:215]
    v_pk_fma_f32 v[178:179], v[178:179], v[92:93], v[94:95]
    v_pk_fma_f32 v[180:181], v[180:181], v[92:93], v[94:95]
    v_pk_mul_f32 v[178:179], v[178:179], v[212:213]
    v_pk_mul_f32 v[180:181], v[180:181], v[214:215]
    v_exp_f32 v178, v178
    v_exp_f32 v179, v179
    v_exp_f32 v180, v180
    v_exp_f32 v181, v181
    v_pk_mul_f32 v[212:213], v[212:213], v[244:245]
    v_pk_mul_f32 v[214:215], v[214:215], v[246:247]
    v_pk_fma_f32 v[178:179], v[178:179], v[98:99], v[98:99]
    v_pk_fma_f32 v[180:181], v[180:181], v[98:99], v[98:99]
    v_rcp_f32 v178, v178
    v_rcp_f32 v179, v179
    v_rcp_f32 v180, v180
    v_rcp_f32 v181, v181
    s_nop 0
    v_pk_mul_f32 v[212:213], v[212:213], v[178:179]
    v_pk_mul_f32 v[214:215], v[214:215], v[180:181]
    v_cvt_pk_bf16_f32 v184, v212, v213
    v_cvt_pk_bf16_f32 v185, v214, v215
    s_add_u32 s42, s35, 2048
    buffer_store_dwordx4 v[182:185], v170, s[20:23], s42 offen sc1
    v_accvgpr_read_b32 v216, a24
    v_accvgpr_read_b32 v217, a25
    v_accvgpr_read_b32 v218, a26
    v_accvgpr_read_b32 v219, a27
    v_accvgpr_read_b32 v248, a56
    v_accvgpr_read_b32 v249, a57
    v_accvgpr_read_b32 v250, a58
    v_accvgpr_read_b32 v251, a59
    v_pk_mul_f32 v[216:217], v[216:217], v[96:97]
    v_pk_mul_f32 v[218:219], v[218:219], v[96:97]
    v_pk_mul_f32 v[174:175], v[216:217], v[216:217]
    v_pk_mul_f32 v[176:177], v[218:219], v[218:219]
    v_pk_fma_f32 v[174:175], v[174:175], v[92:93], v[94:95]
    v_pk_fma_f32 v[176:177], v[176:177], v[92:93], v[94:95]
    v_pk_mul_f32 v[174:175], v[174:175], v[216:217]
    v_pk_mul_f32 v[176:177], v[176:177], v[218:219]
    v_exp_f32 v174, v174
    v_exp_f32 v175, v175
    v_exp_f32 v176, v176
    v_exp_f32 v177, v177
    v_pk_mul_f32 v[216:217], v[216:217], v[248:249]
    v_pk_mul_f32 v[218:219], v[218:219], v[250:251]
    v_pk_fma_f32 v[174:175], v[174:175], v[98:99], v[98:99]
    v_pk_fma_f32 v[176:177], v[176:177], v[98:99], v[98:99]
    v_rcp_f32 v174, v174
    v_rcp_f32 v175, v175
    v_rcp_f32 v176, v176
    v_rcp_f32 v177, v177
    s_nop 0
    v_pk_mul_f32 v[216:217], v[216:217], v[174:175]
    v_pk_mul_f32 v[218:219], v[218:219], v[176:177]
    v_cvt_pk_bf16_f32 v186, v216, v217
    v_cvt_pk_bf16_f32 v187, v218, v219
    v_accvgpr_read_b32 v220, a28
    v_accvgpr_read_b32 v221, a29
    v_accvgpr_read_b32 v222, a30
    v_accvgpr_read_b32 v223, a31
    v_accvgpr_read_b32 v252, a60
    v_accvgpr_read_b32 v253, a61
    v_accvgpr_read_b32 v254, a62
    v_accvgpr_read_b32 v255, a63
    v_pk_mul_f32 v[220:221], v[220:221], v[96:97]
    v_pk_mul_f32 v[222:223], v[222:223], v[96:97]
    v_pk_mul_f32 v[178:179], v[220:221], v[220:221]
    v_pk_mul_f32 v[180:181], v[222:223], v[222:223]
    v_pk_fma_f32 v[178:179], v[178:179], v[92:93], v[94:95]
    v_pk_fma_f32 v[180:181], v[180:181], v[92:93], v[94:95]
    v_pk_mul_f32 v[178:179], v[178:179], v[220:221]
    v_pk_mul_f32 v[180:181], v[180:181], v[222:223]
    v_exp_f32 v178, v178
    v_exp_f32 v179, v179
    v_exp_f32 v180, v180
    v_exp_f32 v181, v181
    v_pk_mul_f32 v[220:221], v[220:221], v[252:253]
    v_pk_mul_f32 v[222:223], v[222:223], v[254:255]
    v_pk_fma_f32 v[178:179], v[178:179], v[98:99], v[98:99]
    v_pk_fma_f32 v[180:181], v[180:181], v[98:99], v[98:99]
    v_rcp_f32 v178, v178
    v_rcp_f32 v179, v179
    v_rcp_f32 v180, v180
    v_rcp_f32 v181, v181
    s_nop 0
    v_pk_mul_f32 v[220:221], v[220:221], v[178:179]
    v_pk_mul_f32 v[222:223], v[222:223], v[180:181]
    v_cvt_pk_bf16_f32 v188, v220, v221
    v_cvt_pk_bf16_f32 v189, v222, v223
    s_add_u32 s42, s35, 3072
    buffer_store_dwordx4 v[186:189], v170, s[20:23], s42 offen sc1
    s_branch K1_DONE
K1_SP:
    s_add_u32 s37, s68, 0
    buffer_load_dwordx4 a[252:255], v170, s[4:7], s37 offen
    s_add_u32 s37, s68, 1048576
    buffer_load_dwordx4 a[252:255], v170, s[4:7], s37 offen
    s_add_u32 s37, s68, 2097152
    buffer_load_dwordx4 a[252:255], v170, s[4:7], s37 offen
    s_add_u32 m0, s36, 0
    s_add_u32 s37, s43, 0
    buffer_load_dwordx4 v192, s[4:7], s37 offen lds
    buffer_load_dwordx4 v193, s[4:7], s37 offen offset:1024 lds
    s_add_u32 m0, s36, 8192
    s_add_u32 s37, s43, 0
    buffer_load_dwordx4 v194, s[4:7], s37 offen lds
    buffer_load_dwordx4 v195, s[4:7], s37 offen offset:1024 lds
    s_add_u32 m0, s36, 16384
    s_add_u32 s37, s43, 128
    buffer_load_dwordx4 v192, s[4:7], s37 offen lds
    buffer_load_dwordx4 v193, s[4:7], s37 offen offset:1024 lds
    s_add_u32 m0, s36, 24576
    s_add_u32 s37, s43, 128
    buffer_load_dwordx4 v194, s[4:7], s37 offen lds
    buffer_load_dwordx4 v195, s[4:7], s37 offen offset:1024 lds
    s_add_u32 m0, s36, 32768
    s_add_u32 s37, s43, 256
    buffer_load_dwordx4 v192, s[4:7], s37 offen lds
    buffer_load_dwordx4 v193, s[4:7], s37 offen offset:1024 lds
    s_add_u32 m0, s36, 40960
    s_add_u32 s37, s43, 256
    buffer_load_dwordx4 v194, s[4:7], s37 offen lds
    buffer_load_dwordx4 v195, s[4:7], s37 offen offset:1024 lds
    s_add_u32 m0, s36, 49152
    s_add_u32 s37, s43, 384
    buffer_load_dwordx4 v192, s[4:7], s37 offen lds
    buffer_load_dwordx4 v193, s[4:7], s37 offen offset:1024 lds
    s_add_u32 m0, s36, 57344
    s_add_u32 s37, s43, 384
    buffer_load_dwordx4 v194, s[4:7], s37 offen lds
    buffer_load_dwordx4 v195, s[4:7], s37 offen offset:1024 lds
    s_add_u32 m0, s36, 65536
    s_add_u32 s37, s43, 512
    buffer_load_dwordx4 v192, s[4:7], s37 offen lds
    buffer_load_dwordx4 v193, s[4:7], s37 offen offset:1024 lds
    s_add_u32 m0, s36, 73728
    s_add_u32 s37, s43, 512
    buffer_load_dwordx4 v194, s[4:7], s37 offen lds
    buffer_load_dwordx4 v195, s[4:7], s37 offen offset:1024 lds
    s_add_u32 m0, s36, 81920
    s_add_u32 s37, s43, 640
    buffer_load_dwordx4 v192, s[4:7], s37 offen lds
    buffer_load_dwordx4 v193, s[4:7], s37 offen offset:1024 lds
    s_add_u32 m0, s36, 90112
    s_add_u32 s37, s43, 640
    buffer_load_dwordx4 v194, s[4:7], s37 offen lds
    buffer_load_dwordx4 v195, s[4:7], s37 offen offset:1024 lds
    s_add_u32 m0, s36, 98304
    s_add_u32 s37, s43, 768
    buffer_load_dwordx4 v192, s[4:7], s37 offen lds
    buffer_load_dwordx4 v193, s[4:7], s37 offen offset:1024 lds
    s_add_u32 m0, s36, 106496
    s_add_u32 s37, s43, 768
    buffer_load_dwordx4 v194, s[4:7], s37 offen lds
    buffer_load_dwordx4 v195, s[4:7], s37 offen offset:1024 lds
    v_and_b32 v204, 1, v204
    v_lshlrev_b32 v204, 2, v204
    v_xor_b32 v203, v203, v204
    v_lshlrev_b32 v203, 4, v203
    s_lshl_b32 s30, s25, 4
    v_add_u32 v202, s30, v202
    v_mul_u32_u24 v160, 3840, v202
    v_mul_u32_u24 v162, 3456, v202
    v_add_u32 v160, v160, v203
    v_add_u32 v162, v162, v203
    v_add_u32 v161, 29696, v160
    v_add_u32 v163, 26624, v162
    v_and_b32 v202, 3, v201
    v_bfe_u32 v203, v201, 2, 2
    v_bfe_u32 v204, v201, 4, 1
    v_lshrrev_b32 v205, 5, v201
    v_lshlrev_b32 v206, 10, v205
    v_lshl_add_u32 v206, v203, 7, v206
    v_lshl_add_u32 v206, v204, 5, v206
    v_lshl_add_u32 v206, v202, 3, v206
    v_lshrrev_b32 v203, 1, v203
    v_lshlrev_b32 v203, 6, v203
    v_add_u32 v164, v206, v203
    v_xor_b32 v165, 64, v164
    v_add_u32 v166, 0x10000, v164
    v_add_u32 v167, 0x10000, v165
    v_add_u32 v168, 0x20000, v164
    v_add_u32 v169, 0x20000, v165
    v_bfe_u32 v202, v201, 1, 2
    v_lshl_or_b32 v202, v204, 2, v202
    v_xor_b32 v202, v202, v205
    v_lshlrev_b32 v202, 4, v202
    v_lshl_add_u32 v202, v204, 13, v202
    v_and_b32 v203, 15, v201
    v_lshl_add_u32 v202, v203, 7, v202
    v_add_u32 v196, s36, v202
    v_xor_b32 v197, 32, v196
    v_xor_b32 v198, 64, v196
    v_xor_b32 v199, 96, v196
    v_bfe_u32 v202, v201, 2, 1
    v_bfe_u32 v203, v201, 3, 1
    v_bfe_u32 v206, v201, 1, 1
    v_lshl_add_u32 v203, v203, 1, v206
    v_lshl_add_u32 v203, v204, 2, v203
    v_and_b32 v206, 1, v201
    v_lshlrev_b32 v206, 4, v206
    v_mov_b32 v207, 0x3f80
    v_lshlrev_b32 v206, v206, v207
    v_cmp_eq_u32 vcc, v202, v205
    v_mov_b32 v207, 0
    s_nop 0
    v_cndmask_b32 v206, v207, v206, vcc
    v_cmp_eq_u32 vcc, 0, v203
    s_nop 1
    v_cndmask_b32 v240, v207, v206, vcc
    v_cmp_eq_u32 vcc, 1, v203
    s_nop 1
    v_cndmask_b32 v241, v207, v206, vcc
    v_cmp_eq_u32 vcc, 2, v203
    s_nop 1
    v_cndmask_b32 v242, v207, v206, vcc
    v_cmp_eq_u32 vcc, 3, v203
    s_nop 1
    v_cndmask_b32 v243, v207, v206, vcc
    v_cmp_eq_u32 vcc, 4, v203
    s_nop 1
    v_cndmask_b32 v244, v207, v206, vcc
    v_cmp_eq_u32 vcc, 5, v203
    s_nop 1
    v_cndmask_b32 v245, v207, v206, vcc
    v_cmp_eq_u32 vcc, 6, v203
    s_nop 1
    v_cndmask_b32 v246, v207, v206, vcc
    v_cmp_eq_u32 vcc, 7, v203
    s_nop 1
    v_cndmask_b32 v247, v207, v206, vcc
    s_mul_i32 s52, s29, 122880
    s_mul_i32 s53, s29, 151552
    s_add_u32 s53, s53, 8388608
    s_lshl_b32 s30, s28, 8
    s_lshl_b32 s33, s28, 13
    s_add_u32 s33, s33, s52
    s_cmp_lt_u32 s28, 5
    s_cselect_b32 s40, 0x3ea52b5c, 1.0
    s_lshl_b32 s31, s28, 8
    s_add_u32 s32, s31, 128
    s_lshl_b32 s34, s28, 13
    s_add_u32 s34, s34, s53
    s_add_u32 s35, s34, 4096
    s_mov_b32 s31, 3584
    s_mov_b32 s32, 3328
    s_add_u32 s34, s52, 114688
    s_add_u32 s35, s53, 106496
    v_mov_b32 v200, 0
    v_mov_b32 v201, 0
    v_mov_b32 v202, 0
    v_mov_b32 v203, 0
    s_mov_b32 s38, 0x3f803f80
    s_waitcnt vmcnt(24)
    ds_read_b128 v[0:3], v196 offset:0
    ds_read_b128 v[4:7], v197 offset:0
    ds_read_b128 v[8:11], v198 offset:0
    ds_read_b128 v[12:15], v199 offset:0
    s_add_u32 m0, s36, 114688
    s_add_u32 s37, s43, 896
    buffer_load_dwordx4 v192, s[4:7], s37 offen lds
    buffer_load_dwordx4 v193, s[4:7], s37 offen offset:1024 lds
    s_add_u32 m0, s36, 122880
    s_add_u32 s37, s43, 896
    buffer_load_dwordx4 v194, s[4:7], s37 offen lds
    buffer_load_dwordx4 v195, s[4:7], s37 offen offset:1024 lds
    s_waitcnt lgkmcnt(0)
    s_waitcnt vmcnt(24)
    ds_read_b128 v[16:19], v196 offset:16384
    ds_read_b128 v[20:23], v197 offset:16384
    ds_read_b128 v[24:27], v198 offset:16384
    ds_read_b128 v[28:31], v199 offset:16384
    s_add_u32 m0, s36, 131072
    s_add_u32 s37, s43, 1024
    buffer_load_dwordx4 v192, s[4:7], s37 offen lds
    v_dot2_f32_bf16 v200, v0, s38, v200
    v_dot2_f32_bf16 v202, v0, v0, v202
    v_dot2_f32_bf16 v201, v1, s38, v201
    v_dot2_f32_bf16 v203, v1, v1, v203
    v_dot2_f32_bf16 v200, v2, s38, v200
    v_dot2_f32_bf16 v202, v2, v2, v202
    v_dot2_f32_bf16 v201, v3, s38, v201
    v_dot2_f32_bf16 v203, v3, v3, v203
    buffer_load_dwordx4 v193, s[4:7], s37 offen offset:1024 lds
    v_dot2_f32_bf16 v200, v4, s38, v200
    v_dot2_f32_bf16 v202, v4, v4, v202
    v_dot2_f32_bf16 v201, v5, s38, v201
    v_dot2_f32_bf16 v203, v5, v5, v203
    v_dot2_f32_bf16 v200, v6, s38, v200
    v_dot2_f32_bf16 v202, v6, v6, v202
    v_dot2_f32_bf16 v201, v7, s38, v201
    v_dot2_f32_bf16 v203, v7, v7, v203
    s_add_u32 m0, s36, 139264
    s_add_u32 s37, s43, 1024
    buffer_load_dwordx4 v194, s[4:7], s37 offen lds
    v_dot2_f32_bf16 v200, v8, s38, v200
    v_dot2_f32_bf16 v202, v8, v8, v202
    v_dot2_f32_bf16 v201, v9, s38, v201
    v_dot2_f32_bf16 v203, v9, v9, v203
    v_dot2_f32_bf16 v200, v10, s38, v200
    v_dot2_f32_bf16 v202, v10, v10, v202
    v_dot2_f32_bf16 v201, v11, s38, v201
    v_dot2_f32_bf16 v203, v11, v11, v203
    buffer_load_dwordx4 v195, s[4:7], s37 offen offset:1024 lds
    v_dot2_f32_bf16 v200, v12, s38, v200
    v_dot2_f32_bf16 v202, v12, v12, v202
    v_dot2_f32_bf16 v201, v13, s38, v201
    v_dot2_f32_bf16 v203, v13, v13, v203
    v_dot2_f32_bf16 v200, v14, s38, v200
    v_dot2_f32_bf16 v202, v14, v14, v202
    v_dot2_f32_bf16 v201, v15, s38, v201
    v_dot2_f32_bf16 v203, v15, v15, v203
    s_waitcnt lgkmcnt(0)
    s_waitcnt vmcnt(24)
    ds_read_b128 v[32:35], v196 offset:32768
    ds_read_b128 v[36:39], v197 offset:32768
    ds_read_b128 v[40:43], v198 offset:32768
    ds_read_b128 v[44:47], v199 offset:32768
    s_add_u32 m0, s36, 147456
    s_add_u32 s37, s43, 1152
    buffer_load_dwordx4 v192, s[4:7], s37 offen lds
    v_dot2_f32_bf16 v200, v16, s38, v200
    v_dot2_f32_bf16 v202, v16, v16, v202
    v_dot2_f32_bf16 v201, v17, s38, v201
    v_dot2_f32_bf16 v203, v17, v17, v203
    v_dot2_f32_bf16 v200, v18, s38, v200
    v_dot2_f32_bf16 v202, v18, v18, v202
    v_dot2_f32_bf16 v201, v19, s38, v201
    v_dot2_f32_bf16 v203, v19, v19, v203
    buffer_load_dwordx4 v193, s[4:7], s37 offen offset:1024 lds
    v_dot2_f32_bf16 v200, v20, s38, v200
    v_dot2_f32_bf16 v202, v20, v20, v202
    v_dot2_f32_bf16 v201, v21, s38, v201
    v_dot2_f32_bf16 v203, v21, v21, v203
    v_dot2_f32_bf16 v200, v22, s38, v200
    v_dot2_f32_bf16 v202, v22, v22, v202
    v_dot2_f32_bf16 v201, v23, s38, v201
    v_dot2_f32_bf16 v203, v23, v23, v203
    s_add_u32 m0, s36, 155648
    s_add_u32 s37, s43, 1152
    buffer_load_dwordx4 v194, s[4:7], s37 offen lds
    v_dot2_f32_bf16 v200, v24, s38, v200
    v_dot2_f32_bf16 v202, v24, v24, v202
    v_dot2_f32_bf16 v201, v25, s38, v201
    v_dot2_f32_bf16 v203, v25, v25, v203
    v_dot2_f32_bf16 v200, v26, s38, v200
    v_dot2_f32_bf16 v202, v26, v26, v202
    v_dot2_f32_bf16 v201, v27, s38, v201
    v_dot2_f32_bf16 v203, v27, v27, v203
    buffer_load_dwordx4 v195, s[4:7], s37 offen offset:1024 lds
    v_dot2_f32_bf16 v200, v28, s38, v200
    v_dot2_f32_bf16 v202, v28, v28, v202
    v_dot2_f32_bf16 v201, v29, s38, v201
    v_dot2_f32_bf16 v203, v29, v29, v203
    v_dot2_f32_bf16 v200, v30, s38, v200
    v_dot2_f32_bf16 v202, v30, v30, v202
    v_dot2_f32_bf16 v201, v31, s38, v201
    v_dot2_f32_bf16 v203, v31, v31, v203
    s_waitcnt lgkmcnt(0)
    s_waitcnt vmcnt(24)
    ds_read_b128 v[48:51], v196 offset:49152
    ds_read_b128 v[52:55], v197 offset:49152
    ds_read_b128 v[56:59], v198 offset:49152
    ds_read_b128 v[60:63], v199 offset:49152
    s_add_u32 m0, s36, 0
    s_add_u32 s37, s30, 0
    buffer_load_dwordx4 v160, s[8:11], s37 offen lds
    buffer_load_dwordx4 v161, s[8:11], s37 offen offset:1024 lds
    v_dot2_f32_bf16 v200, v32, s38, v200
    v_dot2_f32_bf16 v202, v32, v32, v202
    v_dot2_f32_bf16 v201, v33, s38, v201
    v_dot2_f32_bf16 v203, v33, v33, v203
    v_dot2_f32_bf16 v200, v34, s38, v200
    v_dot2_f32_bf16 v202, v34, v34, v202
    v_dot2_f32_bf16 v201, v35, s38, v201
    v_dot2_f32_bf16 v203, v35, v35, v203
    s_add_u32 m0, s36, 8192
    s_add_u32 s37, s30, 128
    buffer_load_dwordx4 v160, s[8:11], s37 offen lds
    buffer_load_dwordx4 v161, s[8:11], s37 offen offset:1024 lds
    v_dot2_f32_bf16 v200, v36, s38, v200
    v_dot2_f32_bf16 v202, v36, v36, v202
    v_dot2_f32_bf16 v201, v37, s38, v201
    v_dot2_f32_bf16 v203, v37, v37, v203
    v_dot2_f32_bf16 v200, v38, s38, v200
    v_dot2_f32_bf16 v202, v38, v38, v202
    v_dot2_f32_bf16 v201, v39, s38, v201
    v_dot2_f32_bf16 v203, v39, v39, v203
    s_add_u32 m0, s36, 16384
    s_add_u32 s37, s30, 245760
    buffer_load_dwordx4 v160, s[8:11], s37 offen lds
    buffer_load_dwordx4 v161, s[8:11], s37 offen offset:1024 lds
    v_dot2_f32_bf16 v200, v40, s38, v200
    v_dot2_f32_bf16 v202, v40, v40, v202
    v_dot2_f32_bf16 v201, v41, s38, v201
    v_dot2_f32_bf16 v203, v41, v41, v203
    v_dot2_f32_bf16 v200, v42, s38, v200
    v_dot2_f32_bf16 v202, v42, v42, v202
    v_dot2_f32_bf16 v201, v43, s38, v201
    v_dot2_f32_bf16 v203, v43, v43, v203
    s_add_u32 m0, s36, 24576
    s_add_u32 s37, s30, 245888
    buffer_load_dwordx4 v160, s[8:11], s37 offen lds
    buffer_load_dwordx4 v161, s[8:11], s37 offen offset:1024 lds
    v_dot2_f32_bf16 v200, v44, s38, v200
    v_dot2_f32_bf16 v202, v44, v44, v202
    v_dot2_f32_bf16 v201, v45, s38, v201
    v_dot2_f32_bf16 v203, v45, v45, v203
    v_dot2_f32_bf16 v200, v46, s38, v200
    v_dot2_f32_bf16 v202, v46, v46, v202
    v_dot2_f32_bf16 v201, v47, s38, v201
    v_dot2_f32_bf16 v203, v47, v47, v203
    s_waitcnt lgkmcnt(0)
    s_waitcnt vmcnt(28)
    v_add_u32 v196, 0x10000, v196
    v_add_u32 v197, 0x10000, v197
    v_add_u32 v198, 0x10000, v198
    v_add_u32 v199, 0x10000, v199
    ds_read_b128 v[64:67], v196 offset:0
    ds_read_b128 v[68:71], v197 offset:0
    ds_read_b128 v[72:75], v198 offset:0
    ds_read_b128 v[76:79], v199 offset:0
    s_add_u32 m0, s36, 32768
    s_add_u32 s37, s30, 491520
    buffer_load_dwordx4 v160, s[8:11], s37 offen lds
    buffer_load_dwordx4 v161, s[8:11], s37 offen offset:1024 lds
    v_dot2_f32_bf16 v200, v48, s38, v200
    v_dot2_f32_bf16 v202, v48, v48, v202
    v_dot2_f32_bf16 v201, v49, s38, v201
    v_dot2_f32_bf16 v203, v49, v49, v203
    v_dot2_f32_bf16 v200, v50, s38, v200
    v_dot2_f32_bf16 v202, v50, v50, v202
    v_dot2_f32_bf16 v201, v51, s38, v201
    v_dot2_f32_bf16 v203, v51, v51, v203
    s_add_u32 m0, s36, 40960
    s_add_u32 s37, s30, 491648
    buffer_load_dwordx4 v160, s[8:11], s37 offen lds
    buffer_load_dwordx4 v161, s[8:11], s37 offen offset:1024 lds
    v_dot2_f32_bf16 v200, v52, s38, v200
    v_dot2_f32_bf16 v202, v52, v52, v202
    v_dot2_f32_bf16 v201, v53, s38, v201
    v_dot2_f32_bf16 v203, v53, v53, v203
    v_dot2_f32_bf16 v200, v54, s38, v200
    v_dot2_f32_bf16 v202, v54, v54, v202
    v_dot2_f32_bf16 v201, v55, s38, v201
    v_dot2_f32_bf16 v203, v55, v55, v203
    s_add_u32 m0, s36, 49152
    s_add_u32 s37, s30, 737280
    buffer_load_dwordx4 v160, s[8:11], s37 offen lds
    buffer_load_dwordx4 v161, s[8:11], s37 offen offset:1024 lds
    v_dot2_f32_bf16 v200, v56, s38, v200
    v_dot2_f32_bf16 v202, v56, v56, v202
    v_dot2_f32_bf16 v201, v57, s38, v201
    v_dot2_f32_bf16 v203, v57, v57, v203
    v_dot2_f32_bf16 v200, v58, s38, v200
    v_dot2_f32_bf16 v202, v58, v58, v202
    v_dot2_f32_bf16 v201, v59, s38, v201
    v_dot2_f32_bf16 v203, v59, v59, v203
    s_add_u32 m0, s36, 57344
    s_add_u32 s37, s30, 737408
    buffer_load_dwordx4 v160, s[8:11], s37 offen lds
    buffer_load_dwordx4 v161, s[8:11], s37 offen offset:1024 lds
    v_dot2_f32_bf16 v200, v60, s38, v200
    v_dot2_f32_bf16 v202, v60, v60, v202
    v_dot2_f32_bf16 v201, v61, s38, v201
    v_dot2_f32_bf16 v203, v61, v61, v203
    v_dot2_f32_bf16 v200, v62, s38, v200
    v_dot2_f32_bf16 v202, v62, v62, v202
    v_dot2_f32_bf16 v201, v63, s38, v201
    v_dot2_f32_bf16 v203, v63, v63, v203
    s_waitcnt lgkmcnt(0)
    s_waitcnt vmcnt(32)
    ds_read_b128 v[80:83], v196 offset:16384
    ds_read_b128 v[84:87], v197 offset:16384
    ds_read_b128 v[88:91], v198 offset:16384
    ds_read_b128 v[92:95], v199 offset:16384
    v_dot2_f32_bf16 v200, v64, s38, v200
    v_dot2_f32_bf16 v202, v64, v64, v202
    v_dot2_f32_bf16 v201, v65, s38, v201
    v_dot2_f32_bf16 v203, v65, v65, v203
    v_dot2_f32_bf16 v200, v66, s38, v200
    v_dot2_f32_bf16 v202, v66, v66, v202
    v_dot2_f32_bf16 v201, v67, s38, v201
    v_dot2_f32_bf16 v203, v67, v67, v203
    v_dot2_f32_bf16 v200, v68, s38, v200
    v_dot2_f32_bf16 v202, v68, v68, v202
    v_dot2_f32_bf16 v201, v69, s38, v201
    v_dot2_f32_bf16 v203, v69, v69, v203
    v_dot2_f32_bf16 v200, v70, s38, v200
    v_dot2_f32_bf16 v202, v70, v70, v202
    v_dot2_f32_bf16 v201, v71, s38, v201
    v_dot2_f32_bf16 v203, v71, v71, v203
    v_dot2_f32_bf16 v200, v72, s38, v200
    v_dot2_f32_bf16 v202, v72, v72, v202
    v_dot2_f32_bf16 v201, v73, s38, v201
    v_dot2_f32_bf16 v203, v73, v73, v203
    v_dot2_f32_bf16 v200, v74, s38, v200
    v_dot2_f32_bf16 v202, v74, v74, v202
    v_dot2_f32_bf16 v201, v75, s38, v201
    v_dot2_f32_bf16 v203, v75, v75, v203
    v_dot2_f32_bf16 v200, v76, s38, v200
    v_dot2_f32_bf16 v202, v76, v76, v202
    v_dot2_f32_bf16 v201, v77, s38, v201
    v_dot2_f32_bf16 v203, v77, v77, v203
    v_dot2_f32_bf16 v200, v78, s38, v200
    v_dot2_f32_bf16 v202, v78, v78, v202
    v_dot2_f32_bf16 v201, v79, s38, v201
    v_dot2_f32_bf16 v203, v79, v79, v203
    s_waitcnt lgkmcnt(0)
    s_waitcnt vmcnt(28)
    ds_read_b128 v[96:99], v196 offset:32768
    ds_read_b128 v[100:103], v197 offset:32768
    ds_read_b128 v[104:107], v198 offset:32768
    ds_read_b128 v[108:111], v199 offset:32768
    v_dot2_f32_bf16 v200, v80, s38, v200
    v_dot2_f32_bf16 v202, v80, v80, v202
    v_dot2_f32_bf16 v201, v81, s38, v201
    v_dot2_f32_bf16 v203, v81, v81, v203
    v_dot2_f32_bf16 v200, v82, s38, v200
    v_dot2_f32_bf16 v202, v82, v82, v202
    v_dot2_f32_bf16 v201, v83, s38, v201
    v_dot2_f32_bf16 v203, v83, v83, v203
    v_dot2_f32_bf16 v200, v84, s38, v200
    v_dot2_f32_bf16 v202, v84, v84, v202
    v_dot2_f32_bf16 v201, v85, s38, v201
    v_dot2_f32_bf16 v203, v85, v85, v203
    v_dot2_f32_bf16 v200, v86, s38, v200
    v_dot2_f32_bf16 v202, v86, v86, v202
    v_dot2_f32_bf16 v201, v87, s38, v201
    v_dot2_f32_bf16 v203, v87, v87, v203
    v_dot2_f32_bf16 v200, v88, s38, v200
    v_dot2_f32_bf16 v202, v88, v88, v202
    v_dot2_f32_bf16 v201, v89, s38, v201
    v_dot2_f32_bf16 v203, v89, v89, v203
    v_dot2_f32_bf16 v200, v90, s38, v200
    v_dot2_f32_bf16 v202, v90, v90, v202
    v_dot2_f32_bf16 v201, v91, s38, v201
    v_dot2_f32_bf16 v203, v91, v91, v203
    v_dot2_f32_bf16 v200, v92, s38, v200
    v_dot2_f32_bf16 v202, v92, v92, v202
    v_dot2_f32_bf16 v201, v93, s38, v201
    v_dot2_f32_bf16 v203, v93, v93, v203
    v_dot2_f32_bf16 v200, v94, s38, v200
    v_dot2_f32_bf16 v202, v94, v94, v202
    v_dot2_f32_bf16 v201, v95, s38, v201
    v_dot2_f32_bf16 v203, v95, v95, v203
    s_waitcnt lgkmcnt(0)
    s_waitcnt vmcnt(24)
    ds_read_b128 v[112:115], v196 offset:49152
    ds_read_b128 v[116:119], v197 offset:49152
    ds_read_b128 v[120:123], v198 offset:49152
    ds_read_b128 v[124:127], v199 offset:49152
    v_dot2_f32_bf16 v200, v96, s38, v200
    v_dot2_f32_bf16 v202, v96, v96, v202
    v_dot2_f32_bf16 v201, v97, s38, v201
    v_dot2_f32_bf16 v203, v97, v97, v203
    v_dot2_f32_bf16 v200, v98, s38, v200
    v_dot2_f32_bf16 v202, v98, v98, v202
    v_dot2_f32_bf16 v201, v99, s38, v201
    v_dot2_f32_bf16 v203, v99, v99, v203
    v_dot2_f32_bf16 v200, v100, s38, v200
    v_dot2_f32_bf16 v202, v100, v100, v202
    v_dot2_f32_bf16 v201, v101, s38, v201
    v_dot2_f32_bf16 v203, v101, v101, v203
    v_dot2_f32_bf16 v200, v102, s38, v200
    v_dot2_f32_bf16 v202, v102, v102, v202
    v_dot2_f32_bf16 v201, v103, s38, v201
    v_dot2_f32_bf16 v203, v103, v103, v203
    v_dot2_f32_bf16 v200, v104, s38, v200
    v_dot2_f32_bf16 v202, v104, v104, v202
    v_dot2_f32_bf16 v201, v105, s38, v201
    v_dot2_f32_bf16 v203, v105, v105, v203
    v_dot2_f32_bf16 v200, v106, s38, v200
    v_dot2_f32_bf16 v202, v106, v106, v202
    v_dot2_f32_bf16 v201, v107, s38, v201
    v_dot2_f32_bf16 v203, v107, v107, v203
    v_dot2_f32_bf16 v200, v108, s38, v200
    v_dot2_f32_bf16 v202, v108, v108, v202
    v_dot2_f32_bf16 v201, v109, s38, v201
    v_dot2_f32_bf16 v203, v109, v109, v203
    v_dot2_f32_bf16 v200, v110, s38, v200
    v_dot2_f32_bf16 v202, v110, v110, v202
    v_dot2_f32_bf16 v201, v111, s38, v201
    v_dot2_f32_bf16 v203, v111, v111, v203
    s_waitcnt lgkmcnt(0)
    s_waitcnt vmcnt(20)
    v_add_u32 v196, 0x10000, v196
    v_add_u32 v197, 0x10000, v197
    v_add_u32 v198, 0x10000, v198
    v_add_u32 v199, 0x10000, v199
    ds_read_b128 v[128:131], v196 offset:0
    ds_read_b128 v[132:135], v197 offset:0
    ds_read_b128 v[136:139], v198 offset:0
    ds_read_b128 v[140:143], v199 offset:0
    v_dot2_f32_bf16 v200, v112, s38, v200
    v_dot2_f32_bf16 v202, v112, v112, v202
    v_dot2_f32_bf16 v201, v113, s38, v201
    v_dot2_f32_bf16 v203, v113, v113, v203
    v_dot2_f32_bf16 v200, v114, s38, v200
    v_dot2_f32_bf16 v202, v114, v114, v202
    v_dot2_f32_bf16 v201, v115, s38, v201
    v_dot2_f32_bf16 v203, v115, v115, v203
    v_dot2_f32_bf16 v200, v116, s38, v200
    v_dot2_f32_bf16 v202, v116, v116, v202
    v_dot2_f32_bf16 v201, v117, s38, v201
    v_dot2_f32_bf16 v203, v117, v117, v203
    v_dot2_f32_bf16 v200, v118, s38, v200
    v_dot2_f32_bf16 v202, v118, v118, v202
    v_dot2_f32_bf16 v201, v119, s38, v201
    v_dot2_f32_bf16 v203, v119, v119, v203
    v_dot2_f32_bf16 v200, v120, s38, v200
    v_dot2_f32_bf16 v202, v120, v120, v202
    v_dot2_f32_bf16 v201, v121, s38, v201
    v_dot2_f32_bf16 v203, v121, v121, v203
    v_dot2_f32_bf16 v200, v122, s38, v200
    v_dot2_f32_bf16 v202, v122, v122, v202
    v_dot2_f32_bf16 v201, v123, s38, v201
    v_dot2_f32_bf16 v203, v123, v123, v203
    v_dot2_f32_bf16 v200, v124, s38, v200
    v_dot2_f32_bf16 v202, v124, v124, v202
    v_dot2_f32_bf16 v201, v125, s38, v201
    v_dot2_f32_bf16 v203, v125, v125, v203
    v_dot2_f32_bf16 v200, v126, s38, v200
    v_dot2_f32_bf16 v202, v126, v126, v202
    v_dot2_f32_bf16 v201, v127, s38, v201
    v_dot2_f32_bf16 v203, v127, v127, v203
    s_waitcnt lgkmcnt(0)
    s_waitcnt vmcnt(16)
    ds_read_b128 v[144:147], v196 offset:16384
    ds_read_b128 v[148:151], v197 offset:16384
    ds_read_b128 v[152:155], v198 offset:16384
    ds_read_b128 v[156:159], v199 offset:16384
    s_add_u32 s37, s68, 0
    buffer_load_dwordx4 a[252:255], v170, s[12:15], s37 offen
    s_add_u32 s37, s68, 1048576
    buffer_load_dwordx4 a[252:255], v170, s[12:15], s37 offen
    v_dot2_f32_bf16 v200, v128, s38, v200
    v_dot2_f32_bf16 v202, v128, v128, v202
    v_dot2_f32_bf16 v201, v129, s38, v201
    v_dot2_f32_bf16 v203, v129, v129, v203
    v_dot2_f32_bf16 v200, v130, s38, v200
    v_dot2_f32_bf16 v202, v130, v130, v202
    v_dot2_f32_bf16 v201, v131, s38, v201
    v_dot2_f32_bf16 v203, v131, v131, v203
    s_add_u32 s37, s68, 2097152
    buffer_load_dwordx4 a[252:255], v170, s[12:15], s37 offen
    s_add_u32 s37, s68, 0
    buffer_load_dwordx4 a[252:255], v170, s[16:19], s37 offen
    v_dot2_f32_bf16 v200, v132, s38, v200
    v_dot2_f32_bf16 v202, v132, v132, v202
    v_dot2_f32_bf16 v201, v133, s38, v201
    v_dot2_f32_bf16 v203, v133, v133, v203
    v_dot2_f32_bf16 v200, v134, s38, v200
    v_dot2_f32_bf16 v202, v134, v134, v202
    v_dot2_f32_bf16 v201, v135, s38, v201
    v_dot2_f32_bf16 v203, v135, v135, v203
    s_add_u32 s37, s68, 1048576
    buffer_load_dwordx4 a[252:255], v170, s[16:19], s37 offen
    s_add_u32 s37, s68, 2097152
    buffer_load_dwordx4 a[252:255], v170, s[16:19], s37 offen
    v_dot2_f32_bf16 v200, v136, s38, v200
    v_dot2_f32_bf16 v202, v136, v136, v202
    v_dot2_f32_bf16 v201, v137, s38, v201
    v_dot2_f32_bf16 v203, v137, v137, v203
    v_dot2_f32_bf16 v200, v138, s38, v200
    v_dot2_f32_bf16 v202, v138, v138, v202
    v_dot2_f32_bf16 v201, v139, s38, v201
    v_dot2_f32_bf16 v203, v139, v139, v203
    v_dot2_f32_bf16 v200, v140, s38, v200
    v_dot2_f32_bf16 v202, v140, v140, v202
    v_dot2_f32_bf16 v201, v141, s38, v201
    v_dot2_f32_bf16 v203, v141, v141, v203
    v_dot2_f32_bf16 v200, v142, s38, v200
    v_dot2_f32_bf16 v202, v142, v142, v202
    v_dot2_f32_bf16 v201, v143, s38, v201
    v_dot2_f32_bf16 v203, v143, v143, v203
    s_waitcnt lgkmcnt(0)
    v_dot2_f32_bf16 v200, v144, s38, v200
    v_dot2_f32_bf16 v202, v144, v144, v202
    v_dot2_f32_bf16 v201, v145, s38, v201
    v_dot2_f32_bf16 v203, v145, v145, v203
    v_dot2_f32_bf16 v200, v146, s38, v200
    v_dot2_f32_bf16 v202, v146, v146, v202
    v_dot2_f32_bf16 v201, v147, s38, v201
    v_dot2_f32_bf16 v203, v147, v147, v203
    v_dot2_f32_bf16 v200, v148, s38, v200
    v_dot2_f32_bf16 v202, v148, v148, v202
    v_dot2_f32_bf16 v201, v149, s38, v201
    v_dot2_f32_bf16 v203, v149, v149, v203
    v_dot2_f32_bf16 v200, v150, s38, v200
    v_dot2_f32_bf16 v202, v150, v150, v202
    v_dot2_f32_bf16 v201, v151, s38, v201
    v_dot2_f32_bf16 v203, v151, v151, v203
    v_dot2_f32_bf16 v200, v152, s38, v200
    v_dot2_f32_bf16 v202, v152, v152, v202
    v_dot2_f32_bf16 v201, v153, s38, v201
    v_dot2_f32_bf16 v203, v153, v153, v203
    v_dot2_f32_bf16 v200, v154, s38, v200
    v_dot2_f32_bf16 v202, v154, v154, v202
    v_dot2_f32_bf16 v201, v155, s38, v201
    v_dot2_f32_bf16 v203, v155, v155, v203
    v_dot2_f32_bf16 v200, v156, s38, v200
    v_dot2_f32_bf16 v202, v156, v156, v202
    v_dot2_f32_bf16 v201, v157, s38, v201
    v_dot2_f32_bf16 v203, v157, v157, v203
    v_dot2_f32_bf16 v200, v158, s38, v200
    v_dot2_f32_bf16 v202, v158, v158, v202
    v_dot2_f32_bf16 v201, v159, s38, v201
    v_dot2_f32_bf16 v203, v159, v159, v203
    s_nop 2
    v_add_f32 v200, v200, v201
    v_add_f32 v202, v202, v203
    v_mov_b32 v201, v200
    v_mov_b32 v203, v202
    s_nop 1
    v_permlane32_swap_b32 v200, v201
    v_permlane32_swap_b32 v202, v203
    s_nop 1
    v_add_f32 v200, v200, v201
    v_add_f32 v202, v202, v203
    v_mul_f32 v200, 0xbacccccd, v200
    v_mul_f32 v202, 0x3acccccd, v202
    v_fma_f32 v202, -v200, v200, v202
    v_max_f32 v202, 0, v202
    v_add_f32 v202, 0x3727c5ac, v202
    v_sqrt_f32 v172, v202
    s_mov_b32 s41, 0xc0135761
    v_mov_b32 v173, s41
    v_rcp_f32 v171, v172
    s_mov_b32 s41, 0xbdd2d3e8
    v_mov_b32 v224, v200
    v_mov_b32 v225, v200
    v_mov_b32 v226, v200
    v_mov_b32 v227, v200
    v_mov_b32 v228, v200
    v_mov_b32 v229, v200
    v_mov_b32 v230, v200
    v_mov_b32 v231, v200
    v_mov_b32 v232, v200
    v_mov_b32 v233, v200
    v_mov_b32 v234, v200
    v_mov_b32 v235, v200
    v_mov_b32 v236, v200
    v_mov_b32 v237, v200
    v_mov_b32 v238, v200
    v_mov_b32 v239, v200
    v_mul_f32 v191, s40, v171
    s_nop 0
    v_mfma_f32_32x32x16_bf16 v[192:207], v[240:243], v[0:3], v[224:239]
    v_mfma_f32_32x32x16_bf16 v[192:207], v[244:247], v[4:7], v[192:207]
    s_waitcnt vmcnt(14)
    s_barrier
    ds_read_b64_tr_b16 a[64:65], v164 offset:0
    ds_read_b64_tr_b16 a[66:67], v164 offset:512
    ds_read_b64_tr_b16 a[68:69], v165 offset:0
    ds_read_b64_tr_b16 a[70:71], v165 offset:512
    ds_read_b64_tr_b16 a[72:73], v164 offset:8192
    ds_read_b64_tr_b16 a[74:75], v164 offset:8704
    ds_read_b64_tr_b16 a[76:77], v165 offset:8192
    ds_read_b64_tr_b16 a[78:79], v165 offset:8704
    ds_read_b64_tr_b16 a[80:81], v164 offset:2048
    ds_read_b64_tr_b16 a[82:83], v164 offset:2560
    ds_read_b64_tr_b16 a[84:85], v165 offset:2048
    ds_read_b64_tr_b16 a[86:87], v165 offset:2560
    ds_read_b64_tr_b16 a[88:89], v164 offset:10240
    ds_read_b64_tr_b16 a[90:91], v164 offset:10752
    ds_read_b64_tr_b16 a[92:93], v165 offset:10240
    ds_read_b64_tr_b16 a[94:95], v165 offset:10752
    v_cvt_pk_bf16_f32 v0, v192, v193
    v_cvt_pk_bf16_f32 v1, v194, v195
    v_cvt_pk_bf16_f32 v2, v196, v197
    v_cvt_pk_bf16_f32 v3, v198, v199
    v_cvt_pk_bf16_f32 v4, v200, v201
    v_cvt_pk_bf16_f32 v5, v202, v203
    v_cvt_pk_bf16_f32 v6, v204, v205
    v_cvt_pk_bf16_f32 v7, v206, v207
    s_cmp_lg_u32 s25, 0
    s_cbranch_scc1 NO6
    s_or_b32 s98, s100, 1
    s_mov_b32 s99, 0
    s_mov_b32 s101, s98
    s_atomic_cmpswap s[98:99], s[84:85], 0 glc
NO6:
    s_waitcnt lgkmcnt(8)
    v_mfma_f32_32x32x16_bf16 a[0:15], a[64:67], v[0:3], 0
    s_waitcnt vmcnt(6)
    s_barrier
    ds_read_b64_tr_b16 a[96:97], v164 offset:4096
    ds_read_b64_tr_b16 a[98:99], v164 offset:4608
    ds_read_b64_tr_b16 a[100:101], v165 offset:4096
    ds_read_b64_tr_b16 a[102:103], v165 offset:4608
    v_mfma_f32_32x32x16_bf16 a[16:31], a[68:71], v[0:3], 0
    ds_read_b64_tr_b16 a[104:105], v164 offset:12288
    ds_read_b64_tr_b16 a[106:107], v164 offset:12800
    ds_read_b64_tr_b16 a[108:109], v165 offset:12288
    ds_read_b64_tr_b16 a[110:111], v165 offset:12800
    v_mfma_f32_32x32x16_bf16 v[208:223], v[240:243], v[8:11], v[224:239]
    v_mfma_f32_32x32x16_bf16 a[32:47], a[72:75], v[0:3], 0
    s_add_u32 m0, s36, 65536
    s_add_u32 s37, s30, 983040
    buffer_load_dwordx4 v160, s[8:11], s37 offen lds
    v_mfma_f32_32x32x16_bf16 a[48:63], a[76:79], v[0:3], 0
    v_mfma_f32_32x32x16_bf16 v[208:223], v[244:247], v[12:15], v[208:223]
    buffer_load_dwordx4 v161, s[8:11], s37 offen offset:1024 lds
    s_waitcnt lgkmcnt(8)
    v_mfma_f32_32x32x16_bf16 a[0:15], a[80:83], v[4:7], a[0:15]
    ds_read_b64_tr_b16 a[64:65], v164 offset:6144
    ds_read_b64_tr_b16 a[66:67], v164 offset:6656
    ds_read_b64_tr_b16 a[68:69], v165 offset:6144
    ds_read_b64_tr_b16 a[70:71], v165 offset:6656
    v_mfma_f32_32x32x16_bf16 a[16:31], a[84:87], v[4:7], a[16:31]
    ds_read_b64_tr_b16 a[72:73], v164 offset:14336
    ds_read_b64_tr_b16 a[74:75], v164 offset:14848
    ds_read_b64_tr_b16 a[76:77], v165 offset:14336
    ds_read_b64_tr_b16 a[78:79], v165 offset:14848
    v_mfma_f32_32x32x16_bf16 a[32:47], a[88:91], v[4:7], a[32:47]
    v_cvt_pk_bf16_f32 v8, v208, v209
    v_cvt_pk_bf16_f32 v9, v210, v211
    v_cvt_pk_bf16_f32 v10, v212, v213
    v_cvt_pk_bf16_f32 v11, v214, v215
    s_add_u32 m0, s36, 73728
    s_add_u32 s37, s30, 983168
    buffer_load_dwordx4 v160, s[8:11], s37 offen lds
    v_mfma_f32_32x32x16_bf16 a[48:63], a[92:95], v[4:7], a[48:63]
    v_cvt_pk_bf16_f32 v12, v216, v217
    v_cvt_pk_bf16_f32 v13, v218, v219
    v_cvt_pk_bf16_f32 v14, v220, v221
    v_cvt_pk_bf16_f32 v15, v222, v223
    s_nop 0
    buffer_load_dwordx4 v161, s[8:11], s37 offen offset:1024 lds
    s_waitcnt lgkmcnt(8)
    v_mfma_f32_32x32x16_bf16 a[0:15], a[96:99], v[8:11], a[0:15]
    ds_read_b64_tr_b16 a[80:81], v164 offset:16384
    ds_read_b64_tr_b16 a[82:83], v164 offset:16896
    ds_read_b64_tr_b16 a[84:85], v165 offset:16384
    ds_read_b64_tr_b16 a[86:87], v165 offset:16896
    v_mfma_f32_32x32x16_bf16 a[16:31], a[100:103], v[8:11], a[16:31]
    ds_read_b64_tr_b16 a[88:89], v164 offset:24576
    ds_read_b64_tr_b16 a[90:91], v164 offset:25088
    ds_read_b64_tr_b16 a[92:93], v165 offset:24576
    ds_read_b64_tr_b16 a[94:95], v165 offset:25088
    v_mfma_f32_32x32x16_bf16 v[192:207], v[240:243], v[16:19], v[224:239]
    v_mfma_f32_32x32x16_bf16 a[32:47], a[104:107], v[8:11], a[32:47]
    s_add_u32 m0, s36, 81920
    s_add_u32 s37, s30, 1228800
    buffer_load_dwordx4 v160, s[8:11], s37 offen lds
    v_mfma_f32_32x32x16_bf16 a[48:63], a[108:111], v[8:11], a[48:63]
    v_mfma_f32_32x32x16_bf16 v[192:207], v[244:247], v[20:23], v[192:207]
    buffer_load_dwordx4 v161, s[8:11], s37 offen offset:1024 lds
    s_waitcnt lgkmcnt(8)
    v_mfma_f32_32x32x16_bf16 a[0:15], a[64:67], v[12:15], a[0:15]
    ds_read_b64_tr_b16 a[96:97], v164 offset:18432
    ds_read_b64_tr_b16 a[98:99], v164 offset:18944
    ds_read_b64_tr_b16 a[100:101], v165 offset:18432
    ds_read_b64_tr_b16 a[102:103], v165 offset:18944
    v_mfma_f32_32x32x16_bf16 a[16:31], a[68:71], v[12:15], a[16:31]
    ds_read_b64_tr_b16 a[104:105], v164 offset:26624
    ds_read_b64_tr_b16 a[106:107], v164 offset:27136
    ds_read_b64_tr_b16 a[108:109], v165 offset:26624
    ds_read_b64_tr_b16 a[110:111], v165 offset:27136
    v_mfma_f32_32x32x16_bf16 a[32:47], a[72:75], v[12:15], a[32:47]
    v_cvt_pk_bf16_f32 v16, v192, v193
    v_cvt_pk_bf16_f32 v17, v194, v195
    v_cvt_pk_bf16_f32 v18, v196, v197
    v_cvt_pk_bf16_f32 v19, v198, v199
    s_add_u32 m0, s36, 90112
    s_add_u32 s37, s30, 1228928
    buffer_load_dwordx4 v160, s[8:11], s37 offen lds
    v_mfma_f32_32x32x16_bf16 a[48:63], a[76:79], v[12:15], a[48:63]
    v_cvt_pk_bf16_f32 v20, v200, v201
    v_cvt_pk_bf16_f32 v21, v202, v203
    v_cvt_pk_bf16_f32 v22, v204, v205
    v_cvt_pk_bf16_f32 v23, v206, v207
    s_nop 0
    buffer_load_dwordx4 v161, s[8:11], s37 offen offset:1024 lds
    s_waitcnt lgkmcnt(8)
    v_mfma_f32_32x32x16_bf16 a[0:15], a[80:83], v[16:19], a[0:15]
    ds_read_b64_tr_b16 a[64:65], v164 offset:20480
    ds_read_b64_tr_b16 a[66:67], v164 offset:20992
    ds_read_b64_tr_b16 a[68:69], v165 offset:20480
    ds_read_b64_tr_b16 a[70:71], v165 offset:20992
    v_mfma_f32_32x32x16_bf16 a[16:31], a[84:87], v[16:19], a[16:31]
    ds_read_b64_tr_b16 a[72:73], v164 offset:28672
    ds_read_b64_tr_b16 a[74:75], v164 offset:29184
    ds_read_b64_tr_b16 a[76:77], v165 offset:28672
    ds_read_b64_tr_b16 a[78:79], v165 offset:29184
    v_mfma_f32_32x32x16_bf16 v[208:223], v[240:243], v[24:27], v[224:239]
    v_mfma_f32_32x32x16_bf16 a[32:47], a[88:91], v[16:19], a[32:47]
    s_add_u32 m0, s36, 98304
    s_add_u32 s37, s30, 1474560
    buffer_load_dwordx4 v160, s[8:11], s37 offen lds
    v_mfma_f32_32x32x16_bf16 a[48:63], a[92:95], v[16:19], a[48:63]
    v_mfma_f32_32x32x16_bf16 v[208:223], v[244:247], v[28:31], v[208:223]
    buffer_load_dwordx4 v161, s[8:11], s37 offen offset:1024 lds
    s_waitcnt lgkmcnt(8)
    v_mfma_f32_32x32x16_bf16 a[0:15], a[96:99], v[20:23], a[0:15]
    ds_read_b64_tr_b16 a[80:81], v164 offset:22528
    ds_read_b64_tr_b16 a[82:83], v164 offset:23040
    ds_read_b64_tr_b16 a[84:85], v165 offset:22528
    ds_read_b64_tr_b16 a[86:87], v165 offset:23040
    v_mfma_f32_32x32x16_bf16 a[16:31], a[100:103], v[20:23], a[16:31]
    ds_read_b64_tr_b16 a[88:89], v164 offset:30720
    ds_read_b64_tr_b16 a[90:91], v164 offset:31232
    ds_read_b64_tr_b16 a[92:93], v165 offset:30720
    ds_read_b64_tr_b16 a[94:95], v165 offset:31232
    v_mfma_f32_32x32x16_bf16 a[32:47], a[104:107], v[20:23], a[32:47]
    v_cvt_pk_bf16_f32 v24, v208, v209
    v_cvt_pk_bf16_f32 v25, v210, v211
    v_cvt_pk_bf16_f32 v26, v212, v213
    v_cvt_pk_bf16_f32 v27, v214, v215
    s_add_u32 m0, s36, 106496
    s_add_u32 s37, s30, 1474688
    buffer_load_dwordx4 v160, s[8:11], s37 offen lds
    v_mfma_f32_32x32x16_bf16 a[48:63], a[108:111], v[20:23], a[48:63]
    v_cvt_pk_bf16_f32 v28, v216, v217
    v_cvt_pk_bf16_f32 v29, v218, v219
    v_cvt_pk_bf16_f32 v30, v220, v221
    v_cvt_pk_bf16_f32 v31, v222, v223
    s_nop 0
    buffer_load_dwordx4 v161, s[8:11], s37 offen offset:1024 lds
    s_waitcnt lgkmcnt(8)
    v_mfma_f32_32x32x16_bf16 a[0:15], a[64:67], v[24:27], a[0:15]
    ds_read_b64_tr_b16 a[96:97], v164 offset:32768
    ds_read_b64_tr_b16 a[98:99], v164 offset:33280
    ds_read_b64_tr_b16 a[100:101], v165 offset:32768
    ds_read_b64_tr_b16 a[102:103], v165 offset:33280
    v_mfma_f32_32x32x16_bf16 a[16:31], a[68:71], v[24:27], a[16:31]
    ds_read_b64_tr_b16 a[104:105], v164 offset:40960
    ds_read_b64_tr_b16 a[106:107], v164 offset:41472
    ds_read_b64_tr_b16 a[108:109], v165 offset:40960
    ds_read_b64_tr_b16 a[110:111], v165 offset:41472
    v_mfma_f32_32x32x16_bf16 v[192:207], v[240:243], v[32:35], v[224:239]
    v_mfma_f32_32x32x16_bf16 a[32:47], a[72:75], v[24:27], a[32:47]
    s_add_u32 m0, s36, 114688
    s_add_u32 s37, s30, 1720320
    buffer_load_dwordx4 v160, s[8:11], s37 offen lds
    v_mfma_f32_32x32x16_bf16 a[48:63], a[76:79], v[24:27], a[48:63]
    v_mfma_f32_32x32x16_bf16 v[192:207], v[244:247], v[36:39], v[192:207]
    buffer_load_dwordx4 v161, s[8:11], s37 offen offset:1024 lds
    s_waitcnt lgkmcnt(8)
    v_mfma_f32_32x32x16_bf16 a[0:15], a[80:83], v[28:31], a[0:15]
    ds_read_b64_tr_b16 a[64:65], v164 offset:34816
    ds_read_b64_tr_b16 a[66:67], v164 offset:35328
    ds_read_b64_tr_b16 a[68:69], v165 offset:34816
    ds_read_b64_tr_b16 a[70:71], v165 offset:35328
    v_mfma_f32_32x32x16_bf16 a[16:31], a[84:87], v[28:31], a[16:31]
    ds_read_b64_tr_b16 a[72:73], v164 offset:43008
    ds_read_b64_tr_b16 a[74:75], v164 offset:43520
    ds_read_b64_tr_b16 a[76:77], v165 offset:43008
    ds_read_b64_tr_b16 a[78:79], v165 offset:43520
    v_mfma_f32_32x32x16_bf16 a[32:47], a[88:91], v[28:31], a[32:47]
    v_cvt_pk_bf16_f32 v32, v192, v193
    v_cvt_pk_bf16_f32 v33, v194, v195
    v_cvt_pk_bf16_f32 v34, v196, v197
    v_cvt_pk_bf16_f32 v35, v198, v199
    s_add_u32 m0, s36, 122880
    s_add_u32 s37, s30, 1720448
    buffer_load_dwordx4 v160, s[8:11], s37 offen lds
    v_mfma_f32_32x32x16_bf16 a[48:63], a[92:95], v[28:31], a[48:63]
    v_cvt_pk_bf16_f32 v36, v200, v201
    v_cvt_pk_bf16_f32 v37, v202, v203
    v_cvt_pk_bf16_f32 v38, v204, v205
    v_cvt_pk_bf16_f32 v39, v206, v207
    s_nop 0
    buffer_load_dwordx4 v161, s[8:11], s37 offen offset:1024 lds
    s_waitcnt lgkmcnt(8)
    v_mfma_f32_32x32x16_bf16 a[0:15], a[96:99], v[32:35], a[0:15]
    s_waitcnt vmcnt(8)
    s_barrier
    ds_read_b64_tr_b16 a[80:81], v164 offset:36864
    ds_read_b64_tr_b16 a[82:83], v164 offset:37376
    ds_read_b64_tr_b16 a[84:85], v165 offset:36864
    ds_read_b64_tr_b16 a[86:87], v165 offset:37376
    v_mfma_f32_32x32x16_bf16 a[16:31], a[100:103], v[32:35], a[16:31]
    ds_read_b64_tr_b16 a[88:89], v164 offset:45056
    ds_read_b64_tr_b16 a[90:91], v164 offset:45568
    ds_read_b64_tr_b16 a[92:93], v165 offset:45056
    ds_read_b64_tr_b16 a[94:95], v165 offset:45568
    v_mfma_f32_32x32x16_bf16 v[208:223], v[240:243], v[40:43], v[224:239]
    v_mfma_f32_32x32x16_bf16 a[32:47], a[104:107], v[32:35], a[32:47]
    s_add_u32 m0, s36, 131072
    s_add_u32 s37, s30, 1966080
    buffer_load_dwordx4 v160, s[8:11], s37 offen lds
    v_mfma_f32_32x32x16_bf16 a[48:63], a[108:111], v[32:35], a[48:63]
    v_mfma_f32_32x32x16_bf16 v[208:223], v[244:247], v[44:47], v[208:223]
    buffer_load_dwordx4 v161, s[8:11], s37 offen offset:1024 lds
    s_waitcnt lgkmcnt(8)
    v_mfma_f32_32x32x16_bf16 a[0:15], a[64:67], v[36:39], a[0:15]
    ds_read_b64_tr_b16 a[96:97], v164 offset:38912
    ds_read_b64_tr_b16 a[98:99], v164 offset:39424
    ds_read_b64_tr_b16 a[100:101], v165 offset:38912
    ds_read_b64_tr_b16 a[102:103], v165 offset:39424
    v_mfma_f32_32x32x16_bf16 a[16:31], a[68:71], v[36:39], a[16:31]
    ds_read_b64_tr_b16 a[104:105], v164 offset:47104
    ds_read_b64_tr_b16 a[106:107], v164 offset:47616
    ds_read_b64_tr_b16 a[108:109], v165 offset:47104
    ds_read_b64_tr_b16 a[110:111], v165 offset:47616
    v_mfma_f32_32x32x16_bf16 a[32:47], a[72:75], v[36:39], a[32:47]
    v_cvt_pk_bf16_f32 v40, v208, v209
    v_cvt_pk_bf16_f32 v41, v210, v211
    v_cvt_pk_bf16_f32 v42, v212, v213
    v_cvt_pk_bf16_f32 v43, v214, v215
    s_add_u32 m0, s36, 139264
    s_add_u32 s37, s30, 1966208
    buffer_load_dwordx4 v160, s[8:11], s37 offen lds
    v_mfma_f32_32x32x16_bf16 a[48:63], a[76:79], v[36:39], a[48:63]
    v_cvt_pk_bf16_f32 v44, v216, v217
    v_cvt_pk_bf16_f32 v45, v218, v219
    v_cvt_pk_bf16_f32 v46, v220, v221
    v_cvt_pk_bf16_f32 v47, v222, v223
    s_nop 0
    buffer_load_dwordx4 v161, s[8:11], s37 offen offset:1024 lds
    s_waitcnt lgkmcnt(8)
    v_mfma_f32_32x32x16_bf16 a[0:15], a[80:83], v[40:43], a[0:15]
    ds_read_b64_tr_b16 a[64:65], v164 offset:49152
    ds_read_b64_tr_b16 a[66:67], v164 offset:49664
    ds_read_b64_tr_b16 a[68:69], v165 offset:49152
    ds_read_b64_tr_b16 a[70:71], v165 offset:49664
    v_mfma_f32_32x32x16_bf16 a[16:31], a[84:87], v[40:43], a[16:31]
    ds_read_b64_tr_b16 a[72:73], v164 offset:57344
    ds_read_b64_tr_b16 a[74:75], v164 offset:57856
    ds_read_b64_tr_b16 a[76:77], v165 offset:57344
    ds_read_b64_tr_b16 a[78:79], v165 offset:57856
    v_mfma_f32_32x32x16_bf16 v[192:207], v[240:243], v[48:51], v[224:239]
    v_mfma_f32_32x32x16_bf16 a[32:47], a[88:91], v[40:43], a[32:47]
    s_add_u32 m0, s36, 147456
    s_add_u32 s37, s30, 2211840
    buffer_load_dwordx4 v160, s[8:11], s37 offen lds
    v_mfma_f32_32x32x16_bf16 a[48:63], a[92:95], v[40:43], a[48:63]
    v_mfma_f32_32x32x16_bf16 v[192:207], v[244:247], v[52:55], v[192:207]
    buffer_load_dwordx4 v161, s[8:11], s37 offen offset:1024 lds
    s_waitcnt lgkmcnt(8)
    v_mfma_f32_32x32x16_bf16 a[0:15], a[96:99], v[44:47], a[0:15]
    ds_read_b64_tr_b16 a[80:81], v164 offset:51200
    ds_read_b64_tr_b16 a[82:83], v164 offset:51712
    ds_read_b64_tr_b16 a[84:85], v165 offset:51200
    ds_read_b64_tr_b16 a[86:87], v165 offset:51712
    v_mfma_f32_32x32x16_bf16 a[16:31], a[100:103], v[44:47], a[16:31]
    ds_read_b64_tr_b16 a[88:89], v164 offset:59392
    ds_read_b64_tr_b16 a[90:91], v164 offset:59904
    ds_read_b64_tr_b16 a[92:93], v165 offset:59392
    ds_read_b64_tr_b16 a[94:95], v165 offset:59904
    v_mfma_f32_32x32x16_bf16 a[32:47], a[104:107], v[44:47], a[32:47]
    v_cvt_pk_bf16_f32 v48, v192, v193
    v_cvt_pk_bf16_f32 v49, v194, v195
    v_cvt_pk_bf16_f32 v50, v196, v197
    v_cvt_pk_bf16_f32 v51, v198, v199
    s_add_u32 m0, s36, 155648
    s_add_u32 s37, s30, 2211968
    buffer_load_dwordx4 v160, s[8:11], s37 offen lds
    v_mfma_f32_32x32x16_bf16 a[48:63], a[108:111], v[44:47], a[48:63]
    v_cvt_pk_bf16_f32 v52, v200, v201
    v_cvt_pk_bf16_f32 v53, v202, v203
    v_cvt_pk_bf16_f32 v54, v204, v205
    v_cvt_pk_bf16_f32 v55, v206, v207
    s_nop 0
    buffer_load_dwordx4 v161, s[8:11], s37 offen offset:1024 lds
    s_waitcnt lgkmcnt(8)
    v_mfma_f32_32x32x16_bf16 a[0:15], a[64:67], v[48:51], a[0:15]
    ds_read_b64_tr_b16 a[96:97], v164 offset:53248
    ds_read_b64_tr_b16 a[98:99], v164 offset:53760
    ds_read_b64_tr_b16 a[100:101], v165 offset:53248
    ds_read_b64_tr_b16 a[102:103], v165 offset:53760
    v_mfma_f32_32x32x16_bf16 a[16:31], a[68:71], v[48:51], a[16:31]
    ds_read_b64_tr_b16 a[104:105], v164 offset:61440
    ds_read_b64_tr_b16 a[106:107], v164 offset:61952
    ds_read_b64_tr_b16 a[108:109], v165 offset:61440
    ds_read_b64_tr_b16 a[110:111], v165 offset:61952
    v_mfma_f32_32x32x16_bf16 v[208:223], v[240:243], v[56:59], v[224:239]
    v_mfma_f32_32x32x16_bf16 a[32:47], a[72:75], v[48:51], a[32:47]
    s_add_u32 m0, s36, 0
    s_add_u32 s37, s31, 0
    buffer_load_dwordx4 v160, s[8:11], s37 offen lds
    v_mfma_f32_32x32x16_bf16 a[48:63], a[76:79], v[48:51], a[48:63]
    v_mfma_f32_32x32x16_bf16 v[208:223], v[244:247], v[60:63], v[208:223]
    buffer_load_dwordx4 v161, s[8:11], s37 offen offset:1024 lds
    s_waitcnt lgkmcnt(8)
    v_mfma_f32_32x32x16_bf16 a[0:15], a[80:83], v[52:55], a[0:15]
    ds_read_b64_tr_b16 a[64:65], v164 offset:55296
    ds_read_b64_tr_b16 a[66:67], v164 offset:55808
    ds_read_b64_tr_b16 a[68:69], v165 offset:55296
    ds_read_b64_tr_b16 a[70:71], v165 offset:55808
    v_mfma_f32_32x32x16_bf16 a[16:31], a[84:87], v[52:55], a[16:31]
    ds_read_b64_tr_b16 a[72:73], v164 offset:63488
    ds_read_b64_tr_b16 a[74:75], v164 offset:64000
    ds_read_b64_tr_b16 a[76:77], v165 offset:63488
    ds_read_b64_tr_b16 a[78:79], v165 offset:64000
    v_mfma_f32_32x32x16_bf16 a[32:47], a[88:91], v[52:55], a[32:47]
    v_cvt_pk_bf16_f32 v56, v208, v209
    v_cvt_pk_bf16_f32 v57, v210, v211
    v_cvt_pk_bf16_f32 v58, v212, v213
    v_cvt_pk_bf16_f32 v59, v214, v215
    s_add_u32 m0, s36, 8192
    s_add_u32 s37, s31, 128
    buffer_load_dwordx4 v160, s[8:11], s37 offen lds
    v_mfma_f32_32x32x16_bf16 a[48:63], a[92:95], v[52:55], a[48:63]
    v_cvt_pk_bf16_f32 v60, v216, v217
    v_cvt_pk_bf16_f32 v61, v218, v219
    v_cvt_pk_bf16_f32 v62, v220, v221
    v_cvt_pk_bf16_f32 v63, v222, v223
    s_nop 0
    buffer_load_dwordx4 v161, s[8:11], s37 offen offset:1024 lds
    s_waitcnt lgkmcnt(8)
    v_mfma_f32_32x32x16_bf16 a[0:15], a[96:99], v[56:59], a[0:15]
    ds_read_b64_tr_b16 a[80:81], v166 offset:0
    ds_read_b64_tr_b16 a[82:83], v166 offset:512
    ds_read_b64_tr_b16 a[84:85], v167 offset:0
    ds_read_b64_tr_b16 a[86:87], v167 offset:512
    v_mfma_f32_32x32x16_bf16 a[16:31], a[100:103], v[56:59], a[16:31]
    ds_read_b64_tr_b16 a[88:89], v166 offset:8192
    ds_read_b64_tr_b16 a[90:91], v166 offset:8704
    ds_read_b64_tr_b16 a[92:93], v167 offset:8192
    ds_read_b64_tr_b16 a[94:95], v167 offset:8704
    v_mfma_f32_32x32x16_bf16 v[192:207], v[240:243], v[64:67], v[224:239]
    v_mfma_f32_32x32x16_bf16 a[32:47], a[104:107], v[56:59], a[32:47]
    s_add_u32 m0, s36, 16384
    s_add_u32 s37, s31, 245760
    buffer_load_dwordx4 v160, s[8:11], s37 offen lds
    v_mfma_f32_32x32x16_bf16 a[48:63], a[108:111], v[56:59], a[48:63]
    v_mfma_f32_32x32x16_bf16 v[192:207], v[244:247], v[68:71], v[192:207]
    buffer_load_dwordx4 v161, s[8:11], s37 offen offset:1024 lds
    s_waitcnt lgkmcnt(8)
    v_mfma_f32_32x32x16_bf16 a[0:15], a[64:67], v[60:63], a[0:15]
    ds_read_b64_tr_b16 a[96:97], v166 offset:2048
    ds_read_b64_tr_b16 a[98:99], v166 offset:2560
    ds_read_b64_tr_b16 a[100:101], v167 offset:2048
    ds_read_b64_tr_b16 a[102:103], v167 offset:2560
    v_mfma_f32_32x32x16_bf16 a[16:31], a[68:71], v[60:63], a[16:31]
    ds_read_b64_tr_b16 a[104:105], v166 offset:10240
    ds_read_b64_tr_b16 a[106:107], v166 offset:10752
    ds_read_b64_tr_b16 a[108:109], v167 offset:10240
    ds_read_b64_tr_b16 a[110:111], v167 offset:10752
    v_mfma_f32_32x32x16_bf16 a[32:47], a[72:75], v[60:63], a[32:47]
    v_cvt_pk_bf16_f32 v64, v192, v193
    v_cvt_pk_bf16_f32 v65, v194, v195
    v_cvt_pk_bf16_f32 v66, v196, v197
    v_cvt_pk_bf16_f32 v67, v198, v199
    s_add_u32 m0, s36, 24576
    s_add_u32 s37, s31, 245888
    buffer_load_dwordx4 v160, s[8:11], s37 offen lds
    v_mfma_f32_32x32x16_bf16 a[48:63], a[76:79], v[60:63], a[48:63]
    v_cvt_pk_bf16_f32 v68, v200, v201
    v_cvt_pk_bf16_f32 v69, v202, v203
    v_cvt_pk_bf16_f32 v70, v204, v205
    v_cvt_pk_bf16_f32 v71, v206, v207
    s_nop 0
    buffer_load_dwordx4 v161, s[8:11], s37 offen offset:1024 lds
    s_waitcnt lgkmcnt(8)
    v_mfma_f32_32x32x16_bf16 a[0:15], a[80:83], v[64:67], a[0:15]
    s_waitcnt vmcnt(16)
    s_barrier
    ds_read_b64_tr_b16 a[64:65], v166 offset:4096
    ds_read_b64_tr_b16 a[66:67], v166 offset:4608
    ds_read_b64_tr_b16 a[68:69], v167 offset:4096
    ds_read_b64_tr_b16 a[70:71], v167 offset:4608
    v_mfma_f32_32x32x16_bf16 a[16:31], a[84:87], v[64:67], a[16:31]
    ds_read_b64_tr_b16 a[72:73], v166 offset:12288
    ds_read_b64_tr_b16 a[74:75], v166 offset:12800
    ds_read_b64_tr_b16 a[76:77], v167 offset:12288
    ds_read_b64_tr_b16 a[78:79], v167 offset:12800
    v_mfma_f32_32x32x16_bf16 v[208:223], v[240:243], v[72:75], v[224:239]
    v_mfma_f32_32x32x16_bf16 a[32:47], a[88:91], v[64:67], a[32:47]
    s_add_u32 m0, s36, 32768
    s_add_u32 s37, s31, 491520
    buffer_load_dwordx4 v160, s[8:11], s37 offen lds
    v_mfma_f32_32x32x16_bf16 a[48:63], a[92:95], v[64:67], a[48:63]
    v_mfma_f32_32x32x16_bf16 v[208:223], v[244:247], v[76:79], v[208:223]
    s_waitcnt lgkmcnt(8)
    v_mfma_f32_32x32x16_bf16 a[0:15], a[96:99], v[68:71], a[0:15]
    ds_read_b64_tr_b16 a[80:81], v166 offset:6144
    ds_read_b64_tr_b16 a[82:83], v166 offset:6656
    ds_read_b64_tr_b16 a[84:85], v167 offset:6144
    ds_read_b64_tr_b16 a[86:87], v167 offset:6656
    v_mfma_f32_32x32x16_bf16 a[16:31], a[100:103], v[68:71], a[16:31]
    ds_read_b64_tr_b16 a[88:89], v166 offset:14336
    ds_read_b64_tr_b16 a[90:91], v166 offset:14848
    ds_read_b64_tr_b16 a[92:93], v167 offset:14336
    ds_read_b64_tr_b16 a[94:95], v167 offset:14848
    v_mfma_f32_32x32x16_bf16 a[32:47], a[104:107], v[68:71], a[32:47]
    v_cvt_pk_bf16_f32 v72, v208, v209
    v_cvt_pk_bf16_f32 v73, v210, v211
    v_cvt_pk_bf16_f32 v74, v212, v213
    v_cvt_pk_bf16_f32 v75, v214, v215
    buffer_load_dwordx4 v161, s[8:11], s37 offen offset:1024 lds
    v_mfma_f32_32x32x16_bf16 a[48:63], a[108:111], v[68:71], a[48:63]
    v_cvt_pk_bf16_f32 v76, v216, v217
    v_cvt_pk_bf16_f32 v77, v218, v219
    v_cvt_pk_bf16_f32 v78, v220, v221
    v_cvt_pk_bf16_f32 v79, v222, v223
    s_nop 0
    s_waitcnt lgkmcnt(8)
    v_mfma_f32_32x32x16_bf16 a[0:15], a[64:67], v[72:75], a[0:15]
    ds_read_b64_tr_b16 a[96:97], v166 offset:16384
    ds_read_b64_tr_b16 a[98:99], v166 offset:16896
    ds_read_b64_tr_b16 a[100:101], v167 offset:16384
    ds_read_b64_tr_b16 a[102:103], v167 offset:16896
    v_mfma_f32_32x32x16_bf16 a[16:31], a[68:71], v[72:75], a[16:31]
    ds_read_b64_tr_b16 a[104:105], v166 offset:24576
    ds_read_b64_tr_b16 a[106:107], v166 offset:25088
    ds_read_b64_tr_b16 a[108:109], v167 offset:24576
    ds_read_b64_tr_b16 a[110:111], v167 offset:25088
    v_mfma_f32_32x32x16_bf16 v[192:207], v[240:243], v[80:83], v[224:239]
    v_mfma_f32_32x32x16_bf16 a[32:47], a[72:75], v[72:75], a[32:47]
    s_add_u32 m0, s36, 40960
    s_add_u32 s37, s31, 491648
    buffer_load_dwordx4 v160, s[8:11], s37 offen lds
    v_mfma_f32_32x32x16_bf16 a[48:63], a[76:79], v[72:75], a[48:63]
    v_mfma_f32_32x32x16_bf16 v[192:207], v[244:247], v[84:87], v[192:207]
    s_waitcnt lgkmcnt(8)
    v_mfma_f32_32x32x16_bf16 a[0:15], a[80:83], v[76:79], a[0:15]
    ds_read_b64_tr_b16 a[64:65], v166 offset:18432
    ds_read_b64_tr_b16 a[66:67], v166 offset:18944
    ds_read_b64_tr_b16 a[68:69], v167 offset:18432
    ds_read_b64_tr_b16 a[70:71], v167 offset:18944
    v_mfma_f32_32x32x16_bf16 a[16:31], a[84:87], v[76:79], a[16:31]
    ds_read_b64_tr_b16 a[72:73], v166 offset:26624
    ds_read_b64_tr_b16 a[74:75], v166 offset:27136
    ds_read_b64_tr_b16 a[76:77], v167 offset:26624
    ds_read_b64_tr_b16 a[78:79], v167 offset:27136
    v_mfma_f32_32x32x16_bf16 a[32:47], a[88:91], v[76:79], a[32:47]
    v_cvt_pk_bf16_f32 v80, v192, v193
    v_cvt_pk_bf16_f32 v81, v194, v195
    v_cvt_pk_bf16_f32 v82, v196, v197
    v_cvt_pk_bf16_f32 v83, v198, v199
    buffer_load_dwordx4 v161, s[8:11], s37 offen offset:1024 lds
    v_mfma_f32_32x32x16_bf16 a[48:63], a[92:95], v[76:79], a[48:63]
    v_cvt_pk_bf16_f32 v84, v200, v201
    v_cvt_pk_bf16_f32 v85, v202, v203
    v_cvt_pk_bf16_f32 v86, v204, v205
    v_cvt_pk_bf16_f32 v87, v206, v207
    s_nop 0
    s_waitcnt lgkmcnt(8)
    v_mfma_f32_32x32x16_bf16 a[0:15], a[96:99], v[80:83], a[0:15]
    ds_read_b64_tr_b16 a[80:81], v166 offset:20480
    ds_read_b64_tr_b16 a[82:83], v166 offset:20992
    ds_read_b64_tr_b16 a[84:85], v167 offset:20480
    ds_read_b64_tr_b16 a[86:87], v167 offset:20992
    v_mfma_f32_32x32x16_bf16 a[16:31], a[100:103], v[80:83], a[16:31]
    ds_read_b64_tr_b16 a[88:89], v166 offset:28672
    ds_read_b64_tr_b16 a[90:91], v166 offset:29184
    ds_read_b64_tr_b16 a[92:93], v167 offset:28672
    ds_read_b64_tr_b16 a[94:95], v167 offset:29184
    v_mfma_f32_32x32x16_bf16 v[208:223], v[240:243], v[88:91], v[224:239]
    v_mfma_f32_32x32x16_bf16 a[32:47], a[104:107], v[80:83], a[32:47]
    s_add_u32 m0, s36, 49152
    s_add_u32 s37, s31, 737280
    buffer_load_dwordx4 v160, s[8:11], s37 offen lds
    v_mfma_f32_32x32x16_bf16 a[48:63], a[108:111], v[80:83], a[48:63]
    v_mfma_f32_32x32x16_bf16 v[208:223], v[244:247], v[92:95], v[208:223]
    s_waitcnt lgkmcnt(8)
    v_mfma_f32_32x32x16_bf16 a[0:15], a[64:67], v[84:87], a[0:15]
    ds_read_b64_tr_b16 a[96:97], v166 offset:22528
    ds_read_b64_tr_b16 a[98:99], v166 offset:23040
    ds_read_b64_tr_b16 a[100:101], v167 offset:22528
    ds_read_b64_tr_b16 a[102:103], v167 offset:23040
    v_mfma_f32_32x32x16_bf16 a[16:31], a[68:71], v[84:87], a[16:31]
    ds_read_b64_tr_b16 a[104:105], v166 offset:30720
    ds_read_b64_tr_b16 a[106:107], v166 offset:31232
    ds_read_b64_tr_b16 a[108:109], v167 offset:30720
    ds_read_b64_tr_b16 a[110:111], v167 offset:31232
    v_mfma_f32_32x32x16_bf16 a[32:47], a[72:75], v[84:87], a[32:47]
    v_cvt_pk_bf16_f32 v88, v208, v209
    v_cvt_pk_bf16_f32 v89, v210, v211
    v_cvt_pk_bf16_f32 v90, v212, v213
    v_cvt_pk_bf16_f32 v91, v214, v215
    buffer_load_dwordx4 v161, s[8:11], s37 offen offset:1024 lds
    v_mfma_f32_32x32x16_bf16 a[48:63], a[76:79], v[84:87], a[48:63]
    v_cvt_pk_bf16_f32 v92, v216, v217
    v_cvt_pk_bf16_f32 v93, v218, v219
    v_cvt_pk_bf16_f32 v94, v220, v221
    v_cvt_pk_bf16_f32 v95, v222, v223
    s_nop 0
    s_waitcnt lgkmcnt(8)
    v_mfma_f32_32x32x16_bf16 a[0:15], a[80:83], v[88:91], a[0:15]
    ds_read_b64_tr_b16 a[64:65], v166 offset:32768
    ds_read_b64_tr_b16 a[66:67], v166 offset:33280
    ds_read_b64_tr_b16 a[68:69], v167 offset:32768
    ds_read_b64_tr_b16 a[70:71], v167 offset:33280
    v_mfma_f32_32x32x16_bf16 a[16:31], a[84:87], v[88:91], a[16:31]
    ds_read_b64_tr_b16 a[72:73], v166 offset:40960
    ds_read_b64_tr_b16 a[74:75], v166 offset:41472
    ds_read_b64_tr_b16 a[76:77], v167 offset:40960
    ds_read_b64_tr_b16 a[78:79], v167 offset:41472
    v_mfma_f32_32x32x16_bf16 v[192:207], v[240:243], v[96:99], v[224:239]
    v_mfma_f32_32x32x16_bf16 a[32:47], a[88:91], v[88:91], a[32:47]
    s_add_u32 m0, s36, 57344
    s_add_u32 s37, s31, 737408
    buffer_load_dwordx4 v160, s[8:11], s37 offen lds
    v_mfma_f32_32x32x16_bf16 a[48:63], a[92:95], v[88:91], a[48:63]
    v_mfma_f32_32x32x16_bf16 v[192:207], v[244:247], v[100:103], v[192:207]
    s_waitcnt lgkmcnt(8)
    v_mfma_f32_32x32x16_bf16 a[0:15], a[96:99], v[92:95], a[0:15]
    ds_read_b64_tr_b16 a[80:81], v166 offset:34816
    ds_read_b64_tr_b16 a[82:83], v166 offset:35328
    ds_read_b64_tr_b16 a[84:85], v167 offset:34816
    ds_read_b64_tr_b16 a[86:87], v167 offset:35328
    v_mfma_f32_32x32x16_bf16 a[16:31], a[100:103], v[92:95], a[16:31]
    ds_read_b64_tr_b16 a[88:89], v166 offset:43008
    ds_read_b64_tr_b16 a[90:91], v166 offset:43520
    ds_read_b64_tr_b16 a[92:93], v167 offset:43008
    ds_read_b64_tr_b16 a[94:95], v167 offset:43520
    v_mfma_f32_32x32x16_bf16 a[32:47], a[104:107], v[92:95], a[32:47]
    v_cvt_pk_bf16_f32 v96, v192, v193
    v_cvt_pk_bf16_f32 v97, v194, v195
    v_cvt_pk_bf16_f32 v98, v196, v197
    v_cvt_pk_bf16_f32 v99, v198, v199
    buffer_load_dwordx4 v161, s[8:11], s37 offen offset:1024 lds
    v_mfma_f32_32x32x16_bf16 a[48:63], a[108:111], v[92:95], a[48:63]
    v_cvt_pk_bf16_f32 v100, v200, v201
    v_cvt_pk_bf16_f32 v101, v202, v203
    v_cvt_pk_bf16_f32 v102, v204, v205
    v_cvt_pk_bf16_f32 v103, v206, v207
    s_nop 0
    s_waitcnt lgkmcnt(8)
    v_mfma_f32_32x32x16_bf16 a[0:15], a[64:67], v[96:99], a[0:15]
    s_waitcnt vmcnt(16)
    s_barrier
    ds_read_b64_tr_b16 a[96:97], v166 offset:36864
    ds_read_b64_tr_b16 a[98:99], v166 offset:37376
    ds_read_b64_tr_b16 a[100:101], v167 offset:36864
    ds_read_b64_tr_b16 a[102:103], v167 offset:37376
    v_mfma_f32_32x32x16_bf16 a[16:31], a[68:71], v[96:99], a[16:31]
    ds_read_b64_tr_b16 a[104:105], v166 offset:45056
    ds_read_b64_tr_b16 a[106:107], v166 offset:45568
    ds_read_b64_tr_b16 a[108:109], v167 offset:45056
    ds_read_b64_tr_b16 a[110:111], v167 offset:45568
    v_mfma_f32_32x32x16_bf16 v[208:223], v[240:243], v[104:107], v[224:239]
    v_mfma_f32_32x32x16_bf16 a[32:47], a[72:75], v[96:99], a[32:47]
    s_add_u32 m0, s36, 65536
    s_add_u32 s37, s31, 983040
    buffer_load_dwordx4 v160, s[8:11], s37 offen lds
    v_mfma_f32_32x32x16_bf16 a[48:63], a[76:79], v[96:99], a[48:63]
    v_mfma_f32_32x32x16_bf16 v[208:223], v[244:247], v[108:111], v[208:223]
    s_waitcnt lgkmcnt(8)
    v_mfma_f32_32x32x16_bf16 a[0:15], a[80:83], v[100:103], a[0:15]
    ds_read_b64_tr_b16 a[64:65], v166 offset:38912
    ds_read_b64_tr_b16 a[66:67], v166 offset:39424
    ds_read_b64_tr_b16 a[68:69], v167 offset:38912
    ds_read_b64_tr_b16 a[70:71], v167 offset:39424
    v_mfma_f32_32x32x16_bf16 a[16:31], a[84:87], v[100:103], a[16:31]
    ds_read_b64_tr_b16 a[72:73], v166 offset:47104
    ds_read_b64_tr_b16 a[74:75], v166 offset:47616
    ds_read_b64_tr_b16 a[76:77], v167 offset:47104
    ds_read_b64_tr_b16 a[78:79], v167 offset:47616
    v_mfma_f32_32x32x16_bf16 a[32:47], a[88:91], v[100:103], a[32:47]
    v_cvt_pk_bf16_f32 v104, v208, v209
    v_cvt_pk_bf16_f32 v105, v210, v211
    v_cvt_pk_bf16_f32 v106, v212, v213
    v_cvt_pk_bf16_f32 v107, v214, v215
    buffer_load_dwordx4 v161, s[8:11], s37 offen offset:1024 lds
    v_mfma_f32_32x32x16_bf16 a[48:63], a[92:95], v[100:103], a[48:63]
    v_cvt_pk_bf16_f32 v108, v216, v217
    v_cvt_pk_bf16_f32 v109, v218, v219
    v_cvt_pk_bf16_f32 v110, v220, v221
    v_cvt_pk_bf16_f32 v111, v222, v223
    s_nop 0
    s_waitcnt lgkmcnt(8)
    v_mfma_f32_32x32x16_bf16 a[0:15], a[96:99], v[104:107], a[0:15]
    ds_read_b64_tr_b16 a[80:81], v166 offset:49152
    ds_read_b64_tr_b16 a[82:83], v166 offset:49664
    ds_read_b64_tr_b16 a[84:85], v167 offset:49152
    ds_read_b64_tr_b16 a[86:87], v167 offset:49664
    v_mfma_f32_32x32x16_bf16 a[16:31], a[100:103], v[104:107], a[16:31]
    ds_read_b64_tr_b16 a[88:89], v166 offset:57344
    ds_read_b64_tr_b16 a[90:91], v166 offset:57856
    ds_read_b64_tr_b16 a[92:93], v167 offset:57344
    ds_read_b64_tr_b16 a[94:95], v167 offset:57856
    v_mfma_f32_32x32x16_bf16 v[192:207], v[240:243], v[112:115], v[224:239]
    v_mfma_f32_32x32x16_bf16 a[32:47], a[104:107], v[104:107], a[32:47]
    s_add_u32 m0, s36, 73728
    s_add_u32 s37, s31, 983168
    buffer_load_dwordx4 v160, s[8:11], s37 offen lds
    v_mfma_f32_32x32x16_bf16 a[48:63], a[108:111], v[104:107], a[48:63]
    v_mfma_f32_32x32x16_bf16 v[192:207], v[244:247], v[116:119], v[192:207]
    s_waitcnt lgkmcnt(8)
    v_mfma_f32_32x32x16_bf16 a[0:15], a[64:67], v[108:111], a[0:15]
    ds_read_b64_tr_b16 a[96:97], v166 offset:51200
    ds_read_b64_tr_b16 a[98:99], v166 offset:51712
    ds_read_b64_tr_b16 a[100:101], v167 offset:51200
    ds_read_b64_tr_b16 a[102:103], v167 offset:51712
    v_mfma_f32_32x32x16_bf16 a[16:31], a[68:71], v[108:111], a[16:31]
    ds_read_b64_tr_b16 a[104:105], v166 offset:59392
    ds_read_b64_tr_b16 a[106:107], v166 offset:59904
    ds_read_b64_tr_b16 a[108:109], v167 offset:59392
    ds_read_b64_tr_b16 a[110:111], v167 offset:59904
    v_mfma_f32_32x32x16_bf16 a[32:47], a[72:75], v[108:111], a[32:47]
    v_cvt_pk_bf16_f32 v112, v192, v193
    v_cvt_pk_bf16_f32 v113, v194, v195
    v_cvt_pk_bf16_f32 v114, v196, v197
    v_cvt_pk_bf16_f32 v115, v198, v199
    buffer_load_dwordx4 v161, s[8:11], s37 offen offset:1024 lds
    v_mfma_f32_32x32x16_bf16 a[48:63], a[76:79], v[108:111], a[48:63]
    v_cvt_pk_bf16_f32 v116, v200, v201
    v_cvt_pk_bf16_f32 v117, v202, v203
    v_cvt_pk_bf16_f32 v118, v204, v205
    v_cvt_pk_bf16_f32 v119, v206, v207
    s_nop 0
    s_waitcnt lgkmcnt(8)
    v_mfma_f32_32x32x16_bf16 a[0:15], a[80:83], v[112:115], a[0:15]
    ds_read_b64_tr_b16 a[64:65], v166 offset:53248
    ds_read_b64_tr_b16 a[66:67], v166 offset:53760
    ds_read_b64_tr_b16 a[68:69], v167 offset:53248
    ds_read_b64_tr_b16 a[70:71], v167 offset:53760
    v_mfma_f32_32x32x16_bf16 a[16:31], a[84:87], v[112:115], a[16:31]
    ds_read_b64_tr_b16 a[72:73], v166 offset:61440
    ds_read_b64_tr_b16 a[74:75], v166 offset:61952
    ds_read_b64_tr_b16 a[76:77], v167 offset:61440
    ds_read_b64_tr_b16 a[78:79], v167 offset:61952
    v_mfma_f32_32x32x16_bf16 v[208:223], v[240:243], v[120:123], v[224:239]
    v_mfma_f32_32x32x16_bf16 a[32:47], a[88:91], v[112:115], a[32:47]
    s_add_u32 m0, s36, 81920
    s_add_u32 s37, s31, 1228800
    buffer_load_dwordx4 v160, s[8:11], s37 offen lds
    v_mfma_f32_32x32x16_bf16 a[48:63], a[92:95], v[112:115], a[48:63]
    v_mfma_f32_32x32x16_bf16 v[208:223], v[244:247], v[124:127], v[208:223]
    s_waitcnt lgkmcnt(8)
    v_mfma_f32_32x32x16_bf16 a[0:15], a[96:99], v[116:119], a[0:15]
    ds_read_b64_tr_b16 a[80:81], v166 offset:55296
    ds_read_b64_tr_b16 a[82:83], v166 offset:55808
    ds_read_b64_tr_b16 a[84:85], v167 offset:55296
    ds_read_b64_tr_b16 a[86:87], v167 offset:55808
    v_mfma_f32_32x32x16_bf16 a[16:31], a[100:103], v[116:119], a[16:31]
    ds_read_b64_tr_b16 a[88:89], v166 offset:63488
    ds_read_b64_tr_b16 a[90:91], v166 offset:64000
    ds_read_b64_tr_b16 a[92:93], v167 offset:63488
    ds_read_b64_tr_b16 a[94:95], v167 offset:64000
    v_mfma_f32_32x32x16_bf16 a[32:47], a[104:107], v[116:119], a[32:47]
    v_cvt_pk_bf16_f32 v120, v208, v209
    v_cvt_pk_bf16_f32 v121, v210, v211
    v_cvt_pk_bf16_f32 v122, v212, v213
    v_cvt_pk_bf16_f32 v123, v214, v215
    buffer_load_dwordx4 v161, s[8:11], s37 offen offset:1024 lds
    v_mfma_f32_32x32x16_bf16 a[48:63], a[108:111], v[116:119], a[48:63]
    v_cvt_pk_bf16_f32 v124, v216, v217
    v_cvt_pk_bf16_f32 v125, v218, v219
    v_cvt_pk_bf16_f32 v126, v220, v221
    v_cvt_pk_bf16_f32 v127, v222, v223
    s_nop 0
    s_waitcnt lgkmcnt(8)
    v_mfma_f32_32x32x16_bf16 a[0:15], a[64:67], v[120:123], a[0:15]
    ds_read_b64_tr_b16 a[96:97], v168 offset:0
    ds_read_b64_tr_b16 a[98:99], v168 offset:512
    ds_read_b64_tr_b16 a[100:101], v169 offset:0
    ds_read_b64_tr_b16 a[102:103], v169 offset:512
    v_mfma_f32_32x32x16_bf16 a[16:31], a[68:71], v[120:123], a[16:31]
    ds_read_b64_tr_b16 a[104:105], v168 offset:8192
    ds_read_b64_tr_b16 a[106:107], v168 offset:8704
    ds_read_b64_tr_b16 a[108:109], v169 offset:8192
    ds_read_b64_tr_b16 a[110:111], v169 offset:8704
    v_mfma_f32_32x32x16_bf16 v[192:207], v[240:243], v[128:131], v[224:239]
    v_mfma_f32_32x32x16_bf16 a[32:47], a[72:75], v[120:123], a[32:47]
    s_add_u32 m0, s36, 90112
    s_add_u32 s37, s31, 1228928
    buffer_load_dwordx4 v160, s[8:11], s37 offen lds
    v_mfma_f32_32x32x16_bf16 a[48:63], a[76:79], v[120:123], a[48:63]
    v_mfma_f32_32x32x16_bf16 v[192:207], v[244:247], v[132:135], v[192:207]
    s_waitcnt lgkmcnt(8)
    v_mfma_f32_32x32x16_bf16 a[0:15], a[80:83], v[124:127], a[0:15]
    ds_read_b64_tr_b16 a[64:65], v168 offset:2048
    ds_read_b64_tr_b16 a[66:67], v168 offset:2560
    ds_read_b64_tr_b16 a[68:69], v169 offset:2048
    ds_read_b64_tr_b16 a[70:71], v169 offset:2560
    v_mfma_f32_32x32x16_bf16 a[16:31], a[84:87], v[124:127], a[16:31]
    ds_read_b64_tr_b16 a[72:73], v168 offset:10240
    ds_read_b64_tr_b16 a[74:75], v168 offset:10752
    ds_read_b64_tr_b16 a[76:77], v169 offset:10240
    ds_read_b64_tr_b16 a[78:79], v169 offset:10752
    v_mfma_f32_32x32x16_bf16 a[32:47], a[88:91], v[124:127], a[32:47]
    v_cvt_pk_bf16_f32 v128, v192, v193
    v_cvt_pk_bf16_f32 v129, v194, v195
    v_cvt_pk_bf16_f32 v130, v196, v197
    v_cvt_pk_bf16_f32 v131, v198, v199
    buffer_load_dwordx4 v161, s[8:11], s37 offen offset:1024 lds
    v_mfma_f32_32x32x16_bf16 a[48:63], a[92:95], v[124:127], a[48:63]
    v_cvt_pk_bf16_f32 v132, v200, v201
    v_cvt_pk_bf16_f32 v133, v202, v203
    v_cvt_pk_bf16_f32 v134, v204, v205
    v_cvt_pk_bf16_f32 v135, v206, v207
    s_nop 0
    s_waitcnt lgkmcnt(8)
    v_mfma_f32_32x32x16_bf16 a[0:15], a[96:99], v[128:131], a[0:15]
    s_waitcnt vmcnt(16)
    s_barrier
    ds_read_b64_tr_b16 a[80:81], v168 offset:4096
    ds_read_b64_tr_b16 a[82:83], v168 offset:4608
    ds_read_b64_tr_b16 a[84:85], v169 offset:4096
    ds_read_b64_tr_b16 a[86:87], v169 offset:4608
    v_mfma_f32_32x32x16_bf16 a[16:31], a[100:103], v[128:131], a[16:31]
    ds_read_b64_tr_b16 a[88:89], v168 offset:12288
    ds_read_b64_tr_b16 a[90:91], v168 offset:12800
    ds_read_b64_tr_b16 a[92:93], v169 offset:12288
    ds_read_b64_tr_b16 a[94:95], v169 offset:12800
    v_mfma_f32_32x32x16_bf16 v[208:223], v[240:243], v[136:139], v[224:239]
    v_mfma_f32_32x32x16_bf16 a[32:47], a[104:107], v[128:131], a[32:47]
    s_add_u32 m0, s36, 98304
    s_add_u32 s37, s31, 1474560
    buffer_load_dwordx4 v160, s[8:11], s37 offen lds
    v_mfma_f32_32x32x16_bf16 a[48:63], a[108:111], v[128:131], a[48:63]
    v_mfma_f32_32x32x16_bf16 v[208:223], v[244:247], v[140:143], v[208:223]
    s_waitcnt lgkmcnt(8)
    v_mfma_f32_32x32x16_bf16 a[0:15], a[64:67], v[132:135], a[0:15]
    ds_read_b64_tr_b16 a[96:97], v168 offset:6144
    ds_read_b64_tr_b16 a[98:99], v168 offset:6656
    ds_read_b64_tr_b16 a[100:101], v169 offset:6144
    ds_read_b64_tr_b16 a[102:103], v169 offset:6656
    v_mfma_f32_32x32x16_bf16 a[16:31], a[68:71], v[132:135], a[16:31]
    ds_read_b64_tr_b16 a[104:105], v168 offset:14336
    ds_read_b64_tr_b16 a[106:107], v168 offset:14848
    ds_read_b64_tr_b16 a[108:109], v169 offset:14336
    ds_read_b64_tr_b16 a[110:111], v169 offset:14848
    v_mfma_f32_32x32x16_bf16 a[32:47], a[72:75], v[132:135], a[32:47]
    v_cvt_pk_bf16_f32 v136, v208, v209
    v_cvt_pk_bf16_f32 v137, v210, v211
    v_cvt_pk_bf16_f32 v138, v212, v213
    v_cvt_pk_bf16_f32 v139, v214, v215
    buffer_load_dwordx4 v161, s[8:11], s37 offen offset:1024 lds
    v_mfma_f32_32x32x16_bf16 a[48:63], a[76:79], v[132:135], a[48:63]
    v_cvt_pk_bf16_f32 v140, v216, v217
    v_cvt_pk_bf16_f32 v141, v218, v219
    v_cvt_pk_bf16_f32 v142, v220, v221
    v_cvt_pk_bf16_f32 v143, v222, v223
    s_nop 0
    s_waitcnt lgkmcnt(8)
    v_mfma_f32_32x32x16_bf16 a[0:15], a[80:83], v[136:139], a[0:15]
    ds_read_b64_tr_b16 a[64:65], v168 offset:16384
    ds_read_b64_tr_b16 a[66:67], v168 offset:16896
    ds_read_b64_tr_b16 a[68:69], v169 offset:16384
    ds_read_b64_tr_b16 a[70:71], v169 offset:16896
    v_mfma_f32_32x32x16_bf16 a[16:31], a[84:87], v[136:139], a[16:31]
    ds_read_b64_tr_b16 a[72:73], v168 offset:24576
    ds_read_b64_tr_b16 a[74:75], v168 offset:25088
    ds_read_b64_tr_b16 a[76:77], v169 offset:24576
    ds_read_b64_tr_b16 a[78:79], v169 offset:25088
    v_mfma_f32_32x32x16_bf16 v[192:207], v[240:243], v[144:147], v[224:239]
    v_mfma_f32_32x32x16_bf16 a[32:47], a[88:91], v[136:139], a[32:47]
    s_add_u32 m0, s36, 106496
    s_add_u32 s37, s31, 1474688
    buffer_load_dwordx4 v160, s[8:11], s37 offen lds
    v_mfma_f32_32x32x16_bf16 a[48:63], a[92:95], v[136:139], a[48:63]
    v_mfma_f32_32x32x16_bf16 v[192:207], v[244:247], v[148:151], v[192:207]
    s_waitcnt lgkmcnt(8)
    v_mfma_f32_32x32x16_bf16 a[0:15], a[96:99], v[140:143], a[0:15]
    ds_read_b64_tr_b16 a[80:81], v168 offset:18432
    ds_read_b64_tr_b16 a[82:83], v168 offset:18944
    ds_read_b64_tr_b16 a[84:85], v169 offset:18432
    ds_read_b64_tr_b16 a[86:87], v169 offset:18944
    v_mfma_f32_32x32x16_bf16 a[16:31], a[100:103], v[140:143], a[16:31]
    ds_read_b64_tr_b16 a[88:89], v168 offset:26624
    ds_read_b64_tr_b16 a[90:91], v168 offset:27136
    ds_read_b64_tr_b16 a[92:93], v169 offset:26624
    ds_read_b64_tr_b16 a[94:95], v169 offset:27136
    v_mfma_f32_32x32x16_bf16 a[32:47], a[104:107], v[140:143], a[32:47]
    v_cvt_pk_bf16_f32 v144, v192, v193
    v_cvt_pk_bf16_f32 v145, v194, v195
    v_cvt_pk_bf16_f32 v146, v196, v197
    v_cvt_pk_bf16_f32 v147, v198, v199
    buffer_load_dwordx4 v161, s[8:11], s37 offen offset:1024 lds
    v_mfma_f32_32x32x16_bf16 a[48:63], a[108:111], v[140:143], a[48:63]
    v_cvt_pk_bf16_f32 v148, v200, v201
    v_cvt_pk_bf16_f32 v149, v202, v203
    v_cvt_pk_bf16_f32 v150, v204, v205
    v_cvt_pk_bf16_f32 v151, v206, v207
    s_nop 0
    s_waitcnt lgkmcnt(8)
    v_mfma_f32_32x32x16_bf16 a[0:15], a[64:67], v[144:147], a[0:15]
    ds_read_b64_tr_b16 a[96:97], v168 offset:20480
    ds_read_b64_tr_b16 a[98:99], v168 offset:20992
    ds_read_b64_tr_b16 a[100:101], v169 offset:20480
    ds_read_b64_tr_b16 a[102:103], v169 offset:20992
    v_mfma_f32_32x32x16_bf16 a[16:31], a[68:71], v[144:147], a[16:31]
    ds_read_b64_tr_b16 a[104:105], v168 offset:28672
    ds_read_b64_tr_b16 a[106:107], v168 offset:29184
    ds_read_b64_tr_b16 a[108:109], v169 offset:28672
    ds_read_b64_tr_b16 a[110:111], v169 offset:29184
    v_mfma_f32_32x32x16_bf16 v[208:223], v[240:243], v[152:155], v[224:239]
    v_mfma_f32_32x32x16_bf16 a[32:47], a[72:75], v[144:147], a[32:47]
    s_add_u32 m0, s36, 114688
    s_add_u32 s37, s31, 1720320
    buffer_load_dwordx4 v160, s[8:11], s37 offen lds
    v_mfma_f32_32x32x16_bf16 a[48:63], a[76:79], v[144:147], a[48:63]
    v_mfma_f32_32x32x16_bf16 v[208:223], v[244:247], v[156:159], v[208:223]
    s_waitcnt lgkmcnt(8)
    v_mfma_f32_32x32x16_bf16 a[0:15], a[80:83], v[148:151], a[0:15]
    ds_read_b64_tr_b16 a[64:65], v168 offset:22528
    ds_read_b64_tr_b16 a[66:67], v168 offset:23040
    ds_read_b64_tr_b16 a[68:69], v169 offset:22528
    ds_read_b64_tr_b16 a[70:71], v169 offset:23040
    v_mfma_f32_32x32x16_bf16 a[16:31], a[84:87], v[148:151], a[16:31]
    ds_read_b64_tr_b16 a[72:73], v168 offset:30720
    ds_read_b64_tr_b16 a[74:75], v168 offset:31232
    ds_read_b64_tr_b16 a[76:77], v169 offset:30720
    ds_read_b64_tr_b16 a[78:79], v169 offset:31232
    v_mfma_f32_32x32x16_bf16 a[32:47], a[88:91], v[148:151], a[32:47]
    v_cvt_pk_bf16_f32 v152, v208, v209
    v_cvt_pk_bf16_f32 v153, v210, v211
    v_cvt_pk_bf16_f32 v154, v212, v213
    v_cvt_pk_bf16_f32 v155, v214, v215
    buffer_load_dwordx4 v161, s[8:11], s37 offen offset:1024 lds
    v_mfma_f32_32x32x16_bf16 a[48:63], a[92:95], v[148:151], a[48:63]
    v_cvt_pk_bf16_f32 v156, v216, v217
    v_cvt_pk_bf16_f32 v157, v218, v219
    v_cvt_pk_bf16_f32 v158, v220, v221
    v_cvt_pk_bf16_f32 v159, v222, v223
    s_nop 0
    s_waitcnt lgkmcnt(8)
    v_mfma_f32_32x32x16_bf16 a[0:15], a[96:99], v[152:155], a[0:15]
    ds_read_b64_tr_b16 a[80:81], v164 offset:0
    ds_read_b64_tr_b16 a[82:83], v164 offset:512
    ds_read_b64_tr_b16 a[84:85], v165 offset:0
    ds_read_b64_tr_b16 a[86:87], v165 offset:512
    v_mfma_f32_32x32x16_bf16 a[16:31], a[100:103], v[152:155], a[16:31]
    ds_read_b64_tr_b16 a[88:89], v164 offset:8192
    ds_read_b64_tr_b16 a[90:91], v164 offset:8704
    ds_read_b64_tr_b16 a[92:93], v165 offset:8192
    ds_read_b64_tr_b16 a[94:95], v165 offset:8704
    v_mfma_f32_32x32x16_bf16 a[32:47], a[104:107], v[152:155], a[32:47]
    s_add_u32 m0, s36, 122880
    s_add_u32 s37, s31, 1720448
    buffer_load_dwordx4 v160, s[8:11], s37 offen lds
    v_mfma_f32_32x32x16_bf16 a[48:63], a[108:111], v[152:155], a[48:63]
    s_waitcnt lgkmcnt(8)
    v_mfma_f32_32x32x16_bf16 a[0:15], a[64:67], v[156:159], a[0:15]
    ds_read_b64_tr_b16 a[96:97], v164 offset:2048
    ds_read_b64_tr_b16 a[98:99], v164 offset:2560
    ds_read_b64_tr_b16 a[100:101], v165 offset:2048
    ds_read_b64_tr_b16 a[102:103], v165 offset:2560
    v_mfma_f32_32x32x16_bf16 a[16:31], a[68:71], v[156:159], a[16:31]
    ds_read_b64_tr_b16 a[104:105], v164 offset:10240
    ds_read_b64_tr_b16 a[106:107], v164 offset:10752
    ds_read_b64_tr_b16 a[108:109], v165 offset:10240
    ds_read_b64_tr_b16 a[110:111], v165 offset:10752
    v_mfma_f32_32x32x16_bf16 a[32:47], a[72:75], v[156:159], a[32:47]
    buffer_load_dwordx4 v161, s[8:11], s37 offen offset:1024 lds
    v_mfma_f32_32x32x16_bf16 a[48:63], a[76:79], v[156:159], a[48:63]
    s_waitcnt lgkmcnt(8)
    v_mfma_f32_32x32x16_bf16 v[192:207], a[80:83], v[0:3], 0
    s_waitcnt vmcnt(16)
    s_barrier
    ds_read_b64_tr_b16 a[64:65], v164 offset:4096
    ds_read_b64_tr_b16 a[66:67], v164 offset:4608
    ds_read_b64_tr_b16 a[68:69], v165 offset:4096
    ds_read_b64_tr_b16 a[70:71], v165 offset:4608
    v_mfma_f32_32x32x16_bf16 v[208:223], a[84:87], v[0:3], 0
    ds_read_b64_tr_b16 a[72:73], v164 offset:12288
    ds_read_b64_tr_b16 a[74:75], v164 offset:12800
    ds_read_b64_tr_b16 a[76:77], v165 offset:12288
    ds_read_b64_tr_b16 a[78:79], v165 offset:12800
    v_mfma_f32_32x32x16_bf16 v[224:239], a[88:91], v[0:3], 0
    s_add_u32 m0, s36, 131072
    s_add_u32 s37, s31, 1966080
    buffer_load_dwordx4 v160, s[8:11], s37 offen lds
    v_mfma_f32_32x32x16_bf16 v[240:255], a[92:95], v[0:3], 0
    s_waitcnt lgkmcnt(8)
    v_mfma_f32_32x32x16_bf16 v[192:207], a[96:99], v[4:7], v[192:207]
    ds_read_b64_tr_b16 a[80:81], v164 offset:6144
    ds_read_b64_tr_b16 a[82:83], v164 offset:6656
    ds_read_b64_tr_b16 a[84:85], v165 offset:6144
    ds_read_b64_tr_b16 a[86:87], v165 offset:6656
    v_mfma_f32_32x32x16_bf16 v[208:223], a[100:103], v[4:7], v[208:223]
    ds_read_b64_tr_b16 a[88:89], v164 offset:14336
    ds_read_b64_tr_b16 a[90:91], v164 offset:14848
    ds_read_b64_tr_b16 a[92:93], v165 offset:14336
    ds_read_b64_tr_b16 a[94:95], v165 offset:14848
    v_accvgpr_read_b32 v174, a0
    v_mfma_f32_32x32x16_bf16 v[224:239], a[104:107], v[4:7], v[224:239]
    buffer_load_dwordx4 v161, s[8:11], s37 offen offset:1024 lds
    v_accvgpr_read_b32 v175, a1
    v_accvgpr_read_b32 v176, a2
    v_accvgpr_read_b32 v177, a3
    v_mfma_f32_32x32x16_bf16 v[240:255], a[108:111], v[4:7], v[240:255]
    v_accvgpr_read_b32 v178, a4
    v_accvgpr_read_b32 v179, a5
    v_accvgpr_read_b32 v180, a6
    s_waitcnt lgkmcnt(8)
    v_mfma_f32_32x32x16_bf16 v[192:207], a[64:67], v[8:11], v[192:207]
    ds_read_b64_tr_b16 a[96:97], v164 offset:16384
    ds_read_b64_tr_b16 a[98:99], v164 offset:16896
    ds_read_b64_tr_b16 a[100:101], v165 offset:16384
    ds_read_b64_tr_b16 a[102:103], v165 offset:16896
    v_accvgpr_read_b32 v181, a7
    v_mfma_f32_32x32x16_bf16 v[208:223], a[68:71], v[8:11], v[208:223]
    ds_read_b64_tr_b16 a[104:105], v164 offset:24576
    ds_read_b64_tr_b16 a[106:107], v164 offset:25088
    ds_read_b64_tr_b16 a[108:109], v165 offset:24576
    ds_read_b64_tr_b16 a[110:111], v165 offset:25088
    v_mul_f32 v174, v191, v174
    v_mfma_f32_32x32x16_bf16 v[224:239], a[72:75], v[8:11], v[224:239]
    s_add_u32 m0, s36, 139264
    s_add_u32 s37, s31, 1966208
    buffer_load_dwordx4 v160, s[8:11], s37 offen lds
    v_mul_f32 v175, v191, v175
    v_mul_f32 v176, v191, v176
    v_mul_f32 v177, v191, v177
    v_mfma_f32_32x32x16_bf16 v[240:255], a[76:79], v[8:11], v[240:255]
    v_mul_f32 v178, v191, v178
    v_mul_f32 v179, v191, v179
    v_mul_f32 v180, v191, v180
    s_waitcnt lgkmcnt(8)
    v_mfma_f32_32x32x16_bf16 v[192:207], a[80:83], v[12:15], v[192:207]
    ds_read_b64_tr_b16 a[64:65], v164 offset:18432
    ds_read_b64_tr_b16 a[66:67], v164 offset:18944
    ds_read_b64_tr_b16 a[68:69], v165 offset:18432
    ds_read_b64_tr_b16 a[70:71], v165 offset:18944
    v_mul_f32 v181, v191, v181
    v_mfma_f32_32x32x16_bf16 v[208:223], a[84:87], v[12:15], v[208:223]
    ds_read_b64_tr_b16 a[72:73], v164 offset:26624
    ds_read_b64_tr_b16 a[74:75], v164 offset:27136
    ds_read_b64_tr_b16 a[76:77], v165 offset:26624
    ds_read_b64_tr_b16 a[78:79], v165 offset:27136
    v_cvt_pk_bf16_f32 v182, v174, v175
    v_mfma_f32_32x32x16_bf16 v[224:239], a[88:91], v[12:15], v[224:239]
    buffer_load_dwordx4 v161, s[8:11], s37 offen offset:1024 lds
    v_cvt_pk_bf16_f32 v183, v176, v177
    v_cvt_pk_bf16_f32 v184, v178, v179
    v_cvt_pk_bf16_f32 v185, v180, v181
    v_mfma_f32_32x32x16_bf16 v[240:255], a[92:95], v[12:15], v[240:255]
    s_add_u32 s42, s33, 0
    buffer_store_dwordx4 v[182:185], v170, s[20:23], s42 offen sc1
    v_accvgpr_read_b32 v174, a8
    v_accvgpr_read_b32 v175, a9
    s_waitcnt lgkmcnt(8)
    v_mfma_f32_32x32x16_bf16 v[192:207], a[96:99], v[16:19], v[192:207]
    ds_read_b64_tr_b16 a[80:81], v164 offset:20480
    ds_read_b64_tr_b16 a[82:83], v164 offset:20992
    ds_read_b64_tr_b16 a[84:85], v165 offset:20480
    ds_read_b64_tr_b16 a[86:87], v165 offset:20992
    v_accvgpr_read_b32 v176, a10
    v_mfma_f32_32x32x16_bf16 v[208:223], a[100:103], v[16:19], v[208:223]
    ds_read_b64_tr_b16 a[88:89], v164 offset:28672
    ds_read_b64_tr_b16 a[90:91], v164 offset:29184
    ds_read_b64_tr_b16 a[92:93], v165 offset:28672
    ds_read_b64_tr_b16 a[94:95], v165 offset:29184
    v_accvgpr_read_b32 v177, a11
    v_mfma_f32_32x32x16_bf16 v[224:239], a[104:107], v[16:19], v[224:239]
    s_add_u32 m0, s36, 147456
    s_add_u32 s37, s31, 2211840
    buffer_load_dwordx4 v160, s[8:11], s37 offen lds
    v_accvgpr_read_b32 v178, a12
    v_accvgpr_read_b32 v179, a13
    v_accvgpr_read_b32 v180, a14
    v_mfma_f32_32x32x16_bf16 v[240:255], a[108:111], v[16:19], v[240:255]
    v_accvgpr_read_b32 v181, a15
    v_mul_f32 v174, v191, v174
    v_mul_f32 v175, v191, v175
    s_waitcnt lgkmcnt(8)
    v_mfma_f32_32x32x16_bf16 v[192:207], a[64:67], v[20:23], v[192:207]
    ds_read_b64_tr_b16 a[96:97], v164 offset:22528
    ds_read_b64_tr_b16 a[98:99], v164 offset:23040
    ds_read_b64_tr_b16 a[100:101], v165 offset:22528
    ds_read_b64_tr_b16 a[102:103], v165 offset:23040
    v_mul_f32 v176, v191, v176
    v_mfma_f32_32x32x16_bf16 v[208:223], a[68:71], v[20:23], v[208:223]
    ds_read_b64_tr_b16 a[104:105], v164 offset:30720
    ds_read_b64_tr_b16 a[106:107], v164 offset:31232
    ds_read_b64_tr_b16 a[108:109], v165 offset:30720
    ds_read_b64_tr_b16 a[110:111], v165 offset:31232
    v_mul_f32 v177, v191, v177
    v_mfma_f32_32x32x16_bf16 v[224:239], a[72:75], v[20:23], v[224:239]
    buffer_load_dwordx4 v161, s[8:11], s37 offen offset:1024 lds
    v_mul_f32 v178, v191, v178
    v_mul_f32 v179, v191, v179
    v_mul_f32 v180, v191, v180
    v_mfma_f32_32x32x16_bf16 v[240:255], a[76:79], v[20:23], v[240:255]
    v_mul_f32 v181, v191, v181
    v_cvt_pk_bf16_f32 v186, v174, v175
    v_cvt_pk_bf16_f32 v187, v176, v177
    s_waitcnt lgkmcnt(8)
    v_mfma_f32_32x32x16_bf16 v[192:207], a[80:83], v[24:27], v[192:207]
    ds_read_b64_tr_b16 a[64:65], v164 offset:32768
    ds_read_b64_tr_b16 a[66:67], v164 offset:33280
    ds_read_b64_tr_b16 a[68:69], v165 offset:32768
    ds_read_b64_tr_b16 a[70:71], v165 offset:33280
    v_cvt_pk_bf16_f32 v188, v178, v179
    v_mfma_f32_32x32x16_bf16 v[208:223], a[84:87], v[24:27], v[208:223]
    ds_read_b64_tr_b16 a[72:73], v164 offset:40960
    ds_read_b64_tr_b16 a[74:75], v164 offset:41472
    ds_read_b64_tr_b16 a[76:77], v165 offset:40960
    ds_read_b64_tr_b16 a[78:79], v165 offset:41472
    v_cvt_pk_bf16_f32 v189, v180, v181
    v_mfma_f32_32x32x16_bf16 v[224:239], a[88:91], v[24:27], v[224:239]
    s_add_u32 m0, s36, 155648
    s_add_u32 s37, s31, 2211968
    buffer_load_dwordx4 v160, s[8:11], s37 offen lds
    s_add_u32 s42, s33, 1024
    buffer_store_dwordx4 v[186:189], v170, s[20:23], s42 offen sc1
    v_accvgpr_read_b32 v174, a16
    v_accvgpr_read_b32 v175, a17
    v_mfma_f32_32x32x16_bf16 v[240:255], a[92:95], v[24:27], v[240:255]
    v_accvgpr_read_b32 v176, a18
    v_accvgpr_read_b32 v177, a19
    v_accvgpr_read_b32 v178, a20
    s_waitcnt lgkmcnt(8)
    v_mfma_f32_32x32x16_bf16 v[192:207], a[96:99], v[28:31], v[192:207]
    ds_read_b64_tr_b16 a[80:81], v164 offset:34816
    ds_read_b64_tr_b16 a[82:83], v164 offset:35328
    ds_read_b64_tr_b16 a[84:85], v165 offset:34816
    ds_read_b64_tr_b16 a[86:87], v165 offset:35328
    v_accvgpr_read_b32 v179, a21
    v_mfma_f32_32x32x16_bf16 v[208:223], a[100:103], v[28:31], v[208:223]
    ds_read_b64_tr_b16 a[88:89], v164 offset:43008
    ds_read_b64_tr_b16 a[90:91], v164 offset:43520
    ds_read_b64_tr_b16 a[92:93], v165 offset:43008
    ds_read_b64_tr_b16 a[94:95], v165 offset:43520
    v_accvgpr_read_b32 v180, a22
    v_mfma_f32_32x32x16_bf16 v[224:239], a[104:107], v[28:31], v[224:239]
    buffer_load_dwordx4 v161, s[8:11], s37 offen offset:1024 lds
    v_accvgpr_read_b32 v181, a23
    v_mul_f32 v174, v191, v174
    v_mul_f32 v175, v191, v175
    v_mfma_f32_32x32x16_bf16 v[240:255], a[108:111], v[28:31], v[240:255]
    v_mul_f32 v176, v191, v176
    v_mul_f32 v177, v191, v177
    v_mul_f32 v178, v191, v178
    s_waitcnt lgkmcnt(8)
    v_mfma_f32_32x32x16_bf16 v[192:207], a[64:67], v[32:35], v[192:207]
    s_waitcnt vmcnt(18)
    s_barrier
    ds_read_b64_tr_b16 a[96:97], v164 offset:36864
    ds_read_b64_tr_b16 a[98:99], v164 offset:37376
    ds_read_b64_tr_b16 a[100:101], v165 offset:36864
    ds_read_b64_tr_b16 a[102:103], v165 offset:37376
    v_mul_f32 v179, v191, v179
    v_mfma_f32_32x32x16_bf16 v[208:223], a[68:71], v[32:35], v[208:223]
    ds_read_b64_tr_b16 a[104:105], v164 offset:45056
    ds_read_b64_tr_b16 a[106:107], v164 offset:45568
    ds_read_b64_tr_b16 a[108:109], v165 offset:45056
    ds_read_b64_tr_b16 a[110:111], v165 offset:45568
    v_mul_f32 v180, v191, v180
    v_mfma_f32_32x32x16_bf16 v[224:239], a[72:75], v[32:35], v[224:239]
    s_add_u32 m0, s36, 0
    s_add_u32 s37, s32, 0
    buffer_load_dwordx4 v162, s[12:15], s37 offen lds
    v_mul_f32 v181, v191, v181
    v_cvt_pk_bf16_f32 v182, v174, v175
    v_cvt_pk_bf16_f32 v183, v176, v177
    v_mfma_f32_32x32x16_bf16 v[240:255], a[76:79], v[32:35], v[240:255]
    v_cvt_pk_bf16_f32 v184, v178, v179
    v_cvt_pk_bf16_f32 v185, v180, v181
    s_add_u32 s42, s33, 2048
    buffer_store_dwordx4 v[182:185], v170, s[20:23], s42 offen sc1
    s_waitcnt lgkmcnt(8)
    v_mfma_f32_32x32x16_bf16 v[192:207], a[80:83], v[36:39], v[192:207]
    ds_read_b64_tr_b16 a[64:65], v164 offset:38912
    ds_read_b64_tr_b16 a[66:67], v164 offset:39424
    ds_read_b64_tr_b16 a[68:69], v165 offset:38912
    ds_read_b64_tr_b16 a[70:71], v165 offset:39424
    v_accvgpr_read_b32 v174, a24
    v_mfma_f32_32x32x16_bf16 v[208:223], a[84:87], v[36:39], v[208:223]
    ds_read_b64_tr_b16 a[72:73], v164 offset:47104
    ds_read_b64_tr_b16 a[74:75], v164 offset:47616
    ds_read_b64_tr_b16 a[76:77], v165 offset:47104
    ds_read_b64_tr_b16 a[78:79], v165 offset:47616
    v_accvgpr_read_b32 v175, a25
    v_mfma_f32_32x32x16_bf16 v[224:239], a[88:91], v[36:39], v[224:239]
    buffer_load_dwordx4 v163, s[12:15], s37 offen offset:1024 lds
    v_accvgpr_read_b32 v176, a26
    v_accvgpr_read_b32 v177, a27
    v_accvgpr_read_b32 v178, a28
    v_mfma_f32_32x32x16_bf16 v[240:255], a[92:95], v[36:39], v[240:255]
    v_accvgpr_read_b32 v179, a29
    v_accvgpr_read_b32 v180, a30
    v_accvgpr_read_b32 v181, a31
    s_waitcnt lgkmcnt(8)
    v_mfma_f32_32x32x16_bf16 v[192:207], a[96:99], v[40:43], v[192:207]
    ds_read_b64_tr_b16 a[80:81], v164 offset:49152
    ds_read_b64_tr_b16 a[82:83], v164 offset:49664
    ds_read_b64_tr_b16 a[84:85], v165 offset:49152
    ds_read_b64_tr_b16 a[86:87], v165 offset:49664
    v_mul_f32 v174, v191, v174
    v_mfma_f32_32x32x16_bf16 v[208:223], a[100:103], v[40:43], v[208:223]
    ds_read_b64_tr_b16 a[88:89], v164 offset:57344
    ds_read_b64_tr_b16 a[90:91], v164 offset:57856
    ds_read_b64_tr_b16 a[92:93], v165 offset:57344
    ds_read_b64_tr_b16 a[94:95], v165 offset:57856
    v_mul_f32 v175, v191, v175
    v_mfma_f32_32x32x16_bf16 v[224:239], a[104:107], v[40:43], v[224:239]
    s_add_u32 m0, s36, 8192
    s_nop 0
    buffer_load_dwordx4 v162, s[16:19], s37 offen lds
    v_mul_f32 v176, v191, v176
    v_mul_f32 v177, v191, v177
    v_mul_f32 v178, v191, v178
    v_mfma_f32_32x32x16_bf16 v[240:255], a[108:111], v[40:43], v[240:255]
    v_mul_f32 v179, v191, v179
    v_mul_f32 v180, v191, v180
    v_mul_f32 v181, v191, v181
    s_waitcnt lgkmcnt(8)
    v_mfma_f32_32x32x16_bf16 v[192:207], a[64:67], v[44:47], v[192:207]
    ds_read_b64_tr_b16 a[96:97], v164 offset:51200
    ds_read_b64_tr_b16 a[98:99], v164 offset:51712
    ds_read_b64_tr_b16 a[100:101], v165 offset:51200
    ds_read_b64_tr_b16 a[102:103], v165 offset:51712
    v_cvt_pk_bf16_f32 v186, v174, v175
    v_mfma_f32_32x32x16_bf16 v[208:223], a[68:71], v[44:47], v[208:223]
    ds_read_b64_tr_b16 a[104:105], v164 offset:59392
    ds_read_b64_tr_b16 a[106:107], v164 offset:59904
    ds_read_b64_tr_b16 a[108:109], v165 offset:59392
    ds_read_b64_tr_b16 a[110:111], v165 offset:59904
    v_cvt_pk_bf16_f32 v187, v176, v177
    v_mfma_f32_32x32x16_bf16 v[224:239], a[72:75], v[44:47], v[224:239]
    buffer_load_dwordx4 v163, s[16:19], s37 offen offset:1024 lds
    v_cvt_pk_bf16_f32 v188, v178, v179
    v_cvt_pk_bf16_f32 v189, v180, v181
    s_add_u32 s42, s33, 3072
    buffer_store_dwordx4 v[186:189], v170, s[20:23], s42 offen sc1
    v_mfma_f32_32x32x16_bf16 v[240:255], a[76:79], v[44:47], v[240:255]
    v_accvgpr_read_b32 v174, a32
    v_accvgpr_read_b32 v175, a33
    s_waitcnt lgkmcnt(8)
    v_mfma_f32_32x32x16_bf16 v[192:207], a[80:83], v[48:51], v[192:207]
    ds_read_b64_tr_b16 a[64:65], v164 offset:53248
    ds_read_b64_tr_b16 a[66:67], v164 offset:53760
    ds_read_b64_tr_b16 a[68:69], v165 offset:53248
    ds_read_b64_tr_b16 a[70:71], v165 offset:53760
    v_accvgpr_read_b32 v176, a34
    v_mfma_f32_32x32x16_bf16 v[208:223], a[84:87], v[48:51], v[208:223]
    ds_read_b64_tr_b16 a[72:73], v164 offset:61440
    ds_read_b64_tr_b16 a[74:75], v164 offset:61952
    ds_read_b64_tr_b16 a[76:77], v165 offset:61440
    ds_read_b64_tr_b16 a[78:79], v165 offset:61952
    v_accvgpr_read_b32 v177, a35
    v_mfma_f32_32x32x16_bf16 v[224:239], a[88:91], v[48:51], v[224:239]
    s_add_u32 m0, s36, 16384
    s_add_u32 s37, s32, 221184
    buffer_load_dwordx4 v162, s[12:15], s37 offen lds
    v_accvgpr_read_b32 v178, a36
    v_accvgpr_read_b32 v179, a37
    v_accvgpr_read_b32 v180, a38
    v_mfma_f32_32x32x16_bf16 v[240:255], a[92:95], v[48:51], v[240:255]
    v_accvgpr_read_b32 v181, a39
    v_mul_f32 v174, v191, v174
    v_mul_f32 v175, v191, v175
    s_waitcnt lgkmcnt(8)
    v_mfma_f32_32x32x16_bf16 v[192:207], a[96:99], v[52:55], v[192:207]
    ds_read_b64_tr_b16 a[80:81], v164 offset:55296
    ds_read_b64_tr_b16 a[82:83], v164 offset:55808
    ds_read_b64_tr_b16 a[84:85], v165 offset:55296
    ds_read_b64_tr_b16 a[86:87], v165 offset:55808
    v_mul_f32 v176, v191, v176
    v_mfma_f32_32x32x16_bf16 v[208:223], a[100:103], v[52:55], v[208:223]
    ds_read_b64_tr_b16 a[88:89], v164 offset:63488
    ds_read_b64_tr_b16 a[90:91], v164 offset:64000
    ds_read_b64_tr_b16 a[92:93], v165 offset:63488
    ds_read_b64_tr_b16 a[94:95], v165 offset:64000
    v_mul_f32 v177, v191, v177
    v_mfma_f32_32x32x16_bf16 v[224:239], a[104:107], v[52:55], v[224:239]
    buffer_load_dwordx4 v163, s[12:15], s37 offen offset:1024 lds
    v_mul_f32 v178, v191, v178
    v_mul_f32 v179, v191, v179
    v_mul_f32 v180, v191, v180
    v_mfma_f32_32x32x16_bf16 v[240:255], a[108:111], v[52:55], v[240:255]
    v_mul_f32 v181, v191, v181
    v_cvt_pk_bf16_f32 v182, v174, v175
    v_cvt_pk_bf16_f32 v183, v176, v177
    s_waitcnt lgkmcnt(8)
    v_mfma_f32_32x32x16_bf16 v[192:207], a[64:67], v[56:59], v[192:207]
    ds_read_b64_tr_b16 a[96:97], v166 offset:0
    ds_read_b64_tr_b16 a[98:99], v166 offset:512
    ds_read_b64_tr_b16 a[100:101], v167 offset:0
    ds_read_b64_tr_b16 a[102:103], v167 offset:512
    v_cvt_pk_bf16_f32 v184, v178, v179
    v_mfma_f32_32x32x16_bf16 v[208:223], a[68:71], v[56:59], v[208:223]
    ds_read_b64_tr_b16 a[104:105], v166 offset:8192
    ds_read_b64_tr_b16 a[106:107], v166 offset:8704
    ds_read_b64_tr_b16 a[108:109], v167 offset:8192
    ds_read_b64_tr_b16 a[110:111], v167 offset:8704
    v_cvt_pk_bf16_f32 v185, v180, v181
    v_mfma_f32_32x32x16_bf16 v[224:239], a[72:75], v[56:59], v[224:239]
    s_add_u32 m0, s36, 24576
    s_nop 0
    buffer_load_dwordx4 v162, s[16:19], s37 offen lds
    s_add_u32 s42, s33, 4096
    buffer_store_dwordx4 v[182:185], v170, s[20:23], s42 offen sc1
    v_accvgpr_read_b32 v174, a40
    v_accvgpr_read_b32 v175, a41
    v_mfma_f32_32x32x16_bf16 v[240:255], a[76:79], v[56:59], v[240:255]
    v_accvgpr_read_b32 v176, a42
    v_accvgpr_read_b32 v177, a43
    v_accvgpr_read_b32 v178, a44
    s_waitcnt lgkmcnt(8)
    v_mfma_f32_32x32x16_bf16 v[192:207], a[80:83], v[60:63], v[192:207]
    ds_read_b64_tr_b16 a[64:65], v166 offset:2048
    ds_read_b64_tr_b16 a[66:67], v166 offset:2560
    ds_read_b64_tr_b16 a[68:69], v167 offset:2048
    ds_read_b64_tr_b16 a[70:71], v167 offset:2560
    v_accvgpr_read_b32 v179, a45
    v_mfma_f32_32x32x16_bf16 v[208:223], a[84:87], v[60:63], v[208:223]
    ds_read_b64_tr_b16 a[72:73], v166 offset:10240
    ds_read_b64_tr_b16 a[74:75], v166 offset:10752
    ds_read_b64_tr_b16 a[76:77], v167 offset:10240
    ds_read_b64_tr_b16 a[78:79], v167 offset:10752
    v_accvgpr_read_b32 v180, a46
    v_mfma_f32_32x32x16_bf16 v[224:239], a[88:91], v[60:63], v[224:239]
    buffer_load_dwordx4 v163, s[16:19], s37 offen offset:1024 lds
    v_accvgpr_read_b32 v181, a47
    v_mul_f32 v174, v191, v174
    v_mul_f32 v175, v191, v175
    v_mfma_f32_32x32x16_bf16 v[240:255], a[92:95], v[60:63], v[240:255]
    v_mul_f32 v176, v191, v176
    v_mul_f32 v177, v191, v177
    v_mul_f32 v178, v191, v178
    s_waitcnt lgkmcnt(8)
    v_mfma_f32_32x32x16_bf16 v[192:207], a[96:99], v[64:67], v[192:207]
    s_waitcnt vmcnt(21)
    s_barrier
    ds_read_b64_tr_b16 a[80:81], v166 offset:4096
    ds_read_b64_tr_b16 a[82:83], v166 offset:4608
    ds_read_b64_tr_b16 a[84:85], v167 offset:4096
    ds_read_b64_tr_b16 a[86:87], v167 offset:4608
    v_mul_f32 v179, v191, v179
    v_mfma_f32_32x32x16_bf16 v[208:223], a[100:103], v[64:67], v[208:223]
    ds_read_b64_tr_b16 a[88:89], v166 offset:12288
    ds_read_b64_tr_b16 a[90:91], v166 offset:12800
    ds_read_b64_tr_b16 a[92:93], v167 offset:12288
    ds_read_b64_tr_b16 a[94:95], v167 offset:12800
    v_mul_f32 v180, v191, v180
    v_mfma_f32_32x32x16_bf16 v[224:239], a[104:107], v[64:67], v[224:239]
    s_add_u32 m0, s36, 32768
    s_add_u32 s37, s32, 442368
    buffer_load_dwordx4 v162, s[12:15], s37 offen lds
    v_mul_f32 v181, v191, v181
    v_cvt_pk_bf16_f32 v186, v174, v175
    v_cvt_pk_bf16_f32 v187, v176, v177
    v_mfma_f32_32x32x16_bf16 v[240:255], a[108:111], v[64:67], v[240:255]
    v_cvt_pk_bf16_f32 v188, v178, v179
    v_cvt_pk_bf16_f32 v189, v180, v181
    s_add_u32 s42, s33, 5120
    buffer_store_dwordx4 v[186:189], v170, s[20:23], s42 offen sc1
    s_waitcnt lgkmcnt(8)
    v_mfma_f32_32x32x16_bf16 v[192:207], a[64:67], v[68:71], v[192:207]
    ds_read_b64_tr_b16 a[96:97], v166 offset:6144
    ds_read_b64_tr_b16 a[98:99], v166 offset:6656
    ds_read_b64_tr_b16 a[100:101], v167 offset:6144
    ds_read_b64_tr_b16 a[102:103], v167 offset:6656
    v_accvgpr_read_b32 v174, a48
    v_mfma_f32_32x32x16_bf16 v[208:223], a[68:71], v[68:71], v[208:223]
    ds_read_b64_tr_b16 a[104:105], v166 offset:14336
    ds_read_b64_tr_b16 a[106:107], v166 offset:14848
    ds_read_b64_tr_b16 a[108:109], v167 offset:14336
    ds_read_b64_tr_b16 a[110:111], v167 offset:14848
    v_accvgpr_read_b32 v175, a49
    v_mfma_f32_32x32x16_bf16 v[224:239], a[72:75], v[68:71], v[224:239]
    buffer_load_dwordx4 v163, s[12:15], s37 offen offset:1024 lds
    v_accvgpr_read_b32 v176, a50
    v_accvgpr_read_b32 v177, a51
    v_accvgpr_read_b32 v178, a52
    v_mfma_f32_32x32x16_bf16 v[240:255], a[76:79], v[68:71], v[240:255]
    v_accvgpr_read_b32 v179, a53
    v_accvgpr_read_b32 v180, a54
    v_accvgpr_read_b32 v181, a55
    s_waitcnt lgkmcnt(8)
    v_mfma_f32_32x32x16_bf16 v[192:207], a[80:83], v[72:75], v[192:207]
    ds_read_b64_tr_b16 a[64:65], v166 offset:16384
    ds_read_b64_tr_b16 a[66:67], v166 offset:16896
    ds_read_b64_tr_b16 a[68:69], v167 offset:16384
    ds_read_b64_tr_b16 a[70:71], v167 offset:16896
    v_mul_f32 v174, v191, v174
    v_mfma_f32_32x32x16_bf16 v[208:223], a[84:87], v[72:75], v[208:223]
    ds_read_b64_tr_b16 a[72:73], v166 offset:24576
    ds_read_b64_tr_b16 a[74:75], v166 offset:25088
    ds_read_b64_tr_b16 a[76:77], v167 offset:24576
    ds_read_b64_tr_b16 a[78:79], v167 offset:25088
    v_mul_f32 v175, v191, v175
    v_mfma_f32_32x32x16_bf16 v[224:239], a[88:91], v[72:75], v[224:239]
    s_add_u32 m0, s36, 40960
    s_nop 0
    buffer_load_dwordx4 v162, s[16:19], s37 offen lds
    v_mul_f32 v176, v191, v176
    v_mul_f32 v177, v191, v177
    v_mul_f32 v178, v191, v178
    v_mfma_f32_32x32x16_bf16 v[240:255], a[92:95], v[72:75], v[240:255]
    v_mul_f32 v179, v191, v179
    v_mul_f32 v180, v191, v180
    v_mul_f32 v181, v191, v181
    s_waitcnt lgkmcnt(8)
    v_mfma_f32_32x32x16_bf16 v[192:207], a[96:99], v[76:79], v[192:207]
    ds_read_b64_tr_b16 a[80:81], v166 offset:18432
    ds_read_b64_tr_b16 a[82:83], v166 offset:18944
    ds_read_b64_tr_b16 a[84:85], v167 offset:18432
    ds_read_b64_tr_b16 a[86:87], v167 offset:18944
    v_cvt_pk_bf16_f32 v182, v174, v175
    v_mfma_f32_32x32x16_bf16 v[208:223], a[100:103], v[76:79], v[208:223]
    ds_read_b64_tr_b16 a[88:89], v166 offset:26624
    ds_read_b64_tr_b16 a[90:91], v166 offset:27136
    ds_read_b64_tr_b16 a[92:93], v167 offset:26624
    ds_read_b64_tr_b16 a[94:95], v167 offset:27136
    v_cvt_pk_bf16_f32 v183, v176, v177
    v_mfma_f32_32x32x16_bf16 v[224:239], a[104:107], v[76:79], v[224:239]
    buffer_load_dwordx4 v163, s[16:19], s37 offen offset:1024 lds
    v_cvt_pk_bf16_f32 v184, v178, v179
    v_cvt_pk_bf16_f32 v185, v180, v181
    s_add_u32 s42, s33, 6144
    buffer_store_dwordx4 v[182:185], v170, s[20:23], s42 offen sc1
    v_mfma_f32_32x32x16_bf16 v[240:255], a[108:111], v[76:79], v[240:255]
    v_accvgpr_read_b32 v174, a56
    v_accvgpr_read_b32 v175, a57
    v_accvgpr_read_b32 v176, a58
    s_waitcnt lgkmcnt(8)
    v_mfma_f32_32x32x16_bf16 v[192:207], a[64:67], v[80:83], v[192:207]
    ds_read_b64_tr_b16 a[96:97], v166 offset:20480
    ds_read_b64_tr_b16 a[98:99], v166 offset:20992
    ds_read_b64_tr_b16 a[100:101], v167 offset:20480
    ds_read_b64_tr_b16 a[102:103], v167 offset:20992
    v_accvgpr_read_b32 v177, a59
    v_mfma_f32_32x32x16_bf16 v[208:223], a[68:71], v[80:83], v[208:223]
    ds_read_b64_tr_b16 a[104:105], v166 offset:28672
    ds_read_b64_tr_b16 a[106:107], v166 offset:29184
    ds_read_b64_tr_b16 a[108:109], v167 offset:28672
    ds_read_b64_tr_b16 a[110:111], v167 offset:29184
    v_accvgpr_read_b32 v178, a60
    v_mfma_f32_32x32x16_bf16 v[224:239], a[72:75], v[80:83], v[224:239]
    s_add_u32 m0, s36, 49152
    s_add_u32 s37, s32, 663552
    buffer_load_dwordx4 v162, s[12:15], s37 offen lds
    v_accvgpr_read_b32 v179, a61
    v_accvgpr_read_b32 v180, a62
    v_accvgpr_read_b32 v181, a63
    v_mfma_f32_32x32x16_bf16 v[240:255], a[76:79], v[80:83], v[240:255]
    v_mul_f32 v174, v191, v174
    v_mul_f32 v175, v191, v175
    v_mul_f32 v176, v191, v176
    s_waitcnt lgkmcnt(8)
    v_mfma_f32_32x32x16_bf16 v[192:207], a[80:83], v[84:87], v[192:207]
    ds_read_b64_tr_b16 a[64:65], v166 offset:22528
    ds_read_b64_tr_b16 a[66:67], v166 offset:23040
    ds_read_b64_tr_b16 a[68:69], v167 offset:22528
    ds_read_b64_tr_b16 a[70:71], v167 offset:23040
    v_mul_f32 v177, v191, v177
    v_mfma_f32_32x32x16_bf16 v[208:223], a[84:87], v[84:87], v[208:223]
    ds_read_b64_tr_b16 a[72:73], v166 offset:30720
    ds_read_b64_tr_b16 a[74:75], v166 offset:31232
    ds_read_b64_tr_b16 a[76:77], v167 offset:30720
    ds_read_b64_tr_b16 a[78:79], v167 offset:31232
    v_mul_f32 v178, v191, v178
    v_mfma_f32_32x32x16_bf16 v[224:239], a[88:91], v[84:87], v[224:239]
    buffer_load_dwordx4 v163, s[12:15], s37 offen offset:1024 lds
    v_mul_f32 v179, v191, v179
    v_mul_f32 v180, v191, v180
    v_mul_f32 v181, v191, v181
    v_mfma_f32_32x32x16_bf16 v[240:255], a[92:95], v[84:87], v[240:255]
    v_cvt_pk_bf16_f32 v186, v174, v175
    v_cvt_pk_bf16_f32 v187, v176, v177
    v_cvt_pk_bf16_f32 v188, v178, v179
    s_waitcnt lgkmcnt(8)
    v_mfma_f32_32x32x16_bf16 v[192:207], a[96:99], v[88:91], v[192:207]
    ds_read_b64_tr_b16 a[80:81], v166 offset:32768
    ds_read_b64_tr_b16 a[82:83], v166 offset:33280
    ds_read_b64_tr_b16 a[84:85], v167 offset:32768
    ds_read_b64_tr_b16 a[86:87], v167 offset:33280
    v_cvt_pk_bf16_f32 v189, v180, v181
    v_mfma_f32_32x32x16_bf16 v[208:223], a[100:103], v[88:91], v[208:223]
    ds_read_b64_tr_b16 a[88:89], v166 offset:40960
    ds_read_b64_tr_b16 a[90:91], v166 offset:41472
    ds_read_b64_tr_b16 a[92:93], v167 offset:40960
    ds_read_b64_tr_b16 a[94:95], v167 offset:41472
    s_add_u32 s42, s33, 7168
    buffer_store_dwordx4 v[186:189], v170, s[20:23], s42 offen sc1
    v_mfma_f32_32x32x16_bf16 v[224:239], a[104:107], v[88:91], v[224:239]
    s_add_u32 m0, s36, 57344
    s_nop 0
    buffer_load_dwordx4 v162, s[16:19], s37 offen lds
    v_mfma_f32_32x32x16_bf16 v[240:255], a[108:111], v[88:91], v[240:255]
    s_waitcnt lgkmcnt(8)
    v_mfma_f32_32x32x16_bf16 v[192:207], a[64:67], v[92:95], v[192:207]
    ds_read_b64_tr_b16 a[96:97], v166 offset:34816
    ds_read_b64_tr_b16 a[98:99], v166 offset:35328
    ds_read_b64_tr_b16 a[100:101], v167 offset:34816
    ds_read_b64_tr_b16 a[102:103], v167 offset:35328
    v_mfma_f32_32x32x16_bf16 v[208:223], a[68:71], v[92:95], v[208:223]
    ds_read_b64_tr_b16 a[104:105], v166 offset:43008
    ds_read_b64_tr_b16 a[106:107], v166 offset:43520
    ds_read_b64_tr_b16 a[108:109], v167 offset:43008
    ds_read_b64_tr_b16 a[110:111], v167 offset:43520
    v_mfma_f32_32x32x16_bf16 v[224:239], a[72:75], v[92:95], v[224:239]
    buffer_load_dwordx4 v163, s[16:19], s37 offen offset:1024 lds
    v_mfma_f32_32x32x16_bf16 v[240:255], a[76:79], v[92:95], v[240:255]
    s_waitcnt lgkmcnt(8)
    v_mfma_f32_32x32x16_bf16 v[192:207], a[80:83], v[96:99], v[192:207]
    s_waitcnt vmcnt(22)
    s_barrier
    s_waitcnt lgkmcnt(0)
    s_cmp_eq_u32 s98, 0
    s_cselect_b32 s98, s101, s98
    ds_read_b64_tr_b16 a[64:65], v166 offset:36864
    ds_read_b64_tr_b16 a[66:67], v166 offset:37376
    ds_read_b64_tr_b16 a[68:69], v167 offset:36864
    ds_read_b64_tr_b16 a[70:71], v167 offset:37376
    v_mfma_f32_32x32x16_bf16 v[208:223], a[84:87], v[96:99], v[208:223]
    ds_read_b64_tr_b16 a[72:73], v166 offset:45056
    ds_read_b64_tr_b16 a[74:75], v166 offset:45568
    ds_read_b64_tr_b16 a[76:77], v167 offset:45056
    ds_read_b64_tr_b16 a[78:79], v167 offset:45568
    v_mfma_f32_32x32x16_bf16 v[224:239], a[88:91], v[96:99], v[224:239]
    s_add_u32 m0, s36, 65536
    s_add_u32 s37, s32, 884736
    buffer_load_dwordx4 v162, s[12:15], s37 offen lds
    v_mfma_f32_32x32x16_bf16 v[240:255], a[92:95], v[96:99], v[240:255]
    s_waitcnt lgkmcnt(8)
    v_mfma_f32_32x32x16_bf16 v[192:207], a[96:99], v[100:103], v[192:207]
    ds_read_b64_tr_b16 a[80:81], v166 offset:38912
    ds_read_b64_tr_b16 a[82:83], v166 offset:39424
    ds_read_b64_tr_b16 a[84:85], v167 offset:38912
    ds_read_b64_tr_b16 a[86:87], v167 offset:39424
    v_mfma_f32_32x32x16_bf16 v[208:223], a[100:103], v[100:103], v[208:223]
    ds_read_b64_tr_b16 a[88:89], v166 offset:47104
    ds_read_b64_tr_b16 a[90:91], v166 offset:47616
    ds_read_b64_tr_b16 a[92:93], v167 offset:47104
    ds_read_b64_tr_b16 a[94:95], v167 offset:47616
    v_mfma_f32_32x32x16_bf16 v[224:239], a[104:107], v[100:103], v[224:239]
    buffer_load_dwordx4 v163, s[12:15], s37 offen offset:1024 lds
    v_mfma_f32_32x32x16_bf16 v[240:255], a[108:111], v[100:103], v[240:255]
    s_waitcnt lgkmcnt(8)
    v_mfma_f32_32x32x16_bf16 v[192:207], a[64:67], v[104:107], v[192:207]
    ds_read_b64_tr_b16 a[96:97], v166 offset:49152
    ds_read_b64_tr_b16 a[98:99], v166 offset:49664
    ds_read_b64_tr_b16 a[100:101], v167 offset:49152
    ds_read_b64_tr_b16 a[102:103], v167 offset:49664
    v_mfma_f32_32x32x16_bf16 v[208:223], a[68:71], v[104:107], v[208:223]
    ds_read_b64_tr_b16 a[104:105], v166 offset:57344
    ds_read_b64_tr_b16 a[106:107], v166 offset:57856
    ds_read_b64_tr_b16 a[108:109], v167 offset:57344
    ds_read_b64_tr_b16 a[110:111], v167 offset:57856
    v_mfma_f32_32x32x16_bf16 v[224:239], a[72:75], v[104:107], v[224:239]
    s_add_u32 m0, s36, 73728
    s_nop 0
    buffer_load_dwordx4 v162, s[16:19], s37 offen lds
    v_mfma_f32_32x32x16_bf16 v[240:255], a[76:79], v[104:107], v[240:255]
    s_waitcnt lgkmcnt(8)
    v_mfma_f32_32x32x16_bf16 v[192:207], a[80:83], v[108:111], v[192:207]
    ds_read_b64_tr_b16 a[64:65], v166 offset:51200
    ds_read_b64_tr_b16 a[66:67], v166 offset:51712
    ds_read_b64_tr_b16 a[68:69], v167 offset:51200
    ds_read_b64_tr_b16 a[70:71], v167 offset:51712
    v_mfma_f32_32x32x16_bf16 v[208:223], a[84:87], v[108:111], v[208:223]
    ds_read_b64_tr_b16 a[72:73], v166 offset:59392
    ds_read_b64_tr_b16 a[74:75], v166 offset:59904
    ds_read_b64_tr_b16 a[76:77], v167 offset:59392
    ds_read_b64_tr_b16 a[78:79], v167 offset:59904
    v_mfma_f32_32x32x16_bf16 v[224:239], a[88:91], v[108:111], v[224:239]
    buffer_load_dwordx4 v163, s[16:19], s37 offen offset:1024 lds
    v_mfma_f32_32x32x16_bf16 v[240:255], a[92:95], v[108:111], v[240:255]
    s_waitcnt lgkmcnt(8)
    v_mfma_f32_32x32x16_bf16 v[192:207], a[96:99], v[112:115], v[192:207]
    ds_read_b64_tr_b16 a[80:81], v166 offset:53248
    ds_read_b64_tr_b16 a[82:83], v166 offset:53760
    ds_read_b64_tr_b16 a[84:85], v167 offset:53248
    ds_read_b64_tr_b16 a[86:87], v167 offset:53760
    v_mfma_f32_32x32x16_bf16 v[208:223], a[100:103], v[112:115], v[208:223]
    ds_read_b64_tr_b16 a[88:89], v166 offset:61440
    ds_read_b64_tr_b16 a[90:91], v166 offset:61952
    ds_read_b64_tr_b16 a[92:93], v167 offset:61440
    ds_read_b64_tr_b16 a[94:95], v167 offset:61952
    v_mfma_f32_32x32x16_bf16 v[224:239], a[104:107], v[112:115], v[224:239]
    s_add_u32 m0, s36, 81920
    s_add_u32 s37, s32, 1105920
    buffer_load_dwordx4 v162, s[12:15], s37 offen lds
    v_mfma_f32_32x32x16_bf16 v[240:255], a[108:111], v[112:115], v[240:255]
    s_waitcnt lgkmcnt(8)
    v_mfma_f32_32x32x16_bf16 v[192:207], a[64:67], v[116:119], v[192:207]
    ds_read_b64_tr_b16 a[96:97], v166 offset:55296
    ds_read_b64_tr_b16 a[98:99], v166 offset:55808
    ds_read_b64_tr_b16 a[100:101], v167 offset:55296
    ds_read_b64_tr_b16 a[102:103], v167 offset:55808
    v_mfma_f32_32x32x16_bf16 v[208:223], a[68:71], v[116:119], v[208:223]
    ds_read_b64_tr_b16 a[104:105], v166 offset:63488
    ds_read_b64_tr_b16 a[106:107], v166 offset:64000
    ds_read_b64_tr_b16 a[108:109], v167 offset:63488
    ds_read_b64_tr_b16 a[110:111], v167 offset:64000
    v_mfma_f32_32x32x16_bf16 v[224:239], a[72:75], v[116:119], v[224:239]
    buffer_load_dwordx4 v163, s[12:15], s37 offen offset:1024 lds
    v_mfma_f32_32x32x16_bf16 v[240:255], a[76:79], v[116:119], v[240:255]
    s_waitcnt lgkmcnt(8)
    v_mfma_f32_32x32x16_bf16 v[192:207], a[80:83], v[120:123], v[192:207]
    ds_read_b64_tr_b16 a[64:65], v168 offset:0
    ds_read_b64_tr_b16 a[66:67], v168 offset:512
    ds_read_b64_tr_b16 a[68:69], v169 offset:0
    ds_read_b64_tr_b16 a[70:71], v169 offset:512
    v_mfma_f32_32x32x16_bf16 v[208:223], a[84:87], v[120:123], v[208:223]
    ds_read_b64_tr_b16 a[72:73], v168 offset:8192
    ds_read_b64_tr_b16 a[74:75], v168 offset:8704
    ds_read_b64_tr_b16 a[76:77], v169 offset:8192
    ds_read_b64_tr_b16 a[78:79], v169 offset:8704
    v_mfma_f32_32x32x16_bf16 v[224:239], a[88:91], v[120:123], v[224:239]
    s_add_u32 m0, s36, 90112
    s_nop 0
    buffer_load_dwordx4 v162, s[16:19], s37 offen lds
    v_mfma_f32_32x32x16_bf16 v[240:255], a[92:95], v[120:123], v[240:255]
    s_waitcnt lgkmcnt(8)
    v_mfma_f32_32x32x16_bf16 v[192:207], a[96:99], v[124:127], v[192:207]
    ds_read_b64_tr_b16 a[80:81], v168 offset:2048
    ds_read_b64_tr_b16 a[82:83], v168 offset:2560
    ds_read_b64_tr_b16 a[84:85], v169 offset:2048
    ds_read_b64_tr_b16 a[86:87], v169 offset:2560
    v_mfma_f32_32x32x16_bf16 v[208:223], a[100:103], v[124:127], v[208:223]
    ds_read_b64_tr_b16 a[88:89], v168 offset:10240
    ds_read_b64_tr_b16 a[90:91], v168 offset:10752
    ds_read_b64_tr_b16 a[92:93], v169 offset:10240
    ds_read_b64_tr_b16 a[94:95], v169 offset:10752
    v_mfma_f32_32x32x16_bf16 v[224:239], a[104:107], v[124:127], v[224:239]
    buffer_load_dwordx4 v163, s[16:19], s37 offen offset:1024 lds
    v_mfma_f32_32x32x16_bf16 v[240:255], a[108:111], v[124:127], v[240:255]
    s_waitcnt lgkmcnt(8)
    v_mfma_f32_32x32x16_bf16 v[192:207], a[64:67], v[128:131], v[192:207]
    s_waitcnt vmcnt(19)
    s_barrier
    ds_read_b64_tr_b16 a[96:97], v168 offset:4096
    ds_read_b64_tr_b16 a[98:99], v168 offset:4608
    ds_read_b64_tr_b16 a[100:101], v169 offset:4096
    ds_read_b64_tr_b16 a[102:103], v169 offset:4608
    v_mfma_f32_32x32x16_bf16 v[208:223], a[68:71], v[128:131], v[208:223]
    ds_read_b64_tr_b16 a[104:105], v168 offset:12288
    ds_read_b64_tr_b16 a[106:107], v168 offset:12800
    ds_read_b64_tr_b16 a[108:109], v169 offset:12288
    ds_read_b64_tr_b16 a[110:111], v169 offset:12800
    v_mfma_f32_32x32x16_bf16 v[224:239], a[72:75], v[128:131], v[224:239]
    s_add_u32 m0, s36, 98304
    s_add_u32 s37, s32, 1327104
    buffer_load_dwordx4 v162, s[12:15], s37 offen lds
    v_mfma_f32_32x32x16_bf16 v[240:255], a[76:79], v[128:131], v[240:255]
    s_waitcnt lgkmcnt(8)
    v_mfma_f32_32x32x16_bf16 v[192:207], a[80:83], v[132:135], v[192:207]
    ds_read_b64_tr_b16 a[64:65], v168 offset:6144
    ds_read_b64_tr_b16 a[66:67], v168 offset:6656
    ds_read_b64_tr_b16 a[68:69], v169 offset:6144
    ds_read_b64_tr_b16 a[70:71], v169 offset:6656
    v_mfma_f32_32x32x16_bf16 v[208:223], a[84:87], v[132:135], v[208:223]
    ds_read_b64_tr_b16 a[72:73], v168 offset:14336
    ds_read_b64_tr_b16 a[74:75], v168 offset:14848
    ds_read_b64_tr_b16 a[76:77], v169 offset:14336
    ds_read_b64_tr_b16 a[78:79], v169 offset:14848
    v_mfma_f32_32x32x16_bf16 v[224:239], a[88:91], v[132:135], v[224:239]
    buffer_load_dwordx4 v163, s[12:15], s37 offen offset:1024 lds
    v_mfma_f32_32x32x16_bf16 v[240:255], a[92:95], v[132:135], v[240:255]
    s_waitcnt lgkmcnt(8)
    v_mfma_f32_32x32x16_bf16 v[192:207], a[96:99], v[136:139], v[192:207]
    ds_read_b64_tr_b16 a[80:81], v168 offset:16384
    ds_read_b64_tr_b16 a[82:83], v168 offset:16896
    ds_read_b64_tr_b16 a[84:85], v169 offset:16384
    ds_read_b64_tr_b16 a[86:87], v169 offset:16896
    v_mfma_f32_32x32x16_bf16 v[208:223], a[100:103], v[136:139], v[208:223]
    ds_read_b64_tr_b16 a[88:89], v168 offset:24576
    ds_read_b64_tr_b16 a[90:91], v168 offset:25088
    ds_read_b64_tr_b16 a[92:93], v169 offset:24576
    ds_read_b64_tr_b16 a[94:95], v169 offset:25088
    v_mfma_f32_32x32x16_bf16 v[224:239], a[104:107], v[136:139], v[224:239]
    s_add_u32 m0, s36, 106496
    s_nop 0
    buffer_load_dwordx4 v162, s[16:19], s37 offen lds
    v_mfma_f32_32x32x16_bf16 v[240:255], a[108:111], v[136:139], v[240:255]
    s_waitcnt lgkmcnt(8)
    v_mfma_f32_32x32x16_bf16 v[192:207], a[64:67], v[140:143], v[192:207]
    ds_read_b64_tr_b16 a[96:97], v168 offset:18432
    ds_read_b64_tr_b16 a[98:99], v168 offset:18944
    ds_read_b64_tr_b16 a[100:101], v169 offset:18432
    ds_read_b64_tr_b16 a[102:103], v169 offset:18944
    v_mfma_f32_32x32x16_bf16 v[208:223], a[68:71], v[140:143], v[208:223]
    ds_read_b64_tr_b16 a[104:105], v168 offset:26624
    ds_read_b64_tr_b16 a[106:107], v168 offset:27136
    ds_read_b64_tr_b16 a[108:109], v169 offset:26624
    ds_read_b64_tr_b16 a[110:111], v169 offset:27136
    v_mfma_f32_32x32x16_bf16 v[224:239], a[72:75], v[140:143], v[224:239]
    buffer_load_dwordx4 v163, s[16:19], s37 offen offset:1024 lds
    v_mfma_f32_32x32x16_bf16 v[240:255], a[76:79], v[140:143], v[240:255]
    s_waitcnt lgkmcnt(8)
    v_mfma_f32_32x32x16_bf16 v[192:207], a[80:83], v[144:147], v[192:207]
    ds_read_b64_tr_b16 a[64:65], v168 offset:20480
    ds_read_b64_tr_b16 a[66:67], v168 offset:20992
    ds_read_b64_tr_b16 a[68:69], v169 offset:20480
    ds_read_b64_tr_b16 a[70:71], v169 offset:20992
    v_mfma_f32_32x32x16_bf16 v[208:223], a[84:87], v[144:147], v[208:223]
    ds_read_b64_tr_b16 a[72:73], v168 offset:28672
    ds_read_b64_tr_b16 a[74:75], v168 offset:29184
    ds_read_b64_tr_b16 a[76:77], v169 offset:28672
    ds_read_b64_tr_b16 a[78:79], v169 offset:29184
    v_mfma_f32_32x32x16_bf16 v[224:239], a[88:91], v[144:147], v[224:239]
    s_add_u32 m0, s36, 114688
    s_add_u32 s37, s32, 1548288
    buffer_load_dwordx4 v162, s[12:15], s37 offen lds
    v_mfma_f32_32x32x16_bf16 v[240:255], a[92:95], v[144:147], v[240:255]
    s_waitcnt lgkmcnt(8)
    v_mfma_f32_32x32x16_bf16 v[192:207], a[96:99], v[148:151], v[192:207]
    ds_read_b64_tr_b16 a[80:81], v168 offset:22528
    ds_read_b64_tr_b16 a[82:83], v168 offset:23040
    ds_read_b64_tr_b16 a[84:85], v169 offset:22528
    ds_read_b64_tr_b16 a[86:87], v169 offset:23040
    v_mfma_f32_32x32x16_bf16 v[208:223], a[100:103], v[148:151], v[208:223]
    ds_read_b64_tr_b16 a[88:89], v168 offset:30720
    ds_read_b64_tr_b16 a[90:91], v168 offset:31232
    ds_read_b64_tr_b16 a[92:93], v169 offset:30720
    ds_read_b64_tr_b16 a[94:95], v169 offset:31232
    v_mfma_f32_32x32x16_bf16 v[224:239], a[104:107], v[148:151], v[224:239]
    buffer_load_dwordx4 v163, s[12:15], s37 offen offset:1024 lds
    v_mfma_f32_32x32x16_bf16 v[240:255], a[108:111], v[148:151], v[240:255]
    s_waitcnt lgkmcnt(8)
    v_mfma_f32_32x32x16_bf16 v[192:207], a[64:67], v[152:155], v[192:207]
    ds_read_b64_tr_b16 a[96:97], v164 offset:0
    ds_read_b64_tr_b16 a[98:99], v164 offset:512
    ds_read_b64_tr_b16 a[100:101], v165 offset:0
    ds_read_b64_tr_b16 a[102:103], v165 offset:512
    v_mfma_f32_32x32x16_bf16 v[208:223], a[68:71], v[152:155], v[208:223]
    ds_read_b64_tr_b16 a[104:105], v164 offset:8192
    ds_read_b64_tr_b16 a[106:107], v164 offset:8704
    ds_read_b64_tr_b16 a[108:109], v165 offset:8192
    ds_read_b64_tr_b16 a[110:111], v165 offset:8704
    v_mfma_f32_32x32x16_bf16 v[224:239], a[72:75], v[152:155], v[224:239]
    s_add_u32 m0, s36, 122880
    s_nop 0
    buffer_load_dwordx4 v162, s[16:19], s37 offen lds
    v_mfma_f32_32x32x16_bf16 v[240:255], a[76:79], v[152:155], v[240:255]
    s_waitcnt lgkmcnt(8)
    v_mfma_f32_32x32x16_bf16 v[192:207], a[80:83], v[156:159], v[192:207]
    ds_read_b64_tr_b16 a[64:65], v164 offset:2048
    ds_read_b64_tr_b16 a[66:67], v164 offset:2560
    ds_read_b64_tr_b16 a[68:69], v165 offset:2048
    ds_read_b64_tr_b16 a[70:71], v165 offset:2560
    v_mfma_f32_32x32x16_bf16 v[208:223], a[84:87], v[156:159], v[208:223]
    ds_read_b64_tr_b16 a[72:73], v164 offset:10240
    ds_read_b64_tr_b16 a[74:75], v164 offset:10752
    ds_read_b64_tr_b16 a[76:77], v165 offset:10240
    ds_read_b64_tr_b16 a[78:79], v165 offset:10752
    v_mfma_f32_32x32x16_bf16 v[224:239], a[88:91], v[156:159], v[224:239]
    buffer_load_dwordx4 v163, s[16:19], s37 offen offset:1024 lds
    v_mfma_f32_32x32x16_bf16 v[240:255], a[92:95], v[156:159], v[240:255]
    s_waitcnt lgkmcnt(8)
    v_mfma_f32_32x32x16_bf16 a[0:15], a[96:99], v[0:3], 0
    s_waitcnt vmcnt(16)
    s_barrier
    s_cmp_lg_u32 s25, 0
    s_cbranch_scc1 FL7
    s_add_u32 s83, s98, 1
    v_mov_b32 v174, s83
    v_mov_b32 v175, 0
    s_mov_b64 exec, 1
    buffer_store_dword v174, v175, s[20:23], s89 offen offset:0 sc1
    s_mov_b64 exec, -1
FL7:
    ds_read_b64_tr_b16 a[80:81], v164 offset:4096
    ds_read_b64_tr_b16 a[82:83], v164 offset:4608
    ds_read_b64_tr_b16 a[84:85], v165 offset:4096
    ds_read_b64_tr_b16 a[86:87], v165 offset:4608
    v_mfma_f32_32x32x16_bf16 a[16:31], a[100:103], v[0:3], 0
    ds_read_b64_tr_b16 a[88:89], v164 offset:12288
    ds_read_b64_tr_b16 a[90:91], v164 offset:12800
    ds_read_b64_tr_b16 a[92:93], v165 offset:12288
    ds_read_b64_tr_b16 a[94:95], v165 offset:12800
    v_mfma_f32_32x32x16_bf16 a[32:47], a[104:107], v[0:3], 0
    s_add_u32 m0, s36, 131072
    s_add_u32 s37, s32, 1769472
    buffer_load_dwordx4 v162, s[12:15], s37 offen lds
    v_mfma_f32_32x32x16_bf16 a[48:63], a[108:111], v[0:3], 0
    s_waitcnt lgkmcnt(8)
    v_mfma_f32_32x32x16_bf16 a[0:15], a[64:67], v[4:7], a[0:15]
    ds_read_b64_tr_b16 a[96:97], v164 offset:6144
    ds_read_b64_tr_b16 a[98:99], v164 offset:6656
    ds_read_b64_tr_b16 a[100:101], v165 offset:6144
    ds_read_b64_tr_b16 a[102:103], v165 offset:6656
    v_mul_f32 v192, v171, v192
    v_mfma_f32_32x32x16_bf16 a[16:31], a[68:71], v[4:7], a[16:31]
    ds_read_b64_tr_b16 a[104:105], v164 offset:14336
    ds_read_b64_tr_b16 a[106:107], v164 offset:14848
    ds_read_b64_tr_b16 a[108:109], v165 offset:14336
    ds_read_b64_tr_b16 a[110:111], v165 offset:14848
    v_mul_f32 v193, v171, v193
    v_mfma_f32_32x32x16_bf16 a[32:47], a[72:75], v[4:7], a[32:47]
    buffer_load_dwordx4 v163, s[12:15], s37 offen offset:1024 lds
    v_mul_f32 v194, v171, v194
    v_mul_f32 v195, v171, v195
    v_mul_f32 v196, v171, v196
    v_mul_f32 v197, v171, v197
    v_mfma_f32_32x32x16_bf16 a[48:63], a[76:79], v[4:7], a[48:63]
    v_mul_f32 v198, v171, v198
    v_mul_f32 v199, v171, v199
    v_cvt_pk_bf16_f32 v182, v192, v193
    s_waitcnt lgkmcnt(8)
    v_mfma_f32_32x32x16_bf16 a[0:15], a[80:83], v[8:11], a[0:15]
    ds_read_b64_tr_b16 a[64:65], v164 offset:16384
    ds_read_b64_tr_b16 a[66:67], v164 offset:16896
    ds_read_b64_tr_b16 a[68:69], v165 offset:16384
    ds_read_b64_tr_b16 a[70:71], v165 offset:16896
    v_cvt_pk_bf16_f32 v183, v194, v195
    v_cvt_pk_bf16_f32 v184, v196, v197
    v_mfma_f32_32x32x16_bf16 a[16:31], a[84:87], v[8:11], a[16:31]
    ds_read_b64_tr_b16 a[72:73], v164 offset:24576
    ds_read_b64_tr_b16 a[74:75], v164 offset:25088
    ds_read_b64_tr_b16 a[76:77], v165 offset:24576
    ds_read_b64_tr_b16 a[78:79], v165 offset:25088
    v_cvt_pk_bf16_f32 v185, v198, v199
    v_mfma_f32_32x32x16_bf16 a[32:47], a[88:91], v[8:11], a[32:47]
    s_add_u32 m0, s36, 139264
    s_nop 0
    buffer_load_dwordx4 v162, s[16:19], s37 offen lds
    s_add_u32 s42, s34, 0
    buffer_store_dwordx4 v[182:185], v170, s[20:23], s42 offen sc1
    v_mul_f32 v200, v171, v200
    v_mul_f32 v201, v171, v201
    v_mfma_f32_32x32x16_bf16 a[48:63], a[92:95], v[8:11], a[48:63]
    v_mul_f32 v202, v171, v202
    v_mul_f32 v203, v171, v203
    v_mul_f32 v204, v171, v204
    v_mul_f32 v205, v171, v205
    s_waitcnt lgkmcnt(8)
    v_mfma_f32_32x32x16_bf16 a[0:15], a[96:99], v[12:15], a[0:15]
    ds_read_b64_tr_b16 a[80:81], v164 offset:18432
    ds_read_b64_tr_b16 a[82:83], v164 offset:18944
    ds_read_b64_tr_b16 a[84:85], v165 offset:18432
    ds_read_b64_tr_b16 a[86:87], v165 offset:18944
    v_mul_f32 v206, v171, v206
    v_mfma_f32_32x32x16_bf16 a[16:31], a[100:103], v[12:15], a[16:31]
    ds_read_b64_tr_b16 a[88:89], v164 offset:26624
    ds_read_b64_tr_b16 a[90:91], v164 offset:27136
    ds_read_b64_tr_b16 a[92:93], v165 offset:26624
    ds_read_b64_tr_b16 a[94:95], v165 offset:27136
    v_mul_f32 v207, v171, v207
    v_cvt_pk_bf16_f32 v186, v200, v201
    v_mfma_f32_32x32x16_bf16 a[32:47], a[104:107], v[12:15], a[32:47]
    buffer_load_dwordx4 v163, s[16:19], s37 offen offset:1024 lds
    v_cvt_pk_bf16_f32 v187, v202, v203
    v_cvt_pk_bf16_f32 v188, v204, v205
    v_cvt_pk_bf16_f32 v189, v206, v207
    v_mfma_f32_32x32x16_bf16 a[48:63], a[108:111], v[12:15], a[48:63]
    s_add_u32 s42, s34, 1024
    buffer_store_dwordx4 v[186:189], v170, s[20:23], s42 offen sc1
    v_mul_f32 v208, v171, v208
    v_mul_f32 v209, v171, v209
    v_mul_f32 v210, v171, v210
    s_waitcnt lgkmcnt(8)
    v_mfma_f32_32x32x16_bf16 a[0:15], a[64:67], v[16:19], a[0:15]
    ds_read_b64_tr_b16 a[96:97], v164 offset:20480
    ds_read_b64_tr_b16 a[98:99], v164 offset:20992
    ds_read_b64_tr_b16 a[100:101], v165 offset:20480
    ds_read_b64_tr_b16 a[102:103], v165 offset:20992
    v_mul_f32 v211, v171, v211
    v_mfma_f32_32x32x16_bf16 a[16:31], a[68:71], v[16:19], a[16:31]
    s_lshl_b32 s60, s24, 12
    s_add_u32 s60, s60, s81
    s_add_u32 s60, s60, 0x40000
    v_and_b32 v190, 0x1ff, v170
    v_lshrrev_b32 v190, 2, v190
    v_add_u32 v190, s60, v190
    buffer_load_dword v0, v190, s[20:23], 0 offen sc1
    ds_read_b64_tr_b16 a[104:105], v164 offset:28672
    ds_read_b64_tr_b16 a[106:107], v164 offset:29184
    ds_read_b64_tr_b16 a[108:109], v165 offset:28672
    ds_read_b64_tr_b16 a[110:111], v165 offset:29184
    v_mul_f32 v212, v171, v212
    v_mfma_f32_32x32x16_bf16 a[32:47], a[72:75], v[16:19], a[32:47]
    s_add_u32 m0, s36, 147456
    s_add_u32 s37, s32, 1990656
    buffer_load_dwordx4 v162, s[12:15], s37 offen lds
    v_mul_f32 v213, v171, v213
    v_mul_f32 v214, v171, v214
    v_mul_f32 v215, v171, v215
    v_cvt_pk_bf16_f32 v182, v208, v209
    v_mfma_f32_32x32x16_bf16 a[48:63], a[76:79], v[16:19], a[48:63]
    v_cvt_pk_bf16_f32 v183, v210, v211
    v_cvt_pk_bf16_f32 v184, v212, v213
    v_cvt_pk_bf16_f32 v185, v214, v215
    s_add_u32 s42, s34, 2048
    buffer_store_dwordx4 v[182:185], v170, s[20:23], s42 offen sc1
    s_waitcnt lgkmcnt(8)
    v_mfma_f32_32x32x16_bf16 a[0:15], a[80:83], v[20:23], a[0:15]
    ds_read_b64_tr_b16 a[64:65], v164 offset:22528
    ds_read_b64_tr_b16 a[66:67], v164 offset:23040
    ds_read_b64_tr_b16 a[68:69], v165 offset:22528
    ds_read_b64_tr_b16 a[70:71], v165 offset:23040
    v_mul_f32 v216, v171, v216
    v_mfma_f32_32x32x16_bf16 a[16:31], a[84:87], v[20:23], a[16:31]
    ds_read_b64_tr_b16 a[72:73], v164 offset:30720
    ds_read_b64_tr_b16 a[74:75], v164 offset:31232
    ds_read_b64_tr_b16 a[76:77], v165 offset:30720
    ds_read_b64_tr_b16 a[78:79], v165 offset:31232
    v_mul_f32 v217, v171, v217
    v_mfma_f32_32x32x16_bf16 a[32:47], a[88:91], v[20:23], a[32:47]
    buffer_load_dwordx4 v163, s[12:15], s37 offen offset:1024 lds
    v_mul_f32 v218, v171, v218
    v_mul_f32 v219, v171, v219
    v_mul_f32 v220, v171, v220
    v_mul_f32 v221, v171, v221
    v_mfma_f32_32x32x16_bf16 a[48:63], a[92:95], v[20:23], a[48:63]
    v_mul_f32 v222, v171, v222
    v_mul_f32 v223, v171, v223
    v_cvt_pk_bf16_f32 v186, v216, v217
    s_waitcnt lgkmcnt(8)
    v_mfma_f32_32x32x16_bf16 a[0:15], a[96:99], v[24:27], a[0:15]
    ds_read_b64_tr_b16 a[80:81], v164 offset:32768
    ds_read_b64_tr_b16 a[82:83], v164 offset:33280
    ds_read_b64_tr_b16 a[84:85], v165 offset:32768
    ds_read_b64_tr_b16 a[86:87], v165 offset:33280
    v_cvt_pk_bf16_f32 v187, v218, v219
    v_cvt_pk_bf16_f32 v188, v220, v221
    v_mfma_f32_32x32x16_bf16 a[16:31], a[100:103], v[24:27], a[16:31]
    ds_read_b64_tr_b16 a[88:89], v164 offset:40960
    ds_read_b64_tr_b16 a[90:91], v164 offset:41472
    ds_read_b64_tr_b16 a[92:93], v165 offset:40960
    ds_read_b64_tr_b16 a[94:95], v165 offset:41472
    v_cvt_pk_bf16_f32 v189, v222, v223
    v_mfma_f32_32x32x16_bf16 a[32:47], a[104:107], v[24:27], a[32:47]
    s_add_u32 m0, s36, 155648
    s_nop 0
    buffer_load_dwordx4 v162, s[16:19], s37 offen lds
    s_add_u32 s42, s34, 3072
    buffer_store_dwordx4 v[186:189], v170, s[20:23], s42 offen sc1
    v_mul_f32 v224, v171, v224
    v_mul_f32 v225, v171, v225
    v_mul_f32 v226, v171, v226
    v_mfma_f32_32x32x16_bf16 a[48:63], a[108:111], v[24:27], a[48:63]
    v_mul_f32 v227, v171, v227
    v_mul_f32 v228, v171, v228
    v_mul_f32 v229, v171, v229
    s_waitcnt lgkmcnt(8)
    v_mfma_f32_32x32x16_bf16 a[0:15], a[64:67], v[28:31], a[0:15]
    ds_read_b64_tr_b16 a[96:97], v164 offset:34816
    ds_read_b64_tr_b16 a[98:99], v164 offset:35328
    ds_read_b64_tr_b16 a[100:101], v165 offset:34816
    ds_read_b64_tr_b16 a[102:103], v165 offset:35328
    v_mul_f32 v230, v171, v230
    v_mfma_f32_32x32x16_bf16 a[16:31], a[68:71], v[28:31], a[16:31]
    ds_read_b64_tr_b16 a[104:105], v164 offset:43008
    ds_read_b64_tr_b16 a[106:107], v164 offset:43520
    ds_read_b64_tr_b16 a[108:109], v165 offset:43008
    ds_read_b64_tr_b16 a[110:111], v165 offset:43520
    v_mul_f32 v231, v171, v231
    v_cvt_pk_bf16_f32 v182, v224, v225
    v_mfma_f32_32x32x16_bf16 a[32:47], a[72:75], v[28:31], a[32:47]
    buffer_load_dwordx4 v163, s[16:19], s37 offen offset:1024 lds
    v_cvt_pk_bf16_f32 v183, v226, v227
    v_cvt_pk_bf16_f32 v184, v228, v229
    v_cvt_pk_bf16_f32 v185, v230, v231
    v_mfma_f32_32x32x16_bf16 a[48:63], a[76:79], v[28:31], a[48:63]
    s_add_u32 s42, s34, 4096
    buffer_store_dwordx4 v[182:185], v170, s[20:23], s42 offen sc1
    v_mul_f32 v232, v171, v232
    v_mul_f32 v233, v171, v233
    v_mul_f32 v234, v171, v234
    s_waitcnt lgkmcnt(8)
    v_mfma_f32_32x32x16_bf16 a[0:15], a[80:83], v[32:35], a[0:15]
    s_waitcnt vmcnt(22)
    v_mov_b32 v1, 2
    s_cmp_lg_u32 s25, 0
    s_cbranch_scc1 PD8
    s_waitcnt vmcnt(7)
    s_mov_b32 s88, 0
    s_add_u32 s83, s98, 1
PL8:
    v_subrev_u32 v0, s83, v0
    v_cmp_lt_u32 vcc, v1, v0
    s_cbranch_vccz PD8
    s_add_u32 s88, s88, 1
    s_cmp_gt_u32 s88, 0x40000
    s_cbranch_scc1 PD8
    s_sleep 4
    buffer_load_dword v0, v190, s[20:23], 0 offen sc1
    s_waitcnt vmcnt(0)
    s_branch PL8
PD8:
    s_barrier
    s_lshr_b32 s56, s26, 2
    s_mul_i32 s57, s56, 378880
    s_mul_i32 s67, s25, 5120
    s_add_u32 s57, s57, s67
    s_add_u32 s57, s57, 18874368
    ds_read_b64_tr_b16 a[64:65], v164 offset:36864
    ds_read_b64_tr_b16 a[66:67], v164 offset:37376
    ds_read_b64_tr_b16 a[68:69], v165 offset:36864
    ds_read_b64_tr_b16 a[70:71], v165 offset:37376
    v_mul_f32 v235, v171, v235
    v_mfma_f32_32x32x16_bf16 a[16:31], a[84:87], v[32:35], a[16:31]
    ds_read_b64_tr_b16 a[72:73], v164 offset:45056
    ds_read_b64_tr_b16 a[74:75], v164 offset:45568
    ds_read_b64_tr_b16 a[76:77], v165 offset:45056
    ds_read_b64_tr_b16 a[78:79], v165 offset:45568
    v_mul_f32 v236, v171, v236
    v_mfma_f32_32x32x16_bf16 a[32:47], a[88:91], v[32:35], a[32:47]
    s_add_u32 s67, s57, 0
    buffer_load_dwordx4 a[112:115], v170, s[20:23], s67 offen offset:0 sc1
    v_mul_f32 v237, v171, v237
    v_mul_f32 v238, v171, v238
    v_mul_f32 v239, v171, v239
    v_cvt_pk_bf16_f32 v186, v232, v233
    v_mfma_f32_32x32x16_bf16 a[48:63], a[92:95], v[32:35], a[48:63]
    buffer_load_dwordx4 a[116:119], v170, s[20:23], s67 offen offset:1024 sc1
    v_cvt_pk_bf16_f32 v187, v234, v235
    v_cvt_pk_bf16_f32 v188, v236, v237
    v_cvt_pk_bf16_f32 v189, v238, v239
    s_add_u32 s42, s34, 5120
    buffer_store_dwordx4 v[186:189], v170, s[20:23], s42 offen sc1
    s_waitcnt lgkmcnt(8)
    v_mfma_f32_32x32x16_bf16 a[0:15], a[96:99], v[36:39], a[0:15]
    ds_read_b64_tr_b16 a[80:81], v164 offset:38912
    ds_read_b64_tr_b16 a[82:83], v164 offset:39424
    ds_read_b64_tr_b16 a[84:85], v165 offset:38912
    ds_read_b64_tr_b16 a[86:87], v165 offset:39424
    v_mul_f32 v240, v171, v240
    v_mfma_f32_32x32x16_bf16 a[16:31], a[100:103], v[36:39], a[16:31]
    ds_read_b64_tr_b16 a[88:89], v164 offset:47104
    ds_read_b64_tr_b16 a[90:91], v164 offset:47616
    ds_read_b64_tr_b16 a[92:93], v165 offset:47104
    ds_read_b64_tr_b16 a[94:95], v165 offset:47616
    v_mul_f32 v241, v171, v241
    v_mfma_f32_32x32x16_bf16 a[32:47], a[104:107], v[36:39], a[32:47]
    buffer_load_dwordx4 a[120:123], v170, s[20:23], s67 offen offset:2048 sc1
    v_mul_f32 v242, v171, v242
    v_mul_f32 v243, v171, v243
    v_mul_f32 v244, v171, v244
    v_mul_f32 v245, v171, v245
    v_mfma_f32_32x32x16_bf16 a[48:63], a[108:111], v[36:39], a[48:63]
    buffer_load_dwordx4 a[124:127], v170, s[20:23], s67 offen offset:3072 sc1
    v_mul_f32 v246, v171, v246
    v_mul_f32 v247, v171, v247
    v_cvt_pk_bf16_f32 v182, v240, v241
    v_cvt_pk_bf16_f32 v183, v242, v243
    s_waitcnt lgkmcnt(8)
    v_mfma_f32_32x32x16_bf16 a[0:15], a[64:67], v[40:43], a[0:15]
    ds_read_b64_tr_b16 a[96:97], v164 offset:49152
    ds_read_b64_tr_b16 a[98:99], v164 offset:49664
    ds_read_b64_tr_b16 a[100:101], v165 offset:49152
    ds_read_b64_tr_b16 a[102:103], v165 offset:49664
    v_cvt_pk_bf16_f32 v184, v244, v245
    v_mfma_f32_32x32x16_bf16 a[16:31], a[68:71], v[40:43], a[16:31]
    ds_read_b64_tr_b16 a[104:105], v164 offset:57344
    ds_read_b64_tr_b16 a[106:107], v164 offset:57856
    ds_read_b64_tr_b16 a[108:109], v165 offset:57344
    ds_read_b64_tr_b16 a[110:111], v165 offset:57856
    v_cvt_pk_bf16_f32 v185, v246, v247
    v_mfma_f32_32x32x16_bf16 a[32:47], a[72:75], v[40:43], a[32:47]
    s_add_u32 s67, s57, 4096
    buffer_load_dwordx4 a[128:131], v170, s[20:23], s67 offen offset:0 sc1
    s_add_u32 s42, s34, 6144
    buffer_store_dwordx4 v[182:185], v170, s[20:23], s42 offen sc1
    v_mul_f32 v248, v171, v248
    v_mul_f32 v249, v171, v249
    v_mul_f32 v250, v171, v250
    v_mfma_f32_32x32x16_bf16 a[48:63], a[76:79], v[40:43], a[48:63]
    s_add_u32 s67, s57, 20480
    buffer_load_dwordx4 a[132:135], v170, s[20:23], s67 offen offset:0 sc1
    v_mul_f32 v251, v171, v251
    v_mul_f32 v252, v171, v252
    v_mul_f32 v253, v171, v253
    s_waitcnt lgkmcnt(8)
    v_mfma_f32_32x32x16_bf16 a[0:15], a[80:83], v[44:47], a[0:15]
    ds_read_b64_tr_b16 a[64:65], v164 offset:51200
    ds_read_b64_tr_b16 a[66:67], v164 offset:51712
    ds_read_b64_tr_b16 a[68:69], v165 offset:51200
    ds_read_b64_tr_b16 a[70:71], v165 offset:51712
    v_mul_f32 v254, v171, v254
    v_mul_f32 v255, v171, v255
    v_mfma_f32_32x32x16_bf16 a[16:31], a[84:87], v[44:47], a[16:31]
    ds_read_b64_tr_b16 a[72:73], v164 offset:59392
    ds_read_b64_tr_b16 a[74:75], v164 offset:59904
    ds_read_b64_tr_b16 a[76:77], v165 offset:59392
    ds_read_b64_tr_b16 a[78:79], v165 offset:59904
    v_cvt_pk_bf16_f32 v186, v248, v249
    v_mfma_f32_32x32x16_bf16 a[32:47], a[88:91], v[44:47], a[32:47]
    buffer_load_dwordx4 a[136:139], v170, s[20:23], s67 offen offset:1024 sc1
    v_cvt_pk_bf16_f32 v187, v250, v251
    v_cvt_pk_bf16_f32 v188, v252, v253
    v_cvt_pk_bf16_f32 v189, v254, v255
    s_add_u32 s42, s34, 7168
    buffer_store_dwordx4 v[186:189], v170, s[20:23], s42 offen sc1
    v_mfma_f32_32x32x16_bf16 a[48:63], a[92:95], v[44:47], a[48:63]
    buffer_load_dwordx4 a[140:143], v170, s[20:23], s67 offen offset:2048 sc1
    s_waitcnt lgkmcnt(8)
    v_mfma_f32_32x32x16_bf16 a[0:15], a[96:99], v[48:51], a[0:15]
    ds_read_b64_tr_b16 a[80:81], v164 offset:53248
    ds_read_b64_tr_b16 a[82:83], v164 offset:53760
    ds_read_b64_tr_b16 a[84:85], v165 offset:53248
    ds_read_b64_tr_b16 a[86:87], v165 offset:53760
    v_mfma_f32_32x32x16_bf16 a[16:31], a[100:103], v[48:51], a[16:31]
    ds_read_b64_tr_b16 a[88:89], v164 offset:61440
    ds_read_b64_tr_b16 a[90:91], v164 offset:61952
    ds_read_b64_tr_b16 a[92:93], v165 offset:61440
    ds_read_b64_tr_b16 a[94:95], v165 offset:61952
    v_mfma_f32_32x32x16_bf16 a[32:47], a[104:107], v[48:51], a[32:47]
    buffer_load_dwordx4 a[144:147], v170, s[20:23], s67 offen offset:3072 sc1
    v_mfma_f32_32x32x16_bf16 a[48:63], a[108:111], v[48:51], a[48:63]
    s_add_u32 s67, s57, 24576
    buffer_load_dwordx4 a[148:151], v170, s[20:23], s67 offen offset:0 sc1
    s_waitcnt lgkmcnt(8)
    v_mfma_f32_32x32x16_bf16 a[0:15], a[64:67], v[52:55], a[0:15]
    ds_read_b64_tr_b16 a[96:97], v164 offset:55296
    ds_read_b64_tr_b16 a[98:99], v164 offset:55808
    ds_read_b64_tr_b16 a[100:101], v165 offset:55296
    ds_read_b64_tr_b16 a[102:103], v165 offset:55808
    v_mfma_f32_32x32x16_bf16 a[16:31], a[68:71], v[52:55], a[16:31]
    ds_read_b64_tr_b16 a[104:105], v164 offset:63488
    ds_read_b64_tr_b16 a[106:107], v164 offset:64000
    ds_read_b64_tr_b16 a[108:109], v165 offset:63488
    ds_read_b64_tr_b16 a[110:111], v165 offset:64000
    v_mfma_f32_32x32x16_bf16 a[32:47], a[72:75], v[52:55], a[32:47]
    s_add_u32 s67, s57, 40960
    buffer_load_dwordx4 a[152:155], v170, s[20:23], s67 offen offset:0 sc1
    v_mfma_f32_32x32x16_bf16 a[48:63], a[76:79], v[52:55], a[48:63]
    buffer_load_dwordx4 a[156:159], v170, s[20:23], s67 offen offset:1024 sc1
    s_waitcnt lgkmcnt(8)
    v_mfma_f32_32x32x16_bf16 a[0:15], a[80:83], v[56:59], a[0:15]
    ds_read_b64_tr_b16 a[64:65], v166 offset:0
    ds_read_b64_tr_b16 a[66:67], v166 offset:512
    ds_read_b64_tr_b16 a[68:69], v167 offset:0
    ds_read_b64_tr_b16 a[70:71], v167 offset:512
    v_mfma_f32_32x32x16_bf16 a[16:31], a[84:87], v[56:59], a[16:31]
    ds_read_b64_tr_b16 a[72:73], v166 offset:8192
    ds_read_b64_tr_b16 a[74:75], v166 offset:8704
    ds_read_b64_tr_b16 a[76:77], v167 offset:8192
    ds_read_b64_tr_b16 a[78:79], v167 offset:8704
    v_mfma_f32_32x32x16_bf16 a[32:47], a[88:91], v[56:59], a[32:47]
    buffer_load_dwordx4 a[160:163], v170, s[20:23], s67 offen offset:2048 sc1
    v_mfma_f32_32x32x16_bf16 a[48:63], a[92:95], v[56:59], a[48:63]
    buffer_load_dwordx4 a[164:167], v170, s[20:23], s67 offen offset:3072 sc1
    s_waitcnt lgkmcnt(8)
    v_mfma_f32_32x32x16_bf16 a[0:15], a[96:99], v[60:63], a[0:15]
    ds_read_b64_tr_b16 a[80:81], v166 offset:2048
    ds_read_b64_tr_b16 a[82:83], v166 offset:2560
    ds_read_b64_tr_b16 a[84:85], v167 offset:2048
    ds_read_b64_tr_b16 a[86:87], v167 offset:2560
    v_mfma_f32_32x32x16_bf16 a[16:31], a[100:103], v[60:63], a[16:31]
    ds_read_b64_tr_b16 a[88:89], v166 offset:10240
    ds_read_b64_tr_b16 a[90:91], v166 offset:10752
    ds_read_b64_tr_b16 a[92:93], v167 offset:10240
    ds_read_b64_tr_b16 a[94:95], v167 offset:10752
    v_mfma_f32_32x32x16_bf16 a[32:47], a[104:107], v[60:63], a[32:47]
    s_add_u32 s67, s57, 45056
    buffer_load_dwordx4 a[168:171], v170, s[20:23], s67 offen offset:0 sc1
    v_mfma_f32_32x32x16_bf16 a[48:63], a[108:111], v[60:63], a[48:63]
    s_add_u32 s67, s57, 61440
    buffer_load_dwordx4 a[172:175], v170, s[20:23], s67 offen offset:0 sc1
    s_waitcnt lgkmcnt(8)
    v_mfma_f32_32x32x16_bf16 a[0:15], a[64:67], v[64:67], a[0:15]
    s_waitcnt vmcnt(9)
    s_barrier
    s_cmp_lg_u32 s25, 0
    s_cbranch_scc1 FL9
    s_add_u32 s83, s98, 1
    v_mov_b32 v62, s83
    v_mov_b32 v63, 0
    s_mov_b64 exec, 1
    buffer_store_dword v62, v63, s[20:23], s89 offen offset:4 sc1
    s_mov_b64 exec, -1
FL9:
    ds_read_b64_tr_b16 a[96:97], v166 offset:4096
    ds_read_b64_tr_b16 a[98:99], v166 offset:4608
    ds_read_b64_tr_b16 a[100:101], v167 offset:4096
    ds_read_b64_tr_b16 a[102:103], v167 offset:4608
    v_mfma_f32_32x32x16_bf16 a[16:31], a[68:71], v[64:67], a[16:31]
    ds_read_b64_tr_b16 a[104:105], v166 offset:12288
    ds_read_b64_tr_b16 a[106:107], v166 offset:12800
    ds_read_b64_tr_b16 a[108:109], v167 offset:12288
    ds_read_b64_tr_b16 a[110:111], v167 offset:12800
    v_mfma_f32_32x32x16_bf16 a[32:47], a[72:75], v[64:67], a[32:47]
    buffer_load_dwordx4 a[176:179], v170, s[20:23], s67 offen offset:1024 sc1
    v_mfma_f32_32x32x16_bf16 a[48:63], a[76:79], v[64:67], a[48:63]
    buffer_load_dwordx4 a[180:183], v170, s[20:23], s67 offen offset:2048 sc1
    s_waitcnt lgkmcnt(8)
    v_mfma_f32_32x32x16_bf16 a[0:15], a[80:83], v[68:71], a[0:15]
    ds_read_b64_tr_b16 a[64:65], v166 offset:6144
    ds_read_b64_tr_b16 a[66:67], v166 offset:6656
    ds_read_b64_tr_b16 a[68:69], v167 offset:6144
    ds_read_b64_tr_b16 a[70:71], v167 offset:6656
    v_mfma_f32_32x32x16_bf16 a[16:31], a[84:87], v[68:71], a[16:31]
    ds_read_b64_tr_b16 a[72:73], v166 offset:14336
    ds_read_b64_tr_b16 a[74:75], v166 offset:14848
    ds_read_b64_tr_b16 a[76:77], v167 offset:14336
    ds_read_b64_tr_b16 a[78:79], v167 offset:14848
    v_mfma_f32_32x32x16_bf16 a[32:47], a[88:91], v[68:71], a[32:47]
    buffer_load_dwordx4 a[184:187], v170, s[20:23], s67 offen offset:3072 sc1
    v_mfma_f32_32x32x16_bf16 a[48:63], a[92:95], v[68:71], a[48:63]
    s_add_u32 s67, s57, 65536
    buffer_load_dwordx4 a[188:191], v170, s[20:23], s67 offen offset:0 sc1
    s_waitcnt lgkmcnt(8)
    v_mfma_f32_32x32x16_bf16 a[0:15], a[96:99], v[72:75], a[0:15]
    ds_read_b64_tr_b16 a[80:81], v166 offset:16384
    ds_read_b64_tr_b16 a[82:83], v166 offset:16896
    ds_read_b64_tr_b16 a[84:85], v167 offset:16384
    ds_read_b64_tr_b16 a[86:87], v167 offset:16896
    v_mfma_f32_32x32x16_bf16 a[16:31], a[100:103], v[72:75], a[16:31]
    v_lshrrev_b32 v56, 4, v170
    s_cmp_ge_u32 s28, 12
    s_cselect_b32 s61, 15, 14
    v_lshrrev_b32 v59, 4, v56
    v_sub_u32 v57, s27, v59
    v_cmp_gt_u32 vcc, 3, v59
    v_cmp_le_i32 s[94:95], 0, v57
    v_and_b32 v59, 15, v56
    s_and_b64 s[94:95], vcc, s[94:95]
    v_cmp_gt_u32 vcc, s61, v59
    v_lshlrev_b32 v57, 12, v57
    v_lshl_add_u32 v57, v59, 2, v57
    s_and_b64 vcc, vcc, s[94:95]
    v_add_u32 v57, s81, v57
    v_mov_b32 v58, -1
    v_mov_b32 v59, 0x7ff00000
    v_cndmask_b32 v58, v58, 2, vcc
    v_cndmask_b32 v57, v59, v57, vcc
    buffer_load_dword v61, v57, s[20:23], 0 offen sc1
    ds_read_b64_tr_b16 a[88:89], v166 offset:24576
    ds_read_b64_tr_b16 a[90:91], v166 offset:25088
    ds_read_b64_tr_b16 a[92:93], v167 offset:24576
    ds_read_b64_tr_b16 a[94:95], v167 offset:25088
    v_mfma_f32_32x32x16_bf16 a[32:47], a[104:107], v[72:75], a[32:47]
    s_add_u32 s67, s57, 81920
    buffer_load_dwordx4 a[192:195], v170, s[20:23], s67 offen offset:0 sc1
    v_mfma_f32_32x32x16_bf16 a[48:63], a[108:111], v[72:75], a[48:63]
    buffer_load_dwordx4 a[196:199], v170, s[20:23], s67 offen offset:1024 sc1
    s_waitcnt lgkmcnt(8)
    v_mfma_f32_32x32x16_bf16 a[0:15], a[64:67], v[76:79], a[0:15]
    ds_read_b64_tr_b16 a[96:97], v166 offset:18432
    ds_read_b64_tr_b16 a[98:99], v166 offset:18944
    ds_read_b64_tr_b16 a[100:101], v167 offset:18432
    ds_read_b64_tr_b16 a[102:103], v167 offset:18944
    v_mfma_f32_32x32x16_bf16 a[16:31], a[68:71], v[76:79], a[16:31]
    ds_read_b64_tr_b16 a[104:105], v166 offset:26624
    ds_read_b64_tr_b16 a[106:107], v166 offset:27136
    ds_read_b64_tr_b16 a[108:109], v167 offset:26624
    ds_read_b64_tr_b16 a[110:111], v167 offset:27136
    v_mfma_f32_32x32x16_bf16 a[32:47], a[72:75], v[76:79], a[32:47]
    buffer_load_dwordx4 a[200:203], v170, s[20:23], s67 offen offset:2048 sc1
    v_mfma_f32_32x32x16_bf16 a[48:63], a[76:79], v[76:79], a[48:63]
    buffer_load_dwordx4 a[204:207], v170, s[20:23], s67 offen offset:3072 sc1
    s_waitcnt lgkmcnt(8)
    v_mfma_f32_32x32x16_bf16 a[0:15], a[80:83], v[80:83], a[0:15]
    ds_read_b64_tr_b16 a[64:65], v166 offset:20480
    ds_read_b64_tr_b16 a[66:67], v166 offset:20992
    ds_read_b64_tr_b16 a[68:69], v167 offset:20480
    ds_read_b64_tr_b16 a[70:71], v167 offset:20992
    v_mfma_f32_32x32x16_bf16 a[16:31], a[84:87], v[80:83], a[16:31]
    ds_read_b64_tr_b16 a[72:73], v166 offset:28672
    ds_read_b64_tr_b16 a[74:75], v166 offset:29184
    ds_read_b64_tr_b16 a[76:77], v167 offset:28672
    ds_read_b64_tr_b16 a[78:79], v167 offset:29184
    v_mfma_f32_32x32x16_bf16 a[32:47], a[88:91], v[80:83], a[32:47]
    s_add_u32 s67, s57, 86016
    buffer_load_dwordx4 a[208:211], v170, s[20:23], s67 offen offset:0 sc1
    v_mfma_f32_32x32x16_bf16 a[48:63], a[92:95], v[80:83], a[48:63]
    s_add_u32 s67, s57, 102400
    buffer_load_dwordx4 a[212:215], v170, s[20:23], s67 offen offset:0 sc1
    s_waitcnt lgkmcnt(8)
    v_mfma_f32_32x32x16_bf16 a[0:15], a[96:99], v[84:87], a[0:15]
    ds_read_b64_tr_b16 a[80:81], v166 offset:22528
    ds_read_b64_tr_b16 a[82:83], v166 offset:23040
    ds_read_b64_tr_b16 a[84:85], v167 offset:22528
    ds_read_b64_tr_b16 a[86:87], v167 offset:23040
    v_mfma_f32_32x32x16_bf16 a[16:31], a[100:103], v[84:87], a[16:31]
    ds_read_b64_tr_b16 a[88:89], v166 offset:30720
    ds_read_b64_tr_b16 a[90:91], v166 offset:31232
    ds_read_b64_tr_b16 a[92:93], v167 offset:30720
    ds_read_b64_tr_b16 a[94:95], v167 offset:31232
    v_mfma_f32_32x32x16_bf16 a[32:47], a[104:107], v[84:87], a[32:47]
    buffer_load_dwordx4 a[216:219], v170, s[20:23], s67 offen offset:1024 sc1
    v_mfma_f32_32x32x16_bf16 a[48:63], a[108:111], v[84:87], a[48:63]
    buffer_load_dwordx4 a[220:223], v170, s[20:23], s67 offen offset:2048 sc1
    s_waitcnt lgkmcnt(8)
    v_mfma_f32_32x32x16_bf16 a[0:15], a[64:67], v[88:91], a[0:15]
    ds_read_b64_tr_b16 a[96:97], v166 offset:32768
    ds_read_b64_tr_b16 a[98:99], v166 offset:33280
    ds_read_b64_tr_b16 a[100:101], v167 offset:32768
    ds_read_b64_tr_b16 a[102:103], v167 offset:33280
    v_mfma_f32_32x32x16_bf16 a[16:31], a[68:71], v[88:91], a[16:31]
    ds_read_b64_tr_b16 a[104:105], v166 offset:40960
    ds_read_b64_tr_b16 a[106:107], v166 offset:41472
    ds_read_b64_tr_b16 a[108:109], v167 offset:40960
    ds_read_b64_tr_b16 a[110:111], v167 offset:41472
    v_mfma_f32_32x32x16_bf16 a[32:47], a[72:75], v[88:91], a[32:47]
    buffer_load_dwordx4 a[224:227], v170, s[20:23], s67 offen offset:3072 sc1
    v_mfma_f32_32x32x16_bf16 a[48:63], a[76:79], v[88:91], a[48:63]
    s_add_u32 s67, s57, 106496
    buffer_load_dwordx4 a[228:231], v170, s[20:23], s67 offen offset:0 sc1
    s_waitcnt lgkmcnt(8)
    v_mfma_f32_32x32x16_bf16 a[0:15], a[80:83], v[92:95], a[0:15]
    ds_read_b64_tr_b16 a[64:65], v166 offset:34816
    ds_read_b64_tr_b16 a[66:67], v166 offset:35328
    ds_read_b64_tr_b16 a[68:69], v167 offset:34816
    ds_read_b64_tr_b16 a[70:71], v167 offset:35328
    v_mfma_f32_32x32x16_bf16 a[16:31], a[84:87], v[92:95], a[16:31]
    ds_read_b64_tr_b16 a[72:73], v166 offset:43008
    ds_read_b64_tr_b16 a[74:75], v166 offset:43520
    ds_read_b64_tr_b16 a[76:77], v167 offset:43008
    ds_read_b64_tr_b16 a[78:79], v167 offset:43520
    v_mfma_f32_32x32x16_bf16 a[32:47], a[88:91], v[92:95], a[32:47]
    s_add_u32 s67, s57, 122880
    buffer_load_dwordx4 a[232:235], v170, s[20:23], s67 offen offset:0 sc1
    v_mfma_f32_32x32x16_bf16 a[48:63], a[92:95], v[92:95], a[48:63]
    buffer_load_dwordx4 a[236:239], v170, s[20:23], s67 offen offset:1024 sc1
    s_waitcnt lgkmcnt(8)
    v_mfma_f32_32x32x16_bf16 a[0:15], a[96:99], v[96:99], a[0:15]
    s_cmp_lg_u32 s25, 0
    s_cbranch_scc1 PD10
    s_waitcnt vmcnt(12)
    s_mov_b32 s88, 0
    s_add_u32 s83, s98, 1
PL10:
    v_subrev_u32 v61, s83, v61
    v_cmp_lt_u32 vcc, v58, v61
    s_cbranch_vccz PD10
    s_add_u32 s88, s88, 1
    s_cmp_gt_u32 s88, 0x40000
    s_cbranch_scc1 PD10
    s_sleep 4
    buffer_load_dword v61, v57, s[20:23], 0 offen sc1
    s_waitcnt vmcnt(0)
    s_branch PL10
PD10:
    s_barrier
    s_mul_i32 s62, s28, 5
    s_lshr_b32 s62, s62, 1
    s_lshl_b32 s63, s27, 2
    s_add_u32 s63, s63, s25
    s_mul_i32 s64, s63, 122880
    s_lshl_b32 s65, s62, 10
    s_add_u32 s64, s64, s65
    s_mov_b32 s61, s28
    ds_read_b64_tr_b16 a[80:81], v166 offset:36864
    ds_read_b64_tr_b16 a[82:83], v166 offset:37376
    ds_read_b64_tr_b16 a[84:85], v167 offset:36864
    ds_read_b64_tr_b16 a[86:87], v167 offset:37376
    v_mfma_f32_32x32x16_bf16 a[16:31], a[100:103], v[96:99], a[16:31]
    ds_read_b64_tr_b16 a[88:89], v166 offset:45056
    ds_read_b64_tr_b16 a[90:91], v166 offset:45568
    ds_read_b64_tr_b16 a[92:93], v167 offset:45056
    ds_read_b64_tr_b16 a[94:95], v167 offset:45568
    v_mfma_f32_32x32x16_bf16 a[32:47], a[104:107], v[96:99], a[32:47]
    buffer_load_dwordx4 a[240:243], v170, s[20:23], s67 offen offset:2048 sc1
    v_mfma_f32_32x32x16_bf16 a[48:63], a[108:111], v[96:99], a[48:63]
    buffer_load_dwordx4 a[244:247], v170, s[20:23], s67 offen offset:3072 sc1
    s_waitcnt lgkmcnt(8)
    v_mfma_f32_32x32x16_bf16 a[0:15], a[64:67], v[100:103], a[0:15]
    ds_read_b64_tr_b16 a[96:97], v166 offset:38912
    ds_read_b64_tr_b16 a[98:99], v166 offset:39424
    ds_read_b64_tr_b16 a[100:101], v167 offset:38912
    ds_read_b64_tr_b16 a[102:103], v167 offset:39424
    v_mfma_f32_32x32x16_bf16 a[16:31], a[68:71], v[100:103], a[16:31]
    ds_read_b64_tr_b16 a[104:105], v166 offset:47104
    ds_read_b64_tr_b16 a[106:107], v166 offset:47616
    ds_read_b64_tr_b16 a[108:109], v167 offset:47104
    ds_read_b64_tr_b16 a[110:111], v167 offset:47616
    v_mfma_f32_32x32x16_bf16 a[32:47], a[72:75], v[100:103], a[32:47]
    s_add_u32 s67, s57, 126976
    buffer_load_dwordx4 a[248:251], v170, s[20:23], s67 offen offset:0 sc1
    v_mfma_f32_32x32x16_bf16 a[48:63], a[76:79], v[100:103], a[48:63]
    s_add_u32 s65, s64, 4294025216
    s_cmp_lt_u32 s63, 8
    s_cselect_b32 s65, 0x7ff00000, s65
    buffer_load_dwordx4 v[0:3], v170, s[20:23], s65 offen offset:0 sc1
    s_waitcnt lgkmcnt(8)
    v_mfma_f32_32x32x16_bf16 a[0:15], a[80:83], v[104:107], a[0:15]
    ds_read_b64_tr_b16 a[64:65], v166 offset:49152
    ds_read_b64_tr_b16 a[66:67], v166 offset:49664
    ds_read_b64_tr_b16 a[68:69], v167 offset:49152
    ds_read_b64_tr_b16 a[70:71], v167 offset:49664
    v_mfma_f32_32x32x16_bf16 a[16:31], a[84:87], v[104:107], a[16:31]
    ds_read_b64_tr_b16 a[72:73], v166 offset:57344
    ds_read_b64_tr_b16 a[74:75], v166 offset:57856
    ds_read_b64_tr_b16 a[76:77], v167 offset:57344
    ds_read_b64_tr_b16 a[78:79], v167 offset:57856
    v_mfma_f32_32x32x16_bf16 a[32:47], a[88:91], v[104:107], a[32:47]
    buffer_load_dwordx4 v[4:7], v170, s[20:23], s65 offen offset:1024 sc1
    v_mfma_f32_32x32x16_bf16 a[48:63], a[92:95], v[104:107], a[48:63]
    buffer_load_dwordx4 v[8:11], v170, s[20:23], s65 offen offset:2048 sc1
    s_waitcnt lgkmcnt(8)
    v_mfma_f32_32x32x16_bf16 a[0:15], a[96:99], v[108:111], a[0:15]
    ds_read_b64_tr_b16 a[80:81], v166 offset:51200
    ds_read_b64_tr_b16 a[82:83], v166 offset:51712
    ds_read_b64_tr_b16 a[84:85], v167 offset:51200
    ds_read_b64_tr_b16 a[86:87], v167 offset:51712
    v_mfma_f32_32x32x16_bf16 a[16:31], a[100:103], v[108:111], a[16:31]
    ds_read_b64_tr_b16 a[88:89], v166 offset:59392
    ds_read_b64_tr_b16 a[90:91], v166 offset:59904
    ds_read_b64_tr_b16 a[92:93], v167 offset:59392
    ds_read_b64_tr_b16 a[94:95], v167 offset:59904
    v_mfma_f32_32x32x16_bf16 a[32:47], a[104:107], v[108:111], a[32:47]
    s_add_u32 s65, s64, 4294066176
    s_cmp_lt_u32 s63, 8
    s_cselect_b32 s65, 0x7ff00000, s65
    buffer_load_dwordx4 v[12:15], v170, s[20:23], s65 offen offset:0 sc1
    v_mfma_f32_32x32x16_bf16 a[48:63], a[108:111], v[108:111], a[48:63]
    buffer_load_dwordx4 v[16:19], v170, s[20:23], s65 offen offset:1024 sc1
    s_waitcnt lgkmcnt(8)
    v_mfma_f32_32x32x16_bf16 a[0:15], a[64:67], v[112:115], a[0:15]
    ds_read_b64_tr_b16 a[96:97], v166 offset:53248
    ds_read_b64_tr_b16 a[98:99], v166 offset:53760
    ds_read_b64_tr_b16 a[100:101], v167 offset:53248
    ds_read_b64_tr_b16 a[102:103], v167 offset:53760
    v_mfma_f32_32x32x16_bf16 a[16:31], a[68:71], v[112:115], a[16:31]
    ds_read_b64_tr_b16 a[104:105], v166 offset:61440
    ds_read_b64_tr_b16 a[106:107], v166 offset:61952
    ds_read_b64_tr_b16 a[108:109], v167 offset:61440
    ds_read_b64_tr_b16 a[110:111], v167 offset:61952
    v_mfma_f32_32x32x16_bf16 a[32:47], a[72:75], v[112:115], a[32:47]
    buffer_load_dwordx4 v[20:23], v170, s[20:23], s65 offen offset:2048 sc1
    v_mfma_f32_32x32x16_bf16 a[48:63], a[76:79], v[112:115], a[48:63]
    s_add_u32 s65, s64, 4294516736
    s_cmp_lt_u32 s63, 4
    s_cselect_b32 s65, 0x7ff00000, s65
    buffer_load_dwordx4 v[24:27], v170, s[20:23], s65 offen offset:0 sc1
    s_waitcnt lgkmcnt(8)
    v_mfma_f32_32x32x16_bf16 a[0:15], a[80:83], v[116:119], a[0:15]
    ds_read_b64_tr_b16 a[64:65], v166 offset:55296
    ds_read_b64_tr_b16 a[66:67], v166 offset:55808
    ds_read_b64_tr_b16 a[68:69], v167 offset:55296
    ds_read_b64_tr_b16 a[70:71], v167 offset:55808
    v_mfma_f32_32x32x16_bf16 a[16:31], a[84:87], v[116:119], a[16:31]
    ds_read_b64_tr_b16 a[72:73], v166 offset:63488
    ds_read_b64_tr_b16 a[74:75], v166 offset:64000
    ds_read_b64_tr_b16 a[76:77], v167 offset:63488
    ds_read_b64_tr_b16 a[78:79], v167 offset:64000
    v_mfma_f32_32x32x16_bf16 a[32:47], a[88:91], v[116:119], a[32:47]
    buffer_load_dwordx4 v[28:31], v170, s[20:23], s65 offen offset:1024 sc1
    v_mfma_f32_32x32x16_bf16 a[48:63], a[92:95], v[116:119], a[48:63]
    buffer_load_dwordx4 v[32:35], v170, s[20:23], s65 offen offset:2048 sc1
    s_waitcnt lgkmcnt(8)
    v_mfma_f32_32x32x16_bf16 a[0:15], a[96:99], v[120:123], a[0:15]
    ds_read_b64_tr_b16 a[80:81], v168 offset:0
    ds_read_b64_tr_b16 a[82:83], v168 offset:512
    ds_read_b64_tr_b16 a[84:85], v169 offset:0
    ds_read_b64_tr_b16 a[86:87], v169 offset:512
    v_mfma_f32_32x32x16_bf16 a[16:31], a[100:103], v[120:123], a[16:31]
    ds_read_b64_tr_b16 a[88:89], v168 offset:8192
    ds_read_b64_tr_b16 a[90:91], v168 offset:8704
    ds_read_b64_tr_b16 a[92:93], v169 offset:8192
    ds_read_b64_tr_b16 a[94:95], v169 offset:8704
    v_mfma_f32_32x32x16_bf16 a[32:47], a[104:107], v[120:123], a[32:47]
    s_add_u32 s65, s64, 4294557696
    s_cmp_lt_u32 s63, 4
    s_cselect_b32 s65, 0x7ff00000, s65
    buffer_load_dwordx4 v[36:39], v170, s[20:23], s65 offen offset:0 sc1
    v_mfma_f32_32x32x16_bf16 a[48:63], a[108:111], v[120:123], a[48:63]
    buffer_load_dwordx4 v[40:43], v170, s[20:23], s65 offen offset:1024 sc1
    s_waitcnt lgkmcnt(8)
    v_mfma_f32_32x32x16_bf16 a[0:15], a[64:67], v[124:127], a[0:15]
    ds_read_b64_tr_b16 a[96:97], v168 offset:2048
    ds_read_b64_tr_b16 a[98:99], v168 offset:2560
    ds_read_b64_tr_b16 a[100:101], v169 offset:2048
    ds_read_b64_tr_b16 a[102:103], v169 offset:2560
    v_mfma_f32_32x32x16_bf16 a[16:31], a[68:71], v[124:127], a[16:31]
    ds_read_b64_tr_b16 a[104:105], v168 offset:10240
    ds_read_b64_tr_b16 a[106:107], v168 offset:10752
    ds_read_b64_tr_b16 a[108:109], v169 offset:10240
    ds_read_b64_tr_b16 a[110:111], v169 offset:10752
    v_mfma_f32_32x32x16_bf16 a[32:47], a[72:75], v[124:127], a[32:47]
    buffer_load_dwordx4 v[44:47], v170, s[20:23], s65 offen offset:2048 sc1
    v_mfma_f32_32x32x16_bf16 a[48:63], a[76:79], v[124:127], a[48:63]
    s_add_u32 s65, s64, 40960
    buffer_load_dwordx4 v[48:51], v170, s[20:23], s65 offen offset:0 sc1
    s_waitcnt lgkmcnt(8)
    v_mfma_f32_32x32x16_bf16 a[0:15], a[80:83], v[128:131], a[0:15]
    ds_read_b64_tr_b16 a[64:65], v168 offset:4096
    ds_read_b64_tr_b16 a[66:67], v168 offset:4608
    ds_read_b64_tr_b16 a[68:69], v169 offset:4096
    ds_read_b64_tr_b16 a[70:71], v169 offset:4608
    v_mfma_f32_32x32x16_bf16 a[16:31], a[84:87], v[128:131], a[16:31]
    ds_read_b64_tr_b16 a[72:73], v168 offset:12288
    ds_read_b64_tr_b16 a[74:75], v168 offset:12800
    ds_read_b64_tr_b16 a[76:77], v169 offset:12288
    ds_read_b64_tr_b16 a[78:79], v169 offset:12800
    v_mfma_f32_32x32x16_bf16 a[32:47], a[88:91], v[128:131], a[32:47]
    buffer_load_dwordx4 v[52:55], v170, s[20:23], s65 offen offset:1024 sc1
    v_mfma_f32_32x32x16_bf16 a[48:63], a[92:95], v[128:131], a[48:63]
    buffer_load_dwordx4 v[56:59], v170, s[20:23], s65 offen offset:2048 sc1
    s_waitcnt lgkmcnt(8)
    v_mfma_f32_32x32x16_bf16 a[0:15], a[96:99], v[132:135], a[0:15]
    ds_read_b64_tr_b16 a[80:81], v168 offset:6144
    ds_read_b64_tr_b16 a[82:83], v168 offset:6656
    ds_read_b64_tr_b16 a[84:85], v169 offset:6144
    ds_read_b64_tr_b16 a[86:87], v169 offset:6656
    v_mfma_f32_32x32x16_bf16 a[16:31], a[100:103], v[132:135], a[16:31]
    ds_read_b64_tr_b16 a[88:89], v168 offset:14336
    ds_read_b64_tr_b16 a[90:91], v168 offset:14848
    ds_read_b64_tr_b16 a[92:93], v169 offset:14336
    ds_read_b64_tr_b16 a[94:95], v169 offset:14848
    v_mfma_f32_32x32x16_bf16 a[32:47], a[104:107], v[132:135], a[32:47]
    s_add_u32 s65, s64, 81920
    buffer_load_dwordx4 v[60:63], v170, s[20:23], s65 offen offset:0 sc1
    v_mfma_f32_32x32x16_bf16 a[48:63], a[108:111], v[132:135], a[48:63]
    buffer_load_dwordx4 v[64:67], v170, s[20:23], s65 offen offset:1024 sc1
    s_waitcnt lgkmcnt(8)
    v_mfma_f32_32x32x16_bf16 a[0:15], a[64:67], v[136:139], a[0:15]
    ds_read_b64_tr_b16 a[96:97], v168 offset:16384
    ds_read_b64_tr_b16 a[98:99], v168 offset:16896
    ds_read_b64_tr_b16 a[100:101], v169 offset:16384
    ds_read_b64_tr_b16 a[102:103], v169 offset:16896
    v_mfma_f32_32x32x16_bf16 a[16:31], a[68:71], v[136:139], a[16:31]
    ds_read_b64_tr_b16 a[104:105], v168 offset:24576
    ds_read_b64_tr_b16 a[106:107], v168 offset:25088
    ds_read_b64_tr_b16 a[108:109], v169 offset:24576
    ds_read_b64_tr_b16 a[110:111], v169 offset:25088
    v_mfma_f32_32x32x16_bf16 a[32:47], a[72:75], v[136:139], a[32:47]
    buffer_load_dwordx4 v[68:71], v170, s[20:23], s65 offen offset:2048 sc1
    v_mfma_f32_32x32x16_bf16 a[48:63], a[76:79], v[136:139], a[48:63]
    s_and_b32 s66, s61, 1
    v_and_b32 v84, 0x1ff, v170
    v_lshrrev_b32 v85, 9, v170
    s_cmp_eq_u32 s66, 0
    s_cbranch_scc0 AQ0_11
    v_mul_u32_u24 v86, 8, v85
    v_add_u32 v86, v86, v84
    buffer_load_dwordx2 v[72:73], v86, s[20:23], s64 offen offset:0 sc1
    buffer_load_dwordx2 v[74:75], v86, s[20:23], s64 offen offset:512 sc1
    buffer_load_dwordx2 v[76:77], v84, s[20:23], s64 offen offset:1024 sc1
    v_mul_u32_u24 v86, 1016, v85
    v_add_u32 v86, v86, v84
    buffer_load_dwordx2 v[78:79], v86, s[20:23], s64 offen offset:1032 sc1
    buffer_load_dwordx2 v[80:81], v86, s[20:23], s64 offen offset:1544 sc1
    buffer_load_dwordx2 v[82:83], v84, s[20:23], s64 offen offset:1536 sc1
AQ0_11:
    s_cmp_eq_u32 s66, 1
    s_cbranch_scc0 AQ1_11
    v_mul_u32_u24 v86, 1016, v85
    v_add_u32 v86, v86, v84
    buffer_load_dwordx2 v[72:73], v86, s[20:23], s64 offen offset:8 sc1
    buffer_load_dwordx2 v[74:75], v86, s[20:23], s64 offen offset:520 sc1
    buffer_load_dwordx2 v[76:77], v84, s[20:23], s64 offen offset:1032 sc1
    v_mul_u32_u24 v86, 8, v85
    v_add_u32 v86, v86, v84
    buffer_load_dwordx2 v[78:79], v86, s[20:23], s64 offen offset:2048 sc1
    buffer_load_dwordx2 v[80:81], v86, s[20:23], s64 offen offset:2560 sc1
    buffer_load_dwordx2 v[82:83], v84, s[20:23], s64 offen offset:1544 sc1
AQ1_11:
    s_waitcnt lgkmcnt(8)
    v_mfma_f32_32x32x16_bf16 a[0:15], a[80:83], v[140:143], a[0:15]
    ds_read_b64_tr_b16 a[64:65], v168 offset:18432
    ds_read_b64_tr_b16 a[66:67], v168 offset:18944
    ds_read_b64_tr_b16 a[68:69], v169 offset:18432
    ds_read_b64_tr_b16 a[70:71], v169 offset:18944
    v_mfma_f32_32x32x16_bf16 a[16:31], a[84:87], v[140:143], a[16:31]
    ds_read_b64_tr_b16 a[72:73], v168 offset:26624
    ds_read_b64_tr_b16 a[74:75], v168 offset:27136
    ds_read_b64_tr_b16 a[76:77], v169 offset:26624
    ds_read_b64_tr_b16 a[78:79], v169 offset:27136
    v_mfma_f32_32x32x16_bf16 a[32:47], a[88:91], v[140:143], a[32:47]
    v_mfma_f32_32x32x16_bf16 a[48:63], a[92:95], v[140:143], a[48:63]
    s_waitcnt lgkmcnt(8)
    v_mfma_f32_32x32x16_bf16 a[0:15], a[96:99], v[144:147], a[0:15]
    ds_read_b64_tr_b16 a[80:81], v168 offset:20480
    ds_read_b64_tr_b16 a[82:83], v168 offset:20992
    ds_read_b64_tr_b16 a[84:85], v169 offset:20480
    ds_read_b64_tr_b16 a[86:87], v169 offset:20992
    v_mfma_f32_32x32x16_bf16 a[16:31], a[100:103], v[144:147], a[16:31]
    ds_read_b64_tr_b16 a[88:89], v168 offset:28672
    ds_read_b64_tr_b16 a[90:91], v168 offset:29184
    ds_read_b64_tr_b16 a[92:93], v169 offset:28672
    ds_read_b64_tr_b16 a[94:95], v169 offset:29184
    v_mfma_f32_32x32x16_bf16 a[32:47], a[104:107], v[144:147], a[32:47]
    v_mfma_f32_32x32x16_bf16 a[48:63], a[108:111], v[144:147], a[48:63]
    s_waitcnt lgkmcnt(8)
    v_mfma_f32_32x32x16_bf16 a[0:15], a[64:67], v[148:151], a[0:15]
    ds_read_b64_tr_b16 a[96:97], v168 offset:22528
    ds_read_b64_tr_b16 a[98:99], v168 offset:23040
    ds_read_b64_tr_b16 a[100:101], v169 offset:22528
    ds_read_b64_tr_b16 a[102:103], v169 offset:23040
    v_mfma_f32_32x32x16_bf16 a[16:31], a[68:71], v[148:151], a[16:31]
    ds_read_b64_tr_b16 a[104:105], v168 offset:30720
    ds_read_b64_tr_b16 a[106:107], v168 offset:31232
    ds_read_b64_tr_b16 a[108:109], v169 offset:30720
    ds_read_b64_tr_b16 a[110:111], v169 offset:31232
    v_mfma_f32_32x32x16_bf16 a[32:47], a[72:75], v[148:151], a[32:47]
    v_mfma_f32_32x32x16_bf16 a[48:63], a[76:79], v[148:151], a[48:63]
    s_waitcnt lgkmcnt(8)
    v_mfma_f32_32x32x16_bf16 a[0:15], a[80:83], v[152:155], a[0:15]
    v_mfma_f32_32x32x16_bf16 a[16:31], a[84:87], v[152:155], a[16:31]
    v_mfma_f32_32x32x16_bf16 a[32:47], a[88:91], v[152:155], a[32:47]
    v_mfma_f32_32x32x16_bf16 a[48:63], a[92:95], v[152:155], a[48:63]
    s_waitcnt lgkmcnt(0)
    v_mfma_f32_32x32x16_bf16 a[0:15], a[96:99], v[156:159], a[0:15]
    v_mfma_f32_32x32x16_bf16 a[16:31], a[100:103], v[156:159], a[16:31]
    v_mfma_f32_32x32x16_bf16 a[32:47], a[104:107], v[156:159], a[32:47]
    v_mfma_f32_32x32x16_bf16 a[48:63], a[108:111], v[156:159], a[48:63]
    v_lshrrev_b32 v106, 9, v170
    v_mul_u32_u24 v106, 288, v106
    v_bfe_u32 v107, v170, 4, 5
    v_lshl_add_u32 v106, v107, 3, v106
    s_mul_i32 s67, s25, 3744
    s_add_u32 s67, s67, 41472
    v_add_u32 v107, s67, v106
    s_mul_i32 s67, s25, 3456
    v_add_u32 v106, s67, v106
    s_waitcnt vmcnt(0)
    v_mov_b32 v92, s41
    v_mov_b32 v93, s41
    v_mov_b32 v94, v173
    v_mov_b32 v95, v173
    v_mov_b32 v96, v171
    v_mov_b32 v97, v171
    v_mov_b32 v98, v172
    v_mov_b32 v99, v172
    s_nop 3
    v_accvgpr_read_b32 v192, a0
    ds_write_b64 v106, v[0:1] offset:0
    v_accvgpr_read_b32 v193, a1
    v_accvgpr_read_b32 v194, a2
    v_accvgpr_read_b32 v195, a3
    v_accvgpr_read_b32 v224, a32
    v_accvgpr_read_b32 v225, a33
    ds_write_b64 v106, v[2:3] offset:576
    v_accvgpr_read_b32 v226, a34
    v_accvgpr_read_b32 v227, a35
    v_pk_mul_f32 v[192:193], v[192:193], v[96:97]
    v_pk_mul_f32 v[194:195], v[194:195], v[96:97]
    v_pk_mul_f32 v[174:175], v[192:193], v[192:193]
    ds_write_b64 v106, v[4:5] offset:1152
    v_pk_mul_f32 v[176:177], v[194:195], v[194:195]
    v_pk_fma_f32 v[174:175], v[174:175], v[92:93], v[94:95]
    v_pk_fma_f32 v[176:177], v[176:177], v[92:93], v[94:95]
    v_pk_mul_f32 v[174:175], v[174:175], v[192:193]
    v_pk_mul_f32 v[176:177], v[176:177], v[194:195]
    ds_write_b64 v106, v[6:7] offset:1728
    v_exp_f32 v174, v174
    v_exp_f32 v175, v175
    v_exp_f32 v176, v176
    v_exp_f32 v177, v177
    v_pk_mul_f32 v[192:193], v[192:193], v[224:225]
    ds_write_b64 v106, v[8:9] offset:2304
    v_pk_mul_f32 v[194:195], v[194:195], v[226:227]
    v_pk_fma_f32 v[174:175], v[174:175], v[98:99], v[98:99]
    v_pk_fma_f32 v[176:177], v[176:177], v[98:99], v[98:99]
    v_rcp_f32 v174, v174
    v_rcp_f32 v175, v175
    ds_write_b64 v106, v[10:11] offset:2880
    v_rcp_f32 v176, v176
    v_rcp_f32 v177, v177
    s_nop 0
    v_pk_mul_f32 v[192:193], v[192:193], v[174:175]
    v_pk_mul_f32 v[194:195], v[194:195], v[176:177]
    ds_write_b64 v107, v[12:13] offset:0
    v_cvt_pk_bf16_f32 v182, v192, v193
    v_cvt_pk_bf16_f32 v183, v194, v195
    v_accvgpr_read_b32 v196, a4
    v_accvgpr_read_b32 v197, a5
    v_accvgpr_read_b32 v198, a6
    ds_write_b64 v107, v[14:15] offset:576
    v_accvgpr_read_b32 v199, a7
    v_accvgpr_read_b32 v228, a36
    v_accvgpr_read_b32 v229, a37
    v_accvgpr_read_b32 v230, a38
    v_accvgpr_read_b32 v231, a39
    ds_write_b64 v107, v[16:17] offset:1152
    v_pk_mul_f32 v[196:197], v[196:197], v[96:97]
    v_pk_mul_f32 v[198:199], v[198:199], v[96:97]
    v_pk_mul_f32 v[178:179], v[196:197], v[196:197]
    v_pk_mul_f32 v[180:181], v[198:199], v[198:199]
    v_pk_fma_f32 v[178:179], v[178:179], v[92:93], v[94:95]
    ds_write_b64 v107, v[18:19] offset:1728
    v_pk_fma_f32 v[180:181], v[180:181], v[92:93], v[94:95]
    v_pk_mul_f32 v[178:179], v[178:179], v[196:197]
    v_pk_mul_f32 v[180:181], v[180:181], v[198:199]
    v_exp_f32 v178, v178
    v_exp_f32 v179, v179
    ds_write_b64 v107, v[20:21] offset:2304
    v_exp_f32 v180, v180
    v_exp_f32 v181, v181
    v_pk_mul_f32 v[196:197], v[196:197], v[228:229]
    v_pk_mul_f32 v[198:199], v[198:199], v[230:231]
    v_pk_fma_f32 v[178:179], v[178:179], v[98:99], v[98:99]
    ds_write_b64 v107, v[22:23] offset:2880
    v_pk_fma_f32 v[180:181], v[180:181], v[98:99], v[98:99]
    v_rcp_f32 v178, v178
    v_rcp_f32 v179, v179
    v_rcp_f32 v180, v180
    v_rcp_f32 v181, v181
    ds_write_b64 v106, v[24:25] offset:13824
    s_nop 0
    v_pk_mul_f32 v[196:197], v[196:197], v[178:179]
    v_pk_mul_f32 v[198:199], v[198:199], v[180:181]
    v_cvt_pk_bf16_f32 v184, v196, v197
    v_cvt_pk_bf16_f32 v185, v198, v199
    ds_write_b64 v106, v[26:27] offset:14400
    s_add_u32 s42, s35, 0
    buffer_store_dwordx4 v[182:185], v170, s[20:23], s42 offen sc1
    v_accvgpr_read_b32 v200, a8
    v_accvgpr_read_b32 v201, a9
    v_accvgpr_read_b32 v202, a10
    v_accvgpr_read_b32 v203, a11
    ds_write_b64 v106, v[28:29] offset:14976
    v_accvgpr_read_b32 v232, a40
    v_accvgpr_read_b32 v233, a41
    v_accvgpr_read_b32 v234, a42
    v_accvgpr_read_b32 v235, a43
    v_pk_mul_f32 v[200:201], v[200:201], v[96:97]
    ds_write_b64 v106, v[30:31] offset:15552
    v_pk_mul_f32 v[202:203], v[202:203], v[96:97]
    v_pk_mul_f32 v[174:175], v[200:201], v[200:201]
    v_pk_mul_f32 v[176:177], v[202:203], v[202:203]
    v_pk_fma_f32 v[174:175], v[174:175], v[92:93], v[94:95]
    v_pk_fma_f32 v[176:177], v[176:177], v[92:93], v[94:95]
    ds_write_b64 v106, v[32:33] offset:16128
    v_pk_mul_f32 v[174:175], v[174:175], v[200:201]
    v_pk_mul_f32 v[176:177], v[176:177], v[202:203]
    v_exp_f32 v174, v174
    v_exp_f32 v175, v175
    v_exp_f32 v176, v176
    ds_write_b64 v106, v[34:35] offset:16704
    v_exp_f32 v177, v177
    v_pk_mul_f32 v[200:201], v[200:201], v[232:233]
    v_pk_mul_f32 v[202:203], v[202:203], v[234:235]
    v_pk_fma_f32 v[174:175], v[174:175], v[98:99], v[98:99]
    v_pk_fma_f32 v[176:177], v[176:177], v[98:99], v[98:99]
    ds_write_b64 v107, v[36:37] offset:14976
    v_rcp_f32 v174, v174
    v_rcp_f32 v175, v175
    v_rcp_f32 v176, v176
    v_rcp_f32 v177, v177
    s_nop 0
    ds_write_b64 v107, v[38:39] offset:15552
    v_pk_mul_f32 v[200:201], v[200:201], v[174:175]
    v_pk_mul_f32 v[202:203], v[202:203], v[176:177]
    v_cvt_pk_bf16_f32 v186, v200, v201
    v_cvt_pk_bf16_f32 v187, v202, v203
    v_accvgpr_read_b32 v204, a12
    ds_write_b64 v107, v[40:41] offset:16128
    v_accvgpr_read_b32 v205, a13
    v_accvgpr_read_b32 v206, a14
    v_accvgpr_read_b32 v207, a15
    v_accvgpr_read_b32 v236, a44
    v_accvgpr_read_b32 v237, a45
    ds_write_b64 v107, v[42:43] offset:16704
    v_accvgpr_read_b32 v238, a46
    v_accvgpr_read_b32 v239, a47
    v_pk_mul_f32 v[204:205], v[204:205], v[96:97]
    v_pk_mul_f32 v[206:207], v[206:207], v[96:97]
    v_pk_mul_f32 v[178:179], v[204:205], v[204:205]
    ds_write_b64 v107, v[44:45] offset:17280
    v_pk_mul_f32 v[180:181], v[206:207], v[206:207]
    v_pk_fma_f32 v[178:179], v[178:179], v[92:93], v[94:95]
    v_pk_fma_f32 v[180:181], v[180:181], v[92:93], v[94:95]
    v_pk_mul_f32 v[178:179], v[178:179], v[204:205]
    v_pk_mul_f32 v[180:181], v[180:181], v[206:207]
    ds_write_b64 v107, v[46:47] offset:17856
    v_exp_f32 v178, v178
    v_exp_f32 v179, v179
    v_exp_f32 v180, v180
    v_exp_f32 v181, v181
    v_pk_mul_f32 v[204:205], v[204:205], v[236:237]
    ds_write_b64 v106, v[48:49] offset:27648
    v_pk_mul_f32 v[206:207], v[206:207], v[238:239]
    v_pk_fma_f32 v[178:179], v[178:179], v[98:99], v[98:99]
    v_pk_fma_f32 v[180:181], v[180:181], v[98:99], v[98:99]
    v_rcp_f32 v178, v178
    v_rcp_f32 v179, v179
    ds_write_b64 v106, v[50:51] offset:28224
    v_rcp_f32 v180, v180
    v_rcp_f32 v181, v181
    s_nop 0
    v_pk_mul_f32 v[204:205], v[204:205], v[178:179]
    v_pk_mul_f32 v[206:207], v[206:207], v[180:181]
    ds_write_b64 v106, v[52:53] offset:28800
    v_cvt_pk_bf16_f32 v188, v204, v205
    v_cvt_pk_bf16_f32 v189, v206, v207
    s_add_u32 s42, s35, 1024
    buffer_store_dwordx4 v[186:189], v170, s[20:23], s42 offen sc1
    v_accvgpr_read_b32 v208, a16
    v_accvgpr_read_b32 v209, a17
    ds_write_b64 v106, v[54:55] offset:29376
    v_accvgpr_read_b32 v210, a18
    v_accvgpr_read_b32 v211, a19
    v_accvgpr_read_b32 v240, a48
    v_accvgpr_read_b32 v241, a49
    v_accvgpr_read_b32 v242, a50
    ds_write_b64 v106, v[56:57] offset:29952
    v_accvgpr_read_b32 v243, a51
    v_pk_mul_f32 v[208:209], v[208:209], v[96:97]
    v_pk_mul_f32 v[210:211], v[210:211], v[96:97]
    v_pk_mul_f32 v[174:175], v[208:209], v[208:209]
    v_pk_mul_f32 v[176:177], v[210:211], v[210:211]
    ds_write_b64 v106, v[58:59] offset:30528
    v_pk_fma_f32 v[174:175], v[174:175], v[92:93], v[94:95]
    v_pk_fma_f32 v[176:177], v[176:177], v[92:93], v[94:95]
    v_pk_mul_f32 v[174:175], v[174:175], v[208:209]
    v_pk_mul_f32 v[176:177], v[176:177], v[210:211]
    v_exp_f32 v174, v174
    ds_write_b64 v107, v[60:61] offset:29952
    v_exp_f32 v175, v175
    v_exp_f32 v176, v176
    v_exp_f32 v177, v177
    v_pk_mul_f32 v[208:209], v[208:209], v[240:241]
    v_pk_mul_f32 v[210:211], v[210:211], v[242:243]
    ds_write_b64 v107, v[62:63] offset:30528
    v_pk_fma_f32 v[174:175], v[174:175], v[98:99], v[98:99]
    v_pk_fma_f32 v[176:177], v[176:177], v[98:99], v[98:99]
    v_rcp_f32 v174, v174
    v_rcp_f32 v175, v175
    v_rcp_f32 v176, v176
    ds_write_b64 v107, v[64:65] offset:31104
    v_rcp_f32 v177, v177
    s_nop 0
    v_pk_mul_f32 v[208:209], v[208:209], v[174:175]
    v_pk_mul_f32 v[210:211], v[210:211], v[176:177]
    v_cvt_pk_bf16_f32 v182, v208, v209
    ds_write_b64 v107, v[66:67] offset:31680
    v_cvt_pk_bf16_f32 v183, v210, v211
    v_accvgpr_read_b32 v212, a20
    v_accvgpr_read_b32 v213, a21
    v_accvgpr_read_b32 v214, a22
    v_accvgpr_read_b32 v215, a23
    ds_write_b64 v107, v[68:69] offset:32256
    v_accvgpr_read_b32 v244, a52
    v_accvgpr_read_b32 v245, a53
    v_accvgpr_read_b32 v246, a54
    v_accvgpr_read_b32 v247, a55
    v_pk_mul_f32 v[212:213], v[212:213], v[96:97]
    ds_write_b64 v107, v[70:71] offset:32832
    v_pk_mul_f32 v[214:215], v[214:215], v[96:97]
    v_pk_mul_f32 v[178:179], v[212:213], v[212:213]
    v_pk_mul_f32 v[180:181], v[214:215], v[214:215]
    v_pk_fma_f32 v[178:179], v[178:179], v[92:93], v[94:95]
    v_pk_fma_f32 v[180:181], v[180:181], v[92:93], v[94:95]
    v_pk_mul_f32 v[178:179], v[178:179], v[212:213]
    v_pk_mul_f32 v[180:181], v[180:181], v[214:215]
    v_exp_f32 v178, v178
    v_exp_f32 v179, v179
    v_exp_f32 v180, v180
    v_exp_f32 v181, v181
    v_pk_mul_f32 v[212:213], v[212:213], v[244:245]
    v_pk_mul_f32 v[214:215], v[214:215], v[246:247]
    v_pk_fma_f32 v[178:179], v[178:179], v[98:99], v[98:99]
    v_pk_fma_f32 v[180:181], v[180:181], v[98:99], v[98:99]
    v_rcp_f32 v178, v178
    v_rcp_f32 v179, v179
    v_rcp_f32 v180, v180
    v_rcp_f32 v181, v181
    s_nop 0
    v_pk_mul_f32 v[212:213], v[212:213], v[178:179]
    v_pk_mul_f32 v[214:215], v[214:215], v[180:181]
    v_cvt_pk_bf16_f32 v184, v212, v213
    v_cvt_pk_bf16_f32 v185, v214, v215
    s_add_u32 s42, s35, 2048
    buffer_store_dwordx4 v[182:185], v170, s[20:23], s42 offen sc1
    v_accvgpr_read_b32 v216, a24
    v_accvgpr_read_b32 v217, a25
    v_accvgpr_read_b32 v218, a26
    v_accvgpr_read_b32 v219, a27
    v_accvgpr_read_b32 v248, a56
    v_accvgpr_read_b32 v249, a57
    v_accvgpr_read_b32 v250, a58
    v_accvgpr_read_b32 v251, a59
    v_pk_mul_f32 v[216:217], v[216:217], v[96:97]
    v_pk_mul_f32 v[218:219], v[218:219], v[96:97]
    v_pk_mul_f32 v[174:175], v[216:217], v[216:217]
    v_pk_mul_f32 v[176:177], v[218:219], v[218:219]
    v_pk_fma_f32 v[174:175], v[174:175], v[92:93], v[94:95]
    v_pk_fma_f32 v[176:177], v[176:177], v[92:93], v[94:95]
    v_pk_mul_f32 v[174:175], v[174:175], v[216:217]
    v_pk_mul_f32 v[176:177], v[176:177], v[218:219]
    v_exp_f32 v174, v174
    v_exp_f32 v175, v175
    v_exp_f32 v176, v176
    v_exp_f32 v177, v177
    v_pk_mul_f32 v[216:217], v[216:217], v[248:249]
    v_pk_mul_f32 v[218:219], v[218:219], v[250:251]
    v_pk_fma_f32 v[174:175], v[174:175], v[98:99], v[98:99]
    v_pk_fma_f32 v[176:177], v[176:177], v[98:99], v[98:99]
    v_rcp_f32 v174, v174
    v_rcp_f32 v175, v175
    v_rcp_f32 v176, v176
    v_rcp_f32 v177, v177
    s_nop 0
    v_pk_mul_f32 v[216:217], v[216:217], v[174:175]
    v_pk_mul_f32 v[218:219], v[218:219], v[176:177]
    v_cvt_pk_bf16_f32 v186, v216, v217
    v_cvt_pk_bf16_f32 v187, v218, v219
    v_accvgpr_read_b32 v220, a28
    v_accvgpr_read_b32 v221, a29
    v_accvgpr_read_b32 v222, a30
    v_accvgpr_read_b32 v223, a31
    v_accvgpr_read_b32 v252, a60
    v_accvgpr_read_b32 v253, a61
    v_accvgpr_read_b32 v254, a62
    v_accvgpr_read_b32 v255, a63
    v_pk_mul_f32 v[220:221], v[220:221], v[96:97]
    v_pk_mul_f32 v[222:223], v[222:223], v[96:97]
    v_pk_mul_f32 v[178:179], v[220:221], v[220:221]
    v_pk_mul_f32 v[180:181], v[222:223], v[222:223]
    v_pk_fma_f32 v[178:179], v[178:179], v[92:93], v[94:95]
    v_pk_fma_f32 v[180:181], v[180:181], v[92:93], v[94:95]
    v_pk_mul_f32 v[178:179], v[178:179], v[220:221]
    v_pk_mul_f32 v[180:181], v[180:181], v[222:223]
    v_exp_f32 v178, v178
    v_exp_f32 v179, v179
    v_exp_f32 v180, v180
    v_exp_f32 v181, v181
    v_pk_mul_f32 v[220:221], v[220:221], v[252:253]
    v_pk_mul_f32 v[222:223], v[222:223], v[254:255]
    v_pk_fma_f32 v[178:179], v[178:179], v[98:99], v[98:99]
    v_pk_fma_f32 v[180:181], v[180:181], v[98:99], v[98:99]
    v_rcp_f32 v178, v178
    v_rcp_f32 v179, v179
    v_rcp_f32 v180, v180
    v_rcp_f32 v181, v181
    s_nop 0
    v_pk_mul_f32 v[220:221], v[220:221], v[178:179]
    v_pk_mul_f32 v[222:223], v[222:223], v[180:181]
    v_cvt_pk_bf16_f32 v188, v220, v221
    v_cvt_pk_bf16_f32 v189, v222, v223
    s_add_u32 s42, s35, 3072
    buffer_store_dwordx4 v[186:189], v170, s[20:23], s42 offen sc1
    s_branch K1_DONE
K1_RP:
    s_waitcnt lgkmcnt(0)
    s_sub_u32 s82, s28, 14
    s_lshl_b32 s82, s82, 4
    s_add_u32 s82, s82, s27
    s_lshl_b32 s82, s82, 2
    s_add_u32 s82, s82, 23330816
    s_cmp_lg_u32 s25, 0
    s_cbranch_scc1 NO12
    s_or_b32 s98, s100, 1
    s_mov_b32 s99, 0
    s_mov_b32 s101, s98
    s_atomic_cmpswap s[98:99], s[84:85], 0 glc
NO12:
    s_sub_u32 s60, s28, 14
    s_lshl_b32 s60, s60, 4
    s_add_u32 s60, s60, s27
    s_lshl_b32 s60, s60, 2
    s_add_u32 s60, s60, s25
    s_lshl_b32 s60, s60, 10
    s_add_u32 s37, s60, 0
    buffer_load_dwordx4 a[252:255], v170, s[8:11], s37 offen
    s_add_u32 s37, s60, 131072
    buffer_load_dwordx4 a[252:255], v170, s[8:11], s37 offen
    s_add_u32 s37, s60, 262144
    buffer_load_dwordx4 a[252:255], v170, s[8:11], s37 offen
    s_add_u32 s37, s60, 393216
    buffer_load_dwordx4 a[252:255], v170, s[8:11], s37 offen
    s_add_u32 s37, s60, 524288
    buffer_load_dwordx4 a[252:255], v170, s[8:11], s37 offen
    s_add_u32 s37, s60, 655360
    buffer_load_dwordx4 a[252:255], v170, s[8:11], s37 offen
    s_add_u32 s37, s60, 786432
    buffer_load_dwordx4 a[252:255], v170, s[8:11], s37 offen
    s_add_u32 s37, s60, 917504
    buffer_load_dwordx4 a[252:255], v170, s[8:11], s37 offen
    s_add_u32 s37, s60, 1048576
    buffer_load_dwordx4 a[252:255], v170, s[8:11], s37 offen
    s_add_u32 s37, s60, 1179648
    buffer_load_dwordx4 a[252:255], v170, s[8:11], s37 offen
    s_add_u32 s37, s60, 1310720
    buffer_load_dwordx4 a[252:255], v170, s[8:11], s37 offen
    s_add_u32 s37, s60, 1441792
    buffer_load_dwordx4 a[252:255], v170, s[8:11], s37 offen
    s_add_u32 s37, s60, 1572864
    buffer_load_dwordx4 a[252:255], v170, s[8:11], s37 offen
    s_add_u32 s37, s60, 1703936
    buffer_load_dwordx4 a[252:255], v170, s[8:11], s37 offen
    s_add_u32 s37, s60, 1835008
    buffer_load_dwordx4 a[252:255], v170, s[8:11], s37 offen
    s_add_u32 s37, s60, 1966080
    buffer_load_dwordx4 a[252:255], v170, s[8:11], s37 offen
    s_add_u32 s37, s60, 2097152
    buffer_load_dwordx4 a[252:255], v170, s[8:11], s37 offen
    s_add_u32 s37, s60, 2228224
    buffer_load_dwordx4 a[252:255], v170, s[8:11], s37 offen
    s_add_u32 s37, s60, 2359296
    buffer_load_dwordx4 a[252:255], v170, s[8:11], s37 offen
    s_sub_u32 s29, s28, 14
    s_lshl_b32 s29, s29, 4
    s_add_u32 s29, s29, s27
    v_lshrrev_b32 v1, 3, v201
    v_and_b32 v2, 7, v201
    v_mul_u32_u24 v3, 1280, v1
    v_lshl_add_u32 v3, v2, 4, v3
    v_lshrrev_b32 v4, 2, v1
    v_mul_u32_u24 v4, 46080, v4
    v_add_u32 v4, v4, v3
    v_lshrrev_b32 v5, 5, v201
    v_mul_u32_u24 v5, 20480, v5
    v_bfe_u32 v6, v201, 2, 3
    v_lshl_add_u32 v5, v6, 7, v5
    v_and_b32 v6, 3, v201
    v_lshl_add_u32 v5, v6, 3, v5
    s_mul_i32 s36, s25, 10240
    s_lshr_b32 s54, s25, 1
    s_and_b32 s55, s25, 1
    s_mov_b32 s58, s29
    s_mov_b32 s59, 0
    s_waitcnt lgkmcnt(0)
RP_LOOP:
    s_cmp_ge_u32 s29, 54
    s_cbranch_scc1 RP_O
    s_lshl_b32 s30, s29, 5
    s_lshl_b32 s31, s25, 3
    s_add_u32 s30, s30, s31
    s_mul_i32 s30, s30, 1280
    s_add_u32 m0, s36, 0
    s_add_u32 s37, s30, 0
    buffer_load_dwordx4 v3, s[44:47], s37 offen lds
    s_add_u32 m0, s36, 1024
    s_add_u32 s37, s30, 128
    buffer_load_dwordx4 v3, s[44:47], s37 offen lds
    s_add_u32 m0, s36, 2048
    s_add_u32 s37, s30, 256
    buffer_load_dwordx4 v3, s[44:47], s37 offen lds
    s_add_u32 m0, s36, 3072
    s_add_u32 s37, s30, 384
    buffer_load_dwordx4 v3, s[44:47], s37 offen lds
    s_add_u32 m0, s36, 4096
    s_add_u32 s37, s30, 512
    buffer_load_dwordx4 v3, s[44:47], s37 offen lds
    s_add_u32 m0, s36, 5120
    s_add_u32 s37, s30, 640
    buffer_load_dwordx4 v3, s[44:47], s37 offen lds
    s_add_u32 m0, s36, 6144
    s_add_u32 s37, s30, 768
    buffer_load_dwordx4 v3, s[44:47], s37 offen lds
    s_add_u32 m0, s36, 7168
    s_add_u32 s37, s30, 896
    buffer_load_dwordx4 v3, s[44:47], s37 offen lds
    s_add_u32 m0, s36, 8192
    s_add_u32 s37, s30, 1024
    buffer_load_dwordx4 v3, s[44:47], s37 offen lds
    s_add_u32 m0, s36, 9216
    s_add_u32 s37, s30, 1152
    buffer_load_dwordx4 v3, s[44:47], s37 offen lds
    s_branch RP_T
RP_O:
    s_sub_u32 s30, s29, 54
    s_lshl_b32 s30, s30, 1
    s_add_u32 s30, s30, s54
    s_mul_i32 s31, s30, 52429
    s_lshr_b32 s31, s31, 18
    s_mul_i32 s32, s31, 5
    s_sub_u32 s32, s30, s32
    s_mul_i32 s31, s31, 80
    s_cmp_eq_u32 s32, 4
    s_cbranch_scc1 RP_L
    s_mul_i32 s32, s32, 20
    s_add_u32 s31, s31, s32
    s_lshl_b32 s32, s55, 3
    s_add_u32 s31, s31, s32
    v_mov_b32 v7, v3
    s_branch RP_O2
RP_L:
    s_mul_i32 s32, s55, 20
    s_add_u32 s31, s31, s32
    s_add_u32 s31, s31, 16
    v_mov_b32 v7, v4
RP_O2:
    s_mul_i32 s30, s31, 1280
    s_add_u32 m0, s36, 0
    s_add_u32 s37, s30, 0
    buffer_load_dwordx4 v7, s[48:51], s37 offen lds
    s_add_u32 m0, s36, 1024
    s_add_u32 s37, s30, 128
    buffer_load_dwordx4 v7, s[48:51], s37 offen lds
    s_add_u32 m0, s36, 2048
    s_add_u32 s37, s30, 256
    buffer_load_dwordx4 v7, s[48:51], s37 offen lds
    s_add_u32 m0, s36, 3072
    s_add_u32 s37, s30, 384
    buffer_load_dwordx4 v7, s[48:51], s37 offen lds
    s_add_u32 m0, s36, 4096
    s_add_u32 s37, s30, 512
    buffer_load_dwordx4 v7, s[48:51], s37 offen lds
    s_add_u32 m0, s36, 5120
    s_add_u32 s37, s30, 640
    buffer_load_dwordx4 v7, s[48:51], s37 offen lds
    s_add_u32 m0, s36, 6144
    s_add_u32 s37, s30, 768
    buffer_load_dwordx4 v7, s[48:51], s37 offen lds
    s_add_u32 m0, s36, 7168
    s_add_u32 s37, s30, 896
    buffer_load_dwordx4 v7, s[48:51], s37 offen lds
    s_add_u32 m0, s36, 8192
    s_add_u32 s37, s30, 1024
    buffer_load_dwordx4 v7, s[48:51], s37 offen lds
    s_add_u32 m0, s36, 9216
    s_add_u32 s37, s30, 1152
    buffer_load_dwordx4 v7, s[48:51], s37 offen lds
RP_T:
    s_add_u32 s36, s36, 40960
    s_add_u32 s29, s29, 32
    s_cmp_lt_u32 s29, 74
    s_cbranch_scc1 RP_LOOP
    s_mov_b32 s29, s58
    s_add_u32 s37, s68, 0
    buffer_load_dwordx4 a[252:255], v170, s[12:15], s37 offen
    s_add_u32 s37, s68, 1048576
    buffer_load_dwordx4 a[252:255], v170, s[12:15], s37 offen
    s_add_u32 s37, s68, 2097152
    buffer_load_dwordx4 a[252:255], v170, s[12:15], s37 offen
    s_add_u32 s37, s68, 0
    buffer_load_dwordx4 a[252:255], v170, s[16:19], s37 offen
    s_add_u32 s37, s68, 1048576
    buffer_load_dwordx4 a[252:255], v170, s[16:19], s37 offen
    s_add_u32 s37, s68, 2097152
    buffer_load_dwordx4 a[252:255], v170, s[16:19], s37 offen
    s_waitcnt vmcnt(6)
    s_barrier
RP_L2:
    s_mul_i32 s30, s25, 2560
    s_and_b32 s31, s25, 1
    s_mul_i32 s31, s31, -448
    s_add_u32 s30, s30, s31
    s_add_u32 s30, s30, s59
    v_add_u32 v8, s30, v5
    s_mul_i32 s30, s25, 757760
    s_mul_i32 s31, s29, 5120
    s_add_u32 s30, s30, s31
    s_add_u32 s30, s30, 18874368
    s_cmp_eq_u32 s55, 0
    s_cbranch_scc0 RP_ODD
    ds_read_b64_tr_b16 v[16:17], v8 offset:0
    ds_read_b64_tr_b16 v[18:19], v8 offset:10240
    ds_read_b64_tr_b16 v[20:21], v8 offset:32
    ds_read_b64_tr_b16 v[22:23], v8 offset:10272
    ds_read_b64_tr_b16 v[24:25], v8 offset:64
    ds_read_b64_tr_b16 v[26:27], v8 offset:10304
    ds_read_b64_tr_b16 v[28:29], v8 offset:96
    ds_read_b64_tr_b16 v[30:31], v8 offset:10336
    ds_read_b64_tr_b16 v[32:33], v8 offset:1024
    ds_read_b64_tr_b16 v[34:35], v8 offset:11264
    ds_read_b64_tr_b16 v[36:37], v8 offset:1056
    ds_read_b64_tr_b16 v[38:39], v8 offset:11296
    ds_read_b64_tr_b16 v[40:41], v8 offset:1088
    ds_read_b64_tr_b16 v[42:43], v8 offset:11328
    ds_read_b64_tr_b16 v[44:45], v8 offset:1120
    ds_read_b64_tr_b16 v[46:47], v8 offset:11360
    ds_read_b64_tr_b16 v[48:49], v8 offset:2048
    ds_read_b64_tr_b16 v[50:51], v8 offset:12288
    ds_read_b64_tr_b16 v[52:53], v8 offset:2080
    ds_read_b64_tr_b16 v[54:55], v8 offset:12320
    s_branch RP_ST
RP_ODD:
    ds_read_b64_tr_b16 v[16:17], v8 offset:0
    ds_read_b64_tr_b16 v[18:19], v8 offset:10240
    ds_read_b64_tr_b16 v[20:21], v8 offset:32
    ds_read_b64_tr_b16 v[22:23], v8 offset:10272
    ds_read_b64_tr_b16 v[24:25], v8 offset:960
    ds_read_b64_tr_b16 v[26:27], v8 offset:11200
    ds_read_b64_tr_b16 v[28:29], v8 offset:992
    ds_read_b64_tr_b16 v[30:31], v8 offset:11232
    ds_read_b64_tr_b16 v[32:33], v8 offset:1024
    ds_read_b64_tr_b16 v[34:35], v8 offset:11264
    ds_read_b64_tr_b16 v[36:37], v8 offset:1056
    ds_read_b64_tr_b16 v[38:39], v8 offset:11296
    ds_read_b64_tr_b16 v[40:41], v8 offset:1984
    ds_read_b64_tr_b16 v[42:43], v8 offset:12224
    ds_read_b64_tr_b16 v[44:45], v8 offset:2016
    ds_read_b64_tr_b16 v[46:47], v8 offset:12256
    ds_read_b64_tr_b16 v[48:49], v8 offset:2048
    ds_read_b64_tr_b16 v[50:51], v8 offset:12288
    ds_read_b64_tr_b16 v[52:53], v8 offset:2080
    ds_read_b64_tr_b16 v[54:55], v8 offset:12320
RP_ST:
    s_waitcnt lgkmcnt(0)
    s_add_u32 s37, s30, 0
    buffer_store_dwordx4 v[16:19], v170, s[20:23], s37 offen sc1
    s_add_u32 s37, s30, 1024
    buffer_store_dwordx4 v[20:23], v170, s[20:23], s37 offen sc1
    s_add_u32 s37, s30, 2048
    buffer_store_dwordx4 v[24:27], v170, s[20:23], s37 offen sc1
    s_add_u32 s37, s30, 3072
    buffer_store_dwordx4 v[28:31], v170, s[20:23], s37 offen sc1
    s_add_u32 s37, s30, 4096
    buffer_store_dwordx4 v[32:35], v170, s[20:23], s37 offen sc1
    s_add_u32 s37, s30, 378880
    buffer_store_dwordx4 v[36:39], v170, s[20:23], s37 offen sc1
    s_add_u32 s37, s30, 379904
    buffer_store_dwordx4 v[40:43], v170, s[20:23], s37 offen sc1
    s_add_u32 s37, s30, 380928
    buffer_store_dwordx4 v[44:47], v170, s[20:23], s37 offen sc1
    s_add_u32 s37, s30, 381952
    buffer_store_dwordx4 v[48:51], v170, s[20:23], s37 offen sc1
    s_add_u32 s37, s30, 382976
    buffer_store_dwordx4 v[52:55], v170, s[20:23], s37 offen sc1
    s_add_u32 s59, s59, 40960
    s_add_u32 s29, s29, 32
    s_cmp_lt_u32 s29, 74
    s_cbranch_scc1 RP_L2
    s_waitcnt lgkmcnt(0)
    s_cmp_eq_u32 s98, 0
    s_cselect_b32 s98, s101, s98
    s_waitcnt vmcnt(0)
    s_barrier
    s_cmp_lg_u32 s25, 0
    s_cbranch_scc1 FL13
    s_add_u32 s83, s98, 1
    v_mov_b32 v190, s83
    v_lshlrev_b32 v191, 8, v170
    s_mov_b64 exec, 0xff
    buffer_store_dword v190, v191, s[20:23], s82 offen sc1
    s_mov_b64 exec, -1
FL13:
    s_lshl_b32 s60, s24, 12
    s_add_u32 s60, s60, s81
    s_add_u32 s60, s60, 0x40000
    v_and_b32 v190, 0x1ff, v170
    v_lshrrev_b32 v190, 2, v190
    v_add_u32 v190, s60, v190
    buffer_load_dword v0, v190, s[20:23], 0 offen sc1
    v_mov_b32 v1, 2
    s_cmp_lg_u32 s25, 0
    s_cbranch_scc1 PD14
    s_waitcnt vmcnt(0)
    s_mov_b32 s88, 0
    s_add_u32 s83, s98, 1
PL14:
    v_subrev_u32 v0, s83, v0
    v_cmp_lt_u32 vcc, v1, v0
    s_cbranch_vccz PD14
    s_add_u32 s88, s88, 1
    s_cmp_gt_u32 s88, 0x40000
    s_cbranch_scc1 PD14
    s_sleep 4
    buffer_load_dword v0, v190, s[20:23], 0 offen sc1
    s_waitcnt vmcnt(0)
    s_branch PL14
PD14:
    s_barrier
    s_lshr_b32 s56, s26, 2
    s_mul_i32 s57, s56, 378880
    s_mul_i32 s67, s25, 5120
    s_add_u32 s57, s57, s67
    s_add_u32 s57, s57, 18874368
    s_add_u32 s67, s57, 0
    buffer_load_dwordx4 a[112:115], v170, s[20:23], s67 offen offset:0 sc1
    buffer_load_dwordx4 a[116:119], v170, s[20:23], s67 offen offset:1024 sc1
    buffer_load_dwordx4 a[120:123], v170, s[20:23], s67 offen offset:2048 sc1
    buffer_load_dwordx4 a[124:127], v170, s[20:23], s67 offen offset:3072 sc1
    s_add_u32 s67, s57, 4096
    buffer_load_dwordx4 a[128:131], v170, s[20:23], s67 offen offset:0 sc1
    s_add_u32 s67, s57, 20480
    buffer_load_dwordx4 a[132:135], v170, s[20:23], s67 offen offset:0 sc1
    buffer_load_dwordx4 a[136:139], v170, s[20:23], s67 offen offset:1024 sc1
    buffer_load_dwordx4 a[140:143], v170, s[20:23], s67 offen offset:2048 sc1
    buffer_load_dwordx4 a[144:147], v170, s[20:23], s67 offen offset:3072 sc1
    s_add_u32 s67, s57, 24576
    buffer_load_dwordx4 a[148:151], v170, s[20:23], s67 offen offset:0 sc1
    s_add_u32 s67, s57, 40960
    buffer_load_dwordx4 a[152:155], v170, s[20:23], s67 offen offset:0 sc1
    buffer_load_dwordx4 a[156:159], v170, s[20:23], s67 offen offset:1024 sc1
    buffer_load_dwordx4 a[160:163], v170, s[20:23], s67 offen offset:2048 sc1
    buffer_load_dwordx4 a[164:167], v170, s[20:23], s67 offen offset:3072 sc1
    s_add_u32 s67, s57, 45056
    buffer_load_dwordx4 a[168:171], v170, s[20:23], s67 offen offset:0 sc1
    s_add_u32 s67, s57, 61440
    buffer_load_dwordx4 a[172:175], v170, s[20:23], s67 offen offset:0 sc1
    buffer_load_dwordx4 a[176:179], v170, s[20:23], s67 offen offset:1024 sc1
    buffer_load_dwordx4 a[180:183], v170, s[20:23], s67 offen offset:2048 sc1
    buffer_load_dwordx4 a[184:187], v170, s[20:23], s67 offen offset:3072 sc1
    s_add_u32 s67, s57, 65536
    buffer_load_dwordx4 a[188:191], v170, s[20:23], s67 offen offset:0 sc1
    s_add_u32 s67, s57, 81920
    buffer_load_dwordx4 a[192:195], v170, s[20:23], s67 offen offset:0 sc1
    buffer_load_dwordx4 a[196:199], v170, s[20:23], s67 offen offset:1024 sc1
    buffer_load_dwordx4 a[200:203], v170, s[20:23], s67 offen offset:2048 sc1
    buffer_load_dwordx4 a[204:207], v170, s[20:23], s67 offen offset:3072 sc1
    s_add_u32 s67, s57, 86016
    buffer_load_dwordx4 a[208:211], v170, s[20:23], s67 offen offset:0 sc1
    s_add_u32 s67, s57, 102400
    buffer_load_dwordx4 a[212:215], v170, s[20:23], s67 offen offset:0 sc1
    buffer_load_dwordx4 a[216:219], v170, s[20:23], s67 offen offset:1024 sc1
    buffer_load_dwordx4 a[220:223], v170, s[20:23], s67 offen offset:2048 sc1
    buffer_load_dwordx4 a[224:227], v170, s[20:23], s67 offen offset:3072 sc1
    s_add_u32 s67, s57, 106496
    buffer_load_dwordx4 a[228:231], v170, s[20:23], s67 offen offset:0 sc1
    s_add_u32 s67, s57, 122880
    buffer_load_dwordx4 a[232:235], v170, s[20:23], s67 offen offset:0 sc1
    buffer_load_dwordx4 a[236:239], v170, s[20:23], s67 offen offset:1024 sc1
    buffer_load_dwordx4 a[240:243], v170, s[20:23], s67 offen offset:2048 sc1
    buffer_load_dwordx4 a[244:247], v170, s[20:23], s67 offen offset:3072 sc1
    s_add_u32 s67, s57, 126976
    buffer_load_dwordx4 a[248:251], v170, s[20:23], s67 offen offset:0 sc1
    s_waitcnt vmcnt(0)
    v_lshrrev_b32 v56, 4, v170
    s_cmp_ge_u32 s28, 12
    s_cselect_b32 s61, 15, 14
    v_lshrrev_b32 v59, 4, v56
    v_sub_u32 v57, s27, v59
    v_cmp_gt_u32 vcc, 3, v59
    v_cmp_le_i32 s[94:95], 0, v57
    v_and_b32 v59, 15, v56
    s_and_b64 s[94:95], vcc, s[94:95]
    v_cmp_gt_u32 vcc, s61, v59
    v_lshlrev_b32 v57, 12, v57
    v_lshl_add_u32 v57, v59, 2, v57
    s_and_b64 vcc, vcc, s[94:95]
    v_add_u32 v57, s81, v57
    v_mov_b32 v58, -1
    v_mov_b32 v59, 0x7ff00000
    v_cndmask_b32 v58, v58, 2, vcc
    v_cndmask_b32 v57, v59, v57, vcc
    buffer_load_dword v61, v57, s[20:23], 0 offen sc1
    s_cmp_lg_u32 s25, 0
    s_cbranch_scc1 PD15
    s_waitcnt vmcnt(0)
    s_mov_b32 s88, 0
    s_add_u32 s83, s98, 1
PL15:
    v_subrev_u32 v61, s83, v61
    v_cmp_lt_u32 vcc, v58, v61
    s_cbranch_vccz PD15
    s_add_u32 s88, s88, 1
    s_cmp_gt_u32 s88, 0x40000
    s_cbranch_scc1 PD15
    s_sleep 4
    buffer_load_dword v61, v57, s[20:23], 0 offen sc1
    s_waitcnt vmcnt(0)
    s_branch PL15
PD15:
    s_barrier
    s_mul_i32 s62, s28, 5
    s_lshr_b32 s62, s62, 1
    s_lshl_b32 s63, s27, 2
    s_add_u32 s63, s63, s25
    s_mul_i32 s64, s63, 122880
    s_lshl_b32 s65, s62, 10
    s_add_u32 s64, s64, s65
    s_mov_b32 s61, s28
    s_add_u32 s65, s64, 4294025216
    s_cmp_lt_u32 s63, 8
    s_cselect_b32 s65, 0x7ff00000, s65
    buffer_load_dwordx4 v[0:3], v170, s[20:23], s65 offen offset:0 sc1
    buffer_load_dwordx4 v[4:7], v170, s[20:23], s65 offen offset:1024 sc1
    buffer_load_dwordx4 v[8:11], v170, s[20:23], s65 offen offset:2048 sc1
    s_add_u32 s65, s64, 4294066176
    s_cmp_lt_u32 s63, 8
    s_cselect_b32 s65, 0x7ff00000, s65
    buffer_load_dwordx4 v[12:15], v170, s[20:23], s65 offen offset:0 sc1
    buffer_load_dwordx4 v[16:19], v170, s[20:23], s65 offen offset:1024 sc1
    buffer_load_dwordx4 v[20:23], v170, s[20:23], s65 offen offset:2048 sc1
    s_add_u32 s65, s64, 4294516736
    s_cmp_lt_u32 s63, 4
    s_cselect_b32 s65, 0x7ff00000, s65
    buffer_load_dwordx4 v[24:27], v170, s[20:23], s65 offen offset:0 sc1
    buffer_load_dwordx4 v[28:31], v170, s[20:23], s65 offen offset:1024 sc1
    buffer_load_dwordx4 v[32:35], v170, s[20:23], s65 offen offset:2048 sc1
    s_add_u32 s65, s64, 4294557696
    s_cmp_lt_u32 s63, 4
    s_cselect_b32 s65, 0x7ff00000, s65
    buffer_load_dwordx4 v[36:39], v170, s[20:23], s65 offen offset:0 sc1
    buffer_load_dwordx4 v[40:43], v170, s[20:23], s65 offen offset:1024 sc1
    buffer_load_dwordx4 v[44:47], v170, s[20:23], s65 offen offset:2048 sc1
    s_add_u32 s65, s64, 40960
    buffer_load_dwordx4 v[48:51], v170, s[20:23], s65 offen offset:0 sc1
    buffer_load_dwordx4 v[52:55], v170, s[20:23], s65 offen offset:1024 sc1
    buffer_load_dwordx4 v[56:59], v170, s[20:23], s65 offen offset:2048 sc1
    s_add_u32 s65, s64, 81920
    buffer_load_dwordx4 v[60:63], v170, s[20:23], s65 offen offset:0 sc1
    buffer_load_dwordx4 v[64:67], v170, s[20:23], s65 offen offset:1024 sc1
    buffer_load_dwordx4 v[68:71], v170, s[20:23], s65 offen offset:2048 sc1
    s_and_b32 s66, s61, 1
    v_and_b32 v84, 0x1ff, v170
    v_lshrrev_b32 v85, 9, v170
    s_cmp_eq_u32 s66, 0
    s_cbranch_scc0 AQ0_16
    v_mul_u32_u24 v86, 8, v85
    v_add_u32 v86, v86, v84
    buffer_load_dwordx2 v[72:73], v86, s[20:23], s64 offen offset:0 sc1
    buffer_load_dwordx2 v[74:75], v86, s[20:23], s64 offen offset:512 sc1
    buffer_load_dwordx2 v[76:77], v84, s[20:23], s64 offen offset:1024 sc1
    v_mul_u32_u24 v86, 1016, v85
    v_add_u32 v86, v86, v84
    buffer_load_dwordx2 v[78:79], v86, s[20:23], s64 offen offset:1032 sc1
    buffer_load_dwordx2 v[80:81], v86, s[20:23], s64 offen offset:1544 sc1
    buffer_load_dwordx2 v[82:83], v84, s[20:23], s64 offen offset:1536 sc1
AQ0_16:
    s_cmp_eq_u32 s66, 1
    s_cbranch_scc0 AQ1_16
    v_mul_u32_u24 v86, 1016, v85
    v_add_u32 v86, v86, v84
    buffer_load_dwordx2 v[72:73], v86, s[20:23], s64 offen offset:8 sc1
    buffer_load_dwordx2 v[74:75], v86, s[20:23], s64 offen offset:520 sc1
    buffer_load_dwordx2 v[76:77], v84, s[20:23], s64 offen offset:1032 sc1
    v_mul_u32_u24 v86, 8, v85
    v_add_u32 v86, v86, v84
    buffer_load_dwordx2 v[78:79], v86, s[20:23], s64 offen offset:2048 sc1
    buffer_load_dwordx2 v[80:81], v86, s[20:23], s64 offen offset:2560 sc1
    buffer_load_dwordx2 v[82:83], v84, s[20:23], s64 offen offset:1544 sc1
AQ1_16:
    v_lshrrev_b32 v106, 9, v170
    v_mul_u32_u24 v106, 288, v106
    v_bfe_u32 v107, v170, 4, 5
    v_lshl_add_u32 v106, v107, 3, v106
    s_mul_i32 s67, s25, 3744
    s_add_u32 s67, s67, 41472
    v_add_u32 v107, s67, v106
    s_mul_i32 s67, s25, 3456
    v_add_u32 v106, s67, v106
    s_waitcnt vmcnt(0)
    ds_write_b64 v106, v[0:1] offset:0
    ds_write_b64 v106, v[2:3] offset:576
    ds_write_b64 v106, v[4:5] offset:1152
    ds_write_b64 v106, v[6:7] offset:1728
    ds_write_b64 v106, v[8:9] offset:2304
    ds_write_b64 v106, v[10:11] offset:2880
    ds_write_b64 v107, v[12:13] offset:0
    ds_write_b64 v107, v[14:15] offset:576
    ds_write_b64 v107, v[16:17] offset:1152
    ds_write_b64 v107, v[18:19] offset:1728
    ds_write_b64 v107, v[20:21] offset:2304
    ds_write_b64 v107, v[22:23] offset:2880
    ds_write_b64 v106, v[24:25] offset:13824
    ds_write_b64 v106, v[26:27] offset:14400
    ds_write_b64 v106, v[28:29] offset:14976
    ds_write_b64 v106, v[30:31] offset:15552
    ds_write_b64 v106, v[32:33] offset:16128
    ds_write_b64 v106, v[34:35] offset:16704
    ds_write_b64 v107, v[36:37] offset:14976
    ds_write_b64 v107, v[38:39] offset:15552
    ds_write_b64 v107, v[40:41] offset:16128
    ds_write_b64 v107, v[42:43] offset:16704
    ds_write_b64 v107, v[44:45] offset:17280
    ds_write_b64 v107, v[46:47] offset:17856
    ds_write_b64 v106, v[48:49] offset:27648
    ds_write_b64 v106, v[50:51] offset:28224
    ds_write_b64 v106, v[52:53] offset:28800
    ds_write_b64 v106, v[54:55] offset:29376
    ds_write_b64 v106, v[56:57] offset:29952
    ds_write_b64 v106, v[58:59] offset:30528
    ds_write_b64 v107, v[60:61] offset:29952
    ds_write_b64 v107, v[62:63] offset:30528
    ds_write_b64 v107, v[64:65] offset:31104
    ds_write_b64 v107, v[66:67] offset:31680
    ds_write_b64 v107, v[68:69] offset:32256
    ds_write_b64 v107, v[70:71] offset:32832
    s_waitcnt vmcnt(0)
K1_DONE:
    v_lshrrev_b32 v160, 4, v170
    v_and_b32 v246, 31, v160
    v_lshrrev_b32 v247, 5, v160
    v_mul_u32_u24 v242, 288, v247
    v_lshl_add_u32 v242, v246, 3, v242
    s_mul_i32 s67, s25, 3456
    s_mul_i32 s68, s66, 576
    s_add_u32 s69, s67, s68
    v_mul_u32_u24 v243, 576, v247
    v_lshl_add_u32 v243, v246, 3, v243
    v_add_u32 v243, s69, v243
    v_lshlrev_b32 v250, 3, v246
    v_add_u32 v250, s69, v250
    v_add_u32 v251, s67, v242
    s_mul_i32 s67, s25, 3744
    s_add_u32 s67, s67, 41472
    v_add_u32 v252, s67, v242
    v_lshlrev_b32 v253, 2, v160
    v_add_u32 v253, s67, v253
    v_mov_b32 v254, 0x3f803f80
    v_and_b32 v248, 3, v160
    v_bfe_u32 v249, v160, 4, 1
    v_lshl_add_u32 v248, v249, 2, v248
    v_mul_u32_u24 v244, 288, v248
    v_add_u32 v244, s68, v244
    v_add_u32 v245, 1440, v244
    v_cmp_lt_u32 vcc, 4, v248
    v_mov_b32 v249, 3456
    v_bfe_u32 v248, v160, 2, 2
    v_cndmask_b32 v244, v244, v249, vcc
    v_cndmask_b32 v245, v245, v249, vcc
    v_lshlrev_b32 v248, 3, v248
    v_lshl_add_u32 v248, v247, 5, v248
    v_add_u32 v248, s67, v248
    v_add_u32 v244, v244, v248
    v_add_u32 v245, v245, v248
    v_lshlrev_b32 v242, 4, v160
    v_lshlrev_b32 v248, 2, v247
    v_sub_u32 v248, v246, v248
    v_mov_b32 v255, 0
    v_cmp_gt_u32 s[58:59], 32, v160
    v_mov_b32 v220, 0x3f80
    v_cndmask_b32 v222, v255, v254, s[58:59]
    v_cndmask_b32 v223, v255, v220, s[58:59]
    v_mov_b32 v224, 0
    v_mov_b32 v225, 0
    v_mov_b32 v218, 0
    v_mov_b32 v219, 0
    ds_write_b32 v253, v254 offset:3456
    ds_write_b32 v253, v254 offset:18432
    ds_write_b32 v253, v254 offset:33408
    v_cmp_gt_i32 s[12:13], 0, v248
    v_cmp_gt_i32 s[14:15], 1, v248
    v_cmp_gt_i32 s[16:17], 2, v248
    v_cmp_gt_i32 s[18:19], 3, v248
    v_cmp_gt_i32 s[28:29], 8, v248
    v_cmp_gt_i32 s[30:31], 9, v248
    v_cmp_gt_i32 s[32:33], 10, v248
    v_cmp_gt_i32 s[34:35], 11, v248
    v_cmp_gt_i32 s[36:37], 16, v248
    v_cmp_gt_i32 s[38:39], 17, v248
    v_cmp_gt_i32 s[40:41], 18, v248
    v_cmp_gt_i32 s[42:43], 19, v248
    v_cmp_gt_i32 s[44:45], 24, v248
    v_cmp_gt_i32 s[46:47], 25, v248
    v_cmp_gt_i32 s[48:49], 26, v248
    v_cmp_gt_i32 s[50:51], 27, v248
    v_mov_b32 v226, v72
    v_mov_b32 v227, v73
    v_mov_b32 v228, v74
    v_mov_b32 v229, v75
    v_cndmask_b32 v230, v255, v76, s[58:59]
    v_cndmask_b32 v231, v255, v77, s[58:59]
    v_mov_b32 v232, 0
    v_mov_b32 v233, 0
    v_mov_b32 v234, v78
    v_mov_b32 v235, v79
    v_mov_b32 v236, v80
    v_mov_b32 v237, v81
    v_cndmask_b32 v238, v255, v82, s[58:59]
    v_cndmask_b32 v239, v255, v83, s[58:59]
    v_mov_b32 v240, 0
    v_mov_b32 v241, 0
    v_mov_b32 v150, 0
    v_mov_b32 v151, 0
    v_mov_b32 v158, 0
    v_mov_b32 v159, 0
    v_mov_b32 v166, 0
    v_mov_b32 v167, 0
    v_mov_b32 v0, 0xffff
    v_mov_b32 v1, 0xffff0000
    v_cndmask_b32 v2, v255, v0, s[12:13]
    v_cndmask_b32 v3, v255, v1, s[14:15]
    v_or_b32 v2, v2, v3
    v_accvgpr_write_b32 a100, v2
    v_cndmask_b32 v2, v255, v0, s[16:17]
    v_cndmask_b32 v3, v255, v1, s[18:19]
    v_or_b32 v2, v2, v3
    v_accvgpr_write_b32 a101, v2
    v_cndmask_b32 v2, v255, v0, s[28:29]
    v_cndmask_b32 v3, v255, v1, s[30:31]
    v_or_b32 v2, v2, v3
    v_accvgpr_write_b32 a102, v2
    v_cndmask_b32 v2, v255, v0, s[32:33]
    v_cndmask_b32 v3, v255, v1, s[34:35]
    v_or_b32 v2, v2, v3
    v_accvgpr_write_b32 a103, v2
    v_cndmask_b32 v2, v255, v0, s[36:37]
    v_cndmask_b32 v3, v255, v1, s[38:39]
    v_or_b32 v2, v2, v3
    v_accvgpr_write_b32 a104, v2
    v_cndmask_b32 v2, v255, v0, s[40:41]
    v_cndmask_b32 v3, v255, v1, s[42:43]
    v_or_b32 v2, v2, v3
    v_accvgpr_write_b32 a105, v2
    v_cndmask_b32 v2, v255, v0, s[44:45]
    v_cndmask_b32 v3, v255, v1, s[46:47]
    v_or_b32 v2, v2, v3
    v_accvgpr_write_b32 a106, v2
    v_cndmask_b32 v2, v255, v0, s[48:49]
    v_cndmask_b32 v3, v255, v1, s[50:51]
    v_or_b32 v2, v2, v3
    v_accvgpr_write_b32 a107, v2
    s_waitcnt lgkmcnt(0) vmcnt(0)
    s_barrier
    s_cmp_lg_u32 s25, 0
    s_cbranch_scc1 FL17
    s_add_u32 s83, s98, 2
    v_mov_b32 v246, s83
    v_mov_b32 v247, 0
    s_mov_b64 exec, 1
    buffer_store_dword v246, v247, s[20:23], s89 offen offset:0 sc1
    s_mov_b64 exec, -1
FL17:
    s_cmp_lt_u32 s27, 2
    s_cbranch_scc1 ATT_SLOW
    s_mul_i32 s54, s25, 15360
    s_add_u32 s54, s54, 98304
    ds_read_b64 v[144:145], v243 offset:27648
    ds_read_b64 v[146:147], v243 offset:27936
    ds_read_b64 v[148:149], v250 offset:28800
    ds_read_b64 v[152:153], v243 offset:0
    ds_read_b64 v[154:155], v243 offset:288
    ds_read_b64 v[156:157], v250 offset:1152
    s_waitcnt lgkmcnt(3)
    v_mfma_f32_32x32x16_bf16 v[128:143], v[144:147], v[226:229], 0
    v_mfma_f32_32x32x16_bf16 v[128:143], v[148:151], v[230:233], v[128:143]
    ds_read_b64 v[160:161], v243 offset:3456
    ds_read_b64 v[162:163], v243 offset:3744
    ds_read_b64 v[164:165], v250 offset:4608
    s_waitcnt lgkmcnt(3)
    v_mfma_f32_32x32x16_bf16 v[0:15], v[152:155], v[226:229], 0
    v_mfma_f32_32x32x16_bf16 v[0:15], v[156:159], v[230:233], v[0:15]
    ds_read_b64 v[144:145], v243 offset:6912
    ds_read_b64 v[146:147], v243 offset:7200
    ds_read_b64 v[148:149], v250 offset:8064
    s_add_u32 s67, s57, 143360
    buffer_load_dwordx4 a[0:3], v242, s[20:23], s67 offen offset:0 sc1
    s_waitcnt lgkmcnt(3)
    v_mfma_f32_32x32x16_bf16 v[16:31], v[160:163], v[226:229], 0
    v_mfma_f32_32x32x16_bf16 v[16:31], v[164:167], v[230:233], v[16:31]
    ds_read_b64 v[152:153], v243 offset:10368
    ds_read_b64 v[154:155], v243 offset:10656
    ds_read_b64 v[156:157], v250 offset:11520
    s_waitcnt lgkmcnt(3)
    v_mfma_f32_32x32x16_bf16 v[32:47], v[144:147], v[226:229], 0
    v_mfma_f32_32x32x16_bf16 v[32:47], v[148:151], v[230:233], v[32:47]
    ds_read_b64 v[160:161], v243 offset:13824
    ds_read_b64 v[162:163], v243 offset:14112
    ds_read_b64 v[164:165], v250 offset:14976
    buffer_load_dwordx4 a[4:7], v242, s[20:23], s67 offen offset:1024 sc1
    v_cndmask_b32 v0, v128, v0, s[12:13]
    v_cndmask_b32 v1, v129, v1, s[14:15]
    v_cndmask_b32 v2, v130, v2, s[16:17]
    v_cndmask_b32 v3, v131, v3, s[18:19]
    v_cndmask_b32 v4, v132, v4, s[28:29]
    v_cndmask_b32 v5, v133, v5, s[30:31]
    v_cndmask_b32 v6, v134, v6, s[32:33]
    v_cndmask_b32 v7, v135, v7, s[34:35]
    v_cndmask_b32 v8, v136, v8, s[36:37]
    v_cndmask_b32 v9, v137, v9, s[38:39]
    v_cndmask_b32 v10, v138, v10, s[40:41]
    v_cndmask_b32 v11, v139, v11, s[42:43]
    v_cndmask_b32 v12, v140, v12, s[44:45]
    v_cndmask_b32 v13, v141, v13, s[46:47]
    v_cndmask_b32 v14, v142, v14, s[48:49]
    v_cndmask_b32 v15, v143, v15, s[50:51]
    v_max_f32 v246, v0, v1
    v_max_f32 v247, v2, v3
    v_max3_f32 v246, v4, v5, v246
    v_max3_f32 v247, v6, v7, v247
    v_max3_f32 v246, v8, v9, v246
    v_max3_f32 v247, v10, v11, v247
    v_max3_f32 v246, v12, v13, v246
    v_max3_f32 v247, v14, v15, v247
    s_waitcnt lgkmcnt(3)
    v_mfma_f32_32x32x16_bf16 v[48:63], v[152:155], v[226:229], 0
    v_mfma_f32_32x32x16_bf16 v[48:63], v[156:159], v[230:233], v[48:63]
    ds_read_b64 v[144:145], v243 offset:17280
    ds_read_b64 v[146:147], v243 offset:17568
    ds_read_b64 v[148:149], v250 offset:18432
    v_max3_f32 v246, v16, v17, v246
    v_max3_f32 v247, v18, v19, v247
    v_max3_f32 v246, v20, v21, v246
    v_max3_f32 v247, v22, v23, v247
    v_max3_f32 v246, v24, v25, v246
    v_max3_f32 v247, v26, v27, v247
    v_max3_f32 v246, v28, v29, v246
    v_max3_f32 v247, v30, v31, v247
    s_waitcnt lgkmcnt(3)
    v_mfma_f32_32x32x16_bf16 v[64:79], v[160:163], v[226:229], 0
    v_mfma_f32_32x32x16_bf16 v[64:79], v[164:167], v[230:233], v[64:79]
    ds_read_b64 v[152:153], v243 offset:20736
    ds_read_b64 v[154:155], v243 offset:21024
    ds_read_b64 v[156:157], v250 offset:21888
    buffer_load_dwordx4 a[8:11], v242, s[20:23], s67 offen offset:2048 sc1
    v_max3_f32 v246, v32, v33, v246
    v_max3_f32 v247, v34, v35, v247
    v_max3_f32 v246, v36, v37, v246
    v_max3_f32 v247, v38, v39, v247
    v_max3_f32 v246, v40, v41, v246
    v_max3_f32 v247, v42, v43, v247
    v_max3_f32 v246, v44, v45, v246
    v_max3_f32 v247, v46, v47, v247
    s_waitcnt lgkmcnt(3)
    v_mfma_f32_32x32x16_bf16 v[80:95], v[144:147], v[226:229], 0
    v_mfma_f32_32x32x16_bf16 v[80:95], v[148:151], v[230:233], v[80:95]
    ds_read_b64 v[160:161], v243 offset:24192
    ds_read_b64 v[162:163], v243 offset:24480
    ds_read_b64 v[164:165], v250 offset:25344
    v_max3_f32 v246, v48, v49, v246
    v_max3_f32 v247, v50, v51, v247
    v_max3_f32 v246, v52, v53, v246
    v_max3_f32 v247, v54, v55, v247
    v_max3_f32 v246, v56, v57, v246
    v_max3_f32 v247, v58, v59, v247
    v_max3_f32 v246, v60, v61, v246
    v_max3_f32 v247, v62, v63, v247
    s_waitcnt lgkmcnt(3)
    v_mfma_f32_32x32x16_bf16 v[96:111], v[152:155], v[226:229], 0
    v_mfma_f32_32x32x16_bf16 v[96:111], v[156:159], v[230:233], v[96:111]
    buffer_load_dwordx4 a[12:15], v242, s[20:23], s67 offen offset:3072 sc1
    v_max3_f32 v246, v64, v65, v246
    v_max3_f32 v247, v66, v67, v247
    v_max3_f32 v246, v68, v69, v246
    v_max3_f32 v247, v70, v71, v247
    v_max3_f32 v246, v72, v73, v246
    v_max3_f32 v247, v74, v75, v247
    v_max3_f32 v246, v76, v77, v246
    v_max3_f32 v247, v78, v79, v247
    s_waitcnt lgkmcnt(0)
    v_mfma_f32_32x32x16_bf16 v[112:127], v[160:163], v[226:229], 0
    v_mfma_f32_32x32x16_bf16 v[112:127], v[164:167], v[230:233], v[112:127]
    v_max3_f32 v246, v80, v81, v246
    v_max3_f32 v247, v82, v83, v247
    v_max3_f32 v246, v84, v85, v246
    v_max3_f32 v247, v86, v87, v247
    v_max3_f32 v246, v88, v89, v246
    v_max3_f32 v247, v90, v91, v247
    v_max3_f32 v246, v92, v93, v246
    v_max3_f32 v247, v94, v95, v247
    ds_read_b64_tr_b16 v[128:129], v244 offset:29952
    ds_read_b64_tr_b16 v[130:131], v244 offset:30016
    ds_read_b64_tr_b16 v[132:133], v244 offset:30080
    ds_read_b64_tr_b16 v[134:135], v244 offset:30144
    ds_read_b64_tr_b16 v[184:185], v244 offset:0
    ds_read_b64_tr_b16 v[186:187], v244 offset:64
    ds_read_b64_tr_b16 v[188:189], v244 offset:128
    ds_read_b64_tr_b16 v[190:191], v244 offset:192
    v_max3_f32 v246, v96, v97, v246
    v_max3_f32 v247, v98, v99, v247
    v_max3_f32 v246, v100, v101, v246
    v_max3_f32 v247, v102, v103, v247
    v_max3_f32 v246, v104, v105, v246
    v_max3_f32 v247, v106, v107, v247
    v_max3_f32 v246, v108, v109, v246
    v_max3_f32 v247, v110, v111, v247
    v_max3_f32 v246, v112, v113, v246
    v_max3_f32 v247, v114, v115, v247
    v_max3_f32 v246, v116, v117, v246
    v_max3_f32 v247, v118, v119, v247
    v_max3_f32 v246, v120, v121, v246
    v_max3_f32 v247, v122, v123, v247
    v_max3_f32 v246, v124, v125, v246
    v_max3_f32 v247, v126, v127, v247
    v_max_f32 v246, v246, v247
    v_mov_b32 v247, v246
    s_nop 1
    v_permlane32_swap_b32 v246, v247
    s_nop 1
    v_max_f32 v246, v246, v247
    v_and_b32 v247, 0xffff0000, v246
    v_sub_f32 v246, v246, v247
    v_and_b32 v248, 0xffff0000, v246
    v_sub_f32 v246, v246, v248
    v_cvt_pk_bf16_f32 v247, -v247, -v248
    v_cvt_pk_bf16_f32 v248, -v246, v255
    v_cndmask_b32 v216, v255, v247, s[58:59]
    v_cndmask_b32 v217, v255, v248, s[58:59]
    s_nop 1
    v_mfma_f32_32x32x16_bf16 v[0:15], v[222:225], v[216:219], v[0:15]
    v_mfma_f32_32x32x16_bf16 v[16:31], v[222:225], v[216:219], v[16:31]
    v_lshrrev_b32 v220, 4, v242
    s_lshl_b32 s60, s24, 1
    s_bfe_u32 s62, s26, 0x10001
    s_add_u32 s62, s62, s60
    v_lshrrev_b32 v254, 4, v220
    v_sub_u32 v252, s62, v254
    v_cmp_gt_u32 vcc, 1, v254
    v_cmp_le_i32 s[94:95], 0, v252
    v_and_b32 v254, 15, v220
    s_and_b64 s[94:95], vcc, s[94:95]
    v_cmp_gt_u32 vcc, 14, v254
    v_lshlrev_b32 v252, 12, v252
    v_lshl_add_u32 v252, v254, 2, v252
    s_and_b64 vcc, vcc, s[94:95]
    v_add_u32 v252, s81, v252
    v_mov_b32 v253, -1
    v_mov_b32 v254, 0x7ff00000
    v_cndmask_b32 v253, v253, 1, vcc
    v_cndmask_b32 v252, v254, v252, vcc
    ds_read_b64 v[144:145], v243 offset:29376
    ds_read_b64 v[146:147], v243 offset:29664
    ds_read_b64 v[148:149], v250 offset:29088
    ds_read_b64 v[152:153], v243 offset:1728
    ds_read_b64 v[154:155], v243 offset:2016
    ds_read_b64 v[156:157], v250 offset:1440
    ds_read_b64 v[160:161], v243 offset:5184
    ds_read_b64 v[162:163], v243 offset:5472
    ds_read_b64 v[164:165], v250 offset:4896
    v_exp_f32 v0, v0
    v_exp_f32 v1, v1
    v_mfma_f32_32x32x16_bf16 v[32:47], v[222:225], v[216:219], v[32:47]
    v_exp_f32 v2, v2
    v_exp_f32 v3, v3
    s_add_u32 s67, s57, 147456
    buffer_load_dwordx4 a[16:19], v242, s[20:23], s67 offen offset:0 sc1
    v_cvt_pk_bf16_f32 v168, v0, v1
    v_exp_f32 v4, v4
    v_exp_f32 v5, v5
    v_cvt_pk_bf16_f32 v169, v2, v3
    v_exp_f32 v6, v6
    s_add_u32 s67, s57, 163840
    buffer_load_dwordx4 a[20:23], v242, s[20:23], s67 offen offset:0 sc1
    v_exp_f32 v7, v7
    v_cvt_pk_bf16_f32 v170, v4, v5
    v_exp_f32 v8, v8
    buffer_load_dwordx4 a[24:27], v242, s[20:23], s67 offen offset:1024 sc1
    v_exp_f32 v9, v9
    v_cvt_pk_bf16_f32 v171, v6, v7
    v_exp_f32 v10, v10
    ds_read_b64_tr_b16 v[192:193], v244 offset:3744
    ds_read_b64_tr_b16 v[194:195], v244 offset:3808
    ds_read_b64_tr_b16 v[196:197], v244 offset:3872
    ds_read_b64_tr_b16 v[198:199], v244 offset:3936
    v_exp_f32 v11, v11
    buffer_load_dwordx4 a[28:31], v242, s[20:23], s67 offen offset:2048 sc1
    v_cvt_pk_bf16_f32 v172, v8, v9
    v_exp_f32 v12, v12
    v_exp_f32 v13, v13
    buffer_load_dwordx4 a[32:35], v242, s[20:23], s67 offen offset:3072 sc1
    v_cvt_pk_bf16_f32 v173, v10, v11
    v_exp_f32 v14, v14
    v_exp_f32 v15, v15
    v_cvt_pk_bf16_f32 v174, v12, v13
    v_cvt_pk_bf16_f32 v175, v14, v15
    v_accvgpr_read_b32 v220, a100
    v_bfi_b32 v136, v220, v255, v168
    v_and_b32 v168, v220, v168
    v_accvgpr_read_b32 v220, a101
    v_bfi_b32 v137, v220, v255, v169
    v_and_b32 v169, v220, v169
    v_accvgpr_read_b32 v220, a102
    v_bfi_b32 v138, v220, v255, v170
    v_and_b32 v170, v220, v170
    v_accvgpr_read_b32 v220, a103
    v_bfi_b32 v139, v220, v255, v171
    v_and_b32 v171, v220, v171
    v_accvgpr_read_b32 v220, a104
    v_bfi_b32 v140, v220, v255, v172
    v_and_b32 v172, v220, v172
    v_accvgpr_read_b32 v220, a105
    v_bfi_b32 v141, v220, v255, v173
    v_and_b32 v173, v220, v173
    v_accvgpr_read_b32 v220, a106
    v_bfi_b32 v142, v220, v255, v174
    v_and_b32 v174, v220, v174
    v_accvgpr_read_b32 v220, a107
    v_bfi_b32 v143, v220, v255, v175
    v_and_b32 v175, v220, v175
    v_exp_f32 v16, v16
    v_exp_f32 v17, v17
    v_mfma_f32_32x32x16_bf16 v[48:63], v[222:225], v[216:219], v[48:63]
    v_exp_f32 v18, v18
    s_waitcnt lgkmcnt(0)
    v_mfma_f32_32x32x16_bf16 v[200:215], v[128:131], v[136:139], 0
    v_exp_f32 v19, v19
    s_add_u32 s67, s57, 167936
    buffer_load_dwordx4 a[36:39], v242, s[20:23], s67 offen offset:0 sc1
    v_cvt_pk_bf16_f32 v176, v16, v17
    v_exp_f32 v20, v20
    v_mfma_f32_32x32x16_bf16 v[200:215], v[132:135], v[140:143], v[200:215]
    v_exp_f32 v21, v21
    v_cvt_pk_bf16_f32 v177, v18, v19
    v_exp_f32 v22, v22
    v_mfma_f32_32x32x16_bf16 v[200:215], v[184:187], v[168:171], v[200:215]
    s_add_u32 s67, s57, 184320
    buffer_load_dwordx4 a[40:43], v242, s[20:23], s67 offen offset:0 sc1
    v_exp_f32 v23, v23
    v_cvt_pk_bf16_f32 v178, v20, v21
    v_exp_f32 v24, v24
    buffer_load_dwordx4 a[44:47], v242, s[20:23], s67 offen offset:1024 sc1
    v_exp_f32 v25, v25
    v_mfma_f32_32x32x16_bf16 v[200:215], v[188:191], v[172:175], v[200:215]
    v_cvt_pk_bf16_f32 v179, v22, v23
    v_exp_f32 v26, v26
    ds_read_b64_tr_b16 v[184:185], v244 offset:7488
    ds_read_b64_tr_b16 v[186:187], v244 offset:7552
    ds_read_b64_tr_b16 v[188:189], v244 offset:7616
    ds_read_b64_tr_b16 v[190:191], v244 offset:7680
    v_exp_f32 v27, v27
    buffer_load_dwordx4 a[48:51], v242, s[20:23], s67 offen offset:2048 sc1
    v_cvt_pk_bf16_f32 v180, v24, v25
    v_exp_f32 v28, v28
    v_exp_f32 v29, v29
    buffer_load_dwordx4 a[52:55], v242, s[20:23], s67 offen offset:3072 sc1
    v_cvt_pk_bf16_f32 v181, v26, v27
    v_exp_f32 v30, v30
    v_exp_f32 v31, v31
    v_cvt_pk_bf16_f32 v182, v28, v29
    v_cvt_pk_bf16_f32 v183, v30, v31
    v_exp_f32 v32, v32
    v_mfma_f32_32x32x16_bf16 v[128:143], v[144:147], v[234:237], 0
    v_exp_f32 v33, v33
    v_mfma_f32_32x32x16_bf16 v[64:79], v[222:225], v[216:219], v[64:79]
    v_exp_f32 v34, v34
    v_exp_f32 v35, v35
    v_mfma_f32_32x32x16_bf16 v[128:143], v[148:151], v[238:241], v[128:143]
    s_add_u32 s67, s57, 188416
    buffer_load_dwordx4 a[56:59], v242, s[20:23], s67 offen offset:0 sc1
    v_cvt_pk_bf16_f32 v168, v32, v33
    v_exp_f32 v36, v36
    s_waitcnt lgkmcnt(0)
    v_exp_f32 v37, v37
    v_cvt_pk_bf16_f32 v169, v34, v35
    v_exp_f32 v38, v38
    v_mfma_f32_32x32x16_bf16 v[200:215], v[192:195], v[176:179], v[200:215]
    s_add_u32 s67, s57, 204800
    buffer_load_dwordx4 a[60:63], v242, s[20:23], s67 offen offset:0 sc1
    v_exp_f32 v39, v39
    v_cvt_pk_bf16_f32 v170, v36, v37
    v_exp_f32 v40, v40
    buffer_load_dwordx4 a[64:67], v242, s[20:23], s67 offen offset:1024 sc1
    v_exp_f32 v41, v41
    v_mfma_f32_32x32x16_bf16 v[200:215], v[196:199], v[180:183], v[200:215]
    v_cvt_pk_bf16_f32 v171, v38, v39
    v_exp_f32 v42, v42
    ds_read_b64_tr_b16 v[192:193], v244 offset:11232
    ds_read_b64_tr_b16 v[194:195], v244 offset:11296
    ds_read_b64_tr_b16 v[196:197], v244 offset:11360
    ds_read_b64_tr_b16 v[198:199], v244 offset:11424
    v_exp_f32 v43, v43
    buffer_load_dwordx4 a[68:71], v242, s[20:23], s67 offen offset:2048 sc1
    v_cvt_pk_bf16_f32 v172, v40, v41
    v_exp_f32 v44, v44
    v_mfma_f32_32x32x16_bf16 v[0:15], v[152:155], v[234:237], 0
    v_exp_f32 v45, v45
    buffer_load_dwordx4 a[72:75], v242, s[20:23], s67 offen offset:3072 sc1
    v_cvt_pk_bf16_f32 v173, v42, v43
    v_exp_f32 v46, v46
    v_mfma_f32_32x32x16_bf16 v[0:15], v[156:159], v[238:241], v[0:15]
    v_exp_f32 v47, v47
    ds_read_b64 v[144:145], v243 offset:8640
    ds_read_b64 v[146:147], v243 offset:8928
    ds_read_b64 v[148:149], v250 offset:8352
    v_cvt_pk_bf16_f32 v174, v44, v45
    v_cvt_pk_bf16_f32 v175, v46, v47
    v_exp_f32 v48, v48
    v_exp_f32 v49, v49
    v_mfma_f32_32x32x16_bf16 v[80:95], v[222:225], v[216:219], v[80:95]
    v_exp_f32 v50, v50
    v_exp_f32 v51, v51
    s_add_u32 s67, s57, 208896
    buffer_load_dwordx4 a[76:79], v242, s[20:23], s67 offen offset:0 sc1
    v_cvt_pk_bf16_f32 v176, v48, v49
    v_exp_f32 v52, v52
    s_waitcnt lgkmcnt(0)
    v_cndmask_b32 v0, v128, v0, s[12:13]
    v_cndmask_b32 v1, v129, v1, s[14:15]
    v_exp_f32 v53, v53
    v_cvt_pk_bf16_f32 v177, v50, v51
    v_cndmask_b32 v2, v130, v2, s[16:17]
    v_cndmask_b32 v3, v131, v3, s[18:19]
    v_exp_f32 v54, v54
    v_mfma_f32_32x32x16_bf16 v[200:215], v[184:187], v[168:171], v[200:215]
    s_add_u32 s67, s57, 225280
    buffer_load_dwordx4 a[80:83], v242, s[20:23], s67 offen offset:0 sc1
    v_cndmask_b32 v4, v132, v4, s[28:29]
    v_cndmask_b32 v5, v133, v5, s[30:31]
    v_exp_f32 v55, v55
    v_cvt_pk_bf16_f32 v178, v52, v53
    v_cndmask_b32 v6, v134, v6, s[32:33]
    v_cndmask_b32 v7, v135, v7, s[34:35]
    v_exp_f32 v56, v56
    buffer_load_dwordx4 a[84:87], v242, s[20:23], s67 offen offset:1024 sc1
    v_cndmask_b32 v8, v136, v8, s[36:37]
    v_cndmask_b32 v9, v137, v9, s[38:39]
    v_exp_f32 v57, v57
    v_mfma_f32_32x32x16_bf16 v[200:215], v[188:191], v[172:175], v[200:215]
    v_cvt_pk_bf16_f32 v179, v54, v55
    v_cndmask_b32 v10, v138, v10, s[40:41]
    v_cndmask_b32 v11, v139, v11, s[42:43]
    v_exp_f32 v58, v58
    ds_read_b64_tr_b16 v[184:185], v244 offset:14976
    ds_read_b64_tr_b16 v[186:187], v244 offset:15040
    ds_read_b64_tr_b16 v[188:189], v244 offset:15104
    ds_read_b64_tr_b16 v[190:191], v244 offset:15168
    v_cndmask_b32 v12, v140, v12, s[44:45]
    v_cndmask_b32 v13, v141, v13, s[46:47]
    v_exp_f32 v59, v59
    buffer_load_dwordx4 a[88:91], v242, s[20:23], s67 offen offset:2048 sc1
    v_cvt_pk_bf16_f32 v180, v56, v57
    v_cndmask_b32 v14, v142, v14, s[48:49]
    v_cndmask_b32 v15, v143, v15, s[50:51]
    v_exp_f32 v60, v60
    v_mfma_f32_32x32x16_bf16 v[16:31], v[160:163], v[234:237], 0
    v_max_f32 v246, v0, v1
    v_max_f32 v247, v2, v3
    v_exp_f32 v61, v61
    buffer_load_dwordx4 a[92:95], v242, s[20:23], s67 offen offset:3072 sc1
    v_cvt_pk_bf16_f32 v181, v58, v59
    v_max3_f32 v246, v4, v5, v246
    v_max3_f32 v247, v6, v7, v247
    v_exp_f32 v62, v62
    v_mfma_f32_32x32x16_bf16 v[16:31], v[164:167], v[238:241], v[16:31]
    v_max3_f32 v246, v8, v9, v246
    v_max3_f32 v247, v10, v11, v247
    v_exp_f32 v63, v63
    ds_read_b64 v[152:153], v243 offset:12096
    ds_read_b64 v[154:155], v243 offset:12384
    ds_read_b64 v[156:157], v250 offset:11808
    v_cvt_pk_bf16_f32 v182, v60, v61
    v_max3_f32 v246, v12, v13, v246
    v_max3_f32 v247, v14, v15, v247
    v_cvt_pk_bf16_f32 v183, v62, v63
    v_exp_f32 v64, v64
    v_exp_f32 v65, v65
    v_mfma_f32_32x32x16_bf16 v[96:111], v[222:225], v[216:219], v[96:111]
    v_exp_f32 v66, v66
    v_exp_f32 v67, v67
    s_add_u32 s67, s57, 229376
    buffer_load_dwordx4 a[96:99], v242, s[20:23], s67 offen offset:0 sc1
    v_cvt_pk_bf16_f32 v168, v64, v65
    v_exp_f32 v68, v68
    s_waitcnt lgkmcnt(0)
    v_max3_f32 v246, v16, v17, v246
    v_exp_f32 v69, v69
    v_cvt_pk_bf16_f32 v169, v66, v67
    v_max3_f32 v247, v18, v19, v247
    v_exp_f32 v70, v70
    v_mfma_f32_32x32x16_bf16 v[200:215], v[192:195], v[176:179], v[200:215]
    s_add_u32 m0, s54, 0
    s_add_u32 s67, s57, 245760
    buffer_load_dwordx4 v242, s[20:23], s67 offen offset:0 sc1 lds
    v_max3_f32 v246, v20, v21, v246
    v_exp_f32 v71, v71
    v_cvt_pk_bf16_f32 v170, v68, v69
    v_max3_f32 v247, v22, v23, v247
    v_exp_f32 v72, v72
    buffer_load_dwordx4 v242, s[20:23], s67 offen offset:1024 sc1 lds
    v_max3_f32 v246, v24, v25, v246
    v_exp_f32 v73, v73
    v_mfma_f32_32x32x16_bf16 v[200:215], v[196:199], v[180:183], v[200:215]
    v_cvt_pk_bf16_f32 v171, v70, v71
    v_max3_f32 v247, v26, v27, v247
    v_exp_f32 v74, v74
    ds_read_b64_tr_b16 v[192:193], v244 offset:18720
    ds_read_b64_tr_b16 v[194:195], v244 offset:18784
    ds_read_b64_tr_b16 v[196:197], v244 offset:18848
    ds_read_b64_tr_b16 v[198:199], v244 offset:18912
    v_max3_f32 v246, v28, v29, v246
    v_exp_f32 v75, v75
    buffer_load_dwordx4 v242, s[20:23], s67 offen offset:2048 sc1 lds
    v_cvt_pk_bf16_f32 v172, v72, v73
    v_max3_f32 v247, v30, v31, v247
    v_exp_f32 v76, v76
    v_mfma_f32_32x32x16_bf16 v[32:47], v[144:147], v[234:237], 0
    v_exp_f32 v77, v77
    buffer_load_dwordx4 v242, s[20:23], s67 offen offset:3072 sc1 lds
    v_cvt_pk_bf16_f32 v173, v74, v75
    v_exp_f32 v78, v78
    v_mfma_f32_32x32x16_bf16 v[32:47], v[148:151], v[238:241], v[32:47]
    v_exp_f32 v79, v79
    ds_read_b64 v[160:161], v243 offset:15552
    ds_read_b64 v[162:163], v243 offset:15840
    ds_read_b64 v[164:165], v250 offset:15264
    v_cvt_pk_bf16_f32 v174, v76, v77
    v_cvt_pk_bf16_f32 v175, v78, v79
    v_exp_f32 v80, v80
    v_exp_f32 v81, v81
    v_mfma_f32_32x32x16_bf16 v[112:127], v[222:225], v[216:219], v[112:127]
    v_exp_f32 v82, v82
    v_exp_f32 v83, v83
    s_add_u32 m0, s54, 4096
    s_add_u32 s67, s57, 249856
    buffer_load_dwordx4 v242, s[20:23], s67 offen offset:0 sc1 lds
    v_cvt_pk_bf16_f32 v176, v80, v81
    v_exp_f32 v84, v84
    s_waitcnt lgkmcnt(0)
    v_max3_f32 v246, v32, v33, v246
    v_exp_f32 v85, v85
    v_cvt_pk_bf16_f32 v177, v82, v83
    v_max3_f32 v247, v34, v35, v247
    v_exp_f32 v86, v86
    v_mfma_f32_32x32x16_bf16 v[200:215], v[184:187], v[168:171], v[200:215]
    s_add_u32 m0, s54, 5120
    s_add_u32 s67, s57, 266240
    buffer_load_dwordx4 v242, s[20:23], s67 offen offset:0 sc1 lds
    v_max3_f32 v246, v36, v37, v246
    v_exp_f32 v87, v87
    v_cvt_pk_bf16_f32 v178, v84, v85
    v_max3_f32 v247, v38, v39, v247
    v_exp_f32 v88, v88
    buffer_load_dwordx4 v242, s[20:23], s67 offen offset:1024 sc1 lds
    v_max3_f32 v246, v40, v41, v246
    v_exp_f32 v89, v89
    v_mfma_f32_32x32x16_bf16 v[200:215], v[188:191], v[172:175], v[200:215]
    v_cvt_pk_bf16_f32 v179, v86, v87
    v_max3_f32 v247, v42, v43, v247
    v_exp_f32 v90, v90
    ds_read_b64_tr_b16 v[184:185], v244 offset:22464
    ds_read_b64_tr_b16 v[186:187], v244 offset:22528
    ds_read_b64_tr_b16 v[188:189], v244 offset:22592
    ds_read_b64_tr_b16 v[190:191], v244 offset:22656
    v_max3_f32 v246, v44, v45, v246
    v_exp_f32 v91, v91
    buffer_load_dwordx4 v242, s[20:23], s67 offen offset:2048 sc1 lds
    v_cvt_pk_bf16_f32 v180, v88, v89
    v_max3_f32 v247, v46, v47, v247
    v_exp_f32 v92, v92
    v_mfma_f32_32x32x16_bf16 v[48:63], v[152:155], v[234:237], 0
    v_exp_f32 v93, v93
    buffer_load_dwordx4 v242, s[20:23], s67 offen offset:3072 sc1 lds
    v_cvt_pk_bf16_f32 v181, v90, v91
    v_exp_f32 v94, v94
    v_mfma_f32_32x32x16_bf16 v[48:63], v[156:159], v[238:241], v[48:63]
    v_exp_f32 v95, v95
    ds_read_b64 v[144:145], v243 offset:19008
    ds_read_b64 v[146:147], v243 offset:19296
    ds_read_b64 v[148:149], v250 offset:18720
    v_cvt_pk_bf16_f32 v182, v92, v93
    v_cvt_pk_bf16_f32 v183, v94, v95
    v_exp_f32 v96, v96
    v_exp_f32 v97, v97
    v_exp_f32 v98, v98
    v_exp_f32 v99, v99
    s_add_u32 m0, s54, 9216
    s_add_u32 s67, s57, 270336
    buffer_load_dwordx4 v242, s[20:23], s67 offen offset:0 sc1 lds
    v_cvt_pk_bf16_f32 v168, v96, v97
    v_exp_f32 v100, v100
    s_waitcnt lgkmcnt(0)
    v_max3_f32 v246, v48, v49, v246
    v_exp_f32 v101, v101
    v_cvt_pk_bf16_f32 v169, v98, v99
    v_max3_f32 v247, v50, v51, v247
    v_exp_f32 v102, v102
    v_mfma_f32_32x32x16_bf16 v[200:215], v[192:195], v[176:179], v[200:215]
    s_add_u32 m0, s54, 10240
    s_add_u32 s67, s57, 276480
    buffer_load_dwordx4 v242, s[20:23], s67 offen offset:0 sc1 lds
    v_max3_f32 v246, v52, v53, v246
    v_exp_f32 v103, v103
    v_cvt_pk_bf16_f32 v170, v100, v101
    v_max3_f32 v247, v54, v55, v247
    v_exp_f32 v104, v104
    buffer_load_dwordx4 v242, s[20:23], s67 offen offset:1024 sc1 lds
    v_max3_f32 v246, v56, v57, v246
    v_exp_f32 v105, v105
    v_mfma_f32_32x32x16_bf16 v[200:215], v[196:199], v[180:183], v[200:215]
    v_cvt_pk_bf16_f32 v171, v102, v103
    v_max3_f32 v247, v58, v59, v247
    v_exp_f32 v106, v106
    ds_read_b64_tr_b16 v[192:193], v244 offset:26208
    ds_read_b64_tr_b16 v[194:195], v244 offset:26272
    ds_read_b64_tr_b16 v[196:197], v244 offset:26336
    ds_read_b64_tr_b16 v[198:199], v244 offset:26400
    v_max3_f32 v246, v60, v61, v246
    v_exp_f32 v107, v107
    buffer_load_dwordx4 v242, s[20:23], s67 offen offset:2048 sc1 lds
    v_cvt_pk_bf16_f32 v172, v104, v105
    v_max3_f32 v247, v62, v63, v247
    v_exp_f32 v108, v108
    v_mfma_f32_32x32x16_bf16 v[64:79], v[160:163], v[234:237], 0
    v_exp_f32 v109, v109
    buffer_load_dwordx4 v242, s[20:23], s67 offen offset:3072 sc1 lds
    v_cvt_pk_bf16_f32 v173, v106, v107
    v_exp_f32 v110, v110
    v_mfma_f32_32x32x16_bf16 v[64:79], v[164:167], v[238:241], v[64:79]
    v_exp_f32 v111, v111
    ds_read_b64 v[152:153], v243 offset:22464
    ds_read_b64 v[154:155], v243 offset:22752
    ds_read_b64 v[156:157], v250 offset:22176
    v_cvt_pk_bf16_f32 v174, v108, v109
    v_cvt_pk_bf16_f32 v175, v110, v111
    v_exp_f32 v112, v112
    v_exp_f32 v113, v113
    v_exp_f32 v114, v114
    v_exp_f32 v115, v115
    s_add_u32 m0, s54, 14336
    s_add_u32 s67, s57, 280576
    buffer_load_dwordx4 v242, s[20:23], s67 offen offset:0 sc1 lds
    v_cvt_pk_bf16_f32 v176, v112, v113
    v_exp_f32 v116, v116
    s_waitcnt lgkmcnt(0)
    v_max3_f32 v246, v64, v65, v246
    v_exp_f32 v117, v117
    v_cvt_pk_bf16_f32 v177, v114, v115
    v_max3_f32 v247, v66, v67, v247
    v_exp_f32 v118, v118
    v_mfma_f32_32x32x16_bf16 v[200:215], v[184:187], v[168:171], v[200:215]
    v_max3_f32 v246, v68, v69, v246
    v_exp_f32 v119, v119
    v_cvt_pk_bf16_f32 v178, v116, v117
    v_max3_f32 v247, v70, v71, v247
    v_exp_f32 v120, v120
    v_max3_f32 v246, v72, v73, v246
    v_exp_f32 v121, v121
    v_mfma_f32_32x32x16_bf16 v[200:215], v[188:191], v[172:175], v[200:215]
    v_cvt_pk_bf16_f32 v179, v118, v119
    v_max3_f32 v247, v74, v75, v247
    v_exp_f32 v122, v122
    v_max3_f32 v246, v76, v77, v246
    v_exp_f32 v123, v123
    v_cvt_pk_bf16_f32 v180, v120, v121
    v_max3_f32 v247, v78, v79, v247
    v_exp_f32 v124, v124
    v_mfma_f32_32x32x16_bf16 v[80:95], v[144:147], v[234:237], 0
    v_exp_f32 v125, v125
    v_cvt_pk_bf16_f32 v181, v122, v123
    v_exp_f32 v126, v126
    v_mfma_f32_32x32x16_bf16 v[80:95], v[148:151], v[238:241], v[80:95]
    v_exp_f32 v127, v127
    ds_read_b64 v[160:161], v243 offset:25920
    ds_read_b64 v[162:163], v243 offset:26208
    ds_read_b64 v[164:165], v250 offset:25632
    v_cvt_pk_bf16_f32 v182, v124, v125
    v_cvt_pk_bf16_f32 v183, v126, v127
    s_waitcnt lgkmcnt(0)
    s_nop 0
    v_mfma_f32_32x32x16_bf16 v[200:215], v[192:195], v[176:179], v[200:215]
    v_mfma_f32_32x32x16_bf16 v[200:215], v[196:199], v[180:183], v[200:215]
    v_mfma_f32_32x32x16_bf16 v[96:111], v[152:155], v[234:237], 0
    v_mfma_f32_32x32x16_bf16 v[96:111], v[156:159], v[238:241], v[96:111]
    v_mfma_f32_32x32x16_bf16 v[112:127], v[160:163], v[234:237], 0
    v_mfma_f32_32x32x16_bf16 v[112:127], v[164:167], v[238:241], v[112:127]
    v_max3_f32 v246, v80, v81, v246
    v_max3_f32 v247, v82, v83, v247
    v_max3_f32 v246, v84, v85, v246
    v_max3_f32 v247, v86, v87, v247
    v_max3_f32 v246, v88, v89, v246
    v_max3_f32 v247, v90, v91, v247
    v_max3_f32 v246, v92, v93, v246
    v_max3_f32 v247, v94, v95, v247
    s_nop 1
    ds_read_b64_tr_b16 v[128:129], v245 offset:29952
    ds_read_b64_tr_b16 v[130:131], v245 offset:30016
    ds_read_b64_tr_b16 v[132:133], v245 offset:30080
    ds_read_b64_tr_b16 v[134:135], v245 offset:30144
    ds_read_b64_tr_b16 v[184:185], v245 offset:0
    ds_read_b64_tr_b16 v[186:187], v245 offset:64
    ds_read_b64_tr_b16 v[188:189], v245 offset:128
    ds_read_b64_tr_b16 v[190:191], v245 offset:192
    v_max3_f32 v246, v96, v97, v246
    v_max3_f32 v247, v98, v99, v247
    v_max3_f32 v246, v100, v101, v246
    v_max3_f32 v247, v102, v103, v247
    v_max3_f32 v246, v104, v105, v246
    v_max3_f32 v247, v106, v107, v247
    v_max3_f32 v246, v108, v109, v246
    v_max3_f32 v247, v110, v111, v247
    v_max3_f32 v246, v112, v113, v246
    v_max3_f32 v247, v114, v115, v247
    v_max3_f32 v246, v116, v117, v246
    v_max3_f32 v247, v118, v119, v247
    v_max3_f32 v246, v120, v121, v246
    v_max3_f32 v247, v122, v123, v247
    v_max3_f32 v246, v124, v125, v246
    v_max3_f32 v247, v126, v127, v247
    v_max_f32 v246, v246, v247
    v_mov_b32 v247, v246
    s_nop 1
    v_permlane32_swap_b32 v246, v247
    s_nop 1
    v_max_f32 v246, v246, v247
    v_and_b32 v247, 0xffff0000, v246
    v_sub_f32 v246, v246, v247
    v_and_b32 v248, 0xffff0000, v246
    v_sub_f32 v246, v246, v248
    v_cvt_pk_bf16_f32 v247, -v247, -v248
    v_cvt_pk_bf16_f32 v248, -v246, v255
    v_cndmask_b32 v216, v255, v247, s[58:59]
    v_cndmask_b32 v217, v255, v248, s[58:59]
    s_nop 1
    v_mfma_f32_32x32x16_bf16 v[0:15], v[222:225], v[216:219], v[0:15]
    v_mfma_f32_32x32x16_bf16 v[16:31], v[222:225], v[216:219], v[16:31]
    v_mov_b32 v220, v208
    v_mov_b32 v221, v208
    s_lshr_b32 s60, s61, 1
    s_mul_i32 s60, s60, 5
    v_permlane32_swap_b32 v220, v221
    s_lshl_b32 s68, s66, 1
    s_add_u32 s68, s68, s60
    v_rcp_f32 v221, v221
    s_mul_i32 s69, s63, 151552
    s_add_u32 s69, s69, 8499200
    v_mul_f32 v200, v200, v221
    v_mul_f32 v201, v201, v221
    v_mul_f32 v202, v202, v221
    v_mul_f32 v203, v203, v221
    v_mul_f32 v204, v204, v221
    v_mul_f32 v205, v205, v221
    v_mul_f32 v206, v206, v221
    v_mul_f32 v207, v207, v221
    v_mul_f32 v208, v208, v221
    v_mul_f32 v209, v209, v221
    v_mul_f32 v210, v210, v221
    v_mul_f32 v211, v211, v221
    v_cvt_pk_bf16_f32 v212, v200, v201
    v_cvt_pk_bf16_f32 v213, v202, v203
    v_cvt_pk_bf16_f32 v214, v204, v205
    v_cvt_pk_bf16_f32 v215, v206, v207
    v_cvt_pk_bf16_f32 v226, v208, v209
    v_cvt_pk_bf16_f32 v227, v210, v211
    s_lshl_b32 s68, s68, 10
    s_add_u32 s68, s68, s69
    buffer_store_dwordx4 v[212:215], v242, s[20:23], s68 offen offset:0 sc1
    buffer_load_dword v251, v252, s[20:23], 0 offen sc1
    v_exp_f32 v0, v0
    v_exp_f32 v1, v1
    v_mfma_f32_32x32x16_bf16 v[32:47], v[222:225], v[216:219], v[32:47]
    v_exp_f32 v2, v2
    v_exp_f32 v3, v3
    v_cvt_pk_bf16_f32 v168, v0, v1
    v_exp_f32 v4, v4
    v_exp_f32 v5, v5
    v_cvt_pk_bf16_f32 v169, v2, v3
    v_exp_f32 v6, v6
    v_exp_f32 v7, v7
    v_cvt_pk_bf16_f32 v170, v4, v5
    v_exp_f32 v8, v8
    v_exp_f32 v9, v9
    v_cvt_pk_bf16_f32 v171, v6, v7
    v_exp_f32 v10, v10
    ds_read_b64_tr_b16 v[192:193], v245 offset:3744
    ds_read_b64_tr_b16 v[194:195], v245 offset:3808
    ds_read_b64_tr_b16 v[196:197], v245 offset:3872
    ds_read_b64_tr_b16 v[198:199], v245 offset:3936
    v_exp_f32 v11, v11
    v_cvt_pk_bf16_f32 v172, v8, v9
    v_exp_f32 v12, v12
    v_exp_f32 v13, v13
    v_cvt_pk_bf16_f32 v173, v10, v11
    v_exp_f32 v14, v14
    v_exp_f32 v15, v15
    v_cvt_pk_bf16_f32 v174, v12, v13
    v_cvt_pk_bf16_f32 v175, v14, v15
    v_accvgpr_read_b32 v220, a100
    v_bfi_b32 v136, v220, v255, v168
    v_and_b32 v168, v220, v168
    v_accvgpr_read_b32 v220, a101
    v_bfi_b32 v137, v220, v255, v169
    v_and_b32 v169, v220, v169
    v_accvgpr_read_b32 v220, a102
    v_bfi_b32 v138, v220, v255, v170
    v_and_b32 v170, v220, v170
    v_accvgpr_read_b32 v220, a103
    v_bfi_b32 v139, v220, v255, v171
    v_and_b32 v171, v220, v171
    v_accvgpr_read_b32 v220, a104
    v_bfi_b32 v140, v220, v255, v172
    v_and_b32 v172, v220, v172
    v_accvgpr_read_b32 v220, a105
    v_bfi_b32 v141, v220, v255, v173
    v_and_b32 v173, v220, v173
    v_accvgpr_read_b32 v220, a106
    v_bfi_b32 v142, v220, v255, v174
    v_and_b32 v174, v220, v174
    v_accvgpr_read_b32 v220, a107
    v_bfi_b32 v143, v220, v255, v175
    v_and_b32 v175, v220, v175
    v_exp_f32 v16, v16
    v_exp_f32 v17, v17
    v_mfma_f32_32x32x16_bf16 v[48:63], v[222:225], v[216:219], v[48:63]
    v_exp_f32 v18, v18
    s_waitcnt lgkmcnt(0)
    v_mfma_f32_32x32x16_bf16 v[200:215], v[128:131], v[136:139], 0
    v_exp_f32 v19, v19
    v_cvt_pk_bf16_f32 v176, v16, v17
    v_exp_f32 v20, v20
    v_mfma_f32_32x32x16_bf16 v[200:215], v[132:135], v[140:143], v[200:215]
    v_exp_f32 v21, v21
    v_cvt_pk_bf16_f32 v177, v18, v19
    v_exp_f32 v22, v22
    v_mfma_f32_32x32x16_bf16 v[200:215], v[184:187], v[168:171], v[200:215]
    v_exp_f32 v23, v23
    v_cvt_pk_bf16_f32 v178, v20, v21
    v_exp_f32 v24, v24
    v_exp_f32 v25, v25
    v_mfma_f32_32x32x16_bf16 v[200:215], v[188:191], v[172:175], v[200:215]
    v_cvt_pk_bf16_f32 v179, v22, v23
    v_exp_f32 v26, v26
    ds_read_b64_tr_b16 v[184:185], v245 offset:7488
    ds_read_b64_tr_b16 v[186:187], v245 offset:7552
    ds_read_b64_tr_b16 v[188:189], v245 offset:7616
    ds_read_b64_tr_b16 v[190:191], v245 offset:7680
    v_exp_f32 v27, v27
    v_cvt_pk_bf16_f32 v180, v24, v25
    v_exp_f32 v28, v28
    v_exp_f32 v29, v29
    v_cvt_pk_bf16_f32 v181, v26, v27
    v_exp_f32 v30, v30
    v_exp_f32 v31, v31
    v_cvt_pk_bf16_f32 v182, v28, v29
    v_cvt_pk_bf16_f32 v183, v30, v31
    v_exp_f32 v32, v32
    s_cmp_lg_u32 s25, 0
    s_cbranch_scc1 PD18
    s_waitcnt vmcnt(0)
    s_mov_b32 s88, 0
    s_add_u32 s83, s98, 2
PL18:
    v_subrev_u32 v251, s83, v251
    v_cmp_lt_u32 vcc, v253, v251
    s_cbranch_vccz PD18
    s_add_u32 s88, s88, 1
    s_cmp_gt_u32 s88, 0x40000
    s_cbranch_scc1 PD18
    s_sleep 4
    buffer_load_dword v251, v252, s[20:23], 0 offen sc1
    s_waitcnt vmcnt(0)
    s_branch PL18
PD18:
    s_barrier
    v_bfe_u32 v238, v242, 4, 4
    v_lshrrev_b32 v239, 8, v242
    v_lshlrev_b32 v238, 4, v238
    v_lshl_add_u32 v238, v239, 9, v238
    v_add_u32 v239, 151552, v238
    s_lshl_b32 s60, s24, 2
    s_and_b32 s52, s26, 3
    s_add_u32 s55, s60, s52
    s_mul_i32 s52, s55, 303104
    s_lshl_b32 s53, s25, 11
    s_add_u32 s52, s52, s53
    s_add_u32 s52, s52, 8388608
    v_exp_f32 v33, v33
    v_mfma_f32_32x32x16_bf16 v[64:79], v[222:225], v[216:219], v[64:79]
    v_exp_f32 v34, v34
    v_exp_f32 v35, v35
    v_cvt_pk_bf16_f32 v168, v32, v33
    v_exp_f32 v36, v36
    s_waitcnt lgkmcnt(0)
    v_exp_f32 v37, v37
    v_cvt_pk_bf16_f32 v169, v34, v35
    v_exp_f32 v38, v38
    v_mfma_f32_32x32x16_bf16 v[200:215], v[192:195], v[176:179], v[200:215]
    v_exp_f32 v39, v39
    v_cvt_pk_bf16_f32 v170, v36, v37
    v_exp_f32 v40, v40
    v_exp_f32 v41, v41
    v_mfma_f32_32x32x16_bf16 v[200:215], v[196:199], v[180:183], v[200:215]
    v_cvt_pk_bf16_f32 v171, v38, v39
    v_exp_f32 v42, v42
    ds_read_b64_tr_b16 v[192:193], v245 offset:11232
    ds_read_b64_tr_b16 v[194:195], v245 offset:11296
    ds_read_b64_tr_b16 v[196:197], v245 offset:11360
    ds_read_b64_tr_b16 v[198:199], v245 offset:11424
    v_exp_f32 v43, v43
    s_add_u32 s53, s52, 0
    buffer_load_dwordx4 v[0:3], v238, s[20:23], s53 offen offset:0 sc1
    buffer_load_dwordx4 v[4:7], v238, s[20:23], s53 offen offset:256 sc1
    buffer_load_dwordx4 v[8:11], v239, s[20:23], s53 offen offset:0 sc1
    buffer_load_dwordx4 v[12:15], v239, s[20:23], s53 offen offset:256 sc1
    v_cvt_pk_bf16_f32 v172, v40, v41
    v_exp_f32 v44, v44
    v_exp_f32 v45, v45
    v_cvt_pk_bf16_f32 v173, v42, v43
    v_exp_f32 v46, v46
    v_exp_f32 v47, v47
    v_cvt_pk_bf16_f32 v174, v44, v45
    v_cvt_pk_bf16_f32 v175, v46, v47
    v_exp_f32 v48, v48
    v_exp_f32 v49, v49
    v_mfma_f32_32x32x16_bf16 v[80:95], v[222:225], v[216:219], v[80:95]
    v_exp_f32 v50, v50
    v_exp_f32 v51, v51
    v_cvt_pk_bf16_f32 v176, v48, v49
    v_exp_f32 v52, v52
    s_waitcnt lgkmcnt(0)
    v_exp_f32 v53, v53
    v_cvt_pk_bf16_f32 v177, v50, v51
    v_exp_f32 v54, v54
    v_mfma_f32_32x32x16_bf16 v[200:215], v[184:187], v[168:171], v[200:215]
    v_exp_f32 v55, v55
    v_cvt_pk_bf16_f32 v178, v52, v53
    v_exp_f32 v56, v56
    v_exp_f32 v57, v57
    v_mfma_f32_32x32x16_bf16 v[200:215], v[188:191], v[172:175], v[200:215]
    v_cvt_pk_bf16_f32 v179, v54, v55
    v_exp_f32 v58, v58
    ds_read_b64_tr_b16 v[184:185], v245 offset:14976
    ds_read_b64_tr_b16 v[186:187], v245 offset:15040
    ds_read_b64_tr_b16 v[188:189], v245 offset:15104
    ds_read_b64_tr_b16 v[190:191], v245 offset:15168
    v_exp_f32 v59, v59
    s_add_u32 s53, s52, 8192
    buffer_load_dwordx4 v[16:19], v238, s[20:23], s53 offen offset:0 sc1
    buffer_load_dwordx4 v[20:23], v238, s[20:23], s53 offen offset:256 sc1
    buffer_load_dwordx4 v[24:27], v239, s[20:23], s53 offen offset:0 sc1
    buffer_load_dwordx4 v[28:31], v239, s[20:23], s53 offen offset:256 sc1
    v_cvt_pk_bf16_f32 v180, v56, v57
    v_exp_f32 v60, v60
    v_exp_f32 v61, v61
    v_cvt_pk_bf16_f32 v181, v58, v59
    v_exp_f32 v62, v62
    v_exp_f32 v63, v63
    v_cvt_pk_bf16_f32 v182, v60, v61
    v_cvt_pk_bf16_f32 v183, v62, v63
    v_exp_f32 v64, v64
    v_exp_f32 v65, v65
    v_mfma_f32_32x32x16_bf16 v[96:111], v[222:225], v[216:219], v[96:111]
    v_exp_f32 v66, v66
    v_exp_f32 v67, v67
    v_cvt_pk_bf16_f32 v168, v64, v65
    v_exp_f32 v68, v68
    s_waitcnt lgkmcnt(0)
    v_exp_f32 v69, v69
    v_cvt_pk_bf16_f32 v169, v66, v67
    v_exp_f32 v70, v70
    v_mfma_f32_32x32x16_bf16 v[200:215], v[192:195], v[176:179], v[200:215]
    v_exp_f32 v71, v71
    v_cvt_pk_bf16_f32 v170, v68, v69
    v_exp_f32 v72, v72
    v_exp_f32 v73, v73
    v_mfma_f32_32x32x16_bf16 v[200:215], v[196:199], v[180:183], v[200:215]
    v_cvt_pk_bf16_f32 v171, v70, v71
    v_exp_f32 v74, v74
    ds_read_b64_tr_b16 v[192:193], v245 offset:18720
    ds_read_b64_tr_b16 v[194:195], v245 offset:18784
    ds_read_b64_tr_b16 v[196:197], v245 offset:18848
    ds_read_b64_tr_b16 v[198:199], v245 offset:18912
    v_exp_f32 v75, v75
    s_add_u32 s53, s52, 16384
    buffer_load_dwordx4 v[32:35], v238, s[20:23], s53 offen offset:0 sc1
    buffer_load_dwordx4 v[36:39], v238, s[20:23], s53 offen offset:256 sc1
    buffer_load_dwordx4 v[40:43], v239, s[20:23], s53 offen offset:0 sc1
    buffer_load_dwordx4 v[44:47], v239, s[20:23], s53 offen offset:256 sc1
    v_cvt_pk_bf16_f32 v172, v72, v73
    v_exp_f32 v76, v76
    v_exp_f32 v77, v77
    v_cvt_pk_bf16_f32 v173, v74, v75
    v_exp_f32 v78, v78
    v_exp_f32 v79, v79
    v_cvt_pk_bf16_f32 v174, v76, v77
    v_cvt_pk_bf16_f32 v175, v78, v79
    v_exp_f32 v80, v80
    v_exp_f32 v81, v81
    v_mfma_f32_32x32x16_bf16 v[112:127], v[222:225], v[216:219], v[112:127]
    v_exp_f32 v82, v82
    v_exp_f32 v83, v83
    v_cvt_pk_bf16_f32 v176, v80, v81
    v_exp_f32 v84, v84
    s_waitcnt lgkmcnt(0)
    v_exp_f32 v85, v85
    v_cvt_pk_bf16_f32 v177, v82, v83
    v_exp_f32 v86, v86
    v_mfma_f32_32x32x16_bf16 v[200:215], v[184:187], v[168:171], v[200:215]
    v_exp_f32 v87, v87
    v_cvt_pk_bf16_f32 v178, v84, v85
    v_exp_f32 v88, v88
    v_exp_f32 v89, v89
    v_mfma_f32_32x32x16_bf16 v[200:215], v[188:191], v[172:175], v[200:215]
    v_cvt_pk_bf16_f32 v179, v86, v87
    v_exp_f32 v90, v90
    ds_read_b64_tr_b16 v[184:185], v245 offset:22464
    ds_read_b64_tr_b16 v[186:187], v245 offset:22528
    ds_read_b64_tr_b16 v[188:189], v245 offset:22592
    ds_read_b64_tr_b16 v[190:191], v245 offset:22656
    v_exp_f32 v91, v91
    s_add_u32 s53, s52, 24576
    buffer_load_dwordx4 v[48:51], v238, s[20:23], s53 offen offset:0 sc1
    buffer_load_dwordx4 v[52:55], v238, s[20:23], s53 offen offset:256 sc1
    buffer_load_dwordx4 v[56:59], v239, s[20:23], s53 offen offset:0 sc1
    buffer_load_dwordx4 v[60:63], v239, s[20:23], s53 offen offset:256 sc1
    v_cvt_pk_bf16_f32 v180, v88, v89
    v_exp_f32 v92, v92
    v_exp_f32 v93, v93
    v_cvt_pk_bf16_f32 v181, v90, v91
    v_exp_f32 v94, v94
    v_exp_f32 v95, v95
    v_cvt_pk_bf16_f32 v182, v92, v93
    v_cvt_pk_bf16_f32 v183, v94, v95
    v_exp_f32 v96, v96
    v_exp_f32 v97, v97
    v_exp_f32 v98, v98
    v_exp_f32 v99, v99
    v_cvt_pk_bf16_f32 v168, v96, v97
    v_exp_f32 v100, v100
    s_waitcnt lgkmcnt(0)
    v_exp_f32 v101, v101
    v_cvt_pk_bf16_f32 v169, v98, v99
    v_exp_f32 v102, v102
    v_mfma_f32_32x32x16_bf16 v[200:215], v[192:195], v[176:179], v[200:215]
    v_exp_f32 v103, v103
    v_cvt_pk_bf16_f32 v170, v100, v101
    v_exp_f32 v104, v104
    v_exp_f32 v105, v105
    v_mfma_f32_32x32x16_bf16 v[200:215], v[196:199], v[180:183], v[200:215]
    v_cvt_pk_bf16_f32 v171, v102, v103
    v_exp_f32 v106, v106
    ds_read_b64_tr_b16 v[192:193], v245 offset:26208
    ds_read_b64_tr_b16 v[194:195], v245 offset:26272
    ds_read_b64_tr_b16 v[196:197], v245 offset:26336
    ds_read_b64_tr_b16 v[198:199], v245 offset:26400
    v_exp_f32 v107, v107
    s_add_u32 s53, s52, 32768
    buffer_load_dwordx4 v[64:67], v238, s[20:23], s53 offen offset:0 sc1
    buffer_load_dwordx4 v[68:71], v238, s[20:23], s53 offen offset:256 sc1
    buffer_load_dwordx4 v[72:75], v239, s[20:23], s53 offen offset:0 sc1
    buffer_load_dwordx4 v[76:79], v239, s[20:23], s53 offen offset:256 sc1
    v_cvt_pk_bf16_f32 v172, v104, v105
    v_exp_f32 v108, v108
    v_exp_f32 v109, v109
    v_cvt_pk_bf16_f32 v173, v106, v107
    v_exp_f32 v110, v110
    v_exp_f32 v111, v111
    v_cvt_pk_bf16_f32 v174, v108, v109
    v_cvt_pk_bf16_f32 v175, v110, v111
    v_exp_f32 v112, v112
    v_exp_f32 v113, v113
    v_exp_f32 v114, v114
    v_exp_f32 v115, v115
    v_cvt_pk_bf16_f32 v176, v112, v113
    v_exp_f32 v116, v116
    s_waitcnt lgkmcnt(0)
    v_exp_f32 v117, v117
    v_cvt_pk_bf16_f32 v177, v114, v115
    v_exp_f32 v118, v118
    v_mfma_f32_32x32x16_bf16 v[200:215], v[184:187], v[168:171], v[200:215]
    v_exp_f32 v119, v119
    v_cvt_pk_bf16_f32 v178, v116, v117
    v_exp_f32 v120, v120
    v_exp_f32 v121, v121
    v_mfma_f32_32x32x16_bf16 v[200:215], v[188:191], v[172:175], v[200:215]
    v_cvt_pk_bf16_f32 v179, v118, v119
    v_exp_f32 v122, v122
    v_exp_f32 v123, v123
    s_add_u32 s53, s52, 40960
    buffer_load_dwordx4 v[80:83], v238, s[20:23], s53 offen offset:0 sc1
    buffer_load_dwordx4 v[84:87], v238, s[20:23], s53 offen offset:256 sc1
    buffer_load_dwordx4 v[88:91], v239, s[20:23], s53 offen offset:0 sc1
    buffer_load_dwordx4 v[92:95], v239, s[20:23], s53 offen offset:256 sc1
    v_cvt_pk_bf16_f32 v180, v120, v121
    v_exp_f32 v124, v124
    v_exp_f32 v125, v125
    v_cvt_pk_bf16_f32 v181, v122, v123
    v_exp_f32 v126, v126
    v_exp_f32 v127, v127
    v_cvt_pk_bf16_f32 v182, v124, v125
    v_cvt_pk_bf16_f32 v183, v126, v127
    s_waitcnt lgkmcnt(0)
    s_nop 0
    v_mfma_f32_32x32x16_bf16 v[200:215], v[192:195], v[176:179], v[200:215]
    v_mfma_f32_32x32x16_bf16 v[200:215], v[196:199], v[180:183], v[200:215]
    v_lshrrev_b32 v224, 4, v242
    s_lshr_b32 s62, s55, 1
    v_lshrrev_b32 v230, 2, v224
    v_and_b32 v231, 3, v224
    s_lshl_b32 s64, s55, 2
    s_add_u32 s64, s64, s25
    s_mul_i32 s64, s64, 20480
    s_mul_i32 s65, s56, 160
    s_add_u32 s64, s64, s65
    v_mul_u32_u24 v232, 1280, v230
    v_lshl_add_u32 v232, v231, 4, v232
    v_cmp_gt_u32 s[12:13], 2, v231
    s_mov_b32 s8, s96
    s_mov_b32 s9, s97
    s_mov_b32 s10, 2621440
    s_mov_b32 s11, 0x20000
    v_lshrrev_b32 v235, 4, v224
    v_sub_u32 v233, s62, v235
    v_cmp_gt_u32 vcc, 1, v235
    v_cmp_le_i32 s[94:95], 0, v233
    v_and_b32 v235, 15, v224
    s_and_b64 s[94:95], vcc, s[94:95]
    v_cmp_gt_u32 vcc, 16, v235
    v_lshlrev_b32 v233, 12, v233
    v_lshl_add_u32 v233, v235, 2, v233
    s_and_b64 vcc, vcc, s[94:95]
    v_add_u32 v233, s81, v233
    v_mov_b32 v234, -1
    v_mov_b32 v235, 0x7ff00000
    v_cndmask_b32 v234, v234, 0, vcc
    v_cndmask_b32 v233, v235, v233, vcc
    v_mov_b32 v220, v208
    v_mov_b32 v221, v208
    s_lshr_b32 s60, s61, 1
    s_mul_i32 s60, s60, 5
    v_permlane32_swap_b32 v220, v221
    s_lshl_b32 s68, s66, 1
    s_add_u32 s68, s68, s60
    v_rcp_f32 v221, v221
    s_mul_i32 s69, s63, 151552
    s_add_u32 s69, s69, 8499200
    v_mul_f32 v200, v200, v221
    v_mul_f32 v201, v201, v221
    v_mul_f32 v202, v202, v221
    v_mul_f32 v203, v203, v221
    v_mul_f32 v204, v204, v221
    v_mul_f32 v205, v205, v221
    v_mul_f32 v206, v206, v221
    v_mul_f32 v207, v207, v221
    v_mul_f32 v208, v208, v221
    v_mul_f32 v209, v209, v221
    v_mul_f32 v210, v210, v221
    v_mul_f32 v211, v211, v221
    v_cvt_pk_bf16_f32 v212, v200, v201
    v_cvt_pk_bf16_f32 v213, v202, v203
    v_cvt_pk_bf16_f32 v214, v204, v205
    v_cvt_pk_bf16_f32 v215, v206, v207
    v_cvt_pk_bf16_f32 v228, v208, v209
    v_cvt_pk_bf16_f32 v229, v210, v211
    s_lshl_b32 s68, s68, 10
    s_add_u32 s68, s68, s69
    buffer_store_dwordx4 v[212:215], v242, s[20:23], s68 offen offset:1024 sc1
    s_lshl_b32 s60, s60, 10
    s_add_u32 s60, s60, s69
    s_lshl_b32 s68, s66, 9
    s_add_u32 s60, s60, s68
    s_add_u32 s60, s60, 4096
    s_mov_b64 exec, s[58:59]
    buffer_store_dwordx4 v[226:229], v242, s[20:23], s60 offen sc1
    s_mov_b64 exec, -1
    s_add_u32 s53, s52, 49152
    buffer_load_dwordx4 v[96:99], v238, s[20:23], s53 offen offset:0 sc1
    buffer_load_dwordx4 v[100:103], v238, s[20:23], s53 offen offset:256 sc1
    buffer_load_dwordx4 v[104:107], v239, s[20:23], s53 offen offset:0 sc1
    buffer_load_dwordx4 v[108:111], v239, s[20:23], s53 offen offset:256 sc1
    s_add_u32 s53, s52, 57344
    buffer_load_dwordx4 v[112:115], v238, s[20:23], s53 offen offset:0 sc1
    buffer_load_dwordx4 v[116:119], v238, s[20:23], s53 offen offset:256 sc1
    buffer_load_dwordx4 v[120:123], v239, s[20:23], s53 offen offset:0 sc1
    buffer_load_dwordx4 v[124:127], v239, s[20:23], s53 offen offset:256 sc1
    s_branch ATT_END
ATT_SLOW:
    s_mul_i32 s54, s25, 15360
    s_add_u32 s54, s54, 98304
    ds_read_b64 v[144:145], v243 offset:27648
    ds_read_b64 v[146:147], v243 offset:27936
    ds_read_b64 v[148:149], v250 offset:28800
    ds_read_b64 v[152:153], v243 offset:0
    ds_read_b64 v[154:155], v243 offset:288
    ds_read_b64 v[156:157], v250 offset:1152
    s_waitcnt lgkmcnt(3)
    v_mfma_f32_32x32x16_bf16 v[128:143], v[144:147], v[226:229], 0
    v_mfma_f32_32x32x16_bf16 v[128:143], v[148:151], v[230:233], v[128:143]
    ds_read_b64 v[160:161], v243 offset:3456
    ds_read_b64 v[162:163], v243 offset:3744
    ds_read_b64 v[164:165], v250 offset:4608
    s_waitcnt lgkmcnt(3)
    v_mfma_f32_32x32x16_bf16 v[0:15], v[152:155], v[226:229], 0
    v_mfma_f32_32x32x16_bf16 v[0:15], v[156:159], v[230:233], v[0:15]
    ds_read_b64 v[144:145], v243 offset:6912
    ds_read_b64 v[146:147], v243 offset:7200
    ds_read_b64 v[148:149], v250 offset:8064
    s_add_u32 s67, s57, 143360
    buffer_load_dwordx4 a[0:3], v242, s[20:23], s67 offen offset:0 sc1
    s_waitcnt lgkmcnt(3)
    v_mfma_f32_32x32x16_bf16 v[16:31], v[160:163], v[226:229], 0
    v_mfma_f32_32x32x16_bf16 v[16:31], v[164:167], v[230:233], v[16:31]
    ds_read_b64 v[152:153], v243 offset:10368
    ds_read_b64 v[154:155], v243 offset:10656
    ds_read_b64 v[156:157], v250 offset:11520
    s_waitcnt lgkmcnt(3)
    v_mfma_f32_32x32x16_bf16 v[32:47], v[144:147], v[226:229], 0
    v_mfma_f32_32x32x16_bf16 v[32:47], v[148:151], v[230:233], v[32:47]
    ds_read_b64 v[160:161], v243 offset:13824
    ds_read_b64 v[162:163], v243 offset:14112
    ds_read_b64 v[164:165], v250 offset:14976
    buffer_load_dwordx4 a[4:7], v242, s[20:23], s67 offen offset:1024 sc1
    s_cmp_ge_u32 s63, 8
    s_cbranch_scc1 AV0_0
    v_mov_b32 v0, 0xf149f2ca
    v_mov_b32 v1, 0xf149f2ca
    v_mov_b32 v2, 0xf149f2ca
    v_mov_b32 v3, 0xf149f2ca
    v_mov_b32 v4, 0xf149f2ca
    v_mov_b32 v5, 0xf149f2ca
    v_mov_b32 v6, 0xf149f2ca
    v_mov_b32 v7, 0xf149f2ca
    v_mov_b32 v8, 0xf149f2ca
    v_mov_b32 v9, 0xf149f2ca
    v_mov_b32 v10, 0xf149f2ca
    v_mov_b32 v11, 0xf149f2ca
    v_mov_b32 v12, 0xf149f2ca
    v_mov_b32 v13, 0xf149f2ca
    v_mov_b32 v14, 0xf149f2ca
    v_mov_b32 v15, 0xf149f2ca
AV0_0:
    v_cndmask_b32 v0, v128, v0, s[12:13]
    v_cndmask_b32 v1, v129, v1, s[14:15]
    v_cndmask_b32 v2, v130, v2, s[16:17]
    v_cndmask_b32 v3, v131, v3, s[18:19]
    v_cndmask_b32 v4, v132, v4, s[28:29]
    v_cndmask_b32 v5, v133, v5, s[30:31]
    v_cndmask_b32 v6, v134, v6, s[32:33]
    v_cndmask_b32 v7, v135, v7, s[34:35]
    v_cndmask_b32 v8, v136, v8, s[36:37]
    v_cndmask_b32 v9, v137, v9, s[38:39]
    v_cndmask_b32 v10, v138, v10, s[40:41]
    v_cndmask_b32 v11, v139, v11, s[42:43]
    v_cndmask_b32 v12, v140, v12, s[44:45]
    v_cndmask_b32 v13, v141, v13, s[46:47]
    v_cndmask_b32 v14, v142, v14, s[48:49]
    v_cndmask_b32 v15, v143, v15, s[50:51]
    v_max_f32 v246, v0, v1
    v_max_f32 v247, v2, v3
    v_max3_f32 v246, v4, v5, v246
    v_max3_f32 v247, v6, v7, v247
    v_max3_f32 v246, v8, v9, v246
    v_max3_f32 v247, v10, v11, v247
    v_max3_f32 v246, v12, v13, v246
    v_max3_f32 v247, v14, v15, v247
    s_waitcnt lgkmcnt(3)
    v_mfma_f32_32x32x16_bf16 v[48:63], v[152:155], v[226:229], 0
    v_mfma_f32_32x32x16_bf16 v[48:63], v[156:159], v[230:233], v[48:63]
    ds_read_b64 v[144:145], v243 offset:17280
    ds_read_b64 v[146:147], v243 offset:17568
    ds_read_b64 v[148:149], v250 offset:18432
    s_cmp_ge_u32 s63, 7
    s_cbranch_scc1 AV0_1
    v_mov_b32 v16, 0xf149f2ca
    v_mov_b32 v17, 0xf149f2ca
    v_mov_b32 v18, 0xf149f2ca
    v_mov_b32 v19, 0xf149f2ca
    v_mov_b32 v20, 0xf149f2ca
    v_mov_b32 v21, 0xf149f2ca
    v_mov_b32 v22, 0xf149f2ca
    v_mov_b32 v23, 0xf149f2ca
    v_mov_b32 v24, 0xf149f2ca
    v_mov_b32 v25, 0xf149f2ca
    v_mov_b32 v26, 0xf149f2ca
    v_mov_b32 v27, 0xf149f2ca
    v_mov_b32 v28, 0xf149f2ca
    v_mov_b32 v29, 0xf149f2ca
    v_mov_b32 v30, 0xf149f2ca
    v_mov_b32 v31, 0xf149f2ca
AV0_1:
    v_max3_f32 v246, v16, v17, v246
    v_max3_f32 v247, v18, v19, v247
    v_max3_f32 v246, v20, v21, v246
    v_max3_f32 v247, v22, v23, v247
    v_max3_f32 v246, v24, v25, v246
    v_max3_f32 v247, v26, v27, v247
    v_max3_f32 v246, v28, v29, v246
    v_max3_f32 v247, v30, v31, v247
    s_waitcnt lgkmcnt(3)
    v_mfma_f32_32x32x16_bf16 v[64:79], v[160:163], v[226:229], 0
    v_mfma_f32_32x32x16_bf16 v[64:79], v[164:167], v[230:233], v[64:79]
    ds_read_b64 v[152:153], v243 offset:20736
    ds_read_b64 v[154:155], v243 offset:21024
    ds_read_b64 v[156:157], v250 offset:21888
    buffer_load_dwordx4 a[8:11], v242, s[20:23], s67 offen offset:2048 sc1
    s_cmp_ge_u32 s63, 6
    s_cbranch_scc1 AV0_2
    v_mov_b32 v32, 0xf149f2ca
    v_mov_b32 v33, 0xf149f2ca
    v_mov_b32 v34, 0xf149f2ca
    v_mov_b32 v35, 0xf149f2ca
    v_mov_b32 v36, 0xf149f2ca
    v_mov_b32 v37, 0xf149f2ca
    v_mov_b32 v38, 0xf149f2ca
    v_mov_b32 v39, 0xf149f2ca
    v_mov_b32 v40, 0xf149f2ca
    v_mov_b32 v41, 0xf149f2ca
    v_mov_b32 v42, 0xf149f2ca
    v_mov_b32 v43, 0xf149f2ca
    v_mov_b32 v44, 0xf149f2ca
    v_mov_b32 v45, 0xf149f2ca
    v_mov_b32 v46, 0xf149f2ca
    v_mov_b32 v47, 0xf149f2ca
AV0_2:
    v_max3_f32 v246, v32, v33, v246
    v_max3_f32 v247, v34, v35, v247
    v_max3_f32 v246, v36, v37, v246
    v_max3_f32 v247, v38, v39, v247
    v_max3_f32 v246, v40, v41, v246
    v_max3_f32 v247, v42, v43, v247
    v_max3_f32 v246, v44, v45, v246
    v_max3_f32 v247, v46, v47, v247
    s_waitcnt lgkmcnt(3)
    v_mfma_f32_32x32x16_bf16 v[80:95], v[144:147], v[226:229], 0
    v_mfma_f32_32x32x16_bf16 v[80:95], v[148:151], v[230:233], v[80:95]
    ds_read_b64 v[160:161], v243 offset:24192
    ds_read_b64 v[162:163], v243 offset:24480
    ds_read_b64 v[164:165], v250 offset:25344
    s_cmp_ge_u32 s63, 5
    s_cbranch_scc1 AV0_3
    v_mov_b32 v48, 0xf149f2ca
    v_mov_b32 v49, 0xf149f2ca
    v_mov_b32 v50, 0xf149f2ca
    v_mov_b32 v51, 0xf149f2ca
    v_mov_b32 v52, 0xf149f2ca
    v_mov_b32 v53, 0xf149f2ca
    v_mov_b32 v54, 0xf149f2ca
    v_mov_b32 v55, 0xf149f2ca
    v_mov_b32 v56, 0xf149f2ca
    v_mov_b32 v57, 0xf149f2ca
    v_mov_b32 v58, 0xf149f2ca
    v_mov_b32 v59, 0xf149f2ca
    v_mov_b32 v60, 0xf149f2ca
    v_mov_b32 v61, 0xf149f2ca
    v_mov_b32 v62, 0xf149f2ca
    v_mov_b32 v63, 0xf149f2ca
AV0_3:
    v_max3_f32 v246, v48, v49, v246
    v_max3_f32 v247, v50, v51, v247
    v_max3_f32 v246, v52, v53, v246
    v_max3_f32 v247, v54, v55, v247
    v_max3_f32 v246, v56, v57, v246
    v_max3_f32 v247, v58, v59, v247
    v_max3_f32 v246, v60, v61, v246
    v_max3_f32 v247, v62, v63, v247
    s_waitcnt lgkmcnt(3)
    v_mfma_f32_32x32x16_bf16 v[96:111], v[152:155], v[226:229], 0
    v_mfma_f32_32x32x16_bf16 v[96:111], v[156:159], v[230:233], v[96:111]
    buffer_load_dwordx4 a[12:15], v242, s[20:23], s67 offen offset:3072 sc1
    s_cmp_ge_u32 s63, 4
    s_cbranch_scc1 AV0_4
    v_mov_b32 v64, 0xf149f2ca
    v_mov_b32 v65, 0xf149f2ca
    v_mov_b32 v66, 0xf149f2ca
    v_mov_b32 v67, 0xf149f2ca
    v_mov_b32 v68, 0xf149f2ca
    v_mov_b32 v69, 0xf149f2ca
    v_mov_b32 v70, 0xf149f2ca
    v_mov_b32 v71, 0xf149f2ca
    v_mov_b32 v72, 0xf149f2ca
    v_mov_b32 v73, 0xf149f2ca
    v_mov_b32 v74, 0xf149f2ca
    v_mov_b32 v75, 0xf149f2ca
    v_mov_b32 v76, 0xf149f2ca
    v_mov_b32 v77, 0xf149f2ca
    v_mov_b32 v78, 0xf149f2ca
    v_mov_b32 v79, 0xf149f2ca
AV0_4:
    v_max3_f32 v246, v64, v65, v246
    v_max3_f32 v247, v66, v67, v247
    v_max3_f32 v246, v68, v69, v246
    v_max3_f32 v247, v70, v71, v247
    v_max3_f32 v246, v72, v73, v246
    v_max3_f32 v247, v74, v75, v247
    v_max3_f32 v246, v76, v77, v246
    v_max3_f32 v247, v78, v79, v247
    s_waitcnt lgkmcnt(0)
    v_mfma_f32_32x32x16_bf16 v[112:127], v[160:163], v[226:229], 0
    v_mfma_f32_32x32x16_bf16 v[112:127], v[164:167], v[230:233], v[112:127]
    s_cmp_ge_u32 s63, 3
    s_cbranch_scc1 AV0_5
    v_mov_b32 v80, 0xf149f2ca
    v_mov_b32 v81, 0xf149f2ca
    v_mov_b32 v82, 0xf149f2ca
    v_mov_b32 v83, 0xf149f2ca
    v_mov_b32 v84, 0xf149f2ca
    v_mov_b32 v85, 0xf149f2ca
    v_mov_b32 v86, 0xf149f2ca
    v_mov_b32 v87, 0xf149f2ca
    v_mov_b32 v88, 0xf149f2ca
    v_mov_b32 v89, 0xf149f2ca
    v_mov_b32 v90, 0xf149f2ca
    v_mov_b32 v91, 0xf149f2ca
    v_mov_b32 v92, 0xf149f2ca
    v_mov_b32 v93, 0xf149f2ca
    v_mov_b32 v94, 0xf149f2ca
    v_mov_b32 v95, 0xf149f2ca
AV0_5:
    v_max3_f32 v246, v80, v81, v246
    v_max3_f32 v247, v82, v83, v247
    v_max3_f32 v246, v84, v85, v246
    v_max3_f32 v247, v86, v87, v247
    v_max3_f32 v246, v88, v89, v246
    v_max3_f32 v247, v90, v91, v247
    v_max3_f32 v246, v92, v93, v246
    v_max3_f32 v247, v94, v95, v247
    ds_read_b64_tr_b16 v[128:129], v244 offset:29952
    ds_read_b64_tr_b16 v[130:131], v244 offset:30016
    ds_read_b64_tr_b16 v[132:133], v244 offset:30080
    ds_read_b64_tr_b16 v[134:135], v244 offset:30144
    ds_read_b64_tr_b16 v[184:185], v244 offset:0
    ds_read_b64_tr_b16 v[186:187], v244 offset:64
    ds_read_b64_tr_b16 v[188:189], v244 offset:128
    ds_read_b64_tr_b16 v[190:191], v244 offset:192
    s_cmp_ge_u32 s63, 2
    s_cbranch_scc1 AV0_6
    v_mov_b32 v96, 0xf149f2ca
    v_mov_b32 v97, 0xf149f2ca
    v_mov_b32 v98, 0xf149f2ca
    v_mov_b32 v99, 0xf149f2ca
    v_mov_b32 v100, 0xf149f2ca
    v_mov_b32 v101, 0xf149f2ca
    v_mov_b32 v102, 0xf149f2ca
    v_mov_b32 v103, 0xf149f2ca
    v_mov_b32 v104, 0xf149f2ca
    v_mov_b32 v105, 0xf149f2ca
    v_mov_b32 v106, 0xf149f2ca
    v_mov_b32 v107, 0xf149f2ca
    v_mov_b32 v108, 0xf149f2ca
    v_mov_b32 v109, 0xf149f2ca
    v_mov_b32 v110, 0xf149f2ca
    v_mov_b32 v111, 0xf149f2ca
AV0_6:
    v_max3_f32 v246, v96, v97, v246
    v_max3_f32 v247, v98, v99, v247
    v_max3_f32 v246, v100, v101, v246
    v_max3_f32 v247, v102, v103, v247
    v_max3_f32 v246, v104, v105, v246
    v_max3_f32 v247, v106, v107, v247
    v_max3_f32 v246, v108, v109, v246
    v_max3_f32 v247, v110, v111, v247
    s_cmp_ge_u32 s63, 1
    s_cbranch_scc1 AV0_7
    v_mov_b32 v112, 0xf149f2ca
    v_mov_b32 v113, 0xf149f2ca
    v_mov_b32 v114, 0xf149f2ca
    v_mov_b32 v115, 0xf149f2ca
    v_mov_b32 v116, 0xf149f2ca
    v_mov_b32 v117, 0xf149f2ca
    v_mov_b32 v118, 0xf149f2ca
    v_mov_b32 v119, 0xf149f2ca
    v_mov_b32 v120, 0xf149f2ca
    v_mov_b32 v121, 0xf149f2ca
    v_mov_b32 v122, 0xf149f2ca
    v_mov_b32 v123, 0xf149f2ca
    v_mov_b32 v124, 0xf149f2ca
    v_mov_b32 v125, 0xf149f2ca
    v_mov_b32 v126, 0xf149f2ca
    v_mov_b32 v127, 0xf149f2ca
AV0_7:
    v_max3_f32 v246, v112, v113, v246
    v_max3_f32 v247, v114, v115, v247
    v_max3_f32 v246, v116, v117, v246
    v_max3_f32 v247, v118, v119, v247
    v_max3_f32 v246, v120, v121, v246
    v_max3_f32 v247, v122, v123, v247
    v_max3_f32 v246, v124, v125, v246
    v_max3_f32 v247, v126, v127, v247
    v_max_f32 v246, v246, v247
    v_mov_b32 v247, v246
    s_nop 1
    v_permlane32_swap_b32 v246, v247
    s_nop 1
    v_max_f32 v246, v246, v247
    v_and_b32 v247, 0xffff0000, v246
    v_sub_f32 v246, v246, v247
    v_and_b32 v248, 0xffff0000, v246
    v_sub_f32 v246, v246, v248
    v_cvt_pk_bf16_f32 v247, -v247, -v248
    v_cvt_pk_bf16_f32 v248, -v246, v255
    v_cndmask_b32 v216, v255, v247, s[58:59]
    v_cndmask_b32 v217, v255, v248, s[58:59]
    s_nop 1
    v_mfma_f32_32x32x16_bf16 v[0:15], v[222:225], v[216:219], v[0:15]
    v_mfma_f32_32x32x16_bf16 v[16:31], v[222:225], v[216:219], v[16:31]
    v_lshrrev_b32 v220, 4, v242
    s_lshl_b32 s60, s24, 1
    s_bfe_u32 s62, s26, 0x10001
    s_add_u32 s62, s62, s60
    v_lshrrev_b32 v254, 4, v220
    v_sub_u32 v252, s62, v254
    v_cmp_gt_u32 vcc, 1, v254
    v_cmp_le_i32 s[94:95], 0, v252
    v_and_b32 v254, 15, v220
    s_and_b64 s[94:95], vcc, s[94:95]
    v_cmp_gt_u32 vcc, 14, v254
    v_lshlrev_b32 v252, 12, v252
    v_lshl_add_u32 v252, v254, 2, v252
    s_and_b64 vcc, vcc, s[94:95]
    v_add_u32 v252, s81, v252
    v_mov_b32 v253, -1
    v_mov_b32 v254, 0x7ff00000
    v_cndmask_b32 v253, v253, 1, vcc
    v_cndmask_b32 v252, v254, v252, vcc
    ds_read_b64 v[144:145], v243 offset:29376
    ds_read_b64 v[146:147], v243 offset:29664
    ds_read_b64 v[148:149], v250 offset:29088
    ds_read_b64 v[152:153], v243 offset:1728
    ds_read_b64 v[154:155], v243 offset:2016
    ds_read_b64 v[156:157], v250 offset:1440
    ds_read_b64 v[160:161], v243 offset:5184
    ds_read_b64 v[162:163], v243 offset:5472
    ds_read_b64 v[164:165], v250 offset:4896
    v_exp_f32 v0, v0
    v_exp_f32 v1, v1
    v_mfma_f32_32x32x16_bf16 v[32:47], v[222:225], v[216:219], v[32:47]
    v_exp_f32 v2, v2
    v_exp_f32 v3, v3
    s_add_u32 s67, s57, 147456
    buffer_load_dwordx4 a[16:19], v242, s[20:23], s67 offen offset:0 sc1
    v_cvt_pk_bf16_f32 v168, v0, v1
    v_exp_f32 v4, v4
    v_exp_f32 v5, v5
    v_cvt_pk_bf16_f32 v169, v2, v3
    v_exp_f32 v6, v6
    s_add_u32 s67, s57, 163840
    buffer_load_dwordx4 a[20:23], v242, s[20:23], s67 offen offset:0 sc1
    v_exp_f32 v7, v7
    v_cvt_pk_bf16_f32 v170, v4, v5
    v_exp_f32 v8, v8
    buffer_load_dwordx4 a[24:27], v242, s[20:23], s67 offen offset:1024 sc1
    v_exp_f32 v9, v9
    v_cvt_pk_bf16_f32 v171, v6, v7
    v_exp_f32 v10, v10
    ds_read_b64_tr_b16 v[192:193], v244 offset:3744
    ds_read_b64_tr_b16 v[194:195], v244 offset:3808
    ds_read_b64_tr_b16 v[196:197], v244 offset:3872
    ds_read_b64_tr_b16 v[198:199], v244 offset:3936
    v_exp_f32 v11, v11
    buffer_load_dwordx4 a[28:31], v242, s[20:23], s67 offen offset:2048 sc1
    v_cvt_pk_bf16_f32 v172, v8, v9
    v_exp_f32 v12, v12
    v_exp_f32 v13, v13
    buffer_load_dwordx4 a[32:35], v242, s[20:23], s67 offen offset:3072 sc1
    v_cvt_pk_bf16_f32 v173, v10, v11
    v_exp_f32 v14, v14
    v_exp_f32 v15, v15
    v_cvt_pk_bf16_f32 v174, v12, v13
    v_cvt_pk_bf16_f32 v175, v14, v15
    v_accvgpr_read_b32 v220, a100
    v_bfi_b32 v136, v220, v255, v168
    v_and_b32 v168, v220, v168
    v_accvgpr_read_b32 v220, a101
    v_bfi_b32 v137, v220, v255, v169
    v_and_b32 v169, v220, v169
    v_accvgpr_read_b32 v220, a102
    v_bfi_b32 v138, v220, v255, v170
    v_and_b32 v170, v220, v170
    v_accvgpr_read_b32 v220, a103
    v_bfi_b32 v139, v220, v255, v171
    v_and_b32 v171, v220, v171
    v_accvgpr_read_b32 v220, a104
    v_bfi_b32 v140, v220, v255, v172
    v_and_b32 v172, v220, v172
    v_accvgpr_read_b32 v220, a105
    v_bfi_b32 v141, v220, v255, v173
    v_and_b32 v173, v220, v173
    v_accvgpr_read_b32 v220, a106
    v_bfi_b32 v142, v220, v255, v174
    v_and_b32 v174, v220, v174
    v_accvgpr_read_b32 v220, a107
    v_bfi_b32 v143, v220, v255, v175
    v_and_b32 v175, v220, v175
    v_exp_f32 v16, v16
    v_exp_f32 v17, v17
    v_mfma_f32_32x32x16_bf16 v[48:63], v[222:225], v[216:219], v[48:63]
    v_exp_f32 v18, v18
    s_waitcnt lgkmcnt(0)
    v_mfma_f32_32x32x16_bf16 v[200:215], v[128:131], v[136:139], 0
    v_exp_f32 v19, v19
    s_add_u32 s67, s57, 167936
    buffer_load_dwordx4 a[36:39], v242, s[20:23], s67 offen offset:0 sc1
    v_cvt_pk_bf16_f32 v176, v16, v17
    v_exp_f32 v20, v20
    v_mfma_f32_32x32x16_bf16 v[200:215], v[132:135], v[140:143], v[200:215]
    v_exp_f32 v21, v21
    v_cvt_pk_bf16_f32 v177, v18, v19
    v_exp_f32 v22, v22
    v_mfma_f32_32x32x16_bf16 v[200:215], v[184:187], v[168:171], v[200:215]
    s_add_u32 s67, s57, 184320
    buffer_load_dwordx4 a[40:43], v242, s[20:23], s67 offen offset:0 sc1
    v_exp_f32 v23, v23
    v_cvt_pk_bf16_f32 v178, v20, v21
    v_exp_f32 v24, v24
    buffer_load_dwordx4 a[44:47], v242, s[20:23], s67 offen offset:1024 sc1
    v_exp_f32 v25, v25
    v_mfma_f32_32x32x16_bf16 v[200:215], v[188:191], v[172:175], v[200:215]
    v_cvt_pk_bf16_f32 v179, v22, v23
    v_exp_f32 v26, v26
    ds_read_b64_tr_b16 v[184:185], v244 offset:7488
    ds_read_b64_tr_b16 v[186:187], v244 offset:7552
    ds_read_b64_tr_b16 v[188:189], v244 offset:7616
    ds_read_b64_tr_b16 v[190:191], v244 offset:7680
    v_exp_f32 v27, v27
    buffer_load_dwordx4 a[48:51], v242, s[20:23], s67 offen offset:2048 sc1
    v_cvt_pk_bf16_f32 v180, v24, v25
    v_exp_f32 v28, v28
    v_exp_f32 v29, v29
    buffer_load_dwordx4 a[52:55], v242, s[20:23], s67 offen offset:3072 sc1
    v_cvt_pk_bf16_f32 v181, v26, v27
    v_exp_f32 v30, v30
    v_exp_f32 v31, v31
    v_cvt_pk_bf16_f32 v182, v28, v29
    v_cvt_pk_bf16_f32 v183, v30, v31
    v_exp_f32 v32, v32
    v_mfma_f32_32x32x16_bf16 v[128:143], v[144:147], v[234:237], 0
    v_exp_f32 v33, v33
    v_mfma_f32_32x32x16_bf16 v[64:79], v[222:225], v[216:219], v[64:79]
    v_exp_f32 v34, v34
    v_exp_f32 v35, v35
    v_mfma_f32_32x32x16_bf16 v[128:143], v[148:151], v[238:241], v[128:143]
    s_add_u32 s67, s57, 188416
    buffer_load_dwordx4 a[56:59], v242, s[20:23], s67 offen offset:0 sc1
    v_cvt_pk_bf16_f32 v168, v32, v33
    v_exp_f32 v36, v36
    s_waitcnt lgkmcnt(0)
    v_exp_f32 v37, v37
    v_cvt_pk_bf16_f32 v169, v34, v35
    v_exp_f32 v38, v38
    v_mfma_f32_32x32x16_bf16 v[200:215], v[192:195], v[176:179], v[200:215]
    s_add_u32 s67, s57, 204800
    buffer_load_dwordx4 a[60:63], v242, s[20:23], s67 offen offset:0 sc1
    v_exp_f32 v39, v39
    v_cvt_pk_bf16_f32 v170, v36, v37
    v_exp_f32 v40, v40
    buffer_load_dwordx4 a[64:67], v242, s[20:23], s67 offen offset:1024 sc1
    v_exp_f32 v41, v41
    v_mfma_f32_32x32x16_bf16 v[200:215], v[196:199], v[180:183], v[200:215]
    v_cvt_pk_bf16_f32 v171, v38, v39
    v_exp_f32 v42, v42
    ds_read_b64_tr_b16 v[192:193], v244 offset:11232
    ds_read_b64_tr_b16 v[194:195], v244 offset:11296
    ds_read_b64_tr_b16 v[196:197], v244 offset:11360
    ds_read_b64_tr_b16 v[198:199], v244 offset:11424
    v_exp_f32 v43, v43
    buffer_load_dwordx4 a[68:71], v242, s[20:23], s67 offen offset:2048 sc1
    v_cvt_pk_bf16_f32 v172, v40, v41
    v_exp_f32 v44, v44
    v_mfma_f32_32x32x16_bf16 v[0:15], v[152:155], v[234:237], 0
    v_exp_f32 v45, v45
    buffer_load_dwordx4 a[72:75], v242, s[20:23], s67 offen offset:3072 sc1
    v_cvt_pk_bf16_f32 v173, v42, v43
    v_exp_f32 v46, v46
    v_mfma_f32_32x32x16_bf16 v[0:15], v[156:159], v[238:241], v[0:15]
    v_exp_f32 v47, v47
    ds_read_b64 v[144:145], v243 offset:8640
    ds_read_b64 v[146:147], v243 offset:8928
    ds_read_b64 v[148:149], v250 offset:8352
    v_cvt_pk_bf16_f32 v174, v44, v45
    v_cvt_pk_bf16_f32 v175, v46, v47
    v_exp_f32 v48, v48
    v_exp_f32 v49, v49
    v_mfma_f32_32x32x16_bf16 v[80:95], v[222:225], v[216:219], v[80:95]
    v_exp_f32 v50, v50
    v_exp_f32 v51, v51
    s_add_u32 s67, s57, 208896
    buffer_load_dwordx4 a[76:79], v242, s[20:23], s67 offen offset:0 sc1
    v_cvt_pk_bf16_f32 v176, v48, v49
    v_exp_f32 v52, v52
    s_waitcnt lgkmcnt(0)
    s_cmp_ge_u32 s63, 8
    s_cbranch_scc1 AV1_0
    v_mov_b32 v0, 0xf149f2ca
    v_mov_b32 v1, 0xf149f2ca
    v_mov_b32 v2, 0xf149f2ca
    v_mov_b32 v3, 0xf149f2ca
    v_mov_b32 v4, 0xf149f2ca
    v_mov_b32 v5, 0xf149f2ca
    v_mov_b32 v6, 0xf149f2ca
    v_mov_b32 v7, 0xf149f2ca
    v_mov_b32 v8, 0xf149f2ca
    v_mov_b32 v9, 0xf149f2ca
    v_mov_b32 v10, 0xf149f2ca
    v_mov_b32 v11, 0xf149f2ca
    v_mov_b32 v12, 0xf149f2ca
    v_mov_b32 v13, 0xf149f2ca
    v_mov_b32 v14, 0xf149f2ca
    v_mov_b32 v15, 0xf149f2ca
AV1_0:
    v_cndmask_b32 v0, v128, v0, s[12:13]
    v_cndmask_b32 v1, v129, v1, s[14:15]
    v_exp_f32 v53, v53
    v_cvt_pk_bf16_f32 v177, v50, v51
    v_cndmask_b32 v2, v130, v2, s[16:17]
    v_cndmask_b32 v3, v131, v3, s[18:19]
    v_exp_f32 v54, v54
    v_mfma_f32_32x32x16_bf16 v[200:215], v[184:187], v[168:171], v[200:215]
    s_add_u32 s67, s57, 225280
    buffer_load_dwordx4 a[80:83], v242, s[20:23], s67 offen offset:0 sc1
    v_cndmask_b32 v4, v132, v4, s[28:29]
    v_cndmask_b32 v5, v133, v5, s[30:31]
    v_exp_f32 v55, v55
    v_cvt_pk_bf16_f32 v178, v52, v53
    v_cndmask_b32 v6, v134, v6, s[32:33]
    v_cndmask_b32 v7, v135, v7, s[34:35]
    v_exp_f32 v56, v56
    buffer_load_dwordx4 a[84:87], v242, s[20:23], s67 offen offset:1024 sc1
    v_cndmask_b32 v8, v136, v8, s[36:37]
    v_cndmask_b32 v9, v137, v9, s[38:39]
    v_exp_f32 v57, v57
    v_mfma_f32_32x32x16_bf16 v[200:215], v[188:191], v[172:175], v[200:215]
    v_cvt_pk_bf16_f32 v179, v54, v55
    v_cndmask_b32 v10, v138, v10, s[40:41]
    v_cndmask_b32 v11, v139, v11, s[42:43]
    v_exp_f32 v58, v58
    ds_read_b64_tr_b16 v[184:185], v244 offset:14976
    ds_read_b64_tr_b16 v[186:187], v244 offset:15040
    ds_read_b64_tr_b16 v[188:189], v244 offset:15104
    ds_read_b64_tr_b16 v[190:191], v244 offset:15168
    v_cndmask_b32 v12, v140, v12, s[44:45]
    v_cndmask_b32 v13, v141, v13, s[46:47]
    v_exp_f32 v59, v59
    buffer_load_dwordx4 a[88:91], v242, s[20:23], s67 offen offset:2048 sc1
    v_cvt_pk_bf16_f32 v180, v56, v57
    v_cndmask_b32 v14, v142, v14, s[48:49]
    v_cndmask_b32 v15, v143, v15, s[50:51]
    v_exp_f32 v60, v60
    v_mfma_f32_32x32x16_bf16 v[16:31], v[160:163], v[234:237], 0
    v_max_f32 v246, v0, v1
    v_max_f32 v247, v2, v3
    v_exp_f32 v61, v61
    buffer_load_dwordx4 a[92:95], v242, s[20:23], s67 offen offset:3072 sc1
    v_cvt_pk_bf16_f32 v181, v58, v59
    v_max3_f32 v246, v4, v5, v246
    v_max3_f32 v247, v6, v7, v247
    v_exp_f32 v62, v62
    v_mfma_f32_32x32x16_bf16 v[16:31], v[164:167], v[238:241], v[16:31]
    v_max3_f32 v246, v8, v9, v246
    v_max3_f32 v247, v10, v11, v247
    v_exp_f32 v63, v63
    ds_read_b64 v[152:153], v243 offset:12096
    ds_read_b64 v[154:155], v243 offset:12384
    ds_read_b64 v[156:157], v250 offset:11808
    v_cvt_pk_bf16_f32 v182, v60, v61
    v_max3_f32 v246, v12, v13, v246
    v_max3_f32 v247, v14, v15, v247
    v_cvt_pk_bf16_f32 v183, v62, v63
    v_exp_f32 v64, v64
    v_exp_f32 v65, v65
    v_mfma_f32_32x32x16_bf16 v[96:111], v[222:225], v[216:219], v[96:111]
    v_exp_f32 v66, v66
    v_exp_f32 v67, v67
    s_add_u32 s67, s57, 229376
    buffer_load_dwordx4 a[96:99], v242, s[20:23], s67 offen offset:0 sc1
    v_cvt_pk_bf16_f32 v168, v64, v65
    v_exp_f32 v68, v68
    s_waitcnt lgkmcnt(0)
    s_cmp_ge_u32 s63, 7
    s_cbranch_scc1 AV1_1
    v_mov_b32 v16, 0xf149f2ca
    v_mov_b32 v17, 0xf149f2ca
    v_mov_b32 v18, 0xf149f2ca
    v_mov_b32 v19, 0xf149f2ca
    v_mov_b32 v20, 0xf149f2ca
    v_mov_b32 v21, 0xf149f2ca
    v_mov_b32 v22, 0xf149f2ca
    v_mov_b32 v23, 0xf149f2ca
    v_mov_b32 v24, 0xf149f2ca
    v_mov_b32 v25, 0xf149f2ca
    v_mov_b32 v26, 0xf149f2ca
    v_mov_b32 v27, 0xf149f2ca
    v_mov_b32 v28, 0xf149f2ca
    v_mov_b32 v29, 0xf149f2ca
    v_mov_b32 v30, 0xf149f2ca
    v_mov_b32 v31, 0xf149f2ca
AV1_1:
    v_exp_f32 v69, v69
    v_cvt_pk_bf16_f32 v169, v66, v67
    v_max3_f32 v246, v16, v17, v246
    v_exp_f32 v70, v70
    v_mfma_f32_32x32x16_bf16 v[200:215], v[192:195], v[176:179], v[200:215]
    s_add_u32 m0, s54, 0
    s_add_u32 s67, s57, 245760
    buffer_load_dwordx4 v242, s[20:23], s67 offen offset:0 sc1 lds
    v_max3_f32 v247, v18, v19, v247
    v_exp_f32 v71, v71
    v_cvt_pk_bf16_f32 v170, v68, v69
    v_max3_f32 v246, v20, v21, v246
    v_exp_f32 v72, v72
    buffer_load_dwordx4 v242, s[20:23], s67 offen offset:1024 sc1 lds
    v_max3_f32 v247, v22, v23, v247
    v_exp_f32 v73, v73
    v_mfma_f32_32x32x16_bf16 v[200:215], v[196:199], v[180:183], v[200:215]
    v_cvt_pk_bf16_f32 v171, v70, v71
    v_max3_f32 v246, v24, v25, v246
    v_exp_f32 v74, v74
    ds_read_b64_tr_b16 v[192:193], v244 offset:18720
    ds_read_b64_tr_b16 v[194:195], v244 offset:18784
    ds_read_b64_tr_b16 v[196:197], v244 offset:18848
    ds_read_b64_tr_b16 v[198:199], v244 offset:18912
    v_max3_f32 v247, v26, v27, v247
    v_exp_f32 v75, v75
    buffer_load_dwordx4 v242, s[20:23], s67 offen offset:2048 sc1 lds
    v_cvt_pk_bf16_f32 v172, v72, v73
    v_max3_f32 v246, v28, v29, v246
    v_exp_f32 v76, v76
    v_mfma_f32_32x32x16_bf16 v[32:47], v[144:147], v[234:237], 0
    v_max3_f32 v247, v30, v31, v247
    v_exp_f32 v77, v77
    buffer_load_dwordx4 v242, s[20:23], s67 offen offset:3072 sc1 lds
    v_cvt_pk_bf16_f32 v173, v74, v75
    v_exp_f32 v78, v78
    v_mfma_f32_32x32x16_bf16 v[32:47], v[148:151], v[238:241], v[32:47]
    v_exp_f32 v79, v79
    ds_read_b64 v[160:161], v243 offset:15552
    ds_read_b64 v[162:163], v243 offset:15840
    ds_read_b64 v[164:165], v250 offset:15264
    v_cvt_pk_bf16_f32 v174, v76, v77
    v_cvt_pk_bf16_f32 v175, v78, v79
    v_exp_f32 v80, v80
    v_exp_f32 v81, v81
    v_mfma_f32_32x32x16_bf16 v[112:127], v[222:225], v[216:219], v[112:127]
    v_exp_f32 v82, v82
    v_exp_f32 v83, v83
    s_add_u32 m0, s54, 4096
    s_add_u32 s67, s57, 249856
    buffer_load_dwordx4 v242, s[20:23], s67 offen offset:0 sc1 lds
    v_cvt_pk_bf16_f32 v176, v80, v81
    v_exp_f32 v84, v84
    s_waitcnt lgkmcnt(0)
    s_cmp_ge_u32 s63, 6
    s_cbranch_scc1 AV1_2
    v_mov_b32 v32, 0xf149f2ca
    v_mov_b32 v33, 0xf149f2ca
    v_mov_b32 v34, 0xf149f2ca
    v_mov_b32 v35, 0xf149f2ca
    v_mov_b32 v36, 0xf149f2ca
    v_mov_b32 v37, 0xf149f2ca
    v_mov_b32 v38, 0xf149f2ca
    v_mov_b32 v39, 0xf149f2ca
    v_mov_b32 v40, 0xf149f2ca
    v_mov_b32 v41, 0xf149f2ca
    v_mov_b32 v42, 0xf149f2ca
    v_mov_b32 v43, 0xf149f2ca
    v_mov_b32 v44, 0xf149f2ca
    v_mov_b32 v45, 0xf149f2ca
    v_mov_b32 v46, 0xf149f2ca
    v_mov_b32 v47, 0xf149f2ca
AV1_2:
    v_exp_f32 v85, v85
    v_cvt_pk_bf16_f32 v177, v82, v83
    v_max3_f32 v246, v32, v33, v246
    v_exp_f32 v86, v86
    v_mfma_f32_32x32x16_bf16 v[200:215], v[184:187], v[168:171], v[200:215]
    s_add_u32 m0, s54, 5120
    s_add_u32 s67, s57, 266240
    buffer_load_dwordx4 v242, s[20:23], s67 offen offset:0 sc1 lds
    v_max3_f32 v247, v34, v35, v247
    v_exp_f32 v87, v87
    v_cvt_pk_bf16_f32 v178, v84, v85
    v_max3_f32 v246, v36, v37, v246
    v_exp_f32 v88, v88
    buffer_load_dwordx4 v242, s[20:23], s67 offen offset:1024 sc1 lds
    v_max3_f32 v247, v38, v39, v247
    v_exp_f32 v89, v89
    v_mfma_f32_32x32x16_bf16 v[200:215], v[188:191], v[172:175], v[200:215]
    v_cvt_pk_bf16_f32 v179, v86, v87
    v_max3_f32 v246, v40, v41, v246
    v_exp_f32 v90, v90
    ds_read_b64_tr_b16 v[184:185], v244 offset:22464
    ds_read_b64_tr_b16 v[186:187], v244 offset:22528
    ds_read_b64_tr_b16 v[188:189], v244 offset:22592
    ds_read_b64_tr_b16 v[190:191], v244 offset:22656
    v_max3_f32 v247, v42, v43, v247
    v_exp_f32 v91, v91
    buffer_load_dwordx4 v242, s[20:23], s67 offen offset:2048 sc1 lds
    v_cvt_pk_bf16_f32 v180, v88, v89
    v_max3_f32 v246, v44, v45, v246
    v_exp_f32 v92, v92
    v_mfma_f32_32x32x16_bf16 v[48:63], v[152:155], v[234:237], 0
    v_max3_f32 v247, v46, v47, v247
    v_exp_f32 v93, v93
    buffer_load_dwordx4 v242, s[20:23], s67 offen offset:3072 sc1 lds
    v_cvt_pk_bf16_f32 v181, v90, v91
    v_exp_f32 v94, v94
    v_mfma_f32_32x32x16_bf16 v[48:63], v[156:159], v[238:241], v[48:63]
    v_exp_f32 v95, v95
    ds_read_b64 v[144:145], v243 offset:19008
    ds_read_b64 v[146:147], v243 offset:19296
    ds_read_b64 v[148:149], v250 offset:18720
    v_cvt_pk_bf16_f32 v182, v92, v93
    v_cvt_pk_bf16_f32 v183, v94, v95
    v_exp_f32 v96, v96
    v_exp_f32 v97, v97
    v_exp_f32 v98, v98
    v_exp_f32 v99, v99
    s_add_u32 m0, s54, 9216
    s_add_u32 s67, s57, 270336
    buffer_load_dwordx4 v242, s[20:23], s67 offen offset:0 sc1 lds
    v_cvt_pk_bf16_f32 v168, v96, v97
    v_exp_f32 v100, v100
    s_waitcnt lgkmcnt(0)
    s_cmp_ge_u32 s63, 5
    s_cbranch_scc1 AV1_3
    v_mov_b32 v48, 0xf149f2ca
    v_mov_b32 v49, 0xf149f2ca
    v_mov_b32 v50, 0xf149f2ca
    v_mov_b32 v51, 0xf149f2ca
    v_mov_b32 v52, 0xf149f2ca
    v_mov_b32 v53, 0xf149f2ca
    v_mov_b32 v54, 0xf149f2ca
    v_mov_b32 v55, 0xf149f2ca
    v_mov_b32 v56, 0xf149f2ca
    v_mov_b32 v57, 0xf149f2ca
    v_mov_b32 v58, 0xf149f2ca
    v_mov_b32 v59, 0xf149f2ca
    v_mov_b32 v60, 0xf149f2ca
    v_mov_b32 v61, 0xf149f2ca
    v_mov_b32 v62, 0xf149f2ca
    v_mov_b32 v63, 0xf149f2ca
AV1_3:
    v_exp_f32 v101, v101
    v_cvt_pk_bf16_f32 v169, v98, v99
    v_max3_f32 v246, v48, v49, v246
    v_exp_f32 v102, v102
    v_mfma_f32_32x32x16_bf16 v[200:215], v[192:195], v[176:179], v[200:215]
    s_add_u32 m0, s54, 10240
    s_add_u32 s67, s57, 276480
    buffer_load_dwordx4 v242, s[20:23], s67 offen offset:0 sc1 lds
    v_max3_f32 v247, v50, v51, v247
    v_exp_f32 v103, v103
    v_cvt_pk_bf16_f32 v170, v100, v101
    v_max3_f32 v246, v52, v53, v246
    v_exp_f32 v104, v104
    buffer_load_dwordx4 v242, s[20:23], s67 offen offset:1024 sc1 lds
    v_max3_f32 v247, v54, v55, v247
    v_exp_f32 v105, v105
    v_mfma_f32_32x32x16_bf16 v[200:215], v[196:199], v[180:183], v[200:215]
    v_cvt_pk_bf16_f32 v171, v102, v103
    v_max3_f32 v246, v56, v57, v246
    v_exp_f32 v106, v106
    ds_read_b64_tr_b16 v[192:193], v244 offset:26208
    ds_read_b64_tr_b16 v[194:195], v244 offset:26272
    ds_read_b64_tr_b16 v[196:197], v244 offset:26336
    ds_read_b64_tr_b16 v[198:199], v244 offset:26400
    v_max3_f32 v247, v58, v59, v247
    v_exp_f32 v107, v107
    buffer_load_dwordx4 v242, s[20:23], s67 offen offset:2048 sc1 lds
    v_cvt_pk_bf16_f32 v172, v104, v105
    v_max3_f32 v246, v60, v61, v246
    v_exp_f32 v108, v108
    v_mfma_f32_32x32x16_bf16 v[64:79], v[160:163], v[234:237], 0
    v_max3_f32 v247, v62, v63, v247
    v_exp_f32 v109, v109
    buffer_load_dwordx4 v242, s[20:23], s67 offen offset:3072 sc1 lds
    v_cvt_pk_bf16_f32 v173, v106, v107
    v_exp_f32 v110, v110
    v_mfma_f32_32x32x16_bf16 v[64:79], v[164:167], v[238:241], v[64:79]
    v_exp_f32 v111, v111
    ds_read_b64 v[152:153], v243 offset:22464
    ds_read_b64 v[154:155], v243 offset:22752
    ds_read_b64 v[156:157], v250 offset:22176
    v_cvt_pk_bf16_f32 v174, v108, v109
    v_cvt_pk_bf16_f32 v175, v110, v111
    v_exp_f32 v112, v112
    v_exp_f32 v113, v113
    v_exp_f32 v114, v114
    v_exp_f32 v115, v115
    s_add_u32 m0, s54, 14336
    s_add_u32 s67, s57, 280576
    buffer_load_dwordx4 v242, s[20:23], s67 offen offset:0 sc1 lds
    v_cvt_pk_bf16_f32 v176, v112, v113
    v_exp_f32 v116, v116
    s_waitcnt lgkmcnt(0)
    s_cmp_ge_u32 s63, 4
    s_cbranch_scc1 AV1_4
    v_mov_b32 v64, 0xf149f2ca
    v_mov_b32 v65, 0xf149f2ca
    v_mov_b32 v66, 0xf149f2ca
    v_mov_b32 v67, 0xf149f2ca
    v_mov_b32 v68, 0xf149f2ca
    v_mov_b32 v69, 0xf149f2ca
    v_mov_b32 v70, 0xf149f2ca
    v_mov_b32 v71, 0xf149f2ca
    v_mov_b32 v72, 0xf149f2ca
    v_mov_b32 v73, 0xf149f2ca
    v_mov_b32 v74, 0xf149f2ca
    v_mov_b32 v75, 0xf149f2ca
    v_mov_b32 v76, 0xf149f2ca
    v_mov_b32 v77, 0xf149f2ca
    v_mov_b32 v78, 0xf149f2ca
    v_mov_b32 v79, 0xf149f2ca
AV1_4:
    v_exp_f32 v117, v117
    v_cvt_pk_bf16_f32 v177, v114, v115
    v_max3_f32 v246, v64, v65, v246
    v_exp_f32 v118, v118
    v_mfma_f32_32x32x16_bf16 v[200:215], v[184:187], v[168:171], v[200:215]
    v_max3_f32 v247, v66, v67, v247
    v_exp_f32 v119, v119
    v_cvt_pk_bf16_f32 v178, v116, v117
    v_max3_f32 v246, v68, v69, v246
    v_exp_f32 v120, v120
    v_max3_f32 v247, v70, v71, v247
    v_exp_f32 v121, v121
    v_mfma_f32_32x32x16_bf16 v[200:215], v[188:191], v[172:175], v[200:215]
    v_cvt_pk_bf16_f32 v179, v118, v119
    v_max3_f32 v246, v72, v73, v246
    v_exp_f32 v122, v122
    v_max3_f32 v247, v74, v75, v247
    v_exp_f32 v123, v123
    v_cvt_pk_bf16_f32 v180, v120, v121
    v_max3_f32 v246, v76, v77, v246
    v_exp_f32 v124, v124
    v_mfma_f32_32x32x16_bf16 v[80:95], v[144:147], v[234:237], 0
    v_max3_f32 v247, v78, v79, v247
    v_exp_f32 v125, v125
    v_cvt_pk_bf16_f32 v181, v122, v123
    v_exp_f32 v126, v126
    v_mfma_f32_32x32x16_bf16 v[80:95], v[148:151], v[238:241], v[80:95]
    v_exp_f32 v127, v127
    ds_read_b64 v[160:161], v243 offset:25920
    ds_read_b64 v[162:163], v243 offset:26208
    ds_read_b64 v[164:165], v250 offset:25632
    v_cvt_pk_bf16_f32 v182, v124, v125
    v_cvt_pk_bf16_f32 v183, v126, v127
    s_waitcnt lgkmcnt(0)
    s_nop 0
    v_mfma_f32_32x32x16_bf16 v[200:215], v[192:195], v[176:179], v[200:215]
    v_mfma_f32_32x32x16_bf16 v[200:215], v[196:199], v[180:183], v[200:215]
    v_mfma_f32_32x32x16_bf16 v[96:111], v[152:155], v[234:237], 0
    v_mfma_f32_32x32x16_bf16 v[96:111], v[156:159], v[238:241], v[96:111]
    v_mfma_f32_32x32x16_bf16 v[112:127], v[160:163], v[234:237], 0
    v_mfma_f32_32x32x16_bf16 v[112:127], v[164:167], v[238:241], v[112:127]
    s_cmp_ge_u32 s63, 3
    s_cbranch_scc1 AV1_5
    v_mov_b32 v80, 0xf149f2ca
    v_mov_b32 v81, 0xf149f2ca
    v_mov_b32 v82, 0xf149f2ca
    v_mov_b32 v83, 0xf149f2ca
    v_mov_b32 v84, 0xf149f2ca
    v_mov_b32 v85, 0xf149f2ca
    v_mov_b32 v86, 0xf149f2ca
    v_mov_b32 v87, 0xf149f2ca
    v_mov_b32 v88, 0xf149f2ca
    v_mov_b32 v89, 0xf149f2ca
    v_mov_b32 v90, 0xf149f2ca
    v_mov_b32 v91, 0xf149f2ca
    v_mov_b32 v92, 0xf149f2ca
    v_mov_b32 v93, 0xf149f2ca
    v_mov_b32 v94, 0xf149f2ca
    v_mov_b32 v95, 0xf149f2ca
AV1_5:
    v_max3_f32 v246, v80, v81, v246
    v_max3_f32 v247, v82, v83, v247
    v_max3_f32 v246, v84, v85, v246
    v_max3_f32 v247, v86, v87, v247
    v_max3_f32 v246, v88, v89, v246
    v_max3_f32 v247, v90, v91, v247
    v_max3_f32 v246, v92, v93, v246
    v_max3_f32 v247, v94, v95, v247
    s_nop 1
    ds_read_b64_tr_b16 v[128:129], v245 offset:29952
    ds_read_b64_tr_b16 v[130:131], v245 offset:30016
    ds_read_b64_tr_b16 v[132:133], v245 offset:30080
    ds_read_b64_tr_b16 v[134:135], v245 offset:30144
    ds_read_b64_tr_b16 v[184:185], v245 offset:0
    ds_read_b64_tr_b16 v[186:187], v245 offset:64
    ds_read_b64_tr_b16 v[188:189], v245 offset:128
    ds_read_b64_tr_b16 v[190:191], v245 offset:192
    s_cmp_ge_u32 s63, 2
    s_cbranch_scc1 AV1_6
    v_mov_b32 v96, 0xf149f2ca
    v_mov_b32 v97, 0xf149f2ca
    v_mov_b32 v98, 0xf149f2ca
    v_mov_b32 v99, 0xf149f2ca
    v_mov_b32 v100, 0xf149f2ca
    v_mov_b32 v101, 0xf149f2ca
    v_mov_b32 v102, 0xf149f2ca
    v_mov_b32 v103, 0xf149f2ca
    v_mov_b32 v104, 0xf149f2ca
    v_mov_b32 v105, 0xf149f2ca
    v_mov_b32 v106, 0xf149f2ca
    v_mov_b32 v107, 0xf149f2ca
    v_mov_b32 v108, 0xf149f2ca
    v_mov_b32 v109, 0xf149f2ca
    v_mov_b32 v110, 0xf149f2ca
    v_mov_b32 v111, 0xf149f2ca
AV1_6:
    v_max3_f32 v246, v96, v97, v246
    v_max3_f32 v247, v98, v99, v247
    v_max3_f32 v246, v100, v101, v246
    v_max3_f32 v247, v102, v103, v247
    v_max3_f32 v246, v104, v105, v246
    v_max3_f32 v247, v106, v107, v247
    v_max3_f32 v246, v108, v109, v246
    v_max3_f32 v247, v110, v111, v247
    s_cmp_ge_u32 s63, 1
    s_cbranch_scc1 AV1_7
    v_mov_b32 v112, 0xf149f2ca
    v_mov_b32 v113, 0xf149f2ca
    v_mov_b32 v114, 0xf149f2ca
    v_mov_b32 v115, 0xf149f2ca
    v_mov_b32 v116, 0xf149f2ca
    v_mov_b32 v117, 0xf149f2ca
    v_mov_b32 v118, 0xf149f2ca
    v_mov_b32 v119, 0xf149f2ca
    v_mov_b32 v120, 0xf149f2ca
    v_mov_b32 v121, 0xf149f2ca
    v_mov_b32 v122, 0xf149f2ca
    v_mov_b32 v123, 0xf149f2ca
    v_mov_b32 v124, 0xf149f2ca
    v_mov_b32 v125, 0xf149f2ca
    v_mov_b32 v126, 0xf149f2ca
    v_mov_b32 v127, 0xf149f2ca
AV1_7:
    v_max3_f32 v246, v112, v113, v246
    v_max3_f32 v247, v114, v115, v247
    v_max3_f32 v246, v116, v117, v246
    v_max3_f32 v247, v118, v119, v247
    v_max3_f32 v246, v120, v121, v246
    v_max3_f32 v247, v122, v123, v247
    v_max3_f32 v246, v124, v125, v246
    v_max3_f32 v247, v126, v127, v247
    v_max_f32 v246, v246, v247
    v_mov_b32 v247, v246
    s_nop 1
    v_permlane32_swap_b32 v246, v247
    s_nop 1
    v_max_f32 v246, v246, v247
    v_and_b32 v247, 0xffff0000, v246
    v_sub_f32 v246, v246, v247
    v_and_b32 v248, 0xffff0000, v246
    v_sub_f32 v246, v246, v248
    v_cvt_pk_bf16_f32 v247, -v247, -v248
    v_cvt_pk_bf16_f32 v248, -v246, v255
    v_cndmask_b32 v216, v255, v247, s[58:59]
    v_cndmask_b32 v217, v255, v248, s[58:59]
    s_nop 1
    v_mfma_f32_32x32x16_bf16 v[0:15], v[222:225], v[216:219], v[0:15]
    v_mfma_f32_32x32x16_bf16 v[16:31], v[222:225], v[216:219], v[16:31]
    v_mov_b32 v220, v208
    v_mov_b32 v221, v208
    s_lshr_b32 s60, s61, 1
    s_mul_i32 s60, s60, 5
    v_permlane32_swap_b32 v220, v221
    s_lshl_b32 s68, s66, 1
    s_add_u32 s68, s68, s60
    v_rcp_f32 v221, v221
    s_mul_i32 s69, s63, 151552
    s_add_u32 s69, s69, 8499200
    v_mul_f32 v200, v200, v221
    v_mul_f32 v201, v201, v221
    v_mul_f32 v202, v202, v221
    v_mul_f32 v203, v203, v221
    v_mul_f32 v204, v204, v221
    v_mul_f32 v205, v205, v221
    v_mul_f32 v206, v206, v221
    v_mul_f32 v207, v207, v221
    v_mul_f32 v208, v208, v221
    v_mul_f32 v209, v209, v221
    v_mul_f32 v210, v210, v221
    v_mul_f32 v211, v211, v221
    v_cvt_pk_bf16_f32 v212, v200, v201
    v_cvt_pk_bf16_f32 v213, v202, v203
    v_cvt_pk_bf16_f32 v214, v204, v205
    v_cvt_pk_bf16_f32 v215, v206, v207
    v_cvt_pk_bf16_f32 v226, v208, v209
    v_cvt_pk_bf16_f32 v227, v210, v211
    s_lshl_b32 s68, s68, 10
    s_add_u32 s68, s68, s69
    buffer_store_dwordx4 v[212:215], v242, s[20:23], s68 offen offset:0 sc1
    buffer_load_dword v251, v252, s[20:23], 0 offen sc1
    v_exp_f32 v0, v0
    v_exp_f32 v1, v1
    v_mfma_f32_32x32x16_bf16 v[32:47], v[222:225], v[216:219], v[32:47]
    v_exp_f32 v2, v2
    v_exp_f32 v3, v3
    v_cvt_pk_bf16_f32 v168, v0, v1
    v_exp_f32 v4, v4
    v_exp_f32 v5, v5
    v_cvt_pk_bf16_f32 v169, v2, v3
    v_exp_f32 v6, v6
    v_exp_f32 v7, v7
    v_cvt_pk_bf16_f32 v170, v4, v5
    v_exp_f32 v8, v8
    v_exp_f32 v9, v9
    v_cvt_pk_bf16_f32 v171, v6, v7
    v_exp_f32 v10, v10
    ds_read_b64_tr_b16 v[192:193], v245 offset:3744
    ds_read_b64_tr_b16 v[194:195], v245 offset:3808
    ds_read_b64_tr_b16 v[196:197], v245 offset:3872
    ds_read_b64_tr_b16 v[198:199], v245 offset:3936
    v_exp_f32 v11, v11
    v_cvt_pk_bf16_f32 v172, v8, v9
    v_exp_f32 v12, v12
    v_exp_f32 v13, v13
    v_cvt_pk_bf16_f32 v173, v10, v11
    v_exp_f32 v14, v14
    v_exp_f32 v15, v15
    v_cvt_pk_bf16_f32 v174, v12, v13
    v_cvt_pk_bf16_f32 v175, v14, v15
    v_accvgpr_read_b32 v220, a100
    v_bfi_b32 v136, v220, v255, v168
    v_and_b32 v168, v220, v168
    v_accvgpr_read_b32 v220, a101
    v_bfi_b32 v137, v220, v255, v169
    v_and_b32 v169, v220, v169
    v_accvgpr_read_b32 v220, a102
    v_bfi_b32 v138, v220, v255, v170
    v_and_b32 v170, v220, v170
    v_accvgpr_read_b32 v220, a103
    v_bfi_b32 v139, v220, v255, v171
    v_and_b32 v171, v220, v171
    v_accvgpr_read_b32 v220, a104
    v_bfi_b32 v140, v220, v255, v172
    v_and_b32 v172, v220, v172
    v_accvgpr_read_b32 v220, a105
    v_bfi_b32 v141, v220, v255, v173
    v_and_b32 v173, v220, v173
    v_accvgpr_read_b32 v220, a106
    v_bfi_b32 v142, v220, v255, v174
    v_and_b32 v174, v220, v174
    v_accvgpr_read_b32 v220, a107
    v_bfi_b32 v143, v220, v255, v175
    v_and_b32 v175, v220, v175
    v_exp_f32 v16, v16
    v_exp_f32 v17, v17
    v_mfma_f32_32x32x16_bf16 v[48:63], v[222:225], v[216:219], v[48:63]
    v_exp_f32 v18, v18
    s_waitcnt lgkmcnt(0)
    v_mfma_f32_32x32x16_bf16 v[200:215], v[128:131], v[136:139], 0
    v_exp_f32 v19, v19
    v_cvt_pk_bf16_f32 v176, v16, v17
    v_exp_f32 v20, v20
    v_mfma_f32_32x32x16_bf16 v[200:215], v[132:135], v[140:143], v[200:215]
    v_exp_f32 v21, v21
    v_cvt_pk_bf16_f32 v177, v18, v19
    v_exp_f32 v22, v22
    v_mfma_f32_32x32x16_bf16 v[200:215], v[184:187], v[168:171], v[200:215]
    v_exp_f32 v23, v23
    v_cvt_pk_bf16_f32 v178, v20, v21
    v_exp_f32 v24, v24
    v_exp_f32 v25, v25
    v_mfma_f32_32x32x16_bf16 v[200:215], v[188:191], v[172:175], v[200:215]
    v_cvt_pk_bf16_f32 v179, v22, v23
    v_exp_f32 v26, v26
    ds_read_b64_tr_b16 v[184:185], v245 offset:7488
    ds_read_b64_tr_b16 v[186:187], v245 offset:7552
    ds_read_b64_tr_b16 v[188:189], v245 offset:7616
    ds_read_b64_tr_b16 v[190:191], v245 offset:7680
    v_exp_f32 v27, v27
    v_cvt_pk_bf16_f32 v180, v24, v25
    v_exp_f32 v28, v28
    v_exp_f32 v29, v29
    v_cvt_pk_bf16_f32 v181, v26, v27
    v_exp_f32 v30, v30
    v_exp_f32 v31, v31
    v_cvt_pk_bf16_f32 v182, v28, v29
    v_cvt_pk_bf16_f32 v183, v30, v31
    v_exp_f32 v32, v32
    s_cmp_lg_u32 s25, 0
    s_cbranch_scc1 PD19
    s_waitcnt vmcnt(0)
    s_mov_b32 s88, 0
    s_add_u32 s83, s98, 2
PL19:
    v_subrev_u32 v251, s83, v251
    v_cmp_lt_u32 vcc, v253, v251
    s_cbranch_vccz PD19
    s_add_u32 s88, s88, 1
    s_cmp_gt_u32 s88, 0x40000
    s_cbranch_scc1 PD19
    s_sleep 4
    buffer_load_dword v251, v252, s[20:23], 0 offen sc1
    s_waitcnt vmcnt(0)
    s_branch PL19
PD19:
    s_barrier
    v_bfe_u32 v238, v242, 4, 4
    v_lshrrev_b32 v239, 8, v242
    v_lshlrev_b32 v238, 4, v238
    v_lshl_add_u32 v238, v239, 9, v238
    v_add_u32 v239, 151552, v238
    s_lshl_b32 s60, s24, 2
    s_and_b32 s52, s26, 3
    s_add_u32 s55, s60, s52
    s_mul_i32 s52, s55, 303104
    s_lshl_b32 s53, s25, 11
    s_add_u32 s52, s52, s53
    s_add_u32 s52, s52, 8388608
    v_exp_f32 v33, v33
    v_mfma_f32_32x32x16_bf16 v[64:79], v[222:225], v[216:219], v[64:79]
    v_exp_f32 v34, v34
    v_exp_f32 v35, v35
    v_cvt_pk_bf16_f32 v168, v32, v33
    v_exp_f32 v36, v36
    s_waitcnt lgkmcnt(0)
    v_exp_f32 v37, v37
    v_cvt_pk_bf16_f32 v169, v34, v35
    v_exp_f32 v38, v38
    v_mfma_f32_32x32x16_bf16 v[200:215], v[192:195], v[176:179], v[200:215]
    v_exp_f32 v39, v39
    v_cvt_pk_bf16_f32 v170, v36, v37
    v_exp_f32 v40, v40
    v_exp_f32 v41, v41
    v_mfma_f32_32x32x16_bf16 v[200:215], v[196:199], v[180:183], v[200:215]
    v_cvt_pk_bf16_f32 v171, v38, v39
    v_exp_f32 v42, v42
    ds_read_b64_tr_b16 v[192:193], v245 offset:11232
    ds_read_b64_tr_b16 v[194:195], v245 offset:11296
    ds_read_b64_tr_b16 v[196:197], v245 offset:11360
    ds_read_b64_tr_b16 v[198:199], v245 offset:11424
    v_exp_f32 v43, v43
    s_add_u32 s53, s52, 0
    buffer_load_dwordx4 v[0:3], v238, s[20:23], s53 offen offset:0 sc1
    buffer_load_dwordx4 v[4:7], v238, s[20:23], s53 offen offset:256 sc1
    buffer_load_dwordx4 v[8:11], v239, s[20:23], s53 offen offset:0 sc1
    buffer_load_dwordx4 v[12:15], v239, s[20:23], s53 offen offset:256 sc1
    v_cvt_pk_bf16_f32 v172, v40, v41
    v_exp_f32 v44, v44
    v_exp_f32 v45, v45
    v_cvt_pk_bf16_f32 v173, v42, v43
    v_exp_f32 v46, v46
    v_exp_f32 v47, v47
    v_cvt_pk_bf16_f32 v174, v44, v45
    v_cvt_pk_bf16_f32 v175, v46, v47
    v_exp_f32 v48, v48
    v_exp_f32 v49, v49
    v_mfma_f32_32x32x16_bf16 v[80:95], v[222:225], v[216:219], v[80:95]
    v_exp_f32 v50, v50
    v_exp_f32 v51, v51
    v_cvt_pk_bf16_f32 v176, v48, v49
    v_exp_f32 v52, v52
    s_waitcnt lgkmcnt(0)
    v_exp_f32 v53, v53
    v_cvt_pk_bf16_f32 v177, v50, v51
    v_exp_f32 v54, v54
    v_mfma_f32_32x32x16_bf16 v[200:215], v[184:187], v[168:171], v[200:215]
    v_exp_f32 v55, v55
    v_cvt_pk_bf16_f32 v178, v52, v53
    v_exp_f32 v56, v56
    v_exp_f32 v57, v57
    v_mfma_f32_32x32x16_bf16 v[200:215], v[188:191], v[172:175], v[200:215]
    v_cvt_pk_bf16_f32 v179, v54, v55
    v_exp_f32 v58, v58
    ds_read_b64_tr_b16 v[184:185], v245 offset:14976
    ds_read_b64_tr_b16 v[186:187], v245 offset:15040
    ds_read_b64_tr_b16 v[188:189], v245 offset:15104
    ds_read_b64_tr_b16 v[190:191], v245 offset:15168
    v_exp_f32 v59, v59
    s_add_u32 s53, s52, 8192
    buffer_load_dwordx4 v[16:19], v238, s[20:23], s53 offen offset:0 sc1
    buffer_load_dwordx4 v[20:23], v238, s[20:23], s53 offen offset:256 sc1
    buffer_load_dwordx4 v[24:27], v239, s[20:23], s53 offen offset:0 sc1
    buffer_load_dwordx4 v[28:31], v239, s[20:23], s53 offen offset:256 sc1
    v_cvt_pk_bf16_f32 v180, v56, v57
    v_exp_f32 v60, v60
    v_exp_f32 v61, v61
    v_cvt_pk_bf16_f32 v181, v58, v59
    v_exp_f32 v62, v62
    v_exp_f32 v63, v63
    v_cvt_pk_bf16_f32 v182, v60, v61
    v_cvt_pk_bf16_f32 v183, v62, v63
    v_exp_f32 v64, v64
    v_exp_f32 v65, v65
    v_mfma_f32_32x32x16_bf16 v[96:111], v[222:225], v[216:219], v[96:111]
    v_exp_f32 v66, v66
    v_exp_f32 v67, v67
    v_cvt_pk_bf16_f32 v168, v64, v65
    v_exp_f32 v68, v68
    s_waitcnt lgkmcnt(0)
    v_exp_f32 v69, v69
    v_cvt_pk_bf16_f32 v169, v66, v67
    v_exp_f32 v70, v70
    v_mfma_f32_32x32x16_bf16 v[200:215], v[192:195], v[176:179], v[200:215]
    v_exp_f32 v71, v71
    v_cvt_pk_bf16_f32 v170, v68, v69
    v_exp_f32 v72, v72
    v_exp_f32 v73, v73
    v_mfma_f32_32x32x16_bf16 v[200:215], v[196:199], v[180:183], v[200:215]
    v_cvt_pk_bf16_f32 v171, v70, v71
    v_exp_f32 v74, v74
    ds_read_b64_tr_b16 v[192:193], v245 offset:18720
    ds_read_b64_tr_b16 v[194:195], v245 offset:18784
    ds_read_b64_tr_b16 v[196:197], v245 offset:18848
    ds_read_b64_tr_b16 v[198:199], v245 offset:18912
    v_exp_f32 v75, v75
    s_add_u32 s53, s52, 16384
    buffer_load_dwordx4 v[32:35], v238, s[20:23], s53 offen offset:0 sc1
    buffer_load_dwordx4 v[36:39], v238, s[20:23], s53 offen offset:256 sc1
    buffer_load_dwordx4 v[40:43], v239, s[20:23], s53 offen offset:0 sc1
    buffer_load_dwordx4 v[44:47], v239, s[20:23], s53 offen offset:256 sc1
    v_cvt_pk_bf16_f32 v172, v72, v73
    v_exp_f32 v76, v76
    v_exp_f32 v77, v77
    v_cvt_pk_bf16_f32 v173, v74, v75
    v_exp_f32 v78, v78
    v_exp_f32 v79, v79
    v_cvt_pk_bf16_f32 v174, v76, v77
    v_cvt_pk_bf16_f32 v175, v78, v79
    v_exp_f32 v80, v80
    v_exp_f32 v81, v81
    v_mfma_f32_32x32x16_bf16 v[112:127], v[222:225], v[216:219], v[112:127]
    v_exp_f32 v82, v82
    v_exp_f32 v83, v83
    v_cvt_pk_bf16_f32 v176, v80, v81
    v_exp_f32 v84, v84
    s_waitcnt lgkmcnt(0)
    v_exp_f32 v85, v85
    v_cvt_pk_bf16_f32 v177, v82, v83
    v_exp_f32 v86, v86
    v_mfma_f32_32x32x16_bf16 v[200:215], v[184:187], v[168:171], v[200:215]
    v_exp_f32 v87, v87
    v_cvt_pk_bf16_f32 v178, v84, v85
    v_exp_f32 v88, v88
    v_exp_f32 v89, v89
    v_mfma_f32_32x32x16_bf16 v[200:215], v[188:191], v[172:175], v[200:215]
    v_cvt_pk_bf16_f32 v179, v86, v87
    v_exp_f32 v90, v90
    ds_read_b64_tr_b16 v[184:185], v245 offset:22464
    ds_read_b64_tr_b16 v[186:187], v245 offset:22528
    ds_read_b64_tr_b16 v[188:189], v245 offset:22592
    ds_read_b64_tr_b16 v[190:191], v245 offset:22656
    v_exp_f32 v91, v91
    s_add_u32 s53, s52, 24576
    buffer_load_dwordx4 v[48:51], v238, s[20:23], s53 offen offset:0 sc1
    buffer_load_dwordx4 v[52:55], v238, s[20:23], s53 offen offset:256 sc1
    buffer_load_dwordx4 v[56:59], v239, s[20:23], s53 offen offset:0 sc1
    buffer_load_dwordx4 v[60:63], v239, s[20:23], s53 offen offset:256 sc1
    v_cvt_pk_bf16_f32 v180, v88, v89
    v_exp_f32 v92, v92
    v_exp_f32 v93, v93
    v_cvt_pk_bf16_f32 v181, v90, v91
    v_exp_f32 v94, v94
    v_exp_f32 v95, v95
    v_cvt_pk_bf16_f32 v182, v92, v93
    v_cvt_pk_bf16_f32 v183, v94, v95
    v_exp_f32 v96, v96
    v_exp_f32 v97, v97
    v_exp_f32 v98, v98
    v_exp_f32 v99, v99
    v_cvt_pk_bf16_f32 v168, v96, v97
    v_exp_f32 v100, v100
    s_waitcnt lgkmcnt(0)
    v_exp_f32 v101, v101
    v_cvt_pk_bf16_f32 v169, v98, v99
    v_exp_f32 v102, v102
    v_mfma_f32_32x32x16_bf16 v[200:215], v[192:195], v[176:179], v[200:215]
    v_exp_f32 v103, v103
    v_cvt_pk_bf16_f32 v170, v100, v101
    v_exp_f32 v104, v104
    v_exp_f32 v105, v105
    v_mfma_f32_32x32x16_bf16 v[200:215], v[196:199], v[180:183], v[200:215]
    v_cvt_pk_bf16_f32 v171, v102, v103
    v_exp_f32 v106, v106
    ds_read_b64_tr_b16 v[192:193], v245 offset:26208
    ds_read_b64_tr_b16 v[194:195], v245 offset:26272
    ds_read_b64_tr_b16 v[196:197], v245 offset:26336
    ds_read_b64_tr_b16 v[198:199], v245 offset:26400
    v_exp_f32 v107, v107
    s_add_u32 s53, s52, 32768
    buffer_load_dwordx4 v[64:67], v238, s[20:23], s53 offen offset:0 sc1
    buffer_load_dwordx4 v[68:71], v238, s[20:23], s53 offen offset:256 sc1
    buffer_load_dwordx4 v[72:75], v239, s[20:23], s53 offen offset:0 sc1
    buffer_load_dwordx4 v[76:79], v239, s[20:23], s53 offen offset:256 sc1
    v_cvt_pk_bf16_f32 v172, v104, v105
    v_exp_f32 v108, v108
    v_exp_f32 v109, v109
    v_cvt_pk_bf16_f32 v173, v106, v107
    v_exp_f32 v110, v110
    v_exp_f32 v111, v111
    v_cvt_pk_bf16_f32 v174, v108, v109
    v_cvt_pk_bf16_f32 v175, v110, v111
    v_exp_f32 v112, v112
    v_exp_f32 v113, v113
    v_exp_f32 v114, v114
    v_exp_f32 v115, v115
    v_cvt_pk_bf16_f32 v176, v112, v113
    v_exp_f32 v116, v116
    s_waitcnt lgkmcnt(0)
    v_exp_f32 v117, v117
    v_cvt_pk_bf16_f32 v177, v114, v115
    v_exp_f32 v118, v118
    v_mfma_f32_32x32x16_bf16 v[200:215], v[184:187], v[168:171], v[200:215]
    v_exp_f32 v119, v119
    v_cvt_pk_bf16_f32 v178, v116, v117
    v_exp_f32 v120, v120
    v_exp_f32 v121, v121
    v_mfma_f32_32x32x16_bf16 v[200:215], v[188:191], v[172:175], v[200:215]
    v_cvt_pk_bf16_f32 v179, v118, v119
    v_exp_f32 v122, v122
    v_exp_f32 v123, v123
    s_add_u32 s53, s52, 40960
    buffer_load_dwordx4 v[80:83], v238, s[20:23], s53 offen offset:0 sc1
    buffer_load_dwordx4 v[84:87], v238, s[20:23], s53 offen offset:256 sc1
    buffer_load_dwordx4 v[88:91], v239, s[20:23], s53 offen offset:0 sc1
    buffer_load_dwordx4 v[92:95], v239, s[20:23], s53 offen offset:256 sc1
    v_cvt_pk_bf16_f32 v180, v120, v121
    v_exp_f32 v124, v124
    v_exp_f32 v125, v125
    v_cvt_pk_bf16_f32 v181, v122, v123
    v_exp_f32 v126, v126
    v_exp_f32 v127, v127
    v_cvt_pk_bf16_f32 v182, v124, v125
    v_cvt_pk_bf16_f32 v183, v126, v127
    s_waitcnt lgkmcnt(0)
    s_nop 0
    v_mfma_f32_32x32x16_bf16 v[200:215], v[192:195], v[176:179], v[200:215]
    v_mfma_f32_32x32x16_bf16 v[200:215], v[196:199], v[180:183], v[200:215]
    v_lshrrev_b32 v224, 4, v242
    s_lshr_b32 s62, s55, 1
    v_lshrrev_b32 v230, 2, v224
    v_and_b32 v231, 3, v224
    s_lshl_b32 s64, s55, 2
    s_add_u32 s64, s64, s25
    s_mul_i32 s64, s64, 20480
    s_mul_i32 s65, s56, 160
    s_add_u32 s64, s64, s65
    v_mul_u32_u24 v232, 1280, v230
    v_lshl_add_u32 v232, v231, 4, v232
    v_cmp_gt_u32 s[12:13], 2, v231
    s_mov_b32 s8, s96
    s_mov_b32 s9, s97
    s_mov_b32 s10, 2621440
    s_mov_b32 s11, 0x20000
    v_lshrrev_b32 v235, 4, v224
    v_sub_u32 v233, s62, v235
    v_cmp_gt_u32 vcc, 1, v235
    v_cmp_le_i32 s[94:95], 0, v233
    v_and_b32 v235, 15, v224
    s_and_b64 s[94:95], vcc, s[94:95]
    v_cmp_gt_u32 vcc, 16, v235
    v_lshlrev_b32 v233, 12, v233
    v_lshl_add_u32 v233, v235, 2, v233
    s_and_b64 vcc, vcc, s[94:95]
    v_add_u32 v233, s81, v233
    v_mov_b32 v234, -1
    v_mov_b32 v235, 0x7ff00000
    v_cndmask_b32 v234, v234, 0, vcc
    v_cndmask_b32 v233, v235, v233, vcc
    v_mov_b32 v220, v208
    v_mov_b32 v221, v208
    s_lshr_b32 s60, s61, 1
    s_mul_i32 s60, s60, 5
    v_permlane32_swap_b32 v220, v221
    s_lshl_b32 s68, s66, 1
    s_add_u32 s68, s68, s60
    v_rcp_f32 v221, v221
    s_mul_i32 s69, s63, 151552
    s_add_u32 s69, s69, 8499200
    v_mul_f32 v200, v200, v221
    v_mul_f32 v201, v201, v221
    v_mul_f32 v202, v202, v221
    v_mul_f32 v203, v203, v221
    v_mul_f32 v204, v204, v221
    v_mul_f32 v205, v205, v221
    v_mul_f32 v206, v206, v221
    v_mul_f32 v207, v207, v221
    v_mul_f32 v208, v208, v221
    v_mul_f32 v209, v209, v221
    v_mul_f32 v210, v210, v221
    v_mul_f32 v211, v211, v221
    v_cvt_pk_bf16_f32 v212, v200, v201
    v_cvt_pk_bf16_f32 v213, v202, v203
    v_cvt_pk_bf16_f32 v214, v204, v205
    v_cvt_pk_bf16_f32 v215, v206, v207
    v_cvt_pk_bf16_f32 v228, v208, v209
    v_cvt_pk_bf16_f32 v229, v210, v211
    s_lshl_b32 s68, s68, 10
    s_add_u32 s68, s68, s69
    buffer_store_dwordx4 v[212:215], v242, s[20:23], s68 offen offset:1024 sc1
    s_lshl_b32 s60, s60, 10
    s_add_u32 s60, s60, s69
    s_lshl_b32 s68, s66, 9
    s_add_u32 s60, s60, s68
    s_add_u32 s60, s60, 4096
    s_mov_b64 exec, s[58:59]
    buffer_store_dwordx4 v[226:229], v242, s[20:23], s60 offen sc1
    s_mov_b64 exec, -1
    s_add_u32 s53, s52, 49152
    buffer_load_dwordx4 v[96:99], v238, s[20:23], s53 offen offset:0 sc1
    buffer_load_dwordx4 v[100:103], v238, s[20:23], s53 offen offset:256 sc1
    buffer_load_dwordx4 v[104:107], v239, s[20:23], s53 offen offset:0 sc1
    buffer_load_dwordx4 v[108:111], v239, s[20:23], s53 offen offset:256 sc1
    s_add_u32 s53, s52, 57344
    buffer_load_dwordx4 v[112:115], v238, s[20:23], s53 offen offset:0 sc1
    buffer_load_dwordx4 v[116:119], v238, s[20:23], s53 offen offset:256 sc1
    buffer_load_dwordx4 v[120:123], v239, s[20:23], s53 offen offset:0 sc1
    buffer_load_dwordx4 v[124:127], v239, s[20:23], s53 offen offset:256 sc1
ATT_END:
    s_waitcnt vmcnt(30)
    v_mfma_f32_16x16x32_bf16 v[144:147], a[112:115], v[0:3], 0
    s_add_u32 s53, s52, 65536
    buffer_load_dwordx4 v[128:131], v238, s[20:23], s53 offen offset:0 sc1
    v_mfma_f32_16x16x32_bf16 v[148:151], a[116:119], v[0:3], 0
    v_mfma_f32_16x16x32_bf16 v[152:155], a[120:123], v[0:3], 0
    v_mfma_f32_16x16x32_bf16 v[156:159], a[124:127], v[0:3], 0
    v_mfma_f32_16x16x32_bf16 v[160:163], a[128:131], v[0:3], 0
    v_mfma_f32_16x16x32_bf16 v[164:167], a[112:115], v[4:7], 0
    buffer_load_dwordx4 v[132:135], v238, s[20:23], s53 offen offset:256 sc1
    v_mfma_f32_16x16x32_bf16 v[168:171], a[116:119], v[4:7], 0
    v_mfma_f32_16x16x32_bf16 v[172:175], a[120:123], v[4:7], 0
    v_mfma_f32_16x16x32_bf16 v[176:179], a[124:127], v[4:7], 0
    v_mfma_f32_16x16x32_bf16 v[180:183], a[128:131], v[4:7], 0
    v_mfma_f32_16x16x32_bf16 v[184:187], a[112:115], v[8:11], 0
    buffer_load_dwordx4 v[136:139], v239, s[20:23], s53 offen offset:0 sc1
    v_mfma_f32_16x16x32_bf16 v[188:191], a[116:119], v[8:11], 0
    v_mfma_f32_16x16x32_bf16 v[192:195], a[120:123], v[8:11], 0
    v_mfma_f32_16x16x32_bf16 v[196:199], a[124:127], v[8:11], 0
    v_mfma_f32_16x16x32_bf16 v[200:203], a[128:131], v[8:11], 0
    v_mfma_f32_16x16x32_bf16 v[204:207], a[112:115], v[12:15], 0
    buffer_load_dwordx4 v[140:143], v239, s[20:23], s53 offen offset:256 sc1
    v_mfma_f32_16x16x32_bf16 v[208:211], a[116:119], v[12:15], 0
    v_mfma_f32_16x16x32_bf16 v[212:215], a[120:123], v[12:15], 0
    v_mfma_f32_16x16x32_bf16 v[216:219], a[124:127], v[12:15], 0
    v_mfma_f32_16x16x32_bf16 v[220:223], a[128:131], v[12:15], 0
    s_waitcnt vmcnt(12)
    s_barrier
    s_cmp_lg_u32 s25, 0
    s_cbranch_scc1 FL20
    s_add_u32 s83, s98, 3
    v_mov_b32 v236, s83
    v_mov_b32 v237, 0
    s_mov_b64 exec, 1
    buffer_store_dword v236, v237, s[20:23], s89 offen offset:0 sc1
    s_mov_b64 exec, -1
FL20:
    v_add_u32 v241, s54, v242
    ds_read_b128 a[112:115], v241 offset:0
    ds_read_b128 a[116:119], v241 offset:1024
    ds_read_b128 a[120:123], v241 offset:2048
    ds_read_b128 a[124:127], v241 offset:3072
    ds_read_b128 a[128:131], v241 offset:4096
    v_mfma_f32_16x16x32_bf16 v[144:147], a[132:135], v[16:19], v[144:147]
    s_add_u32 s53, s52, 73728
    buffer_load_dwordx4 v[0:3], v238, s[20:23], s53 offen offset:0 sc1
    v_mfma_f32_16x16x32_bf16 v[148:151], a[136:139], v[16:19], v[148:151]
    v_mfma_f32_16x16x32_bf16 v[152:155], a[140:143], v[16:19], v[152:155]
    v_mfma_f32_16x16x32_bf16 v[156:159], a[144:147], v[16:19], v[156:159]
    v_mfma_f32_16x16x32_bf16 v[160:163], a[148:151], v[16:19], v[160:163]
    v_mfma_f32_16x16x32_bf16 v[164:167], a[132:135], v[20:23], v[164:167]
    buffer_load_dwordx4 v[4:7], v238, s[20:23], s53 offen offset:256 sc1
    v_mfma_f32_16x16x32_bf16 v[168:171], a[136:139], v[20:23], v[168:171]
    v_mfma_f32_16x16x32_bf16 v[172:175], a[140:143], v[20:23], v[172:175]
    v_mfma_f32_16x16x32_bf16 v[176:179], a[144:147], v[20:23], v[176:179]
    v_mfma_f32_16x16x32_bf16 v[180:183], a[148:151], v[20:23], v[180:183]
    v_mfma_f32_16x16x32_bf16 v[184:187], a[132:135], v[24:27], v[184:187]
    buffer_load_dwordx4 v[8:11], v239, s[20:23], s53 offen offset:0 sc1
    v_mfma_f32_16x16x32_bf16 v[188:191], a[136:139], v[24:27], v[188:191]
    v_mfma_f32_16x16x32_bf16 v[192:195], a[140:143], v[24:27], v[192:195]
    v_mfma_f32_16x16x32_bf16 v[196:199], a[144:147], v[24:27], v[196:199]
    v_mfma_f32_16x16x32_bf16 v[200:203], a[148:151], v[24:27], v[200:203]
    v_mfma_f32_16x16x32_bf16 v[204:207], a[132:135], v[28:31], v[204:207]
    buffer_load_dwordx4 v[12:15], v239, s[20:23], s53 offen offset:256 sc1
    v_mfma_f32_16x16x32_bf16 v[208:211], a[136:139], v[28:31], v[208:211]
    v_mfma_f32_16x16x32_bf16 v[212:215], a[140:143], v[28:31], v[212:215]
    v_mfma_f32_16x16x32_bf16 v[216:219], a[144:147], v[28:31], v[216:219]
    v_mfma_f32_16x16x32_bf16 v[220:223], a[148:151], v[28:31], v[220:223]
    ds_read_b128 a[132:135], v241 offset:5120
    ds_read_b128 a[136:139], v241 offset:6144
    ds_read_b128 a[140:143], v241 offset:7168
    ds_read_b128 a[144:147], v241 offset:8192
    ds_read_b128 a[148:151], v241 offset:9216
    v_mfma_f32_16x16x32_bf16 v[144:147], a[152:155], v[32:35], v[144:147]
    s_add_u32 s53, s52, 81920
    buffer_load_dwordx4 v[16:19], v238, s[20:23], s53 offen offset:0 sc1
    v_mfma_f32_16x16x32_bf16 v[148:151], a[156:159], v[32:35], v[148:151]
    v_mfma_f32_16x16x32_bf16 v[152:155], a[160:163], v[32:35], v[152:155]
    v_mfma_f32_16x16x32_bf16 v[156:159], a[164:167], v[32:35], v[156:159]
    v_mfma_f32_16x16x32_bf16 v[160:163], a[168:171], v[32:35], v[160:163]
    v_mfma_f32_16x16x32_bf16 v[164:167], a[152:155], v[36:39], v[164:167]
    buffer_load_dwordx4 v[20:23], v238, s[20:23], s53 offen offset:256 sc1
    v_mfma_f32_16x16x32_bf16 v[168:171], a[156:159], v[36:39], v[168:171]
    v_mfma_f32_16x16x32_bf16 v[172:175], a[160:163], v[36:39], v[172:175]
    v_mfma_f32_16x16x32_bf16 v[176:179], a[164:167], v[36:39], v[176:179]
    v_mfma_f32_16x16x32_bf16 v[180:183], a[168:171], v[36:39], v[180:183]
    v_mfma_f32_16x16x32_bf16 v[184:187], a[152:155], v[40:43], v[184:187]
    buffer_load_dwordx4 v[24:27], v239, s[20:23], s53 offen offset:0 sc1
    v_mfma_f32_16x16x32_bf16 v[188:191], a[156:159], v[40:43], v[188:191]
    v_mfma_f32_16x16x32_bf16 v[192:195], a[160:163], v[40:43], v[192:195]
    v_mfma_f32_16x16x32_bf16 v[196:199], a[164:167], v[40:43], v[196:199]
    v_mfma_f32_16x16x32_bf16 v[200:203], a[168:171], v[40:43], v[200:203]
    v_mfma_f32_16x16x32_bf16 v[204:207], a[152:155], v[44:47], v[204:207]
    buffer_load_dwordx4 v[28:31], v239, s[20:23], s53 offen offset:256 sc1
    v_mfma_f32_16x16x32_bf16 v[208:211], a[156:159], v[44:47], v[208:211]
    v_mfma_f32_16x16x32_bf16 v[212:215], a[160:163], v[44:47], v[212:215]
    v_mfma_f32_16x16x32_bf16 v[216:219], a[164:167], v[44:47], v[216:219]
    v_mfma_f32_16x16x32_bf16 v[220:223], a[168:171], v[44:47], v[220:223]
    ds_read_b128 a[152:155], v241 offset:10240
    ds_read_b128 a[156:159], v241 offset:11264
    ds_read_b128 a[160:163], v241 offset:12288
    ds_read_b128 a[164:167], v241 offset:13312
    ds_read_b128 a[168:171], v241 offset:14336
    v_mfma_f32_16x16x32_bf16 v[144:147], a[172:175], v[48:51], v[144:147]
    s_add_u32 s53, s52, 90112
    buffer_load_dwordx4 v[32:35], v238, s[20:23], s53 offen offset:0 sc1
    v_mfma_f32_16x16x32_bf16 v[148:151], a[176:179], v[48:51], v[148:151]
    v_mfma_f32_16x16x32_bf16 v[152:155], a[180:183], v[48:51], v[152:155]
    v_mfma_f32_16x16x32_bf16 v[156:159], a[184:187], v[48:51], v[156:159]
    v_mfma_f32_16x16x32_bf16 v[160:163], a[188:191], v[48:51], v[160:163]
    v_mfma_f32_16x16x32_bf16 v[164:167], a[172:175], v[52:55], v[164:167]
    buffer_load_dwordx4 v[36:39], v238, s[20:23], s53 offen offset:256 sc1
    v_mfma_f32_16x16x32_bf16 v[168:171], a[176:179], v[52:55], v[168:171]
    v_mfma_f32_16x16x32_bf16 v[172:175], a[180:183], v[52:55], v[172:175]
    v_mfma_f32_16x16x32_bf16 v[176:179], a[184:187], v[52:55], v[176:179]
    v_mfma_f32_16x16x32_bf16 v[180:183], a[188:191], v[52:55], v[180:183]
    v_mfma_f32_16x16x32_bf16 v[184:187], a[172:175], v[56:59], v[184:187]
    buffer_load_dwordx4 v[40:43], v239, s[20:23], s53 offen offset:0 sc1
    v_mfma_f32_16x16x32_bf16 v[188:191], a[176:179], v[56:59], v[188:191]
    v_mfma_f32_16x16x32_bf16 v[192:195], a[180:183], v[56:59], v[192:195]
    v_mfma_f32_16x16x32_bf16 v[196:199], a[184:187], v[56:59], v[196:199]
    v_mfma_f32_16x16x32_bf16 v[200:203], a[188:191], v[56:59], v[200:203]
    v_mfma_f32_16x16x32_bf16 v[204:207], a[172:175], v[60:63], v[204:207]
    buffer_load_dwordx4 v[44:47], v239, s[20:23], s53 offen offset:256 sc1
    v_mfma_f32_16x16x32_bf16 v[208:211], a[176:179], v[60:63], v[208:211]
    v_mfma_f32_16x16x32_bf16 v[212:215], a[180:183], v[60:63], v[212:215]
    v_mfma_f32_16x16x32_bf16 v[216:219], a[184:187], v[60:63], v[216:219]
    v_mfma_f32_16x16x32_bf16 v[220:223], a[188:191], v[60:63], v[220:223]
    v_mfma_f32_16x16x32_bf16 v[144:147], a[192:195], v[64:67], v[144:147]
    s_add_u32 s53, s52, 98304
    buffer_load_dwordx4 v[48:51], v238, s[20:23], s53 offen offset:0 sc1
    v_mfma_f32_16x16x32_bf16 v[148:151], a[196:199], v[64:67], v[148:151]
    v_mfma_f32_16x16x32_bf16 v[152:155], a[200:203], v[64:67], v[152:155]
    buffer_load_dwordx4 v[52:55], v238, s[20:23], s53 offen offset:256 sc1
    v_mfma_f32_16x16x32_bf16 v[156:159], a[204:207], v[64:67], v[156:159]
    v_mfma_f32_16x16x32_bf16 v[160:163], a[208:211], v[64:67], v[160:163]
    buffer_load_dwordx4 v[56:59], v239, s[20:23], s53 offen offset:0 sc1
    v_mfma_f32_16x16x32_bf16 v[164:167], a[192:195], v[68:71], v[164:167]
    v_mfma_f32_16x16x32_bf16 v[168:171], a[196:199], v[68:71], v[168:171]
    buffer_load_dwordx4 v[60:63], v239, s[20:23], s53 offen offset:256 sc1
    v_mfma_f32_16x16x32_bf16 v[172:175], a[200:203], v[68:71], v[172:175]
    v_mfma_f32_16x16x32_bf16 v[176:179], a[204:207], v[68:71], v[176:179]
    s_add_u32 s67, s57, 296960
    buffer_load_dwordx4 a[172:175], v242, s[20:23], s67 offen offset:0 sc1
    v_mfma_f32_16x16x32_bf16 v[180:183], a[208:211], v[68:71], v[180:183]
    v_mfma_f32_16x16x32_bf16 v[184:187], a[192:195], v[72:75], v[184:187]
    v_mfma_f32_16x16x32_bf16 v[188:191], a[196:199], v[72:75], v[188:191]
    buffer_load_dwordx4 a[176:179], v242, s[20:23], s67 offen offset:1024 sc1
    v_mfma_f32_16x16x32_bf16 v[192:195], a[200:203], v[72:75], v[192:195]
    v_mfma_f32_16x16x32_bf16 v[196:199], a[204:207], v[72:75], v[196:199]
    buffer_load_dwordx4 a[180:183], v242, s[20:23], s67 offen offset:2048 sc1
    v_mfma_f32_16x16x32_bf16 v[200:203], a[208:211], v[72:75], v[200:203]
    v_mfma_f32_16x16x32_bf16 v[204:207], a[192:195], v[76:79], v[204:207]
    buffer_load_dwordx4 a[184:187], v242, s[20:23], s67 offen offset:3072 sc1
    v_mfma_f32_16x16x32_bf16 v[208:211], a[196:199], v[76:79], v[208:211]
    v_mfma_f32_16x16x32_bf16 v[212:215], a[200:203], v[76:79], v[212:215]
    s_add_u32 s67, s57, 301056
    buffer_load_dwordx4 a[188:191], v242, s[20:23], s67 offen offset:0 sc1
    v_mfma_f32_16x16x32_bf16 v[216:219], a[204:207], v[76:79], v[216:219]
    v_mfma_f32_16x16x32_bf16 v[220:223], a[208:211], v[76:79], v[220:223]
    v_mfma_f32_16x16x32_bf16 v[144:147], a[212:215], v[80:83], v[144:147]
    s_add_u32 s53, s52, 106496
    s_cmp_ge_u32 s25, 2
    s_cselect_b32 s53, 0x7ff00000, s53
    buffer_load_dwordx4 v[64:67], v238, s[20:23], s53 offen offset:0 sc1
    v_mfma_f32_16x16x32_bf16 v[148:151], a[216:219], v[80:83], v[148:151]
    v_mfma_f32_16x16x32_bf16 v[152:155], a[220:223], v[80:83], v[152:155]
    buffer_load_dwordx4 v[68:71], v238, s[20:23], s53 offen offset:256 sc1
    v_mfma_f32_16x16x32_bf16 v[156:159], a[224:227], v[80:83], v[156:159]
    v_mfma_f32_16x16x32_bf16 v[160:163], a[228:231], v[80:83], v[160:163]
    buffer_load_dwordx4 v[72:75], v239, s[20:23], s53 offen offset:0 sc1
    v_mfma_f32_16x16x32_bf16 v[164:167], a[212:215], v[84:87], v[164:167]
    v_mfma_f32_16x16x32_bf16 v[168:171], a[216:219], v[84:87], v[168:171]
    buffer_load_dwordx4 v[76:79], v239, s[20:23], s53 offen offset:256 sc1
    v_mfma_f32_16x16x32_bf16 v[172:175], a[220:223], v[84:87], v[172:175]
    v_mfma_f32_16x16x32_bf16 v[176:179], a[224:227], v[84:87], v[176:179]
    s_add_u32 s67, s57, 317440
    buffer_load_dwordx4 a[192:195], v242, s[20:23], s67 offen offset:0 sc1
    v_mfma_f32_16x16x32_bf16 v[180:183], a[228:231], v[84:87], v[180:183]
    v_mfma_f32_16x16x32_bf16 v[184:187], a[212:215], v[88:91], v[184:187]
    v_mfma_f32_16x16x32_bf16 v[188:191], a[216:219], v[88:91], v[188:191]
    buffer_load_dwordx4 a[196:199], v242, s[20:23], s67 offen offset:1024 sc1
    v_mfma_f32_16x16x32_bf16 v[192:195], a[220:223], v[88:91], v[192:195]
    v_mfma_f32_16x16x32_bf16 v[196:199], a[224:227], v[88:91], v[196:199]
    buffer_load_dwordx4 a[200:203], v242, s[20:23], s67 offen offset:2048 sc1
    v_mfma_f32_16x16x32_bf16 v[200:203], a[228:231], v[88:91], v[200:203]
    v_mfma_f32_16x16x32_bf16 v[204:207], a[212:215], v[92:95], v[204:207]
    buffer_load_dwordx4 a[204:207], v242, s[20:23], s67 offen offset:3072 sc1
    v_mfma_f32_16x16x32_bf16 v[208:211], a[216:219], v[92:95], v[208:211]
    v_mfma_f32_16x16x32_bf16 v[212:215], a[220:223], v[92:95], v[212:215]
    s_add_u32 s67, s57, 321536
    buffer_load_dwordx4 a[208:211], v242, s[20:23], s67 offen offset:0 sc1
    v_mfma_f32_16x16x32_bf16 v[216:219], a[224:227], v[92:95], v[216:219]
    v_mfma_f32_16x16x32_bf16 v[220:223], a[228:231], v[92:95], v[220:223]
    buffer_load_dword v240, v233, s[20:23], 0 offen sc1
    s_waitcnt vmcnt(39)
    v_mfma_f32_16x16x32_bf16 v[144:147], a[232:235], v[96:99], v[144:147]
    s_add_u32 s67, s57, 337920
    buffer_load_dwordx4 a[212:215], v242, s[20:23], s67 offen offset:0 sc1
    v_mfma_f32_16x16x32_bf16 v[148:151], a[236:239], v[96:99], v[148:151]
    v_mfma_f32_16x16x32_bf16 v[152:155], a[240:243], v[96:99], v[152:155]
    v_mfma_f32_16x16x32_bf16 v[156:159], a[244:247], v[96:99], v[156:159]
    v_mfma_f32_16x16x32_bf16 v[160:163], a[248:251], v[96:99], v[160:163]
    buffer_load_dwordx4 a[216:219], v242, s[20:23], s67 offen offset:1024 sc1
    v_mfma_f32_16x16x32_bf16 v[164:167], a[232:235], v[100:103], v[164:167]
    v_mfma_f32_16x16x32_bf16 v[168:171], a[236:239], v[100:103], v[168:171]
    v_mfma_f32_16x16x32_bf16 v[172:175], a[240:243], v[100:103], v[172:175]
    v_mfma_f32_16x16x32_bf16 v[176:179], a[244:247], v[100:103], v[176:179]
    buffer_load_dwordx4 a[220:223], v242, s[20:23], s67 offen offset:2048 sc1
    v_mfma_f32_16x16x32_bf16 v[180:183], a[248:251], v[100:103], v[180:183]
    v_mfma_f32_16x16x32_bf16 v[184:187], a[232:235], v[104:107], v[184:187]
    v_mfma_f32_16x16x32_bf16 v[188:191], a[236:239], v[104:107], v[188:191]
    v_mfma_f32_16x16x32_bf16 v[192:195], a[240:243], v[104:107], v[192:195]
    buffer_load_dwordx4 a[224:227], v242, s[20:23], s67 offen offset:3072 sc1
    v_mfma_f32_16x16x32_bf16 v[196:199], a[244:247], v[104:107], v[196:199]
    v_mfma_f32_16x16x32_bf16 v[200:203], a[248:251], v[104:107], v[200:203]
    v_mfma_f32_16x16x32_bf16 v[204:207], a[232:235], v[108:111], v[204:207]
    v_mfma_f32_16x16x32_bf16 v[208:211], a[236:239], v[108:111], v[208:211]
    s_add_u32 s67, s57, 342016
    buffer_load_dwordx4 a[228:231], v242, s[20:23], s67 offen offset:0 sc1
    v_mfma_f32_16x16x32_bf16 v[212:215], a[240:243], v[108:111], v[212:215]
    v_mfma_f32_16x16x32_bf16 v[216:219], a[244:247], v[108:111], v[216:219]
    v_mfma_f32_16x16x32_bf16 v[220:223], a[248:251], v[108:111], v[220:223]
    s_waitcnt vmcnt(40)
    v_mfma_f32_16x16x32_bf16 v[144:147], a[0:3], v[112:115], v[144:147]
    s_add_u32 s67, s57, 358400
    buffer_load_dwordx4 a[232:235], v242, s[20:23], s67 offen offset:0 sc1
    v_mfma_f32_16x16x32_bf16 v[148:151], a[4:7], v[112:115], v[148:151]
    v_mfma_f32_16x16x32_bf16 v[152:155], a[8:11], v[112:115], v[152:155]
    v_mfma_f32_16x16x32_bf16 v[156:159], a[12:15], v[112:115], v[156:159]
    v_mfma_f32_16x16x32_bf16 v[160:163], a[16:19], v[112:115], v[160:163]
    buffer_load_dwordx4 a[236:239], v242, s[20:23], s67 offen offset:1024 sc1
    v_mfma_f32_16x16x32_bf16 v[164:167], a[0:3], v[116:119], v[164:167]
    v_mfma_f32_16x16x32_bf16 v[168:171], a[4:7], v[116:119], v[168:171]
    v_mfma_f32_16x16x32_bf16 v[172:175], a[8:11], v[116:119], v[172:175]
    v_mfma_f32_16x16x32_bf16 v[176:179], a[12:15], v[116:119], v[176:179]
    buffer_load_dwordx4 a[240:243], v242, s[20:23], s67 offen offset:2048 sc1
    v_mfma_f32_16x16x32_bf16 v[180:183], a[16:19], v[116:119], v[180:183]
    v_mfma_f32_16x16x32_bf16 v[184:187], a[0:3], v[120:123], v[184:187]
    v_mfma_f32_16x16x32_bf16 v[188:191], a[4:7], v[120:123], v[188:191]
    v_mfma_f32_16x16x32_bf16 v[192:195], a[8:11], v[120:123], v[192:195]
    buffer_load_dwordx4 a[244:247], v242, s[20:23], s67 offen offset:3072 sc1
    v_mfma_f32_16x16x32_bf16 v[196:199], a[12:15], v[120:123], v[196:199]
    v_mfma_f32_16x16x32_bf16 v[200:203], a[16:19], v[120:123], v[200:203]
    v_mfma_f32_16x16x32_bf16 v[204:207], a[0:3], v[124:127], v[204:207]
    v_mfma_f32_16x16x32_bf16 v[208:211], a[4:7], v[124:127], v[208:211]
    s_add_u32 s67, s57, 362496
    buffer_load_dwordx4 a[248:251], v242, s[20:23], s67 offen offset:0 sc1
    v_mfma_f32_16x16x32_bf16 v[212:215], a[8:11], v[124:127], v[212:215]
    v_mfma_f32_16x16x32_bf16 v[216:219], a[12:15], v[124:127], v[216:219]
    v_mfma_f32_16x16x32_bf16 v[220:223], a[16:19], v[124:127], v[220:223]
    s_waitcnt vmcnt(41)
    v_mfma_f32_16x16x32_bf16 v[144:147], a[20:23], v[128:131], v[144:147]
    buffer_load_dwordx4 v[244:247], v232, s[4:7], s64 offen offset:0
    v_mfma_f32_16x16x32_bf16 v[148:151], a[24:27], v[128:131], v[148:151]
    v_mfma_f32_16x16x32_bf16 v[152:155], a[28:31], v[128:131], v[152:155]
    v_mfma_f32_16x16x32_bf16 v[156:159], a[32:35], v[128:131], v[156:159]
    v_mfma_f32_16x16x32_bf16 v[160:163], a[36:39], v[128:131], v[160:163]
    v_mfma_f32_16x16x32_bf16 v[164:167], a[20:23], v[132:135], v[164:167]
    v_mfma_f32_16x16x32_bf16 v[168:171], a[24:27], v[132:135], v[168:171]
    buffer_load_dwordx4 v[248:251], v232, s[4:7], s64 offen offset:64
    v_mfma_f32_16x16x32_bf16 v[172:175], a[28:31], v[132:135], v[172:175]
    v_mfma_f32_16x16x32_bf16 v[176:179], a[32:35], v[132:135], v[176:179]
    v_mfma_f32_16x16x32_bf16 v[180:183], a[36:39], v[132:135], v[180:183]
    v_mfma_f32_16x16x32_bf16 v[184:187], a[20:23], v[136:139], v[184:187]
    v_mfma_f32_16x16x32_bf16 v[188:191], a[24:27], v[136:139], v[188:191]
    v_mfma_f32_16x16x32_bf16 v[192:195], a[28:31], v[136:139], v[192:195]
    v_mfma_f32_16x16x32_bf16 v[196:199], a[32:35], v[136:139], v[196:199]
    s_mov_b64 exec, s[12:13]
    buffer_load_dwordx4 v[252:255], v232, s[4:7], s64 offen offset:128
    s_mov_b64 exec, -1
    v_mfma_f32_16x16x32_bf16 v[200:203], a[36:39], v[136:139], v[200:203]
    v_mfma_f32_16x16x32_bf16 v[204:207], a[20:23], v[140:143], v[204:207]
    v_mfma_f32_16x16x32_bf16 v[208:211], a[24:27], v[140:143], v[208:211]
    v_mfma_f32_16x16x32_bf16 v[212:215], a[28:31], v[140:143], v[212:215]
    v_mfma_f32_16x16x32_bf16 v[216:219], a[32:35], v[140:143], v[216:219]
    v_mfma_f32_16x16x32_bf16 v[220:223], a[36:39], v[140:143], v[220:223]
    s_cmp_lg_u32 s25, 0
    s_cbranch_scc1 PD21
    s_waitcnt vmcnt(13)
    s_mov_b32 s88, 0
    s_add_u32 s83, s98, 3
PL21:
    v_subrev_u32 v240, s83, v240
    v_cmp_lt_u32 vcc, v234, v240
    s_cbranch_vccz PD21
    s_add_u32 s88, s88, 1
    s_cmp_gt_u32 s88, 0x40000
    s_cbranch_scc1 PD21
    s_sleep 4
    buffer_load_dword v240, v233, s[20:23], 0 offen sc1
    s_waitcnt vmcnt(0)
    s_branch PL21
PD21:
    s_barrier
    s_waitcnt vmcnt(40)
    v_mfma_f32_16x16x32_bf16 v[144:147], a[40:43], v[0:3], v[144:147]
    s_add_u32 s53, s52, 110592
    buffer_load_dwordx4 v[80:83], v238, s[20:23], s53 offen offset:0 sc1
    v_mfma_f32_16x16x32_bf16 v[148:151], a[44:47], v[0:3], v[148:151]
    buffer_load_dwordx4 v[84:87], v238, s[20:23], s53 offen offset:256 sc1
    v_mfma_f32_16x16x32_bf16 v[152:155], a[48:51], v[0:3], v[152:155]
    buffer_load_dwordx4 v[88:91], v239, s[20:23], s53 offen offset:0 sc1
    v_mfma_f32_16x16x32_bf16 v[156:159], a[52:55], v[0:3], v[156:159]
    buffer_load_dwordx4 v[92:95], v239, s[20:23], s53 offen offset:256 sc1
    v_mfma_f32_16x16x32_bf16 v[160:163], a[56:59], v[0:3], v[160:163]
    v_mfma_f32_16x16x32_bf16 v[164:167], a[40:43], v[4:7], v[164:167]
    s_add_u32 s53, s52, 118784
    buffer_load_dwordx4 v[96:99], v238, s[20:23], s53 offen offset:0 sc1
    v_mfma_f32_16x16x32_bf16 v[168:171], a[44:47], v[4:7], v[168:171]
    buffer_load_dwordx4 v[100:103], v238, s[20:23], s53 offen offset:256 sc1
    v_mfma_f32_16x16x32_bf16 v[172:175], a[48:51], v[4:7], v[172:175]
    buffer_load_dwordx4 v[104:107], v239, s[20:23], s53 offen offset:0 sc1
    v_mfma_f32_16x16x32_bf16 v[176:179], a[52:55], v[4:7], v[176:179]
    buffer_load_dwordx4 v[108:111], v239, s[20:23], s53 offen offset:256 sc1
    v_mfma_f32_16x16x32_bf16 v[180:183], a[56:59], v[4:7], v[180:183]
    v_mfma_f32_16x16x32_bf16 v[184:187], a[40:43], v[8:11], v[184:187]
    s_add_u32 s53, s52, 126976
    buffer_load_dwordx4 v[112:115], v238, s[20:23], s53 offen offset:0 sc1
    v_mfma_f32_16x16x32_bf16 v[188:191], a[44:47], v[8:11], v[188:191]
    buffer_load_dwordx4 v[116:119], v238, s[20:23], s53 offen offset:256 sc1
    v_mfma_f32_16x16x32_bf16 v[192:195], a[48:51], v[8:11], v[192:195]
    buffer_load_dwordx4 v[120:123], v239, s[20:23], s53 offen offset:0 sc1
    v_mfma_f32_16x16x32_bf16 v[196:199], a[52:55], v[8:11], v[196:199]
    buffer_load_dwordx4 v[124:127], v239, s[20:23], s53 offen offset:256 sc1
    v_mfma_f32_16x16x32_bf16 v[200:203], a[56:59], v[8:11], v[200:203]
    v_mfma_f32_16x16x32_bf16 v[204:207], a[40:43], v[12:15], v[204:207]
    s_add_u32 s53, s52, 135168
    buffer_load_dwordx4 v[128:131], v238, s[20:23], s53 offen offset:0 sc1
    v_mfma_f32_16x16x32_bf16 v[208:211], a[44:47], v[12:15], v[208:211]
    buffer_load_dwordx4 v[132:135], v238, s[20:23], s53 offen offset:256 sc1
    v_mfma_f32_16x16x32_bf16 v[212:215], a[48:51], v[12:15], v[212:215]
    buffer_load_dwordx4 v[136:139], v239, s[20:23], s53 offen offset:0 sc1
    v_mfma_f32_16x16x32_bf16 v[216:219], a[52:55], v[12:15], v[216:219]
    buffer_load_dwordx4 v[140:143], v239, s[20:23], s53 offen offset:256 sc1
    v_mfma_f32_16x16x32_bf16 v[220:223], a[56:59], v[12:15], v[220:223]
    s_waitcnt vmcnt(52)
    v_mfma_f32_16x16x32_bf16 v[144:147], a[60:63], v[16:19], v[144:147]
    s_add_u32 s53, s52, 143360
    buffer_load_dwordx4 v[0:3], v238, s[20:23], s53 offen offset:0 sc1
    v_mfma_f32_16x16x32_bf16 v[148:151], a[64:67], v[16:19], v[148:151]
    v_mfma_f32_16x16x32_bf16 v[152:155], a[68:71], v[16:19], v[152:155]
    v_mfma_f32_16x16x32_bf16 v[156:159], a[72:75], v[16:19], v[156:159]
    v_mfma_f32_16x16x32_bf16 v[160:163], a[76:79], v[16:19], v[160:163]
    v_mfma_f32_16x16x32_bf16 v[164:167], a[60:63], v[20:23], v[164:167]
    buffer_load_dwordx4 v[4:7], v238, s[20:23], s53 offen offset:256 sc1
    v_mfma_f32_16x16x32_bf16 v[168:171], a[64:67], v[20:23], v[168:171]
    v_mfma_f32_16x16x32_bf16 v[172:175], a[68:71], v[20:23], v[172:175]
    v_mfma_f32_16x16x32_bf16 v[176:179], a[72:75], v[20:23], v[176:179]
    v_mfma_f32_16x16x32_bf16 v[180:183], a[76:79], v[20:23], v[180:183]
    v_mfma_f32_16x16x32_bf16 v[184:187], a[60:63], v[24:27], v[184:187]
    buffer_load_dwordx4 v[8:11], v239, s[20:23], s53 offen offset:0 sc1
    v_mfma_f32_16x16x32_bf16 v[188:191], a[64:67], v[24:27], v[188:191]
    v_mfma_f32_16x16x32_bf16 v[192:195], a[68:71], v[24:27], v[192:195]
    v_mfma_f32_16x16x32_bf16 v[196:199], a[72:75], v[24:27], v[196:199]
    v_mfma_f32_16x16x32_bf16 v[200:203], a[76:79], v[24:27], v[200:203]
    v_mfma_f32_16x16x32_bf16 v[204:207], a[60:63], v[28:31], v[204:207]
    buffer_load_dwordx4 v[12:15], v239, s[20:23], s53 offen offset:256 sc1
    v_mfma_f32_16x16x32_bf16 v[208:211], a[64:67], v[28:31], v[208:211]
    v_mfma_f32_16x16x32_bf16 v[212:215], a[68:71], v[28:31], v[212:215]
    v_mfma_f32_16x16x32_bf16 v[216:219], a[72:75], v[28:31], v[216:219]
    v_mfma_f32_16x16x32_bf16 v[220:223], a[76:79], v[28:31], v[220:223]
    s_waitcnt vmcnt(52)
    v_mfma_f32_16x16x32_bf16 v[144:147], a[80:83], v[32:35], v[144:147]
    v_mfma_f32_16x16x32_bf16 v[148:151], a[84:87], v[32:35], v[148:151]
    v_mfma_f32_16x16x32_bf16 v[152:155], a[88:91], v[32:35], v[152:155]
    v_mfma_f32_16x16x32_bf16 v[156:159], a[92:95], v[32:35], v[156:159]
    v_mfma_f32_16x16x32_bf16 v[160:163], a[96:99], v[32:35], v[160:163]
    v_mfma_f32_16x16x32_bf16 v[164:167], a[80:83], v[36:39], v[164:167]
    v_mfma_f32_16x16x32_bf16 v[168:171], a[84:87], v[36:39], v[168:171]
    v_mfma_f32_16x16x32_bf16 v[172:175], a[88:91], v[36:39], v[172:175]
    v_mfma_f32_16x16x32_bf16 v[176:179], a[92:95], v[36:39], v[176:179]
    v_mfma_f32_16x16x32_bf16 v[180:183], a[96:99], v[36:39], v[180:183]
    v_mfma_f32_16x16x32_bf16 v[184:187], a[80:83], v[40:43], v[184:187]
    v_mfma_f32_16x16x32_bf16 v[188:191], a[84:87], v[40:43], v[188:191]
    v_mfma_f32_16x16x32_bf16 v[192:195], a[88:91], v[40:43], v[192:195]
    v_mfma_f32_16x16x32_bf16 v[196:199], a[92:95], v[40:43], v[196:199]
    v_mfma_f32_16x16x32_bf16 v[200:203], a[96:99], v[40:43], v[200:203]
    v_mfma_f32_16x16x32_bf16 v[204:207], a[80:83], v[44:47], v[204:207]
    v_mfma_f32_16x16x32_bf16 v[208:211], a[84:87], v[44:47], v[208:211]
    v_mfma_f32_16x16x32_bf16 v[212:215], a[88:91], v[44:47], v[212:215]
    v_mfma_f32_16x16x32_bf16 v[216:219], a[92:95], v[44:47], v[216:219]
    v_mfma_f32_16x16x32_bf16 v[220:223], a[96:99], v[44:47], v[220:223]
    s_waitcnt lgkmcnt(0)
    s_waitcnt vmcnt(48)
    v_mfma_f32_16x16x32_bf16 v[144:147], a[112:115], v[48:51], v[144:147]
    v_mfma_f32_16x16x32_bf16 v[148:151], a[116:119], v[48:51], v[148:151]
    v_mfma_f32_16x16x32_bf16 v[152:155], a[120:123], v[48:51], v[152:155]
    v_mfma_f32_16x16x32_bf16 v[156:159], a[124:127], v[48:51], v[156:159]
    v_mfma_f32_16x16x32_bf16 v[160:163], a[128:131], v[48:51], v[160:163]
    v_mfma_f32_16x16x32_bf16 v[164:167], a[112:115], v[52:55], v[164:167]
    v_mfma_f32_16x16x32_bf16 v[168:171], a[116:119], v[52:55], v[168:171]
    v_mfma_f32_16x16x32_bf16 v[172:175], a[120:123], v[52:55], v[172:175]
    v_mfma_f32_16x16x32_bf16 v[176:179], a[124:127], v[52:55], v[176:179]
    v_mfma_f32_16x16x32_bf16 v[180:183], a[128:131], v[52:55], v[180:183]
    v_mfma_f32_16x16x32_bf16 v[184:187], a[112:115], v[56:59], v[184:187]
    v_mfma_f32_16x16x32_bf16 v[188:191], a[116:119], v[56:59], v[188:191]
    v_mfma_f32_16x16x32_bf16 v[192:195], a[120:123], v[56:59], v[192:195]
    v_mfma_f32_16x16x32_bf16 v[196:199], a[124:127], v[56:59], v[196:199]
    v_mfma_f32_16x16x32_bf16 v[200:203], a[128:131], v[56:59], v[200:203]
    v_mfma_f32_16x16x32_bf16 v[204:207], a[112:115], v[60:63], v[204:207]
    v_mfma_f32_16x16x32_bf16 v[208:211], a[116:119], v[60:63], v[208:211]
    v_mfma_f32_16x16x32_bf16 v[212:215], a[120:123], v[60:63], v[212:215]
    v_mfma_f32_16x16x32_bf16 v[216:219], a[124:127], v[60:63], v[216:219]
    v_mfma_f32_16x16x32_bf16 v[220:223], a[128:131], v[60:63], v[220:223]
    s_waitcnt vmcnt(39)
    v_mfma_f32_16x16x32_bf16 v[144:147], a[132:135], v[64:67], v[144:147]
    v_mfma_f32_16x16x32_bf16 v[148:151], a[136:139], v[64:67], v[148:151]
    v_mfma_f32_16x16x32_bf16 v[152:155], a[140:143], v[64:67], v[152:155]
    v_mfma_f32_16x16x32_bf16 v[156:159], a[144:147], v[64:67], v[156:159]
    v_mfma_f32_16x16x32_bf16 v[160:163], a[148:151], v[64:67], v[160:163]
    v_mfma_f32_16x16x32_bf16 v[164:167], a[132:135], v[68:71], v[164:167]
    v_mfma_f32_16x16x32_bf16 v[168:171], a[136:139], v[68:71], v[168:171]
    v_mfma_f32_16x16x32_bf16 v[172:175], a[140:143], v[68:71], v[172:175]
    v_mfma_f32_16x16x32_bf16 v[176:179], a[144:147], v[68:71], v[176:179]
    v_mfma_f32_16x16x32_bf16 v[180:183], a[148:151], v[68:71], v[180:183]
    v_mfma_f32_16x16x32_bf16 v[184:187], a[132:135], v[72:75], v[184:187]
    v_mfma_f32_16x16x32_bf16 v[188:191], a[136:139], v[72:75], v[188:191]
    v_mfma_f32_16x16x32_bf16 v[192:195], a[140:143], v[72:75], v[192:195]
    v_mfma_f32_16x16x32_bf16 v[196:199], a[144:147], v[72:75], v[196:199]
    v_mfma_f32_16x16x32_bf16 v[200:203], a[148:151], v[72:75], v[200:203]
    v_mfma_f32_16x16x32_bf16 v[204:207], a[132:135], v[76:79], v[204:207]
    v_mfma_f32_16x16x32_bf16 v[208:211], a[136:139], v[76:79], v[208:211]
    v_mfma_f32_16x16x32_bf16 v[212:215], a[140:143], v[76:79], v[212:215]
    v_mfma_f32_16x16x32_bf16 v[216:219], a[144:147], v[76:79], v[216:219]
    v_mfma_f32_16x16x32_bf16 v[220:223], a[148:151], v[76:79], v[220:223]
    s_waitcnt vmcnt(16)
    v_mfma_f32_16x16x32_bf16 v[144:147], a[152:155], v[80:83], v[144:147]
    v_mfma_f32_16x16x32_bf16 v[148:151], a[156:159], v[80:83], v[148:151]
    v_mfma_f32_16x16x32_bf16 v[152:155], a[160:163], v[80:83], v[152:155]
    v_mfma_f32_16x16x32_bf16 v[156:159], a[164:167], v[80:83], v[156:159]
    v_mfma_f32_16x16x32_bf16 v[160:163], a[168:171], v[80:83], v[160:163]
    v_mfma_f32_16x16x32_bf16 v[164:167], a[152:155], v[84:87], v[164:167]
    v_mfma_f32_16x16x32_bf16 v[168:171], a[156:159], v[84:87], v[168:171]
    v_mfma_f32_16x16x32_bf16 v[172:175], a[160:163], v[84:87], v[172:175]
    v_mfma_f32_16x16x32_bf16 v[176:179], a[164:167], v[84:87], v[176:179]
    v_mfma_f32_16x16x32_bf16 v[180:183], a[168:171], v[84:87], v[180:183]
    v_mfma_f32_16x16x32_bf16 v[184:187], a[152:155], v[88:91], v[184:187]
    v_mfma_f32_16x16x32_bf16 v[188:191], a[156:159], v[88:91], v[188:191]
    v_mfma_f32_16x16x32_bf16 v[192:195], a[160:163], v[88:91], v[192:195]
    v_mfma_f32_16x16x32_bf16 v[196:199], a[164:167], v[88:91], v[196:199]
    v_mfma_f32_16x16x32_bf16 v[200:203], a[168:171], v[88:91], v[200:203]
    v_mfma_f32_16x16x32_bf16 v[204:207], a[152:155], v[92:95], v[204:207]
    v_mfma_f32_16x16x32_bf16 v[208:211], a[156:159], v[92:95], v[208:211]
    v_mfma_f32_16x16x32_bf16 v[212:215], a[160:163], v[92:95], v[212:215]
    v_mfma_f32_16x16x32_bf16 v[216:219], a[164:167], v[92:95], v[216:219]
    v_mfma_f32_16x16x32_bf16 v[220:223], a[168:171], v[92:95], v[220:223]
    s_waitcnt vmcnt(12)
    v_mfma_f32_16x16x32_bf16 v[144:147], a[172:175], v[96:99], v[144:147]
    v_mfma_f32_16x16x32_bf16 v[148:151], a[176:179], v[96:99], v[148:151]
    v_mfma_f32_16x16x32_bf16 v[152:155], a[180:183], v[96:99], v[152:155]
    v_mfma_f32_16x16x32_bf16 v[156:159], a[184:187], v[96:99], v[156:159]
    v_mfma_f32_16x16x32_bf16 v[160:163], a[188:191], v[96:99], v[160:163]
    v_mfma_f32_16x16x32_bf16 v[164:167], a[172:175], v[100:103], v[164:167]
    v_mfma_f32_16x16x32_bf16 v[168:171], a[176:179], v[100:103], v[168:171]
    v_mfma_f32_16x16x32_bf16 v[172:175], a[180:183], v[100:103], v[172:175]
    v_mfma_f32_16x16x32_bf16 v[176:179], a[184:187], v[100:103], v[176:179]
    v_mfma_f32_16x16x32_bf16 v[180:183], a[188:191], v[100:103], v[180:183]
    v_mfma_f32_16x16x32_bf16 v[184:187], a[172:175], v[104:107], v[184:187]
    v_mfma_f32_16x16x32_bf16 v[188:191], a[176:179], v[104:107], v[188:191]
    v_mfma_f32_16x16x32_bf16 v[192:195], a[180:183], v[104:107], v[192:195]
    v_mfma_f32_16x16x32_bf16 v[196:199], a[184:187], v[104:107], v[196:199]
    v_mfma_f32_16x16x32_bf16 v[200:203], a[188:191], v[104:107], v[200:203]
    v_mfma_f32_16x16x32_bf16 v[204:207], a[172:175], v[108:111], v[204:207]
    v_mfma_f32_16x16x32_bf16 v[208:211], a[176:179], v[108:111], v[208:211]
    v_mfma_f32_16x16x32_bf16 v[212:215], a[180:183], v[108:111], v[212:215]
    v_mfma_f32_16x16x32_bf16 v[216:219], a[184:187], v[108:111], v[216:219]
    v_mfma_f32_16x16x32_bf16 v[220:223], a[188:191], v[108:111], v[220:223]
    s_waitcnt vmcnt(8)
    v_mfma_f32_16x16x32_bf16 v[144:147], a[192:195], v[112:115], v[144:147]
    v_mfma_f32_16x16x32_bf16 v[148:151], a[196:199], v[112:115], v[148:151]
    v_mfma_f32_16x16x32_bf16 v[152:155], a[200:203], v[112:115], v[152:155]
    v_mfma_f32_16x16x32_bf16 v[156:159], a[204:207], v[112:115], v[156:159]
    v_mfma_f32_16x16x32_bf16 v[160:163], a[208:211], v[112:115], v[160:163]
    v_mfma_f32_16x16x32_bf16 v[164:167], a[192:195], v[116:119], v[164:167]
    v_mfma_f32_16x16x32_bf16 v[168:171], a[196:199], v[116:119], v[168:171]
    v_mfma_f32_16x16x32_bf16 v[172:175], a[200:203], v[116:119], v[172:175]
    v_mfma_f32_16x16x32_bf16 v[176:179], a[204:207], v[116:119], v[176:179]
    v_mfma_f32_16x16x32_bf16 v[180:183], a[208:211], v[116:119], v[180:183]
    v_mfma_f32_16x16x32_bf16 v[184:187], a[192:195], v[120:123], v[184:187]
    v_mfma_f32_16x16x32_bf16 v[188:191], a[196:199], v[120:123], v[188:191]
    v_mfma_f32_16x16x32_bf16 v[192:195], a[200:203], v[120:123], v[192:195]
    v_mfma_f32_16x16x32_bf16 v[196:199], a[204:207], v[120:123], v[196:199]
    v_mfma_f32_16x16x32_bf16 v[200:203], a[208:211], v[120:123], v[200:203]
    v_mfma_f32_16x16x32_bf16 v[204:207], a[192:195], v[124:127], v[204:207]
    v_mfma_f32_16x16x32_bf16 v[208:211], a[196:199], v[124:127], v[208:211]
    v_mfma_f32_16x16x32_bf16 v[212:215], a[200:203], v[124:127], v[212:215]
    v_mfma_f32_16x16x32_bf16 v[216:219], a[204:207], v[124:127], v[216:219]
    v_mfma_f32_16x16x32_bf16 v[220:223], a[208:211], v[124:127], v[220:223]
    s_waitcnt vmcnt(4)
    v_mfma_f32_16x16x32_bf16 v[144:147], a[212:215], v[128:131], v[144:147]
    v_mfma_f32_16x16x32_bf16 v[148:151], a[216:219], v[128:131], v[148:151]
    v_mfma_f32_16x16x32_bf16 v[152:155], a[220:223], v[128:131], v[152:155]
    v_mfma_f32_16x16x32_bf16 v[156:159], a[224:227], v[128:131], v[156:159]
    v_mfma_f32_16x16x32_bf16 v[160:163], a[228:231], v[128:131], v[160:163]
    v_mfma_f32_16x16x32_bf16 v[164:167], a[212:215], v[132:135], v[164:167]
    v_mfma_f32_16x16x32_bf16 v[168:171], a[216:219], v[132:135], v[168:171]
    v_mfma_f32_16x16x32_bf16 v[172:175], a[220:223], v[132:135], v[172:175]
    v_mfma_f32_16x16x32_bf16 v[176:179], a[224:227], v[132:135], v[176:179]
    v_mfma_f32_16x16x32_bf16 v[180:183], a[228:231], v[132:135], v[180:183]
    v_mfma_f32_16x16x32_bf16 v[184:187], a[212:215], v[136:139], v[184:187]
    v_mfma_f32_16x16x32_bf16 v[188:191], a[216:219], v[136:139], v[188:191]
    v_mfma_f32_16x16x32_bf16 v[192:195], a[220:223], v[136:139], v[192:195]
    v_mfma_f32_16x16x32_bf16 v[196:199], a[224:227], v[136:139], v[196:199]
    v_mfma_f32_16x16x32_bf16 v[200:203], a[228:231], v[136:139], v[200:203]
    v_mfma_f32_16x16x32_bf16 v[204:207], a[212:215], v[140:143], v[204:207]
    v_mfma_f32_16x16x32_bf16 v[208:211], a[216:219], v[140:143], v[208:211]
    v_mfma_f32_16x16x32_bf16 v[212:215], a[220:223], v[140:143], v[212:215]
    v_mfma_f32_16x16x32_bf16 v[216:219], a[224:227], v[140:143], v[216:219]
    v_mfma_f32_16x16x32_bf16 v[220:223], a[228:231], v[140:143], v[220:223]
    s_waitcnt vmcnt(0)
    v_mfma_f32_16x16x32_bf16 v[144:147], a[232:235], v[0:3], v[144:147]
    v_mfma_f32_16x16x32_bf16 v[148:151], a[236:239], v[0:3], v[148:151]
    v_mfma_f32_16x16x32_bf16 v[152:155], a[240:243], v[0:3], v[152:155]
    v_mfma_f32_16x16x32_bf16 v[156:159], a[244:247], v[0:3], v[156:159]
    v_mfma_f32_16x16x32_bf16 v[160:163], a[248:251], v[0:3], v[160:163]
    v_mfma_f32_16x16x32_bf16 v[164:167], a[232:235], v[4:7], v[164:167]
    v_mfma_f32_16x16x32_bf16 v[168:171], a[236:239], v[4:7], v[168:171]
    v_mfma_f32_16x16x32_bf16 v[172:175], a[240:243], v[4:7], v[172:175]
    v_mfma_f32_16x16x32_bf16 v[176:179], a[244:247], v[4:7], v[176:179]
    v_mfma_f32_16x16x32_bf16 v[180:183], a[248:251], v[4:7], v[180:183]
    v_mfma_f32_16x16x32_bf16 v[184:187], a[232:235], v[8:11], v[184:187]
    v_mfma_f32_16x16x32_bf16 v[188:191], a[236:239], v[8:11], v[188:191]
    v_mfma_f32_16x16x32_bf16 v[192:195], a[240:243], v[8:11], v[192:195]
    v_mfma_f32_16x16x32_bf16 v[196:199], a[244:247], v[8:11], v[196:199]
    v_mfma_f32_16x16x32_bf16 v[200:203], a[248:251], v[8:11], v[200:203]
    v_mfma_f32_16x16x32_bf16 v[204:207], a[232:235], v[12:15], v[204:207]
    v_mfma_f32_16x16x32_bf16 v[208:211], a[236:239], v[12:15], v[208:211]
    v_mfma_f32_16x16x32_bf16 v[212:215], a[240:243], v[12:15], v[212:215]
    v_mfma_f32_16x16x32_bf16 v[216:219], a[244:247], v[12:15], v[216:219]
    v_mfma_f32_16x16x32_bf16 v[220:223], a[248:251], v[12:15], v[220:223]
    s_mul_i32 s66, s25, 23040
    v_lshrrev_b32 v233, 9, v242
    v_lshl_add_u32 v233, v233, 6, v242
    v_add_u32 v233, s66, v233
    s_mul_i32 s66, s25, 5760
    v_lshrrev_b32 v234, 1, v231
    v_mul_u32_u24 v234, 1152, v234
    v_and_b32 v235, 1, v231
    v_mul_u32_u24 v235, 576, v235
    v_add_u32 v234, v234, v235
    v_lshl_add_u32 v234, v230, 4, v234
    v_add_u32 v234, s66, v234
    v_add_u32 v235, 46080, v234
    ds_write_b128 v233, v[144:147] offset:0
    ds_write_b128 v233, v[148:151] offset:1152
    ds_write_b128 v233, v[152:155] offset:2304
    ds_write_b128 v233, v[156:159] offset:3456
    ds_write_b128 v233, v[160:163] offset:4608
    ds_write_b128 v233, v[164:167] offset:5760
    ds_write_b128 v233, v[168:171] offset:6912
    ds_write_b128 v233, v[172:175] offset:8064
    ds_write_b128 v233, v[176:179] offset:9216
    ds_write_b128 v233, v[180:183] offset:10368
    ds_write_b128 v233, v[184:187] offset:11520
    ds_write_b128 v233, v[188:191] offset:12672
    ds_write_b128 v233, v[192:195] offset:13824
    ds_write_b128 v233, v[196:199] offset:14976
    ds_write_b128 v233, v[200:203] offset:16128
    ds_write_b128 v233, v[204:207] offset:17280
    ds_write_b128 v233, v[208:211] offset:18432
    ds_write_b128 v233, v[212:215] offset:19584
    ds_write_b128 v233, v[216:219] offset:20736
    ds_write_b128 v233, v[220:223] offset:21888
    s_waitcnt lgkmcnt(0)
    s_barrier
    ds_read_b128 v[0:3], v234 offset:0
    ds_read_b128 v[4:7], v234 offset:256
    ds_read_b128 v[8:11], v234 offset:23040
    ds_read_b128 v[12:15], v234 offset:23296
    ds_read_b128 v[16:19], v235 offset:0
    ds_read_b128 v[20:23], v235 offset:256
    ds_read_b128 v[24:27], v235 offset:23040
    ds_read_b128 v[28:31], v235 offset:23296
    ds_read_b128 v[32:35], v234 offset:2304
    ds_read_b128 v[36:39], v234 offset:2560
    ds_read_b128 v[40:43], v234 offset:25344
    ds_read_b128 v[44:47], v234 offset:25600
    ds_read_b128 v[48:51], v235 offset:2304
    ds_read_b128 v[52:55], v235 offset:2560
    ds_read_b128 v[56:59], v235 offset:25344
    ds_read_b128 v[60:63], v235 offset:25600
    ds_read_b128 v[64:67], v234 offset:4608
    ds_read_b128 v[68:71], v234 offset:4864
    ds_read_b128 v[72:75], v234 offset:27648
    ds_read_b128 v[76:79], v234 offset:27904
    ds_read_b128 v[80:83], v235 offset:4608
    ds_read_b128 v[84:87], v235 offset:4864
    ds_read_b128 v[88:91], v235 offset:27648
    ds_read_b128 v[92:95], v235 offset:27904
    v_lshlrev_b32 v96, 16, v244
    v_and_b32 v97, 0xffff0000, v244
    v_lshlrev_b32 v98, 16, v245
    v_and_b32 v99, 0xffff0000, v245
    v_lshlrev_b32 v100, 16, v246
    v_and_b32 v101, 0xffff0000, v246
    v_lshlrev_b32 v102, 16, v247
    v_and_b32 v103, 0xffff0000, v247
    s_waitcnt lgkmcnt(15)
    v_pk_add_f32 v[0:1], v[0:1], v[8:9]
    v_pk_add_f32 v[16:17], v[16:17], v[24:25]
    v_pk_add_f32 v[2:3], v[2:3], v[10:11]
    v_pk_add_f32 v[18:19], v[18:19], v[26:27]
    v_pk_add_f32 v[4:5], v[4:5], v[12:13]
    v_pk_add_f32 v[20:21], v[20:21], v[28:29]
    v_pk_add_f32 v[6:7], v[6:7], v[14:15]
    v_pk_add_f32 v[22:23], v[22:23], v[30:31]
    v_pk_add_f32 v[0:1], v[0:1], v[96:97]
    v_pk_add_f32 v[2:3], v[2:3], v[98:99]
    v_pk_add_f32 v[4:5], v[4:5], v[100:101]
    v_pk_add_f32 v[6:7], v[6:7], v[102:103]
    v_pk_add_f32 v[0:1], v[0:1], v[16:17]
    v_pk_add_f32 v[2:3], v[2:3], v[18:19]
    v_pk_add_f32 v[4:5], v[4:5], v[20:21]
    v_pk_add_f32 v[6:7], v[6:7], v[22:23]
    v_cvt_pk_bf16_f32 v16, v0, v1
    v_cvt_pk_bf16_f32 v17, v2, v3
    v_cvt_pk_bf16_f32 v18, v4, v5
    v_cvt_pk_bf16_f32 v19, v6, v7
    buffer_store_dwordx4 v[16:19], v232, s[8:11], s64 offen offset:0
    v_lshlrev_b32 v96, 16, v248
    v_and_b32 v97, 0xffff0000, v248
    v_lshlrev_b32 v98, 16, v249
    v_and_b32 v99, 0xffff0000, v249
    v_lshlrev_b32 v100, 16, v250
    v_and_b32 v101, 0xffff0000, v250
    v_lshlrev_b32 v102, 16, v251
    v_and_b32 v103, 0xffff0000, v251
    s_waitcnt lgkmcnt(8)
    v_pk_add_f32 v[32:33], v[32:33], v[40:41]
    v_pk_add_f32 v[48:49], v[48:49], v[56:57]
    v_pk_add_f32 v[34:35], v[34:35], v[42:43]
    v_pk_add_f32 v[50:51], v[50:51], v[58:59]
    v_pk_add_f32 v[36:37], v[36:37], v[44:45]
    v_pk_add_f32 v[52:53], v[52:53], v[60:61]
    v_pk_add_f32 v[38:39], v[38:39], v[46:47]
    v_pk_add_f32 v[54:55], v[54:55], v[62:63]
    v_pk_add_f32 v[32:33], v[32:33], v[96:97]
    v_pk_add_f32 v[34:35], v[34:35], v[98:99]
    v_pk_add_f32 v[36:37], v[36:37], v[100:101]
    v_pk_add_f32 v[38:39], v[38:39], v[102:103]
    v_pk_add_f32 v[32:33], v[32:33], v[48:49]
    v_pk_add_f32 v[34:35], v[34:35], v[50:51]
    v_pk_add_f32 v[36:37], v[36:37], v[52:53]
    v_pk_add_f32 v[38:39], v[38:39], v[54:55]
    v_cvt_pk_bf16_f32 v48, v32, v33
    v_cvt_pk_bf16_f32 v49, v34, v35
    v_cvt_pk_bf16_f32 v50, v36, v37
    v_cvt_pk_bf16_f32 v51, v38, v39
    buffer_store_dwordx4 v[48:51], v232, s[8:11], s64 offen offset:64
    v_lshlrev_b32 v96, 16, v252
    v_and_b32 v97, 0xffff0000, v252
    v_lshlrev_b32 v98, 16, v253
    v_and_b32 v99, 0xffff0000, v253
    v_lshlrev_b32 v100, 16, v254
    v_and_b32 v101, 0xffff0000, v254
    v_lshlrev_b32 v102, 16, v255
    v_and_b32 v103, 0xffff0000, v255
    s_waitcnt lgkmcnt(0)
    v_pk_add_f32 v[64:65], v[64:65], v[72:73]
    v_pk_add_f32 v[80:81], v[80:81], v[88:89]
    v_pk_add_f32 v[66:67], v[66:67], v[74:75]
    v_pk_add_f32 v[82:83], v[82:83], v[90:91]
    v_pk_add_f32 v[68:69], v[68:69], v[76:77]
    v_pk_add_f32 v[84:85], v[84:85], v[92:93]
    v_pk_add_f32 v[70:71], v[70:71], v[78:79]
    v_pk_add_f32 v[86:87], v[86:87], v[94:95]
    v_pk_add_f32 v[64:65], v[64:65], v[96:97]
    v_pk_add_f32 v[66:67], v[66:67], v[98:99]
    v_pk_add_f32 v[68:69], v[68:69], v[100:101]
    v_pk_add_f32 v[70:71], v[70:71], v[102:103]
    v_pk_add_f32 v[64:65], v[64:65], v[80:81]
    v_pk_add_f32 v[66:67], v[66:67], v[82:83]
    v_pk_add_f32 v[68:69], v[68:69], v[84:85]
    v_pk_add_f32 v[70:71], v[70:71], v[86:87]
    v_cvt_pk_bf16_f32 v80, v64, v65
    v_cvt_pk_bf16_f32 v81, v66, v67
    v_cvt_pk_bf16_f32 v82, v68, v69
    v_cvt_pk_bf16_f32 v83, v70, v71
    s_mov_b64 exec, s[12:13]
    buffer_store_dwordx4 v[80:83], v232, s[8:11], s64 offen offset:128
    s_mov_b64 exec, -1
K1_END:
    s_endpgm
.section .rodata,"a"
.p2align 6
.amdhsa_kernel parallel_sum__sliding_block__geglu_ffn__prompt_kernel
  .amdhsa_next_free_vgpr 512
  .amdhsa_next_free_sgpr 102
  .amdhsa_accum_offset 256
  .amdhsa_group_segment_fixed_size 0
  .amdhsa_kernarg_size 80
  .amdhsa_user_sgpr_count 2
  .amdhsa_user_sgpr_kernarg_segment_ptr 1
  .amdhsa_system_sgpr_workgroup_id_x 1
.end_amdhsa_kernel
```
